```python
import torch

def _softmax(x, axis=-1):
    return torch.softmax(x, dim=axis)

def _gelu(x):
    return torch.nn.functional.gelu(x, approximate='tanh')

def _silu(x):
    return torch.nn.functional.silu(x)

def _sigmoid(x):
    return torch.sigmoid(x)

def _layernorm(x, axis=-1, eps=1e-05):
    m = x.mean(dim=axis, keepdim=True)
    v = x.var(dim=axis, keepdim=True, unbiased=False)
    return (x - m) / torch.sqrt(v + eps)

def _scatter_add(tgt, idx, src, axis=0):
    return tgt.clone().index_add_(axis, idx, src)

def _segment_sum(src, seg, n):
    out = torch.zeros((n,) + src.shape[1:], dtype=src.dtype)
    return out.index_add_(0, seg, src)

def _pad(x, pw):
    flat = tuple((v for pair in reversed(pw) for v in pair))
    return torch.nn.functional.pad(x, flat)
kernel_name = 'adaLN_cond__memory_aug_recurrent_mem_tr__mixer_token_mlp__prompt'

def setup_inputs():

    _w = lambda a: (lambda t: t.to(torch.bfloat16) if t.is_floating_point() else t)(torch.as_tensor(a))

    def _A_setup():
        B, S, Dm = (1, 2048, 1024)
        H, Dh = (32, 128)
        M, seg = (8, 32)
        seg = min(seg, S)
        S = S // seg * seg
        return {'x': _w((lambda *s: torch.randn(*s, dtype=torch.bfloat16) * 0.05)(B, S, Dm)), 'mem0': _w((lambda *s: torch.randn(*s, dtype=torch.bfloat16) * 0.8)(B, M, Dm)), 'Wq': _w((lambda *s: torch.randn(*s, dtype=torch.bfloat16) * 1.6)(Dm, H, Dh) * Dm ** (-0.5)), 'Wk': _w((lambda *s: torch.randn(*s, dtype=torch.bfloat16) * 1.6)(Dm, H, Dh) * Dm ** (-0.5)), 'Wv': _w((lambda *s: torch.randn(*s, dtype=torch.bfloat16) * 0.8)(Dm, H, Dh) * Dm ** (-0.5)), 'Wo': _w((lambda *s: torch.randn(*s, dtype=torch.bfloat16) * 0.8)(H, Dh, Dm) * (H * Dh) ** (-0.5)), 'seg_len': seg}
    _A_in = _A_setup()

    def _B_setup():
        B, S, D, F = (1, 2048, 1024, 3584)
        return {'x': _w((lambda *s: torch.randn(*s, dtype=torch.bfloat16) * 0.05)(B, S, D)), 'w1': _w((lambda *s: torch.randn(*s, dtype=torch.bfloat16) * 1.6)(S, F) * S ** (-0.5)), 'b1': _w((lambda *s: torch.randn(*s, dtype=torch.bfloat16) * 1.6)(F) * 0.02), 'w2': _w((lambda *s: torch.randn(*s, dtype=torch.bfloat16) * 0.2)(F, S) * F ** (-0.5)), 'b2': _w((lambda *s: torch.randn(*s, dtype=torch.bfloat16) * 0.2)(S) * 0.02)}
    _B_in = _B_setup()
    return {'A_x': _A_in['x'], 'A_mem0': _A_in['mem0'], 'A_Wq': _A_in['Wq'], 'A_Wk': _A_in['Wk'], 'A_Wv': _A_in['Wv'], 'A_Wo': _A_in['Wo'], 'A_seg_len': _A_in['seg_len'], 'B_x': _B_in['x'], 'B_w1': _B_in['w1'], 'B_b1': _B_in['b1'], 'B_w2': _B_in['w2'], 'B_b2': _B_in['b2'], 'c': _w((lambda *s: torch.randn(*s, dtype=torch.bfloat16) * 0.05)(1, 1024) * 8.0), 'w_mod': _w((lambda *s: torch.randn(*s, dtype=torch.bfloat16) * 0.05)(1024, 6 * 1024) * 1024 ** (-0.5) * 8.0)}

def reference(A_x, A_mem0, A_Wq, A_Wk, A_Wv, A_Wo, A_seg_len, B_x, B_w1, B_b1, B_w2, B_b2, c, w_mod):

    def _A_ref(x, mem0, Wq, Wk, Wv, Wo, seg_len):
        B, S, Dm = x.shape
        H, Dh = (Wq.shape[1], Wq.shape[2])
        M = mem0.shape[1]
        scale = Dh ** (-0.5)
        n_seg = S // seg_len
        L = M + seg_len
        idx = torch.arange(L)
        mask = (idx[:, None] < M) | (idx[:, None] >= idx[None, :])
        mem = mem0
        outs = []
        for s in range(n_seg):
            xs = x[:, s * seg_len:(s + 1) * seg_len, :].clone()
            h = torch.concatenate([mem, xs], axis=1)
            q = torch.einsum('btd,dhe->bhte', h, Wq)
            k = torch.einsum('btd,dhe->bhte', h, Wk)
            v = torch.einsum('btd,dhe->bhte', h, Wv)
            scores = torch.einsum('bhqe,bhke->bhqk', q, k) * scale
            scores = torch.where(mask[None, None], scores, -1000000000.0)
            p = _softmax(scores, axis=-1)
            o = torch.einsum('bhqk,bhke->bhqe', p, v)
            o = torch.einsum('bhte,hed->btd', o, Wo)
            mem = o[:, :M, :].clone()
            outs.append(o[:, M:, :])
        return torch.concatenate(outs, axis=1)

    def _B_ref(x, w1, b1, w2, b2):
        B, S, D = x.shape
        h = _layernorm(x, axis=-1)
        u = torch.einsum('bsd,sf->bdf', h, w1) + b1
        u = _gelu(u)
        y = torch.einsum('bdf,fs->bds', u, w2) + b2
        return (lambda x, *d: x.permute(*d))(y, 0, 2, 1)
    x = A_x
    mod = (_silu(c) @ w_mod).reshape(c.shape[0], 6, 1, -1)
    sa, ca, ga, sb, cb, gb = (mod[:, 0].clone(), mod[:, 1].clone(), mod[:, 2].clone(), mod[:, 3].clone(), mod[:, 4].clone(), mod[:, 5].clone())
    h = _layernorm(x, axis=-1) * (1 + ca) + sa
    x = x + ga * _A_ref(h, A_mem0, A_Wq, A_Wk, A_Wv, A_Wo, A_seg_len)
    h = _layernorm(x, axis=-1) * (1 + cb) + sb
    x = x + gb * _B_ref(h, B_w1, B_b1, B_w2, B_b2)
    return x
```

```asm
; @launch kernel=pre_kernel grid=(256,1,1) block=(256,1,1) lds=16384
; @launch kernel=mega_kernel grid=(256,1,1) block=(256,1,1) lds=131328
.amdgcn_target "amdgcn-amd-amdhsa--gfx950"
.text
.globl pre_kernel
.p2align 8
.type pre_kernel,@function
pre_kernel:

    s_cmp_ge_u32 s2, 256
    s_cbranch_scc1 pre_kernel_exit
    s_cmp_ge_u32 s2, 256
    s_cbranch_scc1 pre_kernel_pf
    s_load_dwordx2 s[4:5], s[0:1], 96
    s_load_dwordx2 s[6:7], s[0:1], 104
    s_load_dwordx2 s[20:21], s[0:1], 128
    s_load_dwordx2 s[30:31], s[0:1], 0
    s_load_dwordx2 s[32:33], s[0:1], 120
    s_waitcnt lgkmcnt(0)

    s_mov_b32 s16, s20
    s_mov_b32 s17, s21
    s_mov_b32 s18, 268435456
    s_mov_b32 s19, 0x20000
    s_mov_b32 s36, s32
    s_mov_b32 s37, s33
    s_mov_b32 s38, 256
    s_mov_b32 s39, 0x20000
    s_cmp_ge_u32 s2, 224
    s_cbranch_scc1 pre_kernel_fill
    s_cmp_ge_u32 s2, 96
    s_cbranch_scc1 pre_kernel_ln

    s_mov_b32 s8, s4
    s_mov_b32 s9, s5
    s_mov_b32 s10, 2048
    s_mov_b32 s11, 0x20000
    s_mov_b32 s12, s6
    s_mov_b32 s13, s7
    s_mov_b32 s14, 12582912
    s_mov_b32 s15, 0x20000
    v_and_b32 v2, 7, v0
    v_lshrrev_b32 v3, 3, v0
    v_mul_u32_u24 v4, 12288, v3
    v_lshl_add_u32 v4, v2, 4, v4
    s_lshl_b32 s22, s2, 7
    v_add_u32 v4, s22, v4
    v_lshlrev_b32 v1, 3, v0
    buffer_load_dwordx2 v[10:11], v1, s[8:11], 0 offen

    s_mov_b32 s23, 0
    buffer_load_dwordx4 v[64:67], v4, s[12:15], s23 offen
    s_mov_b32 s23, 393216
    buffer_load_dwordx4 v[68:71], v4, s[12:15], s23 offen
    s_mov_b32 s23, 786432
    buffer_load_dwordx4 v[72:75], v4, s[12:15], s23 offen
    s_mov_b32 s23, 1179648
    buffer_load_dwordx4 v[76:79], v4, s[12:15], s23 offen
    s_mov_b32 s23, 1572864
    buffer_load_dwordx4 v[80:83], v4, s[12:15], s23 offen
    s_mov_b32 s23, 1966080
    buffer_load_dwordx4 v[84:87], v4, s[12:15], s23 offen
    s_mov_b32 s23, 2359296
    buffer_load_dwordx4 v[88:91], v4, s[12:15], s23 offen
    s_mov_b32 s23, 2752512
    buffer_load_dwordx4 v[92:95], v4, s[12:15], s23 offen
    s_mov_b32 s23, 3145728
    buffer_load_dwordx4 v[96:99], v4, s[12:15], s23 offen
    s_mov_b32 s23, 3538944
    buffer_load_dwordx4 v[100:103], v4, s[12:15], s23 offen
    s_mov_b32 s23, 3932160
    buffer_load_dwordx4 v[104:107], v4, s[12:15], s23 offen
    s_mov_b32 s23, 4325376
    buffer_load_dwordx4 v[108:111], v4, s[12:15], s23 offen
    s_mov_b32 s23, 4718592
    buffer_load_dwordx4 v[112:115], v4, s[12:15], s23 offen
    s_mov_b32 s23, 5111808
    buffer_load_dwordx4 v[116:119], v4, s[12:15], s23 offen
    s_mov_b32 s23, 5505024
    buffer_load_dwordx4 v[120:123], v4, s[12:15], s23 offen
    s_mov_b32 s23, 5898240
    buffer_load_dwordx4 v[124:127], v4, s[12:15], s23 offen
    s_mov_b32 s23, 6291456
    buffer_load_dwordx4 v[128:131], v4, s[12:15], s23 offen
    s_mov_b32 s23, 6684672
    buffer_load_dwordx4 v[132:135], v4, s[12:15], s23 offen
    s_mov_b32 s23, 7077888
    buffer_load_dwordx4 v[136:139], v4, s[12:15], s23 offen
    s_mov_b32 s23, 7471104
    buffer_load_dwordx4 v[140:143], v4, s[12:15], s23 offen
    s_mov_b32 s23, 7864320
    buffer_load_dwordx4 v[144:147], v4, s[12:15], s23 offen
    s_mov_b32 s23, 8257536
    buffer_load_dwordx4 v[148:151], v4, s[12:15], s23 offen
    s_mov_b32 s23, 8650752
    buffer_load_dwordx4 v[152:155], v4, s[12:15], s23 offen
    s_mov_b32 s23, 9043968
    buffer_load_dwordx4 v[156:159], v4, s[12:15], s23 offen
    s_mov_b32 s23, 9437184
    buffer_load_dwordx4 v[160:163], v4, s[12:15], s23 offen
    s_mov_b32 s23, 9830400
    buffer_load_dwordx4 v[164:167], v4, s[12:15], s23 offen
    s_mov_b32 s23, 10223616
    buffer_load_dwordx4 v[168:171], v4, s[12:15], s23 offen
    s_mov_b32 s23, 10616832
    buffer_load_dwordx4 v[172:175], v4, s[12:15], s23 offen
    s_mov_b32 s23, 11010048
    buffer_load_dwordx4 v[176:179], v4, s[12:15], s23 offen
    s_mov_b32 s23, 11403264
    buffer_load_dwordx4 v[180:183], v4, s[12:15], s23 offen
    s_mov_b32 s23, 11796480
    buffer_load_dwordx4 v[184:187], v4, s[12:15], s23 offen
    s_mov_b32 s23, 12189696
    buffer_load_dwordx4 v[188:191], v4, s[12:15], s23 offen
    s_waitcnt vmcnt(32)
    v_lshlrev_b32 v12, 16, v10
    v_and_b32 v13, 0xffff0000, v10
    v_lshlrev_b32 v14, 16, v11
    v_and_b32 v15, 0xffff0000, v11
    s_mov_b32 s22, 0xbfb8aa3b

    v_mul_f32 v16, s22, v12
    v_mul_f32 v17, s22, v13
    v_mul_f32 v18, s22, v14
    v_mul_f32 v19, s22, v15
    v_exp_f32 v16, v16
    v_exp_f32 v17, v17
    v_exp_f32 v18, v18
    v_exp_f32 v19, v19
    s_nop 0
    v_add_f32 v16, 1.0, v16
    v_add_f32 v17, 1.0, v17
    v_add_f32 v18, 1.0, v18
    v_add_f32 v19, 1.0, v19
    v_rcp_f32 v16, v16
    v_rcp_f32 v17, v17
    v_rcp_f32 v18, v18
    v_rcp_f32 v19, v19
    s_nop 0
    v_mul_f32 v16, v16, v12
    v_mul_f32 v17, v17, v13
    v_mul_f32 v18, v18, v14
    v_mul_f32 v19, v19, v15
    v_cvt_pk_bf16_f32 v20, v16, v17
    v_cvt_pk_bf16_f32 v21, v18, v19
    v_lshlrev_b32 v16, 16, v20
    v_and_b32 v17, 0xffff0000, v20
    v_lshlrev_b32 v18, 16, v21
    v_and_b32 v19, 0xffff0000, v21
    v_lshlrev_b32 v1, 4, v0
    ds_write_b128 v1, v[16:19]
    s_waitcnt lgkmcnt(0)
    s_barrier
    v_lshlrev_b32 v5, 2, v3

    ds_read_b32 v24, v5 offset:0
    ds_read_b32 v25, v5 offset:128
    ds_read_b32 v26, v5 offset:256
    ds_read_b32 v27, v5 offset:384
    ds_read_b32 v28, v5 offset:512
    ds_read_b32 v29, v5 offset:640
    ds_read_b32 v30, v5 offset:768
    ds_read_b32 v31, v5 offset:896
    s_waitcnt lgkmcnt(0)
    ds_read_b32 v32, v5 offset:1024
    ds_read_b32 v33, v5 offset:1152
    ds_read_b32 v34, v5 offset:1280
    ds_read_b32 v35, v5 offset:1408
    ds_read_b32 v36, v5 offset:1536
    ds_read_b32 v37, v5 offset:1664
    ds_read_b32 v38, v5 offset:1792
    ds_read_b32 v39, v5 offset:1920
    s_waitcnt lgkmcnt(0)
    ds_read_b32 v40, v5 offset:2048
    ds_read_b32 v41, v5 offset:2176
    ds_read_b32 v42, v5 offset:2304
    ds_read_b32 v43, v5 offset:2432
    ds_read_b32 v44, v5 offset:2560
    ds_read_b32 v45, v5 offset:2688
    ds_read_b32 v46, v5 offset:2816
    ds_read_b32 v47, v5 offset:2944
    s_waitcnt lgkmcnt(0)
    ds_read_b32 v48, v5 offset:3072
    ds_read_b32 v49, v5 offset:3200
    ds_read_b32 v50, v5 offset:3328
    ds_read_b32 v51, v5 offset:3456
    ds_read_b32 v52, v5 offset:3584
    ds_read_b32 v53, v5 offset:3712
    ds_read_b32 v54, v5 offset:3840
    ds_read_b32 v55, v5 offset:3968
    s_waitcnt lgkmcnt(0)
    v_mov_b32 v56, 0
    v_mov_b32 v57, 0
    v_mov_b32 v58, 0
    v_mov_b32 v59, 0
    v_mov_b32 v60, 0
    v_mov_b32 v61, 0
    v_mov_b32 v62, 0
    v_mov_b32 v63, 0
    s_waitcnt vmcnt(24)
    v_lshlrev_b32 v22, 16, v64
    v_and_b32 v23, 0xffff0000, v64
    v_fmac_f32 v56, v22, v24
    v_fmac_f32 v57, v23, v24
    v_lshlrev_b32 v22, 16, v65
    v_and_b32 v23, 0xffff0000, v65
    v_fmac_f32 v58, v22, v24
    v_fmac_f32 v59, v23, v24
    v_lshlrev_b32 v22, 16, v66
    v_and_b32 v23, 0xffff0000, v66
    v_fmac_f32 v60, v22, v24
    v_fmac_f32 v61, v23, v24
    v_lshlrev_b32 v22, 16, v67
    v_and_b32 v23, 0xffff0000, v67
    v_fmac_f32 v62, v22, v24
    v_fmac_f32 v63, v23, v24
    v_lshlrev_b32 v22, 16, v68
    v_and_b32 v23, 0xffff0000, v68
    v_fmac_f32 v56, v22, v25
    v_fmac_f32 v57, v23, v25
    v_lshlrev_b32 v22, 16, v69
    v_and_b32 v23, 0xffff0000, v69
    v_fmac_f32 v58, v22, v25
    v_fmac_f32 v59, v23, v25
    v_lshlrev_b32 v22, 16, v70
    v_and_b32 v23, 0xffff0000, v70
    v_fmac_f32 v60, v22, v25
    v_fmac_f32 v61, v23, v25
    v_lshlrev_b32 v22, 16, v71
    v_and_b32 v23, 0xffff0000, v71
    v_fmac_f32 v62, v22, v25
    v_fmac_f32 v63, v23, v25
    v_lshlrev_b32 v22, 16, v72
    v_and_b32 v23, 0xffff0000, v72
    v_fmac_f32 v56, v22, v26
    v_fmac_f32 v57, v23, v26
    v_lshlrev_b32 v22, 16, v73
    v_and_b32 v23, 0xffff0000, v73
    v_fmac_f32 v58, v22, v26
    v_fmac_f32 v59, v23, v26
    v_lshlrev_b32 v22, 16, v74
    v_and_b32 v23, 0xffff0000, v74
    v_fmac_f32 v60, v22, v26
    v_fmac_f32 v61, v23, v26
    v_lshlrev_b32 v22, 16, v75
    v_and_b32 v23, 0xffff0000, v75
    v_fmac_f32 v62, v22, v26
    v_fmac_f32 v63, v23, v26
    v_lshlrev_b32 v22, 16, v76
    v_and_b32 v23, 0xffff0000, v76
    v_fmac_f32 v56, v22, v27
    v_fmac_f32 v57, v23, v27
    v_lshlrev_b32 v22, 16, v77
    v_and_b32 v23, 0xffff0000, v77
    v_fmac_f32 v58, v22, v27
    v_fmac_f32 v59, v23, v27
    v_lshlrev_b32 v22, 16, v78
    v_and_b32 v23, 0xffff0000, v78
    v_fmac_f32 v60, v22, v27
    v_fmac_f32 v61, v23, v27
    v_lshlrev_b32 v22, 16, v79
    v_and_b32 v23, 0xffff0000, v79
    v_fmac_f32 v62, v22, v27
    v_fmac_f32 v63, v23, v27
    v_lshlrev_b32 v22, 16, v80
    v_and_b32 v23, 0xffff0000, v80
    v_fmac_f32 v56, v22, v28
    v_fmac_f32 v57, v23, v28
    v_lshlrev_b32 v22, 16, v81
    v_and_b32 v23, 0xffff0000, v81
    v_fmac_f32 v58, v22, v28
    v_fmac_f32 v59, v23, v28
    v_lshlrev_b32 v22, 16, v82
    v_and_b32 v23, 0xffff0000, v82
    v_fmac_f32 v60, v22, v28
    v_fmac_f32 v61, v23, v28
    v_lshlrev_b32 v22, 16, v83
    v_and_b32 v23, 0xffff0000, v83
    v_fmac_f32 v62, v22, v28
    v_fmac_f32 v63, v23, v28
    v_lshlrev_b32 v22, 16, v84
    v_and_b32 v23, 0xffff0000, v84
    v_fmac_f32 v56, v22, v29
    v_fmac_f32 v57, v23, v29
    v_lshlrev_b32 v22, 16, v85
    v_and_b32 v23, 0xffff0000, v85
    v_fmac_f32 v58, v22, v29
    v_fmac_f32 v59, v23, v29
    v_lshlrev_b32 v22, 16, v86
    v_and_b32 v23, 0xffff0000, v86
    v_fmac_f32 v60, v22, v29
    v_fmac_f32 v61, v23, v29
    v_lshlrev_b32 v22, 16, v87
    v_and_b32 v23, 0xffff0000, v87
    v_fmac_f32 v62, v22, v29
    v_fmac_f32 v63, v23, v29
    v_lshlrev_b32 v22, 16, v88
    v_and_b32 v23, 0xffff0000, v88
    v_fmac_f32 v56, v22, v30
    v_fmac_f32 v57, v23, v30
    v_lshlrev_b32 v22, 16, v89
    v_and_b32 v23, 0xffff0000, v89
    v_fmac_f32 v58, v22, v30
    v_fmac_f32 v59, v23, v30
    v_lshlrev_b32 v22, 16, v90
    v_and_b32 v23, 0xffff0000, v90
    v_fmac_f32 v60, v22, v30
    v_fmac_f32 v61, v23, v30
    v_lshlrev_b32 v22, 16, v91
    v_and_b32 v23, 0xffff0000, v91
    v_fmac_f32 v62, v22, v30
    v_fmac_f32 v63, v23, v30
    v_lshlrev_b32 v22, 16, v92
    v_and_b32 v23, 0xffff0000, v92
    v_fmac_f32 v56, v22, v31
    v_fmac_f32 v57, v23, v31
    v_lshlrev_b32 v22, 16, v93
    v_and_b32 v23, 0xffff0000, v93
    v_fmac_f32 v58, v22, v31
    v_fmac_f32 v59, v23, v31
    v_lshlrev_b32 v22, 16, v94
    v_and_b32 v23, 0xffff0000, v94
    v_fmac_f32 v60, v22, v31
    v_fmac_f32 v61, v23, v31
    v_lshlrev_b32 v22, 16, v95
    v_and_b32 v23, 0xffff0000, v95
    v_fmac_f32 v62, v22, v31
    v_fmac_f32 v63, v23, v31
    s_waitcnt vmcnt(16)
    v_lshlrev_b32 v22, 16, v96
    v_and_b32 v23, 0xffff0000, v96
    v_fmac_f32 v56, v22, v32
    v_fmac_f32 v57, v23, v32
    v_lshlrev_b32 v22, 16, v97
    v_and_b32 v23, 0xffff0000, v97
    v_fmac_f32 v58, v22, v32
    v_fmac_f32 v59, v23, v32
    v_lshlrev_b32 v22, 16, v98
    v_and_b32 v23, 0xffff0000, v98
    v_fmac_f32 v60, v22, v32
    v_fmac_f32 v61, v23, v32
    v_lshlrev_b32 v22, 16, v99
    v_and_b32 v23, 0xffff0000, v99
    v_fmac_f32 v62, v22, v32
    v_fmac_f32 v63, v23, v32
    v_lshlrev_b32 v22, 16, v100
    v_and_b32 v23, 0xffff0000, v100
    v_fmac_f32 v56, v22, v33
    v_fmac_f32 v57, v23, v33
    v_lshlrev_b32 v22, 16, v101
    v_and_b32 v23, 0xffff0000, v101
    v_fmac_f32 v58, v22, v33
    v_fmac_f32 v59, v23, v33
    v_lshlrev_b32 v22, 16, v102
    v_and_b32 v23, 0xffff0000, v102
    v_fmac_f32 v60, v22, v33
    v_fmac_f32 v61, v23, v33
    v_lshlrev_b32 v22, 16, v103
    v_and_b32 v23, 0xffff0000, v103
    v_fmac_f32 v62, v22, v33
    v_fmac_f32 v63, v23, v33
    v_lshlrev_b32 v22, 16, v104
    v_and_b32 v23, 0xffff0000, v104
    v_fmac_f32 v56, v22, v34
    v_fmac_f32 v57, v23, v34
    v_lshlrev_b32 v22, 16, v105
    v_and_b32 v23, 0xffff0000, v105
    v_fmac_f32 v58, v22, v34
    v_fmac_f32 v59, v23, v34
    v_lshlrev_b32 v22, 16, v106
    v_and_b32 v23, 0xffff0000, v106
    v_fmac_f32 v60, v22, v34
    v_fmac_f32 v61, v23, v34
    v_lshlrev_b32 v22, 16, v107
    v_and_b32 v23, 0xffff0000, v107
    v_fmac_f32 v62, v22, v34
    v_fmac_f32 v63, v23, v34
    v_lshlrev_b32 v22, 16, v108
    v_and_b32 v23, 0xffff0000, v108
    v_fmac_f32 v56, v22, v35
    v_fmac_f32 v57, v23, v35
    v_lshlrev_b32 v22, 16, v109
    v_and_b32 v23, 0xffff0000, v109
    v_fmac_f32 v58, v22, v35
    v_fmac_f32 v59, v23, v35
    v_lshlrev_b32 v22, 16, v110
    v_and_b32 v23, 0xffff0000, v110
    v_fmac_f32 v60, v22, v35
    v_fmac_f32 v61, v23, v35
    v_lshlrev_b32 v22, 16, v111
    v_and_b32 v23, 0xffff0000, v111
    v_fmac_f32 v62, v22, v35
    v_fmac_f32 v63, v23, v35
    v_lshlrev_b32 v22, 16, v112
    v_and_b32 v23, 0xffff0000, v112
    v_fmac_f32 v56, v22, v36
    v_fmac_f32 v57, v23, v36
    v_lshlrev_b32 v22, 16, v113
    v_and_b32 v23, 0xffff0000, v113
    v_fmac_f32 v58, v22, v36
    v_fmac_f32 v59, v23, v36
    v_lshlrev_b32 v22, 16, v114
    v_and_b32 v23, 0xffff0000, v114
    v_fmac_f32 v60, v22, v36
    v_fmac_f32 v61, v23, v36
    v_lshlrev_b32 v22, 16, v115
    v_and_b32 v23, 0xffff0000, v115
    v_fmac_f32 v62, v22, v36
    v_fmac_f32 v63, v23, v36
    v_lshlrev_b32 v22, 16, v116
    v_and_b32 v23, 0xffff0000, v116
    v_fmac_f32 v56, v22, v37
    v_fmac_f32 v57, v23, v37
    v_lshlrev_b32 v22, 16, v117
    v_and_b32 v23, 0xffff0000, v117
    v_fmac_f32 v58, v22, v37
    v_fmac_f32 v59, v23, v37
    v_lshlrev_b32 v22, 16, v118
    v_and_b32 v23, 0xffff0000, v118
    v_fmac_f32 v60, v22, v37
    v_fmac_f32 v61, v23, v37
    v_lshlrev_b32 v22, 16, v119
    v_and_b32 v23, 0xffff0000, v119
    v_fmac_f32 v62, v22, v37
    v_fmac_f32 v63, v23, v37
    v_lshlrev_b32 v22, 16, v120
    v_and_b32 v23, 0xffff0000, v120
    v_fmac_f32 v56, v22, v38
    v_fmac_f32 v57, v23, v38
    v_lshlrev_b32 v22, 16, v121
    v_and_b32 v23, 0xffff0000, v121
    v_fmac_f32 v58, v22, v38
    v_fmac_f32 v59, v23, v38
    v_lshlrev_b32 v22, 16, v122
    v_and_b32 v23, 0xffff0000, v122
    v_fmac_f32 v60, v22, v38
    v_fmac_f32 v61, v23, v38
    v_lshlrev_b32 v22, 16, v123
    v_and_b32 v23, 0xffff0000, v123
    v_fmac_f32 v62, v22, v38
    v_fmac_f32 v63, v23, v38
    v_lshlrev_b32 v22, 16, v124
    v_and_b32 v23, 0xffff0000, v124
    v_fmac_f32 v56, v22, v39
    v_fmac_f32 v57, v23, v39
    v_lshlrev_b32 v22, 16, v125
    v_and_b32 v23, 0xffff0000, v125
    v_fmac_f32 v58, v22, v39
    v_fmac_f32 v59, v23, v39
    v_lshlrev_b32 v22, 16, v126
    v_and_b32 v23, 0xffff0000, v126
    v_fmac_f32 v60, v22, v39
    v_fmac_f32 v61, v23, v39
    v_lshlrev_b32 v22, 16, v127
    v_and_b32 v23, 0xffff0000, v127
    v_fmac_f32 v62, v22, v39
    v_fmac_f32 v63, v23, v39
    s_waitcnt vmcnt(8)
    v_lshlrev_b32 v22, 16, v128
    v_and_b32 v23, 0xffff0000, v128
    v_fmac_f32 v56, v22, v40
    v_fmac_f32 v57, v23, v40
    v_lshlrev_b32 v22, 16, v129
    v_and_b32 v23, 0xffff0000, v129
    v_fmac_f32 v58, v22, v40
    v_fmac_f32 v59, v23, v40
    v_lshlrev_b32 v22, 16, v130
    v_and_b32 v23, 0xffff0000, v130
    v_fmac_f32 v60, v22, v40
    v_fmac_f32 v61, v23, v40
    v_lshlrev_b32 v22, 16, v131
    v_and_b32 v23, 0xffff0000, v131
    v_fmac_f32 v62, v22, v40
    v_fmac_f32 v63, v23, v40
    v_lshlrev_b32 v22, 16, v132
    v_and_b32 v23, 0xffff0000, v132
    v_fmac_f32 v56, v22, v41
    v_fmac_f32 v57, v23, v41
    v_lshlrev_b32 v22, 16, v133
    v_and_b32 v23, 0xffff0000, v133
    v_fmac_f32 v58, v22, v41
    v_fmac_f32 v59, v23, v41
    v_lshlrev_b32 v22, 16, v134
    v_and_b32 v23, 0xffff0000, v134
    v_fmac_f32 v60, v22, v41
    v_fmac_f32 v61, v23, v41
    v_lshlrev_b32 v22, 16, v135
    v_and_b32 v23, 0xffff0000, v135
    v_fmac_f32 v62, v22, v41
    v_fmac_f32 v63, v23, v41
    v_lshlrev_b32 v22, 16, v136
    v_and_b32 v23, 0xffff0000, v136
    v_fmac_f32 v56, v22, v42
    v_fmac_f32 v57, v23, v42
    v_lshlrev_b32 v22, 16, v137
    v_and_b32 v23, 0xffff0000, v137
    v_fmac_f32 v58, v22, v42
    v_fmac_f32 v59, v23, v42
    v_lshlrev_b32 v22, 16, v138
    v_and_b32 v23, 0xffff0000, v138
    v_fmac_f32 v60, v22, v42
    v_fmac_f32 v61, v23, v42
    v_lshlrev_b32 v22, 16, v139
    v_and_b32 v23, 0xffff0000, v139
    v_fmac_f32 v62, v22, v42
    v_fmac_f32 v63, v23, v42
    v_lshlrev_b32 v22, 16, v140
    v_and_b32 v23, 0xffff0000, v140
    v_fmac_f32 v56, v22, v43
    v_fmac_f32 v57, v23, v43
    v_lshlrev_b32 v22, 16, v141
    v_and_b32 v23, 0xffff0000, v141
    v_fmac_f32 v58, v22, v43
    v_fmac_f32 v59, v23, v43
    v_lshlrev_b32 v22, 16, v142
    v_and_b32 v23, 0xffff0000, v142
    v_fmac_f32 v60, v22, v43
    v_fmac_f32 v61, v23, v43
    v_lshlrev_b32 v22, 16, v143
    v_and_b32 v23, 0xffff0000, v143
    v_fmac_f32 v62, v22, v43
    v_fmac_f32 v63, v23, v43
    v_lshlrev_b32 v22, 16, v144
    v_and_b32 v23, 0xffff0000, v144
    v_fmac_f32 v56, v22, v44
    v_fmac_f32 v57, v23, v44
    v_lshlrev_b32 v22, 16, v145
    v_and_b32 v23, 0xffff0000, v145
    v_fmac_f32 v58, v22, v44
    v_fmac_f32 v59, v23, v44
    v_lshlrev_b32 v22, 16, v146
    v_and_b32 v23, 0xffff0000, v146
    v_fmac_f32 v60, v22, v44
    v_fmac_f32 v61, v23, v44
    v_lshlrev_b32 v22, 16, v147
    v_and_b32 v23, 0xffff0000, v147
    v_fmac_f32 v62, v22, v44
    v_fmac_f32 v63, v23, v44
    v_lshlrev_b32 v22, 16, v148
    v_and_b32 v23, 0xffff0000, v148
    v_fmac_f32 v56, v22, v45
    v_fmac_f32 v57, v23, v45
    v_lshlrev_b32 v22, 16, v149
    v_and_b32 v23, 0xffff0000, v149
    v_fmac_f32 v58, v22, v45
    v_fmac_f32 v59, v23, v45
    v_lshlrev_b32 v22, 16, v150
    v_and_b32 v23, 0xffff0000, v150
    v_fmac_f32 v60, v22, v45
    v_fmac_f32 v61, v23, v45
    v_lshlrev_b32 v22, 16, v151
    v_and_b32 v23, 0xffff0000, v151
    v_fmac_f32 v62, v22, v45
    v_fmac_f32 v63, v23, v45
    v_lshlrev_b32 v22, 16, v152
    v_and_b32 v23, 0xffff0000, v152
    v_fmac_f32 v56, v22, v46
    v_fmac_f32 v57, v23, v46
    v_lshlrev_b32 v22, 16, v153
    v_and_b32 v23, 0xffff0000, v153
    v_fmac_f32 v58, v22, v46
    v_fmac_f32 v59, v23, v46
    v_lshlrev_b32 v22, 16, v154
    v_and_b32 v23, 0xffff0000, v154
    v_fmac_f32 v60, v22, v46
    v_fmac_f32 v61, v23, v46
    v_lshlrev_b32 v22, 16, v155
    v_and_b32 v23, 0xffff0000, v155
    v_fmac_f32 v62, v22, v46
    v_fmac_f32 v63, v23, v46
    v_lshlrev_b32 v22, 16, v156
    v_and_b32 v23, 0xffff0000, v156
    v_fmac_f32 v56, v22, v47
    v_fmac_f32 v57, v23, v47
    v_lshlrev_b32 v22, 16, v157
    v_and_b32 v23, 0xffff0000, v157
    v_fmac_f32 v58, v22, v47
    v_fmac_f32 v59, v23, v47
    v_lshlrev_b32 v22, 16, v158
    v_and_b32 v23, 0xffff0000, v158
    v_fmac_f32 v60, v22, v47
    v_fmac_f32 v61, v23, v47
    v_lshlrev_b32 v22, 16, v159
    v_and_b32 v23, 0xffff0000, v159
    v_fmac_f32 v62, v22, v47
    v_fmac_f32 v63, v23, v47
    s_waitcnt vmcnt(0)
    v_lshlrev_b32 v22, 16, v160
    v_and_b32 v23, 0xffff0000, v160
    v_fmac_f32 v56, v22, v48
    v_fmac_f32 v57, v23, v48
    v_lshlrev_b32 v22, 16, v161
    v_and_b32 v23, 0xffff0000, v161
    v_fmac_f32 v58, v22, v48
    v_fmac_f32 v59, v23, v48
    v_lshlrev_b32 v22, 16, v162
    v_and_b32 v23, 0xffff0000, v162
    v_fmac_f32 v60, v22, v48
    v_fmac_f32 v61, v23, v48
    v_lshlrev_b32 v22, 16, v163
    v_and_b32 v23, 0xffff0000, v163
    v_fmac_f32 v62, v22, v48
    v_fmac_f32 v63, v23, v48
    v_lshlrev_b32 v22, 16, v164
    v_and_b32 v23, 0xffff0000, v164
    v_fmac_f32 v56, v22, v49
    v_fmac_f32 v57, v23, v49
    v_lshlrev_b32 v22, 16, v165
    v_and_b32 v23, 0xffff0000, v165
    v_fmac_f32 v58, v22, v49
    v_fmac_f32 v59, v23, v49
    v_lshlrev_b32 v22, 16, v166
    v_and_b32 v23, 0xffff0000, v166
    v_fmac_f32 v60, v22, v49
    v_fmac_f32 v61, v23, v49
    v_lshlrev_b32 v22, 16, v167
    v_and_b32 v23, 0xffff0000, v167
    v_fmac_f32 v62, v22, v49
    v_fmac_f32 v63, v23, v49
    v_lshlrev_b32 v22, 16, v168
    v_and_b32 v23, 0xffff0000, v168
    v_fmac_f32 v56, v22, v50
    v_fmac_f32 v57, v23, v50
    v_lshlrev_b32 v22, 16, v169
    v_and_b32 v23, 0xffff0000, v169
    v_fmac_f32 v58, v22, v50
    v_fmac_f32 v59, v23, v50
    v_lshlrev_b32 v22, 16, v170
    v_and_b32 v23, 0xffff0000, v170
    v_fmac_f32 v60, v22, v50
    v_fmac_f32 v61, v23, v50
    v_lshlrev_b32 v22, 16, v171
    v_and_b32 v23, 0xffff0000, v171
    v_fmac_f32 v62, v22, v50
    v_fmac_f32 v63, v23, v50
    v_lshlrev_b32 v22, 16, v172
    v_and_b32 v23, 0xffff0000, v172
    v_fmac_f32 v56, v22, v51
    v_fmac_f32 v57, v23, v51
    v_lshlrev_b32 v22, 16, v173
    v_and_b32 v23, 0xffff0000, v173
    v_fmac_f32 v58, v22, v51
    v_fmac_f32 v59, v23, v51
    v_lshlrev_b32 v22, 16, v174
    v_and_b32 v23, 0xffff0000, v174
    v_fmac_f32 v60, v22, v51
    v_fmac_f32 v61, v23, v51
    v_lshlrev_b32 v22, 16, v175
    v_and_b32 v23, 0xffff0000, v175
    v_fmac_f32 v62, v22, v51
    v_fmac_f32 v63, v23, v51
    v_lshlrev_b32 v22, 16, v176
    v_and_b32 v23, 0xffff0000, v176
    v_fmac_f32 v56, v22, v52
    v_fmac_f32 v57, v23, v52
    v_lshlrev_b32 v22, 16, v177
    v_and_b32 v23, 0xffff0000, v177
    v_fmac_f32 v58, v22, v52
    v_fmac_f32 v59, v23, v52
    v_lshlrev_b32 v22, 16, v178
    v_and_b32 v23, 0xffff0000, v178
    v_fmac_f32 v60, v22, v52
    v_fmac_f32 v61, v23, v52
    v_lshlrev_b32 v22, 16, v179
    v_and_b32 v23, 0xffff0000, v179
    v_fmac_f32 v62, v22, v52
    v_fmac_f32 v63, v23, v52
    v_lshlrev_b32 v22, 16, v180
    v_and_b32 v23, 0xffff0000, v180
    v_fmac_f32 v56, v22, v53
    v_fmac_f32 v57, v23, v53
    v_lshlrev_b32 v22, 16, v181
    v_and_b32 v23, 0xffff0000, v181
    v_fmac_f32 v58, v22, v53
    v_fmac_f32 v59, v23, v53
    v_lshlrev_b32 v22, 16, v182
    v_and_b32 v23, 0xffff0000, v182
    v_fmac_f32 v60, v22, v53
    v_fmac_f32 v61, v23, v53
    v_lshlrev_b32 v22, 16, v183
    v_and_b32 v23, 0xffff0000, v183
    v_fmac_f32 v62, v22, v53
    v_fmac_f32 v63, v23, v53
    v_lshlrev_b32 v22, 16, v184
    v_and_b32 v23, 0xffff0000, v184
    v_fmac_f32 v56, v22, v54
    v_fmac_f32 v57, v23, v54
    v_lshlrev_b32 v22, 16, v185
    v_and_b32 v23, 0xffff0000, v185
    v_fmac_f32 v58, v22, v54
    v_fmac_f32 v59, v23, v54
    v_lshlrev_b32 v22, 16, v186
    v_and_b32 v23, 0xffff0000, v186
    v_fmac_f32 v60, v22, v54
    v_fmac_f32 v61, v23, v54
    v_lshlrev_b32 v22, 16, v187
    v_and_b32 v23, 0xffff0000, v187
    v_fmac_f32 v62, v22, v54
    v_fmac_f32 v63, v23, v54
    v_lshlrev_b32 v22, 16, v188
    v_and_b32 v23, 0xffff0000, v188
    v_fmac_f32 v56, v22, v55
    v_fmac_f32 v57, v23, v55
    v_lshlrev_b32 v22, 16, v189
    v_and_b32 v23, 0xffff0000, v189
    v_fmac_f32 v58, v22, v55
    v_fmac_f32 v59, v23, v55
    v_lshlrev_b32 v22, 16, v190
    v_and_b32 v23, 0xffff0000, v190
    v_fmac_f32 v60, v22, v55
    v_fmac_f32 v61, v23, v55
    v_lshlrev_b32 v22, 16, v191
    v_and_b32 v23, 0xffff0000, v191
    v_fmac_f32 v62, v22, v55
    v_fmac_f32 v63, v23, v55
    v_lshlrev_b32 v5, 8, v3
    v_lshl_add_u32 v5, v2, 5, v5
    ds_write_b128 v5, v[56:59] offset:4096
    ds_write_b128 v5, v[60:63] offset:4112
    s_waitcnt lgkmcnt(0)
    s_barrier
    v_cmp_gt_u32 vcc, 64, v0
    s_and_saveexec_b64 s[24:25], vcc
    s_cbranch_execz pre_kernel_exit
    v_lshlrev_b32 v5, 2, v0

    ds_read_b32 v64, v5 offset:4096
    ds_read_b32 v65, v5 offset:4352
    ds_read_b32 v66, v5 offset:4608
    ds_read_b32 v67, v5 offset:4864
    ds_read_b32 v68, v5 offset:5120
    ds_read_b32 v69, v5 offset:5376
    ds_read_b32 v70, v5 offset:5632
    ds_read_b32 v71, v5 offset:5888
    s_waitcnt lgkmcnt(0)
    ds_read_b32 v72, v5 offset:6144
    ds_read_b32 v73, v5 offset:6400
    ds_read_b32 v74, v5 offset:6656
    ds_read_b32 v75, v5 offset:6912
    ds_read_b32 v76, v5 offset:7168
    ds_read_b32 v77, v5 offset:7424
    ds_read_b32 v78, v5 offset:7680
    ds_read_b32 v79, v5 offset:7936
    s_waitcnt lgkmcnt(0)
    ds_read_b32 v80, v5 offset:8192
    ds_read_b32 v81, v5 offset:8448
    ds_read_b32 v82, v5 offset:8704
    ds_read_b32 v83, v5 offset:8960
    ds_read_b32 v84, v5 offset:9216
    ds_read_b32 v85, v5 offset:9472
    ds_read_b32 v86, v5 offset:9728
    ds_read_b32 v87, v5 offset:9984
    s_waitcnt lgkmcnt(0)
    ds_read_b32 v88, v5 offset:10240
    ds_read_b32 v89, v5 offset:10496
    ds_read_b32 v90, v5 offset:10752
    ds_read_b32 v91, v5 offset:11008
    ds_read_b32 v92, v5 offset:11264
    ds_read_b32 v93, v5 offset:11520
    ds_read_b32 v94, v5 offset:11776
    ds_read_b32 v95, v5 offset:12032
    s_waitcnt lgkmcnt(0)
    v_add_f32 v64, v64, v80
    v_add_f32 v65, v65, v81
    v_add_f32 v66, v66, v82
    v_add_f32 v67, v67, v83
    v_add_f32 v68, v68, v84
    v_add_f32 v69, v69, v85
    v_add_f32 v70, v70, v86
    v_add_f32 v71, v71, v87
    v_add_f32 v72, v72, v88
    v_add_f32 v73, v73, v89
    v_add_f32 v74, v74, v90
    v_add_f32 v75, v75, v91
    v_add_f32 v76, v76, v92
    v_add_f32 v77, v77, v93
    v_add_f32 v78, v78, v94
    v_add_f32 v79, v79, v95
    v_add_f32 v64, v64, v72
    v_add_f32 v65, v65, v73
    v_add_f32 v66, v66, v74
    v_add_f32 v67, v67, v75
    v_add_f32 v68, v68, v76
    v_add_f32 v69, v69, v77
    v_add_f32 v70, v70, v78
    v_add_f32 v71, v71, v79
    v_add_f32 v64, v64, v68
    v_add_f32 v65, v65, v69
    v_add_f32 v66, v66, v70
    v_add_f32 v67, v67, v71
    v_add_f32 v64, v64, v66
    v_add_f32 v65, v65, v67
    v_add_f32 v64, v64, v65
    v_cvt_pk_bf16_f32 v33, v64, v64
    v_lshlrev_b32 v33, 16, v33
    v_add_f32 v34, 1.0, v33
    v_cvt_pk_bf16_f32 v34, v34, v34
    v_lshlrev_b32 v34, 16, v34
    s_lshr_b32 s22, s2, 4
    s_cmp_eq_u32 s22, 1
    s_cselect_b32 s23, 1, 0
    s_cmp_eq_u32 s22, 4
    s_cselect_b32 s23, 1, s23
    s_cmp_eq_u32 s23, 1
    s_cbranch_scc0 pre_kernel_nop1
    v_mov_b32 v33, v34
pre_kernel_nop1:
    s_lshl_b32 s22, s2, 8
    s_add_u32 s22, s22, 0
    buffer_store_dword v33, v5, s[16:19], s22 offen sc1
    s_cmp_ge_u32 s2, 32
    s_cbranch_scc1 pre_kernel_exit
    s_waitcnt vmcnt(0)
    s_mov_b64 exec, 1
    v_mov_b32 v6, 0
    v_mov_b32 v7, 1
    buffer_atomic_add v7, v6, s[36:39], 0 offen
    s_endpgm

pre_kernel_fill:
    s_sub_u32 s22, s2, 224
    s_lshl_b32 s23, s22, 12
    s_add_u32 s23, s23, 32768
    v_lshlrev_b32 v1, 4, v0
    v_mov_b32 v4, 0
    v_mov_b32 v5, 0
    v_mov_b32 v6, 0
    v_mov_b32 v7, 0
    buffer_store_dwordx4 v[4:7], v1, s[16:19], s23 offen
    v_mov_b32 v8, -1
    v_mov_b32 v9, -1
    v_mov_b32 v10, -1
    v_mov_b32 v11, -1
    s_lshl_b32 s22, s22, 12
    s_add_u32 s22, s22, 163840
pre_kernel_floop:
    buffer_store_dwordx4 v[8:11], v1, s[16:19], s22 offen
    s_add_u32 s22, s22, 131072
    s_cmp_lt_u32 s22, 2523136
    s_cbranch_scc1 pre_kernel_floop
    s_endpgm

pre_kernel_ln:
    s_mov_b32 s8, s30
    s_mov_b32 s9, s31
    s_mov_b32 s10, 4194304
    s_mov_b32 s11, 0x20000
    s_sub_u32 s2, s2, 96
    v_and_b32 v1, 63, v0
    v_lshrrev_b32 v2, 6, v0
    s_nop 0
    v_readfirstlane_b32 s22, v2
    v_and_b32 v3, 15, v1
    v_lshrrev_b32 v4, 4, v1
    v_lshlrev_b32 v5, 4, v1
    v_lshlrev_b32 v6, 11, v3
    v_lshl_add_u32 v6, v4, 3, v6
    s_lshl_b32 s23, s2, 15
    s_lshl_b32 s24, s22, 9
    s_add_u32 s23, s23, s24

    buffer_load_dwordx2 v[96:97], v6, s[8:11], s23 offen offset:0
    buffer_load_dwordx2 v[98:99], v6, s[8:11], s23 offen offset:32
    buffer_load_dwordx2 v[100:101], v6, s[8:11], s23 offen offset:64
    buffer_load_dwordx2 v[102:103], v6, s[8:11], s23 offen offset:96
    buffer_load_dwordx2 v[104:105], v6, s[8:11], s23 offen offset:128
    buffer_load_dwordx2 v[106:107], v6, s[8:11], s23 offen offset:160
    buffer_load_dwordx2 v[108:109], v6, s[8:11], s23 offen offset:192
    buffer_load_dwordx2 v[110:111], v6, s[8:11], s23 offen offset:224
    buffer_load_dwordx2 v[112:113], v6, s[8:11], s23 offen offset:256
    buffer_load_dwordx2 v[114:115], v6, s[8:11], s23 offen offset:288
    buffer_load_dwordx2 v[116:117], v6, s[8:11], s23 offen offset:320
    buffer_load_dwordx2 v[118:119], v6, s[8:11], s23 offen offset:352
    buffer_load_dwordx2 v[120:121], v6, s[8:11], s23 offen offset:384
    buffer_load_dwordx2 v[122:123], v6, s[8:11], s23 offen offset:416
    buffer_load_dwordx2 v[124:125], v6, s[8:11], s23 offen offset:448
    buffer_load_dwordx2 v[126:127], v6, s[8:11], s23 offen offset:480
    v_lshlrev_b32 v7, 4, v4
    s_lshl_b32 s24, s22, 10
    s_add_u32 s26, s24, 0
    s_add_u32 s27, s24, 4096
    s_waitcnt vmcnt(0)

    v_lshlrev_b32 v32, 16, v96
    v_and_b32 v33, 0xffff0000, v96
    v_lshlrev_b32 v34, 16, v97
    v_and_b32 v35, 0xffff0000, v97
    v_lshlrev_b32 v36, 16, v98
    v_and_b32 v37, 0xffff0000, v98
    v_lshlrev_b32 v38, 16, v99
    v_and_b32 v39, 0xffff0000, v99
    v_lshlrev_b32 v40, 16, v100
    v_and_b32 v41, 0xffff0000, v100
    v_lshlrev_b32 v42, 16, v101
    v_and_b32 v43, 0xffff0000, v101
    v_lshlrev_b32 v44, 16, v102
    v_and_b32 v45, 0xffff0000, v102
    v_lshlrev_b32 v46, 16, v103
    v_and_b32 v47, 0xffff0000, v103
    v_lshlrev_b32 v48, 16, v104
    v_and_b32 v49, 0xffff0000, v104
    v_lshlrev_b32 v50, 16, v105
    v_and_b32 v51, 0xffff0000, v105
    v_lshlrev_b32 v52, 16, v106
    v_and_b32 v53, 0xffff0000, v106
    v_lshlrev_b32 v54, 16, v107
    v_and_b32 v55, 0xffff0000, v107
    v_lshlrev_b32 v56, 16, v108
    v_and_b32 v57, 0xffff0000, v108
    v_lshlrev_b32 v58, 16, v109
    v_and_b32 v59, 0xffff0000, v109
    v_lshlrev_b32 v60, 16, v110
    v_and_b32 v61, 0xffff0000, v110
    v_lshlrev_b32 v62, 16, v111
    v_and_b32 v63, 0xffff0000, v111
    v_lshlrev_b32 v64, 16, v112
    v_and_b32 v65, 0xffff0000, v112
    v_lshlrev_b32 v66, 16, v113
    v_and_b32 v67, 0xffff0000, v113
    v_lshlrev_b32 v68, 16, v114
    v_and_b32 v69, 0xffff0000, v114
    v_lshlrev_b32 v70, 16, v115
    v_and_b32 v71, 0xffff0000, v115
    v_lshlrev_b32 v72, 16, v116
    v_and_b32 v73, 0xffff0000, v116
    v_lshlrev_b32 v74, 16, v117
    v_and_b32 v75, 0xffff0000, v117
    v_lshlrev_b32 v76, 16, v118
    v_and_b32 v77, 0xffff0000, v118
    v_lshlrev_b32 v78, 16, v119
    v_and_b32 v79, 0xffff0000, v119
    v_lshlrev_b32 v80, 16, v120
    v_and_b32 v81, 0xffff0000, v120
    v_lshlrev_b32 v82, 16, v121
    v_and_b32 v83, 0xffff0000, v121
    v_lshlrev_b32 v84, 16, v122
    v_and_b32 v85, 0xffff0000, v122
    v_lshlrev_b32 v86, 16, v123
    v_and_b32 v87, 0xffff0000, v123
    v_lshlrev_b32 v88, 16, v124
    v_and_b32 v89, 0xffff0000, v124
    v_lshlrev_b32 v90, 16, v125
    v_and_b32 v91, 0xffff0000, v125
    v_lshlrev_b32 v92, 16, v126
    v_and_b32 v93, 0xffff0000, v126
    v_lshlrev_b32 v94, 16, v127
    v_and_b32 v95, 0xffff0000, v127
    v_add_f32 v8, v32, v33
    v_add_f32 v16, v34, v35
    v_add_f32 v17, v36, v37
    v_add_f32 v18, v38, v39
    v_add_f32 v8, v8, v40
    v_add_f32 v16, v16, v41
    v_add_f32 v17, v17, v42
    v_add_f32 v18, v18, v43
    v_add_f32 v8, v8, v44
    v_add_f32 v16, v16, v45
    v_add_f32 v17, v17, v46
    v_add_f32 v18, v18, v47
    v_add_f32 v8, v8, v48
    v_add_f32 v16, v16, v49
    v_add_f32 v17, v17, v50
    v_add_f32 v18, v18, v51
    v_add_f32 v8, v8, v52
    v_add_f32 v16, v16, v53
    v_add_f32 v17, v17, v54
    v_add_f32 v18, v18, v55
    v_add_f32 v8, v8, v56
    v_add_f32 v16, v16, v57
    v_add_f32 v17, v17, v58
    v_add_f32 v18, v18, v59
    v_add_f32 v8, v8, v60
    v_add_f32 v16, v16, v61
    v_add_f32 v17, v17, v62
    v_add_f32 v18, v18, v63
    v_add_f32 v8, v8, v64
    v_add_f32 v16, v16, v65
    v_add_f32 v17, v17, v66
    v_add_f32 v18, v18, v67
    v_add_f32 v8, v8, v68
    v_add_f32 v16, v16, v69
    v_add_f32 v17, v17, v70
    v_add_f32 v18, v18, v71
    v_add_f32 v8, v8, v72
    v_add_f32 v16, v16, v73
    v_add_f32 v17, v17, v74
    v_add_f32 v18, v18, v75
    v_add_f32 v8, v8, v76
    v_add_f32 v16, v16, v77
    v_add_f32 v17, v17, v78
    v_add_f32 v18, v18, v79
    v_add_f32 v8, v8, v80
    v_add_f32 v16, v16, v81
    v_add_f32 v17, v17, v82
    v_add_f32 v18, v18, v83
    v_add_f32 v8, v8, v84
    v_add_f32 v16, v16, v85
    v_add_f32 v17, v17, v86
    v_add_f32 v18, v18, v87
    v_add_f32 v8, v8, v88
    v_add_f32 v16, v16, v89
    v_add_f32 v17, v17, v90
    v_add_f32 v18, v18, v91
    v_add_f32 v8, v8, v92
    v_add_f32 v16, v16, v93
    v_add_f32 v17, v17, v94
    v_add_f32 v18, v18, v95
    v_add_f32 v8, v8, v16
    v_add_f32 v17, v17, v18
    v_add_f32 v8, v8, v17
    v_mov_b32 v9, v8
    s_nop 1
    v_permlane16_swap_b32 v8, v9
    s_nop 1
    v_add_f32 v8, v8, v9
    v_mov_b32 v9, v8
    s_nop 1
    v_permlane32_swap_b32 v8, v9
    s_nop 1
    v_add_f32 v8, v8, v9
    v_lshlrev_b32 v10, 2, v3
    s_lshl_b32 s24, s22, 6
    v_add_u32 v11, s24, v10
    ds_write_b32 v11, v8 offset:0
    s_waitcnt lgkmcnt(0)
    s_barrier
    ds_read_b32 v12, v10 offset:0
    ds_read_b32 v13, v10 offset:64
    ds_read_b32 v14, v10 offset:128
    ds_read_b32 v15, v10 offset:192
    s_waitcnt lgkmcnt(0)
    v_add_f32 v12, v12, v13
    v_add_f32 v14, v14, v15
    v_add_f32 v8, v12, v14

    v_mul_f32 v16, 0x3a800000, v8
    v_sub_f32 v32, v32, v16
    v_sub_f32 v33, v33, v16
    v_sub_f32 v34, v34, v16
    v_sub_f32 v35, v35, v16
    v_sub_f32 v36, v36, v16
    v_sub_f32 v37, v37, v16
    v_sub_f32 v38, v38, v16
    v_sub_f32 v39, v39, v16
    v_sub_f32 v40, v40, v16
    v_sub_f32 v41, v41, v16
    v_sub_f32 v42, v42, v16
    v_sub_f32 v43, v43, v16
    v_sub_f32 v44, v44, v16
    v_sub_f32 v45, v45, v16
    v_sub_f32 v46, v46, v16
    v_sub_f32 v47, v47, v16
    v_sub_f32 v48, v48, v16
    v_sub_f32 v49, v49, v16
    v_sub_f32 v50, v50, v16
    v_sub_f32 v51, v51, v16
    v_sub_f32 v52, v52, v16
    v_sub_f32 v53, v53, v16
    v_sub_f32 v54, v54, v16
    v_sub_f32 v55, v55, v16
    v_sub_f32 v56, v56, v16
    v_sub_f32 v57, v57, v16
    v_sub_f32 v58, v58, v16
    v_sub_f32 v59, v59, v16
    v_sub_f32 v60, v60, v16
    v_sub_f32 v61, v61, v16
    v_sub_f32 v62, v62, v16
    v_sub_f32 v63, v63, v16
    v_sub_f32 v64, v64, v16
    v_sub_f32 v65, v65, v16
    v_sub_f32 v66, v66, v16
    v_sub_f32 v67, v67, v16
    v_sub_f32 v68, v68, v16
    v_sub_f32 v69, v69, v16
    v_sub_f32 v70, v70, v16
    v_sub_f32 v71, v71, v16
    v_sub_f32 v72, v72, v16
    v_sub_f32 v73, v73, v16
    v_sub_f32 v74, v74, v16
    v_sub_f32 v75, v75, v16
    v_sub_f32 v76, v76, v16
    v_sub_f32 v77, v77, v16
    v_sub_f32 v78, v78, v16
    v_sub_f32 v79, v79, v16
    v_sub_f32 v80, v80, v16
    v_sub_f32 v81, v81, v16
    v_sub_f32 v82, v82, v16
    v_sub_f32 v83, v83, v16
    v_sub_f32 v84, v84, v16
    v_sub_f32 v85, v85, v16
    v_sub_f32 v86, v86, v16
    v_sub_f32 v87, v87, v16
    v_sub_f32 v88, v88, v16
    v_sub_f32 v89, v89, v16
    v_sub_f32 v90, v90, v16
    v_sub_f32 v91, v91, v16
    v_sub_f32 v92, v92, v16
    v_sub_f32 v93, v93, v16
    v_sub_f32 v94, v94, v16
    v_sub_f32 v95, v95, v16
    v_mul_f32 v8, v32, v32
    v_mul_f32 v17, v33, v33
    v_fmac_f32 v8, v34, v34
    v_fmac_f32 v17, v35, v35
    v_fmac_f32 v8, v36, v36
    v_fmac_f32 v17, v37, v37
    v_fmac_f32 v8, v38, v38
    v_fmac_f32 v17, v39, v39
    v_fmac_f32 v8, v40, v40
    v_fmac_f32 v17, v41, v41
    v_fmac_f32 v8, v42, v42
    v_fmac_f32 v17, v43, v43
    v_fmac_f32 v8, v44, v44
    v_fmac_f32 v17, v45, v45
    v_fmac_f32 v8, v46, v46
    v_fmac_f32 v17, v47, v47
    v_fmac_f32 v8, v48, v48
    v_fmac_f32 v17, v49, v49
    v_fmac_f32 v8, v50, v50
    v_fmac_f32 v17, v51, v51
    v_fmac_f32 v8, v52, v52
    v_fmac_f32 v17, v53, v53
    v_fmac_f32 v8, v54, v54
    v_fmac_f32 v17, v55, v55
    v_fmac_f32 v8, v56, v56
    v_fmac_f32 v17, v57, v57
    v_fmac_f32 v8, v58, v58
    v_fmac_f32 v17, v59, v59
    v_fmac_f32 v8, v60, v60
    v_fmac_f32 v17, v61, v61
    v_fmac_f32 v8, v62, v62
    v_fmac_f32 v17, v63, v63
    v_fmac_f32 v8, v64, v64
    v_fmac_f32 v17, v65, v65
    v_fmac_f32 v8, v66, v66
    v_fmac_f32 v17, v67, v67
    v_fmac_f32 v8, v68, v68
    v_fmac_f32 v17, v69, v69
    v_fmac_f32 v8, v70, v70
    v_fmac_f32 v17, v71, v71
    v_fmac_f32 v8, v72, v72
    v_fmac_f32 v17, v73, v73
    v_fmac_f32 v8, v74, v74
    v_fmac_f32 v17, v75, v75
    v_fmac_f32 v8, v76, v76
    v_fmac_f32 v17, v77, v77
    v_fmac_f32 v8, v78, v78
    v_fmac_f32 v17, v79, v79
    v_fmac_f32 v8, v80, v80
    v_fmac_f32 v17, v81, v81
    v_fmac_f32 v8, v82, v82
    v_fmac_f32 v17, v83, v83
    v_fmac_f32 v8, v84, v84
    v_fmac_f32 v17, v85, v85
    v_fmac_f32 v8, v86, v86
    v_fmac_f32 v17, v87, v87
    v_fmac_f32 v8, v88, v88
    v_fmac_f32 v17, v89, v89
    v_fmac_f32 v8, v90, v90
    v_fmac_f32 v17, v91, v91
    v_fmac_f32 v8, v92, v92
    v_fmac_f32 v17, v93, v93
    v_fmac_f32 v8, v94, v94
    v_fmac_f32 v17, v95, v95
    v_add_f32 v8, v8, v17
    v_mov_b32 v9, v8
    s_nop 1
    v_permlane16_swap_b32 v8, v9
    s_nop 1
    v_add_f32 v8, v8, v9
    v_mov_b32 v9, v8
    s_nop 1
    v_permlane32_swap_b32 v8, v9
    s_nop 1
    v_add_f32 v8, v8, v9
    v_lshlrev_b32 v10, 2, v3
    s_lshl_b32 s24, s22, 6
    v_add_u32 v11, s24, v10
    ds_write_b32 v11, v8 offset:256
    s_waitcnt lgkmcnt(0)
    s_barrier
    ds_read_b32 v12, v10 offset:256
    ds_read_b32 v13, v10 offset:320
    ds_read_b32 v14, v10 offset:384
    ds_read_b32 v15, v10 offset:448
    s_waitcnt lgkmcnt(0)
    v_add_f32 v12, v12, v13
    v_add_f32 v14, v14, v15
    v_add_f32 v8, v12, v14

    v_mov_b32 v17, 0x3727c5ac
    v_fmac_f32 v17, 0x3a800000, v8
    v_rsq_f32 v17, v17
    s_nop 0

    v_mul_f32 v32, v32, v17
    v_mul_f32 v33, v33, v17
    v_mul_f32 v34, v34, v17
    v_mul_f32 v35, v35, v17
    v_mul_f32 v36, v36, v17
    v_mul_f32 v37, v37, v17
    v_mul_f32 v38, v38, v17
    v_mul_f32 v39, v39, v17
    v_mul_f32 v40, v40, v17
    v_mul_f32 v41, v41, v17
    v_mul_f32 v42, v42, v17
    v_mul_f32 v43, v43, v17
    v_mul_f32 v44, v44, v17
    v_mul_f32 v45, v45, v17
    v_mul_f32 v46, v46, v17
    v_mul_f32 v47, v47, v17
    v_mul_f32 v48, v48, v17
    v_mul_f32 v49, v49, v17
    v_mul_f32 v50, v50, v17
    v_mul_f32 v51, v51, v17
    v_mul_f32 v52, v52, v17
    v_mul_f32 v53, v53, v17
    v_mul_f32 v54, v54, v17
    v_mul_f32 v55, v55, v17
    v_mul_f32 v56, v56, v17
    v_mul_f32 v57, v57, v17
    v_mul_f32 v58, v58, v17
    v_mul_f32 v59, v59, v17
    v_mul_f32 v60, v60, v17
    v_mul_f32 v61, v61, v17
    v_mul_f32 v62, v62, v17
    v_mul_f32 v63, v63, v17
    v_mul_f32 v64, v64, v17
    v_mul_f32 v65, v65, v17
    v_mul_f32 v66, v66, v17
    v_mul_f32 v67, v67, v17
    v_mul_f32 v68, v68, v17
    v_mul_f32 v69, v69, v17
    v_mul_f32 v70, v70, v17
    v_mul_f32 v71, v71, v17
    v_mul_f32 v72, v72, v17
    v_mul_f32 v73, v73, v17
    v_mul_f32 v74, v74, v17
    v_mul_f32 v75, v75, v17
    v_mul_f32 v76, v76, v17
    v_mul_f32 v77, v77, v17
    v_mul_f32 v78, v78, v17
    v_mul_f32 v79, v79, v17
    v_mul_f32 v80, v80, v17
    v_mul_f32 v81, v81, v17
    v_mul_f32 v82, v82, v17
    v_mul_f32 v83, v83, v17
    v_mul_f32 v84, v84, v17
    v_mul_f32 v85, v85, v17
    v_mul_f32 v86, v86, v17
    v_mul_f32 v87, v87, v17
    v_mul_f32 v88, v88, v17
    v_mul_f32 v89, v89, v17
    v_mul_f32 v90, v90, v17
    v_mul_f32 v91, v91, v17
    v_mul_f32 v92, v92, v17
    v_mul_f32 v93, v93, v17
    v_mul_f32 v94, v94, v17
    v_mul_f32 v95, v95, v17
    v_mov_b32 v18, 0
    s_mov_b32 s34, 4000000
pre_kernel_wm:
    buffer_load_dword v19, v18, s[36:39], 0 offen sc1
    s_waitcnt vmcnt(0)
    v_readfirstlane_b32 s35, v19
    s_cmp_ge_u32 s35, 32
    s_cbranch_scc1 pre_kernel_wmok
    s_sub_u32 s34, s34, 1
    s_cbranch_scc1 pre_kernel_exit
    s_sleep 2
    s_branch pre_kernel_wm
pre_kernel_wmok:

    buffer_load_dwordx4 v[128:131], v7, s[16:19], s27 offen offset:0 sc1
    buffer_load_dwordx4 v[132:135], v7, s[16:19], s27 offen offset:64 sc1
    buffer_load_dwordx4 v[136:139], v7, s[16:19], s26 offen offset:0 sc1
    buffer_load_dwordx4 v[140:143], v7, s[16:19], s26 offen offset:64 sc1
    buffer_load_dwordx4 v[144:147], v7, s[16:19], s27 offen offset:128 sc1
    buffer_load_dwordx4 v[148:151], v7, s[16:19], s27 offen offset:192 sc1
    buffer_load_dwordx4 v[152:155], v7, s[16:19], s26 offen offset:128 sc1
    buffer_load_dwordx4 v[156:159], v7, s[16:19], s26 offen offset:192 sc1
    buffer_load_dwordx4 v[160:163], v7, s[16:19], s27 offen offset:256 sc1
    buffer_load_dwordx4 v[164:167], v7, s[16:19], s27 offen offset:320 sc1
    buffer_load_dwordx4 v[168:171], v7, s[16:19], s26 offen offset:256 sc1
    buffer_load_dwordx4 v[172:175], v7, s[16:19], s26 offen offset:320 sc1
    buffer_load_dwordx4 v[176:179], v7, s[16:19], s27 offen offset:384 sc1
    buffer_load_dwordx4 v[180:183], v7, s[16:19], s27 offen offset:448 sc1
    buffer_load_dwordx4 v[184:187], v7, s[16:19], s26 offen offset:384 sc1
    buffer_load_dwordx4 v[188:191], v7, s[16:19], s26 offen offset:448 sc1
    buffer_load_dwordx4 v[192:195], v7, s[16:19], s27 offen offset:512 sc1
    buffer_load_dwordx4 v[196:199], v7, s[16:19], s27 offen offset:576 sc1
    buffer_load_dwordx4 v[200:203], v7, s[16:19], s26 offen offset:512 sc1
    buffer_load_dwordx4 v[204:207], v7, s[16:19], s26 offen offset:576 sc1
    buffer_load_dwordx4 v[208:211], v7, s[16:19], s27 offen offset:640 sc1
    buffer_load_dwordx4 v[212:215], v7, s[16:19], s27 offen offset:704 sc1
    buffer_load_dwordx4 v[216:219], v7, s[16:19], s26 offen offset:640 sc1
    buffer_load_dwordx4 v[220:223], v7, s[16:19], s26 offen offset:704 sc1
    buffer_load_dwordx4 v[224:227], v7, s[16:19], s27 offen offset:768 sc1
    buffer_load_dwordx4 v[228:231], v7, s[16:19], s27 offen offset:832 sc1
    buffer_load_dwordx4 v[232:235], v7, s[16:19], s26 offen offset:768 sc1
    buffer_load_dwordx4 v[236:239], v7, s[16:19], s26 offen offset:832 sc1
    buffer_load_dwordx4 v[240:243], v7, s[16:19], s27 offen offset:896 sc1
    buffer_load_dwordx4 v[244:247], v7, s[16:19], s27 offen offset:960 sc1
    buffer_load_dwordx4 v[248:251], v7, s[16:19], s26 offen offset:896 sc1
    buffer_load_dwordx4 v[252:255], v7, s[16:19], s26 offen offset:960 sc1
    s_lshl_b32 s28, s2, 15
    s_lshl_b32 s24, s22, 13
    s_add_u32 s28, s28, s24
    s_add_u32 s28, s28, 2523136
    s_add_u32 s29, s28, 4096

    s_waitcnt vmcnt(0)
    v_fma_f32 v32, v32, v128, v136
    v_fma_f32 v33, v33, v129, v137
    v_fma_f32 v34, v34, v130, v138
    v_fma_f32 v35, v35, v131, v139
    v_fma_f32 v36, v36, v132, v140
    v_fma_f32 v37, v37, v133, v141
    v_fma_f32 v38, v38, v134, v142
    v_fma_f32 v39, v39, v135, v143
    v_cvt_pk_bf16_f32 v20, v32, v33
    v_cvt_pk_bf16_f32 v21, v34, v35
    v_cvt_pk_bf16_f32 v22, v36, v37
    v_cvt_pk_bf16_f32 v23, v38, v39
    buffer_store_dwordx4 v[20:23], v5, s[16:19], s28 offen offset:0
    v_fma_f32 v40, v40, v144, v152
    v_fma_f32 v41, v41, v145, v153
    v_fma_f32 v42, v42, v146, v154
    v_fma_f32 v43, v43, v147, v155
    v_fma_f32 v44, v44, v148, v156
    v_fma_f32 v45, v45, v149, v157
    v_fma_f32 v46, v46, v150, v158
    v_fma_f32 v47, v47, v151, v159
    v_cvt_pk_bf16_f32 v24, v40, v41
    v_cvt_pk_bf16_f32 v25, v42, v43
    v_cvt_pk_bf16_f32 v26, v44, v45
    v_cvt_pk_bf16_f32 v27, v46, v47
    buffer_store_dwordx4 v[24:27], v5, s[16:19], s28 offen offset:1024
    v_fma_f32 v48, v48, v160, v168
    v_fma_f32 v49, v49, v161, v169
    v_fma_f32 v50, v50, v162, v170
    v_fma_f32 v51, v51, v163, v171
    v_fma_f32 v52, v52, v164, v172
    v_fma_f32 v53, v53, v165, v173
    v_fma_f32 v54, v54, v166, v174
    v_fma_f32 v55, v55, v167, v175
    v_cvt_pk_bf16_f32 v20, v48, v49
    v_cvt_pk_bf16_f32 v21, v50, v51
    v_cvt_pk_bf16_f32 v22, v52, v53
    v_cvt_pk_bf16_f32 v23, v54, v55
    buffer_store_dwordx4 v[20:23], v5, s[16:19], s28 offen offset:2048
    v_fma_f32 v56, v56, v176, v184
    v_fma_f32 v57, v57, v177, v185
    v_fma_f32 v58, v58, v178, v186
    v_fma_f32 v59, v59, v179, v187
    v_fma_f32 v60, v60, v180, v188
    v_fma_f32 v61, v61, v181, v189
    v_fma_f32 v62, v62, v182, v190
    v_fma_f32 v63, v63, v183, v191
    v_cvt_pk_bf16_f32 v24, v56, v57
    v_cvt_pk_bf16_f32 v25, v58, v59
    v_cvt_pk_bf16_f32 v26, v60, v61
    v_cvt_pk_bf16_f32 v27, v62, v63
    buffer_store_dwordx4 v[24:27], v5, s[16:19], s28 offen offset:3072
    v_fma_f32 v64, v64, v192, v200
    v_fma_f32 v65, v65, v193, v201
    v_fma_f32 v66, v66, v194, v202
    v_fma_f32 v67, v67, v195, v203
    v_fma_f32 v68, v68, v196, v204
    v_fma_f32 v69, v69, v197, v205
    v_fma_f32 v70, v70, v198, v206
    v_fma_f32 v71, v71, v199, v207
    v_cvt_pk_bf16_f32 v20, v64, v65
    v_cvt_pk_bf16_f32 v21, v66, v67
    v_cvt_pk_bf16_f32 v22, v68, v69
    v_cvt_pk_bf16_f32 v23, v70, v71
    buffer_store_dwordx4 v[20:23], v5, s[16:19], s29 offen offset:0
    v_fma_f32 v72, v72, v208, v216
    v_fma_f32 v73, v73, v209, v217
    v_fma_f32 v74, v74, v210, v218
    v_fma_f32 v75, v75, v211, v219
    v_fma_f32 v76, v76, v212, v220
    v_fma_f32 v77, v77, v213, v221
    v_fma_f32 v78, v78, v214, v222
    v_fma_f32 v79, v79, v215, v223
    v_cvt_pk_bf16_f32 v24, v72, v73
    v_cvt_pk_bf16_f32 v25, v74, v75
    v_cvt_pk_bf16_f32 v26, v76, v77
    v_cvt_pk_bf16_f32 v27, v78, v79
    buffer_store_dwordx4 v[24:27], v5, s[16:19], s29 offen offset:1024
    v_fma_f32 v80, v80, v224, v232
    v_fma_f32 v81, v81, v225, v233
    v_fma_f32 v82, v82, v226, v234
    v_fma_f32 v83, v83, v227, v235
    v_fma_f32 v84, v84, v228, v236
    v_fma_f32 v85, v85, v229, v237
    v_fma_f32 v86, v86, v230, v238
    v_fma_f32 v87, v87, v231, v239
    v_cvt_pk_bf16_f32 v20, v80, v81
    v_cvt_pk_bf16_f32 v21, v82, v83
    v_cvt_pk_bf16_f32 v22, v84, v85
    v_cvt_pk_bf16_f32 v23, v86, v87
    buffer_store_dwordx4 v[20:23], v5, s[16:19], s29 offen offset:2048
    v_fma_f32 v88, v88, v240, v248
    v_fma_f32 v89, v89, v241, v249
    v_fma_f32 v90, v90, v242, v250
    v_fma_f32 v91, v91, v243, v251
    v_fma_f32 v92, v92, v244, v252
    v_fma_f32 v93, v93, v245, v253
    v_fma_f32 v94, v94, v246, v254
    v_fma_f32 v95, v95, v247, v255
    v_cvt_pk_bf16_f32 v24, v88, v89
    v_cvt_pk_bf16_f32 v25, v90, v91
    v_cvt_pk_bf16_f32 v26, v92, v93
    v_cvt_pk_bf16_f32 v27, v94, v95
    buffer_store_dwordx4 v[24:27], v5, s[16:19], s29 offen offset:3072
pre_kernel_exit:
    s_endpgm
pre_kernel_pf:
    s_load_dwordx2 s[4:5], s[0:1], 24
    s_load_dwordx2 s[6:7], s[0:1], 32
    s_load_dwordx2 s[8:9], s[0:1], 16
    s_load_dwordx2 s[10:11], s[0:1], 40
    s_sub_u32 s2, s2, 256
    s_lshr_b32 s3, s2, 6
    s_and_b32 s2, s2, 63
    s_waitcnt lgkmcnt(0)
    s_cmp_eq_u32 s3, 1
    s_cselect_b32 s12, s6, s4
    s_cselect_b32 s13, s7, s5
    s_cmp_eq_u32 s3, 2
    s_cselect_b32 s12, s8, s12
    s_cselect_b32 s13, s9, s13
    s_cmp_eq_u32 s3, 3
    s_cselect_b32 s12, s10, s12
    s_cselect_b32 s13, s11, s13
    s_mov_b32 s14, 8388608
    s_mov_b32 s15, 0x20000
    s_lshl_b32 s2, s2, 17
    v_lshlrev_b32 v1, 4, v0

    buffer_load_dwordx4 v[4:7], v1, s[12:15], s2 offen
    s_add_u32 s2, s2, 4096
    buffer_load_dwordx4 v[8:11], v1, s[12:15], s2 offen
    s_add_u32 s2, s2, 4096
    buffer_load_dwordx4 v[12:15], v1, s[12:15], s2 offen
    s_add_u32 s2, s2, 4096
    buffer_load_dwordx4 v[16:19], v1, s[12:15], s2 offen
    s_add_u32 s2, s2, 4096
    buffer_load_dwordx4 v[20:23], v1, s[12:15], s2 offen
    s_add_u32 s2, s2, 4096
    buffer_load_dwordx4 v[24:27], v1, s[12:15], s2 offen
    s_add_u32 s2, s2, 4096
    buffer_load_dwordx4 v[28:31], v1, s[12:15], s2 offen
    s_add_u32 s2, s2, 4096
    buffer_load_dwordx4 v[32:35], v1, s[12:15], s2 offen
    s_add_u32 s2, s2, 4096
    buffer_load_dwordx4 v[36:39], v1, s[12:15], s2 offen
    s_add_u32 s2, s2, 4096
    buffer_load_dwordx4 v[40:43], v1, s[12:15], s2 offen
    s_add_u32 s2, s2, 4096
    buffer_load_dwordx4 v[44:47], v1, s[12:15], s2 offen
    s_add_u32 s2, s2, 4096
    buffer_load_dwordx4 v[48:51], v1, s[12:15], s2 offen
    s_add_u32 s2, s2, 4096
    buffer_load_dwordx4 v[52:55], v1, s[12:15], s2 offen
    s_add_u32 s2, s2, 4096
    buffer_load_dwordx4 v[56:59], v1, s[12:15], s2 offen
    s_add_u32 s2, s2, 4096
    buffer_load_dwordx4 v[60:63], v1, s[12:15], s2 offen
    s_add_u32 s2, s2, 4096
    buffer_load_dwordx4 v[64:67], v1, s[12:15], s2 offen
    s_add_u32 s2, s2, 4096
    buffer_load_dwordx4 v[68:71], v1, s[12:15], s2 offen
    s_add_u32 s2, s2, 4096
    buffer_load_dwordx4 v[72:75], v1, s[12:15], s2 offen
    s_add_u32 s2, s2, 4096
    buffer_load_dwordx4 v[76:79], v1, s[12:15], s2 offen
    s_add_u32 s2, s2, 4096
    buffer_load_dwordx4 v[80:83], v1, s[12:15], s2 offen
    s_add_u32 s2, s2, 4096
    buffer_load_dwordx4 v[84:87], v1, s[12:15], s2 offen
    s_add_u32 s2, s2, 4096
    buffer_load_dwordx4 v[88:91], v1, s[12:15], s2 offen
    s_add_u32 s2, s2, 4096
    buffer_load_dwordx4 v[92:95], v1, s[12:15], s2 offen
    s_add_u32 s2, s2, 4096
    buffer_load_dwordx4 v[96:99], v1, s[12:15], s2 offen
    s_add_u32 s2, s2, 4096
    buffer_load_dwordx4 v[100:103], v1, s[12:15], s2 offen
    s_add_u32 s2, s2, 4096
    buffer_load_dwordx4 v[104:107], v1, s[12:15], s2 offen
    s_add_u32 s2, s2, 4096
    buffer_load_dwordx4 v[108:111], v1, s[12:15], s2 offen
    s_add_u32 s2, s2, 4096
    buffer_load_dwordx4 v[112:115], v1, s[12:15], s2 offen
    s_add_u32 s2, s2, 4096
    buffer_load_dwordx4 v[116:119], v1, s[12:15], s2 offen
    s_add_u32 s2, s2, 4096
    buffer_load_dwordx4 v[120:123], v1, s[12:15], s2 offen
    s_add_u32 s2, s2, 4096
    buffer_load_dwordx4 v[124:127], v1, s[12:15], s2 offen
    s_add_u32 s2, s2, 4096
    buffer_load_dwordx4 v[128:131], v1, s[12:15], s2 offen
    s_add_u32 s2, s2, 4096
    s_waitcnt vmcnt(0)
    s_endpgm
.globl mega_kernel
.p2align 8
.type mega_kernel,@function
mega_kernel:

    s_cmp_ge_u32 s2, 256
    s_cbranch_scc1 mega_kernel_exit

    s_load_dwordx2 s[4:5], s[0:1], 120
    s_load_dwordx2 s[6:7], s[0:1], 128
    s_getreg_b32 s38, hwreg(HW_REG_XCC_ID)
    s_and_b32 s38, s38, 7
    v_and_b32 v1, 63, v0
    v_lshrrev_b32 v5, 6, v0
    s_nop 0
    v_readfirstlane_b32 s20, v5
    v_and_b32 v2, 15, v1
    v_lshrrev_b32 v3, 4, v1
    v_lshlrev_b32 v4, 4, v1
    s_waitcnt lgkmcnt(0)
    s_mov_b32 s8, s6
    s_mov_b32 s9, s7
    s_mov_b32 s10, 268435456
    s_mov_b32 s11, 0x20000
    s_mov_b32 s16, s4
    s_mov_b32 s17, s5
    s_mov_b32 s18, 256
    s_mov_b32 s19, 0x20000
    s_cmp_eq_u32 s20, 0
    s_cbranch_scc1 mega_kernel_w0

    s_branch mega_kernel_tk
mega_kernel_w0:
    s_mov_b64 s[42:43], exec
    s_mov_b64 exec, 1
    v_mov_b32 v5, 1
    s_lshl_b32 s30, s38, 2
    v_mov_b32 v6, s30
    v_mov_b32 v7, 1
    v_mov_b32 v8, 32
    buffer_atomic_add v5, v6, s[16:19], 0 offen sc0
    buffer_atomic_add v7, v8, s[16:19], 0 offen sc0
    s_mov_b32 s31, 4000000
mega_kernel_cen:
    buffer_load_dword v9, v8, s[16:19], 0 offen sc1
    s_waitcnt vmcnt(0)
    v_readfirstlane_b32 s36, v9
    s_cmp_ge_u32 s36, 256
    s_cbranch_scc1 mega_kernel_cenok
    s_sub_u32 s31, s31, 1
    s_cbranch_scc1 mega_kernel_exit
    s_branch mega_kernel_cen
mega_kernel_cenok:
    v_mov_b32 v8, 0
    buffer_load_dwordx4 v[12:15], v8, s[16:19], 0 offen sc1
    buffer_load_dwordx4 v[16:19], v8, s[16:19], 0 offen offset:16 sc1
    s_waitcnt vmcnt(0)
    v_min_u32 v12, v12, v13
    v_min_u32 v14, v14, v15
    v_min_u32 v16, v16, v17
    v_min_u32 v18, v18, v19
    v_min_u32 v12, v12, v14
    v_min_u32 v16, v16, v18
    v_min_u32 v12, v12, v16
    v_cmp_gt_u32 vcc, 32, v12
    s_nop 1
    v_lshrrev_b32 v9, 5, v7
    v_lshlrev_b32 v9, 16, v9
    v_and_b32 v10, 31, v7
    v_or_b32 v9, v9, v10
    v_or_b32 v9, 0x100, v9
    v_mov_b32 v10, s38
    v_lshlrev_b32 v10, 16, v10
    v_or_b32 v10, v10, v5
    v_cndmask_b32 v5, v10, v9, vcc
    v_mov_b32 v6, 131072
    ds_write_b32 v6, v5
    s_waitcnt lgkmcnt(0)
    s_mov_b64 exec, s[42:43]
mega_kernel_tk:
    s_waitcnt vmcnt(0)
    s_barrier
    v_mov_b32 v6, 131072
    ds_read_b32 v5, v6

    s_waitcnt lgkmcnt(0)
    s_nop 0
    v_readfirstlane_b32 s31, v5
    s_nop 3
    s_barrier
    s_lshr_b32 s38, s31, 16
    s_and_b32 s3, s31, 0x100
    s_and_b32 s30, s31, 0xff
    s_cmp_lt_u32 s30, 16
    s_cbranch_scc1 mega_kernel_chain
    s_mov_b32 s61, s30

    s_cmp_ge_u32 s61, 27
    s_cbranch_scc1 mega_kernel_w_tail0
    s_mov_b32 s39, 0
mega_kernel_w_init:
    s_load_dwordx2 s[44:45], s[0:1], 16
    s_load_dwordx2 s[46:47], s[0:1], 24
    s_load_dwordx2 s[48:49], s[0:1], 32
    s_load_dwordx2 s[50:51], s[0:1], 40
    s_load_dwordx2 s[52:53], s[0:1], 0
    s_lshr_b32 s21, s20, 1
    s_and_b32 s22, s20, 1
    s_mov_b32 s40, 2000000
    s_mov_b32 s54, 0x3e0293ee
    s_mov_b32 s41, 0
    s_waitcnt lgkmcnt(0)
    s_mov_b32 s62, -1

    s_cmp_eq_u32 s39, -2
    s_cbranch_scc1 mega_kernel_w_g4s
    s_cmp_eq_u32 s39, -3
    s_cbranch_scc0 mega_kernel_w_next
    s_add_u32 s34, s55, 38
    s_mov_b32 s55, 15
    s_mov_b32 s60, 1
    s_branch mega_kernel_w_attgo
mega_kernel_w_next:
    s_waitcnt vmcnt(0) lgkmcnt(0)
    s_barrier
    s_cmp_lg_u32 s20, 0
    s_cbranch_scc1 mega_kernel_w_nf
    s_mov_b64 s[42:43], exec
    s_mov_b64 exec, 1

    v_mov_b32 v5, 0
    v_mov_b32 v6, 1
    s_cmp_eq_u32 s41, 0
    s_cbranch_scc1 mega_kernel_w_nosig
    s_and_b32 s30, s41, 0xfffffffe
    s_bitcmp1_b32 s41, 0
    s_cbranch_scc0 mega_kernel_w_sig1
    v_mov_b32 v6, 2
    buffer_atomic_add v6, v5, s[8:11], s30 offen offset:128
mega_kernel_w_sig1:
    buffer_atomic_add v6, v5, s[8:11], s30 offen
mega_kernel_w_nosig:
    s_cmp_eq_u32 s39, -20
    s_cbranch_scc1 mega_kernel_w_nofetch
    v_mov_b32 v7, 1
    s_lshl_b32 s30, s38, 7
    s_add_u32 s30, s30, 32768
    buffer_atomic_add v7, v5, s[8:11], s30 offen sc0
    s_waitcnt vmcnt(0)
    v_mov_b32 v5, 131072
    ds_write_b32 v5, v7
    s_waitcnt lgkmcnt(0)
mega_kernel_w_nofetch:
    s_mov_b64 exec, s[42:43]
mega_kernel_w_nf:
    s_cmp_eq_u32 s39, -20
    s_cbranch_scc1 mega_kernel_w_t_g6
    s_barrier
    v_mov_b32 v5, 131072
    ds_read_b32 v6, v5
    s_waitcnt lgkmcnt(0)
    s_nop 0
    v_readfirstlane_b32 s39, v6
    s_mov_b32 s41, 0
    s_nop 2

    s_cmp_lt_u32 s39, 16
    s_cbranch_scc1 mega_kernel_w_kvs

    s_cmp_lt_u32 s39, 44
    s_cbranch_scc1 mega_kernel_w_kvb
    s_cmp_lt_u32 s39, 60
    s_cbranch_scc1 mega_kernel_w_qb
    s_sub_u32 s39, s39, 60

    s_cmp_ge_u32 s39, 48
    s_cbranch_scc1 mega_kernel_w_tail
    s_lshr_b32 s30, s39, 2
    s_mov_b32 s31, 0
    s_cmp_eq_u32 s30, 0
    s_cselect_b32 s31, 0x2200100, s31
    s_cmp_eq_u32 s30, 1
    s_cselect_b32 s31, 0x22038021, s31
    s_cmp_eq_u32 s30, 2
    s_cselect_b32 s31, 0x5812304, s31
    s_cmp_eq_u32 s30, 3
    s_cselect_b32 s31, 0x82250624, s31
    s_cmp_eq_u32 s30, 4
    s_cselect_b32 s31, 0x27082607, s31
    s_cmp_eq_u32 s30, 5
    s_cselect_b32 s31, 0x60280983, s31
    s_cmp_eq_u32 s30, 6
    s_cselect_b32 s31, 0xa636261, s31
    s_cmp_eq_u32 s30, 7
    s_cselect_b32 s31, 0x2a0b8429, s31
    s_cmp_eq_u32 s30, 8
    s_cselect_b32 s31, 0xd852b0c, s31
    s_cmp_eq_u32 s30, 9
    s_cselect_b32 s31, 0x2d0f0e2c, s31
    s_cmp_eq_u32 s30, 10
    s_cselect_b32 s31, 0x4b4a4948, s31
    s_cmp_eq_u32 s30, 11
    s_cselect_b32 s31, 0x4f4e4d4c, s31
    s_and_b32 s30, s39, 3
    s_lshl_b32 s30, s30, 3
    s_lshr_b32 s31, s31, s30
    s_and_b32 s55, s31, 31
    s_bfe_u32 s31, s31, 0x30005
    s_cmp_eq_u32 s31, 0
    s_cbranch_scc1 mega_kernel_w_att
    s_cmp_eq_u32 s31, 1
    s_cbranch_scc1 mega_kernel_w_g4
    s_cmp_eq_u32 s31, 2
    s_cbranch_scc1 mega_kernel_w_g4s
    s_cmp_eq_u32 s31, 4
    s_cbranch_scc1 mega_kernel_w_ln
    s_cmp_eq_u32 s31, 5
    s_cbranch_scc1 mega_kernel_w_g5a
    s_branch mega_kernel_w_pf

mega_kernel_w_kvs:
    s_lshr_b32 s32, s39, 2
    s_and_b32 s32, s32, 1
    s_add_u32 s32, s32, 1
    s_and_b32 s33, s39, 3
    s_lshl_b32 s30, s38, 2
    s_add_u32 s33, s33, s30
    s_lshr_b32 s31, s39, 3
    s_lshl_b32 s24, s31, 3
    s_lshl_b32 s41, s38, 4
    s_add_u32 s41, s41, s31
    s_lshl_b32 s41, s41, 7
    s_add_u32 s41, s41, 33792

    s_cmp_eq_u32 s32, 2
    s_cbranch_scc1 mega_kernel_w_kvs_v

    s_mov_b32 s12, s46
    s_mov_b32 s13, s47
    s_mov_b32 s14, 8388608
    s_mov_b32 s15, 0x20000
    s_lshl_b32 s28, s20, 12
    v_lshrrev_b32 v5, 4, v1
    s_lshl_b32 s30, s20, 4
    v_add_u32 v5, s30, v5
    v_and_b32 v6, 15, v1
    s_mov_b32 s31, 8192
    v_add_u32 v7, 0, v5
    v_and_b32 v8, 7, v7
    v_lshlrev_b32 v8, 1, v8
    v_xor_b32 v8, v8, v6
    v_lshlrev_b32 v8, 4, v8
    v_mul_lo_u32 v7, v7, s31
    v_add_u32 v8, v8, v7
    v_add_u32 v7, 4, v5
    v_and_b32 v9, 7, v7
    v_lshlrev_b32 v9, 1, v9
    v_xor_b32 v9, v9, v6
    v_lshlrev_b32 v9, 4, v9
    v_mul_lo_u32 v7, v7, s31
    v_add_u32 v9, v9, v7
    v_subrev_u32 v9, 1024, v9
    v_add_u32 v7, 8, v5
    v_and_b32 v10, 7, v7
    v_lshlrev_b32 v10, 1, v10
    v_xor_b32 v10, v10, v6
    v_lshlrev_b32 v10, 4, v10
    v_mul_lo_u32 v7, v7, s31
    v_add_u32 v10, v10, v7
    v_subrev_u32 v10, 2048, v10
    v_add_u32 v7, 12, v5
    v_and_b32 v11, 7, v7
    v_lshlrev_b32 v11, 1, v11
    v_xor_b32 v11, v11, v6
    v_lshlrev_b32 v11, 4, v11
    v_mul_lo_u32 v7, v7, s31
    v_add_u32 v11, v11, v7
    v_subrev_u32 v11, 3072, v11
    v_lshrrev_b32 v5, 2, v2
    v_lshl_add_u32 v5, v3, 2, v5
    v_and_b32 v6, 7, v5
    v_lshlrev_b32 v6, 5, v6
    v_lshlrev_b32 v5, 8, v5
    v_and_b32 v7, 3, v2
    v_lshl_add_u32 v5, v7, 3, v5
    v_xor_b32 v14, 0, v6
    v_add_u32 v14, v14, v5
    v_add_u32 v22, 0x10000, v14
    v_xor_b32 v15, 32, v6
    v_add_u32 v15, v15, v5
    v_add_u32 v23, 0x10000, v15
    v_xor_b32 v16, 64, v6
    v_add_u32 v16, v16, v5
    v_add_u32 v24, 0x10000, v16
    v_xor_b32 v17, 96, v6
    v_add_u32 v17, v17, v5
    v_add_u32 v25, 0x10000, v17
    v_xor_b32 v18, 128, v6
    v_add_u32 v18, v18, v5
    v_add_u32 v26, 0x10000, v18
    v_xor_b32 v19, 160, v6
    v_add_u32 v19, v19, v5
    v_add_u32 v27, 0x10000, v19
    v_xor_b32 v20, 192, v6
    v_add_u32 v20, v20, v5
    v_add_u32 v28, 0x10000, v20
    v_xor_b32 v21, 224, v6
    v_add_u32 v21, v21, v5
    v_add_u32 v29, 0x10000, v21
    s_mul_i32 s30, s20, 65536
    v_add_u32 v12, s30, v4
    v_add_u32 v13, 32768, v12
    s_lshl_b32 s25, s24, 15
    s_add_u32 s25, s25, 2523136
    s_lshl_b32 s26, s33, 8

    s_add_u32 m0, s28, 0
    s_nop 0
    buffer_load_dwordx4 v8, s[12:15], s26 offen offset:0 lds
    buffer_load_dwordx4 v9, s[12:15], s26 offen offset:1024 lds
    buffer_load_dwordx4 v10, s[12:15], s26 offen offset:2048 lds
    buffer_load_dwordx4 v11, s[12:15], s26 offen offset:3072 lds
    s_add_u32 s26, s26, 524288
    buffer_load_dwordx4 v[96:99], v12, s[8:11], s25 offen sc1
    buffer_load_dwordx4 v[100:103], v13, s[8:11], s25 offen sc1
    s_add_u32 s25, s25, 1024
    buffer_load_dwordx4 v[104:107], v12, s[8:11], s25 offen sc1
    buffer_load_dwordx4 v[108:111], v13, s[8:11], s25 offen sc1
    s_add_u32 s25, s25, 1024
    s_add_u32 m0, s28, 16384
    s_nop 0
    buffer_load_dwordx4 v8, s[12:15], s26 offen offset:0 lds
    buffer_load_dwordx4 v9, s[12:15], s26 offen offset:1024 lds
    buffer_load_dwordx4 v10, s[12:15], s26 offen offset:2048 lds
    buffer_load_dwordx4 v11, s[12:15], s26 offen offset:3072 lds
    s_add_u32 s26, s26, 524288
    buffer_load_dwordx4 v[112:115], v12, s[8:11], s25 offen sc1
    buffer_load_dwordx4 v[116:119], v13, s[8:11], s25 offen sc1
    s_add_u32 s25, s25, 1024
    buffer_load_dwordx4 v[120:123], v12, s[8:11], s25 offen sc1
    buffer_load_dwordx4 v[124:127], v13, s[8:11], s25 offen sc1
    s_add_u32 s25, s25, 1024
    s_add_u32 m0, s28, 32768
    s_nop 0
    buffer_load_dwordx4 v8, s[12:15], s26 offen offset:0 lds
    buffer_load_dwordx4 v9, s[12:15], s26 offen offset:1024 lds
    buffer_load_dwordx4 v10, s[12:15], s26 offen offset:2048 lds
    buffer_load_dwordx4 v11, s[12:15], s26 offen offset:3072 lds
    s_add_u32 s26, s26, 524288
    buffer_load_dwordx4 v[128:131], v12, s[8:11], s25 offen sc1
    buffer_load_dwordx4 v[132:135], v13, s[8:11], s25 offen sc1
    s_add_u32 s25, s25, 1024
    buffer_load_dwordx4 v[136:139], v12, s[8:11], s25 offen sc1
    buffer_load_dwordx4 v[140:143], v13, s[8:11], s25 offen sc1
    s_add_u32 s25, s25, 1024
    s_add_u32 m0, s28, 49152
    s_nop 0
    buffer_load_dwordx4 v8, s[12:15], s26 offen offset:0 lds
    buffer_load_dwordx4 v9, s[12:15], s26 offen offset:1024 lds
    buffer_load_dwordx4 v10, s[12:15], s26 offen offset:2048 lds
    buffer_load_dwordx4 v11, s[12:15], s26 offen offset:3072 lds
    s_add_u32 s26, s26, 524288
    buffer_load_dwordx4 v[144:147], v12, s[8:11], s25 offen sc1
    buffer_load_dwordx4 v[148:151], v13, s[8:11], s25 offen sc1
    s_add_u32 s25, s25, 1024
    buffer_load_dwordx4 v[152:155], v12, s[8:11], s25 offen sc1
    buffer_load_dwordx4 v[156:159], v13, s[8:11], s25 offen sc1
    s_add_u32 s25, s25, 1024
    s_add_u32 m0, s28, 65536
    s_nop 0
    buffer_load_dwordx4 v8, s[12:15], s26 offen offset:0 lds
    buffer_load_dwordx4 v9, s[12:15], s26 offen offset:1024 lds
    buffer_load_dwordx4 v10, s[12:15], s26 offen offset:2048 lds
    buffer_load_dwordx4 v11, s[12:15], s26 offen offset:3072 lds
    s_add_u32 s26, s26, 524288
    buffer_load_dwordx4 v[160:163], v12, s[8:11], s25 offen sc1
    buffer_load_dwordx4 v[164:167], v13, s[8:11], s25 offen sc1
    s_add_u32 s25, s25, 1024
    buffer_load_dwordx4 v[168:171], v12, s[8:11], s25 offen sc1
    buffer_load_dwordx4 v[172:175], v13, s[8:11], s25 offen sc1
    s_add_u32 s25, s25, 1024
    s_add_u32 m0, s28, 81920
    s_nop 0
    buffer_load_dwordx4 v8, s[12:15], s26 offen offset:0 lds
    buffer_load_dwordx4 v9, s[12:15], s26 offen offset:1024 lds
    buffer_load_dwordx4 v10, s[12:15], s26 offen offset:2048 lds
    buffer_load_dwordx4 v11, s[12:15], s26 offen offset:3072 lds
    s_add_u32 s26, s26, 524288
    buffer_load_dwordx4 v[176:179], v12, s[8:11], s25 offen sc1
    buffer_load_dwordx4 v[180:183], v13, s[8:11], s25 offen sc1
    s_add_u32 s25, s25, 1024
    buffer_load_dwordx4 v[184:187], v12, s[8:11], s25 offen sc1
    buffer_load_dwordx4 v[188:191], v13, s[8:11], s25 offen sc1
    s_add_u32 s25, s25, 1024
    s_add_u32 m0, s28, 98304
    s_nop 0
    buffer_load_dwordx4 v8, s[12:15], s26 offen offset:0 lds
    buffer_load_dwordx4 v9, s[12:15], s26 offen offset:1024 lds
    buffer_load_dwordx4 v10, s[12:15], s26 offen offset:2048 lds
    buffer_load_dwordx4 v11, s[12:15], s26 offen offset:3072 lds
    s_add_u32 s26, s26, 524288
    buffer_load_dwordx4 v[192:195], v12, s[8:11], s25 offen sc1
    buffer_load_dwordx4 v[196:199], v13, s[8:11], s25 offen sc1
    s_add_u32 s25, s25, 1024
    buffer_load_dwordx4 v[200:203], v12, s[8:11], s25 offen sc1
    buffer_load_dwordx4 v[204:207], v13, s[8:11], s25 offen sc1
    s_add_u32 s25, s25, 1024
    s_add_u32 m0, s28, 114688
    s_nop 0
    buffer_load_dwordx4 v8, s[12:15], s26 offen offset:0 lds
    buffer_load_dwordx4 v9, s[12:15], s26 offen offset:1024 lds
    buffer_load_dwordx4 v10, s[12:15], s26 offen offset:2048 lds
    buffer_load_dwordx4 v11, s[12:15], s26 offen offset:3072 lds
    s_add_u32 s26, s26, 524288
    buffer_load_dwordx4 v[208:211], v12, s[8:11], s25 offen sc1
    buffer_load_dwordx4 v[212:215], v13, s[8:11], s25 offen sc1
    s_add_u32 s25, s25, 1024
    v_accvgpr_write_b32 a0, 0
    v_accvgpr_write_b32 a1, 0
    v_accvgpr_write_b32 a2, 0
    v_accvgpr_write_b32 a3, 0
    v_accvgpr_write_b32 a4, 0
    v_accvgpr_write_b32 a5, 0
    v_accvgpr_write_b32 a6, 0
    v_accvgpr_write_b32 a7, 0
    v_accvgpr_write_b32 a8, 0
    v_accvgpr_write_b32 a9, 0
    v_accvgpr_write_b32 a10, 0
    v_accvgpr_write_b32 a11, 0
    v_accvgpr_write_b32 a12, 0
    v_accvgpr_write_b32 a13, 0
    v_accvgpr_write_b32 a14, 0
    v_accvgpr_write_b32 a15, 0
    v_accvgpr_write_b32 a16, 0
    v_accvgpr_write_b32 a17, 0
    v_accvgpr_write_b32 a18, 0
    v_accvgpr_write_b32 a19, 0
    v_accvgpr_write_b32 a20, 0
    v_accvgpr_write_b32 a21, 0
    v_accvgpr_write_b32 a22, 0
    v_accvgpr_write_b32 a23, 0
    v_accvgpr_write_b32 a24, 0
    v_accvgpr_write_b32 a25, 0
    v_accvgpr_write_b32 a26, 0
    v_accvgpr_write_b32 a27, 0
    v_accvgpr_write_b32 a28, 0
    v_accvgpr_write_b32 a29, 0
    v_accvgpr_write_b32 a30, 0
    v_accvgpr_write_b32 a31, 0
    v_accvgpr_write_b32 a32, 0
    v_accvgpr_write_b32 a33, 0
    v_accvgpr_write_b32 a34, 0
    v_accvgpr_write_b32 a35, 0
    v_accvgpr_write_b32 a36, 0
    v_accvgpr_write_b32 a37, 0
    v_accvgpr_write_b32 a38, 0
    v_accvgpr_write_b32 a39, 0
    v_accvgpr_write_b32 a40, 0
    v_accvgpr_write_b32 a41, 0
    v_accvgpr_write_b32 a42, 0
    v_accvgpr_write_b32 a43, 0
    v_accvgpr_write_b32 a44, 0
    v_accvgpr_write_b32 a45, 0
    v_accvgpr_write_b32 a46, 0
    v_accvgpr_write_b32 a47, 0
    v_accvgpr_write_b32 a48, 0
    v_accvgpr_write_b32 a49, 0
    v_accvgpr_write_b32 a50, 0
    v_accvgpr_write_b32 a51, 0
    v_accvgpr_write_b32 a52, 0
    v_accvgpr_write_b32 a53, 0
    v_accvgpr_write_b32 a54, 0
    v_accvgpr_write_b32 a55, 0
    v_accvgpr_write_b32 a56, 0
    v_accvgpr_write_b32 a57, 0
    v_accvgpr_write_b32 a58, 0
    v_accvgpr_write_b32 a59, 0
    v_accvgpr_write_b32 a60, 0
    v_accvgpr_write_b32 a61, 0
    v_accvgpr_write_b32 a62, 0
    v_accvgpr_write_b32 a63, 0
    s_mov_b32 s27, 2
    s_waitcnt vmcnt(58)
    s_barrier
    ds_read_b64_tr_b16 v[32:33], v14 offset:0
    ds_read_b64_tr_b16 v[34:35], v14 offset:4096
    ds_read_b64_tr_b16 v[36:37], v15 offset:0
    ds_read_b64_tr_b16 v[38:39], v15 offset:4096
    ds_read_b64_tr_b16 v[40:41], v16 offset:0
    ds_read_b64_tr_b16 v[42:43], v16 offset:4096
    ds_read_b64_tr_b16 v[44:45], v17 offset:0
    ds_read_b64_tr_b16 v[46:47], v17 offset:4096
    ds_read_b64_tr_b16 v[48:49], v18 offset:0
    ds_read_b64_tr_b16 v[50:51], v18 offset:4096
    ds_read_b64_tr_b16 v[52:53], v19 offset:0
    ds_read_b64_tr_b16 v[54:55], v19 offset:4096
    ds_read_b64_tr_b16 v[56:57], v20 offset:0
    ds_read_b64_tr_b16 v[58:59], v20 offset:4096
    ds_read_b64_tr_b16 v[60:61], v21 offset:0
    ds_read_b64_tr_b16 v[62:63], v21 offset:4096
mega_kernel_w_sk_loop:
    s_waitcnt vmcnt(56) lgkmcnt(0)
    v_mfma_f32_16x16x32_bf16 a[0:3], v[32:35], v[96:99], a[0:3]
    ds_read_b64_tr_b16 v[64:65], v14 offset:8192
    ds_read_b64_tr_b16 v[66:67], v14 offset:12288
    v_mfma_f32_16x16x32_bf16 a[4:7], v[32:35], v[100:103], a[4:7]
    ds_read_b64_tr_b16 v[68:69], v15 offset:8192
    ds_read_b64_tr_b16 v[70:71], v15 offset:12288
    v_mfma_f32_16x16x32_bf16 a[8:11], v[36:39], v[96:99], a[8:11]
    ds_read_b64_tr_b16 v[72:73], v16 offset:8192
    ds_read_b64_tr_b16 v[74:75], v16 offset:12288
    v_mfma_f32_16x16x32_bf16 a[12:15], v[36:39], v[100:103], a[12:15]
    ds_read_b64_tr_b16 v[76:77], v17 offset:8192
    ds_read_b64_tr_b16 v[78:79], v17 offset:12288
    v_mfma_f32_16x16x32_bf16 a[16:19], v[40:43], v[96:99], a[16:19]
    ds_read_b64_tr_b16 v[80:81], v18 offset:8192
    ds_read_b64_tr_b16 v[82:83], v18 offset:12288
    v_mfma_f32_16x16x32_bf16 a[20:23], v[40:43], v[100:103], a[20:23]
    ds_read_b64_tr_b16 v[84:85], v19 offset:8192
    ds_read_b64_tr_b16 v[86:87], v19 offset:12288
    v_mfma_f32_16x16x32_bf16 a[24:27], v[44:47], v[96:99], a[24:27]
    ds_read_b64_tr_b16 v[88:89], v20 offset:8192
    ds_read_b64_tr_b16 v[90:91], v20 offset:12288
    v_mfma_f32_16x16x32_bf16 a[28:31], v[44:47], v[100:103], a[28:31]
    ds_read_b64_tr_b16 v[92:93], v21 offset:8192
    ds_read_b64_tr_b16 v[94:95], v21 offset:12288
    v_mfma_f32_16x16x32_bf16 a[32:35], v[48:51], v[96:99], a[32:35]
    buffer_load_dwordx4 v[216:219], v12, s[8:11], s25 offen sc1
    buffer_load_dwordx4 v[220:223], v13, s[8:11], s25 offen sc1
    v_mfma_f32_16x16x32_bf16 a[36:39], v[48:51], v[100:103], a[36:39]
    s_add_u32 s25, s25, 1024
    v_mfma_f32_16x16x32_bf16 a[40:43], v[52:55], v[96:99], a[40:43]
    v_mfma_f32_16x16x32_bf16 a[44:47], v[52:55], v[100:103], a[44:47]
    v_mfma_f32_16x16x32_bf16 a[48:51], v[56:59], v[96:99], a[48:51]
    v_mfma_f32_16x16x32_bf16 a[52:55], v[56:59], v[100:103], a[52:55]
    v_mfma_f32_16x16x32_bf16 a[56:59], v[60:63], v[96:99], a[56:59]
    v_mfma_f32_16x16x32_bf16 a[60:63], v[60:63], v[100:103], a[60:63]
    s_waitcnt vmcnt(50) lgkmcnt(0)
    s_barrier
    v_mfma_f32_16x16x32_bf16 a[0:3], v[64:67], v[104:107], a[0:3]
    ds_read_b64_tr_b16 v[32:33], v14 offset:16384
    ds_read_b64_tr_b16 v[34:35], v14 offset:20480
    v_mfma_f32_16x16x32_bf16 a[4:7], v[64:67], v[108:111], a[4:7]
    ds_read_b64_tr_b16 v[36:37], v15 offset:16384
    ds_read_b64_tr_b16 v[38:39], v15 offset:20480
    v_mfma_f32_16x16x32_bf16 a[8:11], v[68:71], v[104:107], a[8:11]
    ds_read_b64_tr_b16 v[40:41], v16 offset:16384
    ds_read_b64_tr_b16 v[42:43], v16 offset:20480
    v_mfma_f32_16x16x32_bf16 a[12:15], v[68:71], v[108:111], a[12:15]
    ds_read_b64_tr_b16 v[44:45], v17 offset:16384
    ds_read_b64_tr_b16 v[46:47], v17 offset:20480
    v_mfma_f32_16x16x32_bf16 a[16:19], v[72:75], v[104:107], a[16:19]
    ds_read_b64_tr_b16 v[48:49], v18 offset:16384
    ds_read_b64_tr_b16 v[50:51], v18 offset:20480
    v_mfma_f32_16x16x32_bf16 a[20:23], v[72:75], v[108:111], a[20:23]
    ds_read_b64_tr_b16 v[52:53], v19 offset:16384
    ds_read_b64_tr_b16 v[54:55], v19 offset:20480
    v_mfma_f32_16x16x32_bf16 a[24:27], v[76:79], v[104:107], a[24:27]
    ds_read_b64_tr_b16 v[56:57], v20 offset:16384
    ds_read_b64_tr_b16 v[58:59], v20 offset:20480
    v_mfma_f32_16x16x32_bf16 a[28:31], v[76:79], v[108:111], a[28:31]
    ds_read_b64_tr_b16 v[60:61], v21 offset:16384
    ds_read_b64_tr_b16 v[62:63], v21 offset:20480
    v_mfma_f32_16x16x32_bf16 a[32:35], v[80:83], v[104:107], a[32:35]
    buffer_load_dwordx4 v[96:99], v12, s[8:11], s25 offen sc1
    buffer_load_dwordx4 v[100:103], v13, s[8:11], s25 offen sc1
    v_mfma_f32_16x16x32_bf16 a[36:39], v[80:83], v[108:111], a[36:39]
    s_add_u32 s25, s25, 1024
    s_add_u32 m0, s28, 0
    v_mfma_f32_16x16x32_bf16 a[40:43], v[84:87], v[104:107], a[40:43]
    s_nop 0
    buffer_load_dwordx4 v8, s[12:15], s26 offen offset:0 lds
    v_mfma_f32_16x16x32_bf16 a[44:47], v[84:87], v[108:111], a[44:47]
    buffer_load_dwordx4 v9, s[12:15], s26 offen offset:1024 lds
    buffer_load_dwordx4 v10, s[12:15], s26 offen offset:2048 lds
    v_mfma_f32_16x16x32_bf16 a[48:51], v[88:91], v[104:107], a[48:51]
    buffer_load_dwordx4 v11, s[12:15], s26 offen offset:3072 lds
    s_add_u32 s26, s26, 524288
    v_mfma_f32_16x16x32_bf16 a[52:55], v[88:91], v[108:111], a[52:55]
    v_mfma_f32_16x16x32_bf16 a[56:59], v[92:95], v[104:107], a[56:59]
    v_mfma_f32_16x16x32_bf16 a[60:63], v[92:95], v[108:111], a[60:63]
    s_waitcnt vmcnt(56) lgkmcnt(0)
    v_mfma_f32_16x16x32_bf16 a[0:3], v[32:35], v[112:115], a[0:3]
    ds_read_b64_tr_b16 v[64:65], v14 offset:24576
    ds_read_b64_tr_b16 v[66:67], v14 offset:28672
    v_mfma_f32_16x16x32_bf16 a[4:7], v[32:35], v[116:119], a[4:7]
    ds_read_b64_tr_b16 v[68:69], v15 offset:24576
    ds_read_b64_tr_b16 v[70:71], v15 offset:28672
    v_mfma_f32_16x16x32_bf16 a[8:11], v[36:39], v[112:115], a[8:11]
    ds_read_b64_tr_b16 v[72:73], v16 offset:24576
    ds_read_b64_tr_b16 v[74:75], v16 offset:28672
    v_mfma_f32_16x16x32_bf16 a[12:15], v[36:39], v[116:119], a[12:15]
    ds_read_b64_tr_b16 v[76:77], v17 offset:24576
    ds_read_b64_tr_b16 v[78:79], v17 offset:28672
    v_mfma_f32_16x16x32_bf16 a[16:19], v[40:43], v[112:115], a[16:19]
    ds_read_b64_tr_b16 v[80:81], v18 offset:24576
    ds_read_b64_tr_b16 v[82:83], v18 offset:28672
    v_mfma_f32_16x16x32_bf16 a[20:23], v[40:43], v[116:119], a[20:23]
    ds_read_b64_tr_b16 v[84:85], v19 offset:24576
    ds_read_b64_tr_b16 v[86:87], v19 offset:28672
    v_mfma_f32_16x16x32_bf16 a[24:27], v[44:47], v[112:115], a[24:27]
    ds_read_b64_tr_b16 v[88:89], v20 offset:24576
    ds_read_b64_tr_b16 v[90:91], v20 offset:28672
    v_mfma_f32_16x16x32_bf16 a[28:31], v[44:47], v[116:119], a[28:31]
    ds_read_b64_tr_b16 v[92:93], v21 offset:24576
    ds_read_b64_tr_b16 v[94:95], v21 offset:28672
    v_mfma_f32_16x16x32_bf16 a[32:35], v[48:51], v[112:115], a[32:35]
    buffer_load_dwordx4 v[104:107], v12, s[8:11], s25 offen sc1
    buffer_load_dwordx4 v[108:111], v13, s[8:11], s25 offen sc1
    v_mfma_f32_16x16x32_bf16 a[36:39], v[48:51], v[116:119], a[36:39]
    s_add_u32 s25, s25, 1024
    v_mfma_f32_16x16x32_bf16 a[40:43], v[52:55], v[112:115], a[40:43]
    v_mfma_f32_16x16x32_bf16 a[44:47], v[52:55], v[116:119], a[44:47]
    v_mfma_f32_16x16x32_bf16 a[48:51], v[56:59], v[112:115], a[48:51]
    v_mfma_f32_16x16x32_bf16 a[52:55], v[56:59], v[116:119], a[52:55]
    v_mfma_f32_16x16x32_bf16 a[56:59], v[60:63], v[112:115], a[56:59]
    v_mfma_f32_16x16x32_bf16 a[60:63], v[60:63], v[116:119], a[60:63]
    s_waitcnt vmcnt(50) lgkmcnt(0)
    s_barrier
    v_mfma_f32_16x16x32_bf16 a[0:3], v[64:67], v[120:123], a[0:3]
    ds_read_b64_tr_b16 v[32:33], v14 offset:32768
    ds_read_b64_tr_b16 v[34:35], v14 offset:36864
    v_mfma_f32_16x16x32_bf16 a[4:7], v[64:67], v[124:127], a[4:7]
    ds_read_b64_tr_b16 v[36:37], v15 offset:32768
    ds_read_b64_tr_b16 v[38:39], v15 offset:36864
    v_mfma_f32_16x16x32_bf16 a[8:11], v[68:71], v[120:123], a[8:11]
    ds_read_b64_tr_b16 v[40:41], v16 offset:32768
    ds_read_b64_tr_b16 v[42:43], v16 offset:36864
    v_mfma_f32_16x16x32_bf16 a[12:15], v[68:71], v[124:127], a[12:15]
    ds_read_b64_tr_b16 v[44:45], v17 offset:32768
    ds_read_b64_tr_b16 v[46:47], v17 offset:36864
    v_mfma_f32_16x16x32_bf16 a[16:19], v[72:75], v[120:123], a[16:19]
    ds_read_b64_tr_b16 v[48:49], v18 offset:32768
    ds_read_b64_tr_b16 v[50:51], v18 offset:36864
    v_mfma_f32_16x16x32_bf16 a[20:23], v[72:75], v[124:127], a[20:23]
    ds_read_b64_tr_b16 v[52:53], v19 offset:32768
    ds_read_b64_tr_b16 v[54:55], v19 offset:36864
    v_mfma_f32_16x16x32_bf16 a[24:27], v[76:79], v[120:123], a[24:27]
    ds_read_b64_tr_b16 v[56:57], v20 offset:32768
    ds_read_b64_tr_b16 v[58:59], v20 offset:36864
    v_mfma_f32_16x16x32_bf16 a[28:31], v[76:79], v[124:127], a[28:31]
    ds_read_b64_tr_b16 v[60:61], v21 offset:32768
    ds_read_b64_tr_b16 v[62:63], v21 offset:36864
    v_mfma_f32_16x16x32_bf16 a[32:35], v[80:83], v[120:123], a[32:35]
    buffer_load_dwordx4 v[112:115], v12, s[8:11], s25 offen sc1
    buffer_load_dwordx4 v[116:119], v13, s[8:11], s25 offen sc1
    v_mfma_f32_16x16x32_bf16 a[36:39], v[80:83], v[124:127], a[36:39]
    s_add_u32 s25, s25, 1024
    s_add_u32 m0, s28, 16384
    v_mfma_f32_16x16x32_bf16 a[40:43], v[84:87], v[120:123], a[40:43]
    s_nop 0
    buffer_load_dwordx4 v8, s[12:15], s26 offen offset:0 lds
    v_mfma_f32_16x16x32_bf16 a[44:47], v[84:87], v[124:127], a[44:47]
    buffer_load_dwordx4 v9, s[12:15], s26 offen offset:1024 lds
    buffer_load_dwordx4 v10, s[12:15], s26 offen offset:2048 lds
    v_mfma_f32_16x16x32_bf16 a[48:51], v[88:91], v[120:123], a[48:51]
    buffer_load_dwordx4 v11, s[12:15], s26 offen offset:3072 lds
    s_add_u32 s26, s26, 524288
    v_mfma_f32_16x16x32_bf16 a[52:55], v[88:91], v[124:127], a[52:55]
    v_mfma_f32_16x16x32_bf16 a[56:59], v[92:95], v[120:123], a[56:59]
    v_mfma_f32_16x16x32_bf16 a[60:63], v[92:95], v[124:127], a[60:63]
    s_waitcnt vmcnt(56) lgkmcnt(0)
    v_mfma_f32_16x16x32_bf16 a[0:3], v[32:35], v[128:131], a[0:3]
    ds_read_b64_tr_b16 v[64:65], v14 offset:40960
    ds_read_b64_tr_b16 v[66:67], v14 offset:45056
    v_mfma_f32_16x16x32_bf16 a[4:7], v[32:35], v[132:135], a[4:7]
    ds_read_b64_tr_b16 v[68:69], v15 offset:40960
    ds_read_b64_tr_b16 v[70:71], v15 offset:45056
    v_mfma_f32_16x16x32_bf16 a[8:11], v[36:39], v[128:131], a[8:11]
    ds_read_b64_tr_b16 v[72:73], v16 offset:40960
    ds_read_b64_tr_b16 v[74:75], v16 offset:45056
    v_mfma_f32_16x16x32_bf16 a[12:15], v[36:39], v[132:135], a[12:15]
    ds_read_b64_tr_b16 v[76:77], v17 offset:40960
    ds_read_b64_tr_b16 v[78:79], v17 offset:45056
    v_mfma_f32_16x16x32_bf16 a[16:19], v[40:43], v[128:131], a[16:19]
    ds_read_b64_tr_b16 v[80:81], v18 offset:40960
    ds_read_b64_tr_b16 v[82:83], v18 offset:45056
    v_mfma_f32_16x16x32_bf16 a[20:23], v[40:43], v[132:135], a[20:23]
    ds_read_b64_tr_b16 v[84:85], v19 offset:40960
    ds_read_b64_tr_b16 v[86:87], v19 offset:45056
    v_mfma_f32_16x16x32_bf16 a[24:27], v[44:47], v[128:131], a[24:27]
    ds_read_b64_tr_b16 v[88:89], v20 offset:40960
    ds_read_b64_tr_b16 v[90:91], v20 offset:45056
    v_mfma_f32_16x16x32_bf16 a[28:31], v[44:47], v[132:135], a[28:31]
    ds_read_b64_tr_b16 v[92:93], v21 offset:40960
    ds_read_b64_tr_b16 v[94:95], v21 offset:45056
    v_mfma_f32_16x16x32_bf16 a[32:35], v[48:51], v[128:131], a[32:35]
    buffer_load_dwordx4 v[120:123], v12, s[8:11], s25 offen sc1
    buffer_load_dwordx4 v[124:127], v13, s[8:11], s25 offen sc1
    v_mfma_f32_16x16x32_bf16 a[36:39], v[48:51], v[132:135], a[36:39]
    s_add_u32 s25, s25, 1024
    v_mfma_f32_16x16x32_bf16 a[40:43], v[52:55], v[128:131], a[40:43]
    v_mfma_f32_16x16x32_bf16 a[44:47], v[52:55], v[132:135], a[44:47]
    v_mfma_f32_16x16x32_bf16 a[48:51], v[56:59], v[128:131], a[48:51]
    v_mfma_f32_16x16x32_bf16 a[52:55], v[56:59], v[132:135], a[52:55]
    v_mfma_f32_16x16x32_bf16 a[56:59], v[60:63], v[128:131], a[56:59]
    v_mfma_f32_16x16x32_bf16 a[60:63], v[60:63], v[132:135], a[60:63]
    s_waitcnt vmcnt(50) lgkmcnt(0)
    s_barrier
    v_mfma_f32_16x16x32_bf16 a[0:3], v[64:67], v[136:139], a[0:3]
    ds_read_b64_tr_b16 v[32:33], v14 offset:49152
    ds_read_b64_tr_b16 v[34:35], v14 offset:53248
    v_mfma_f32_16x16x32_bf16 a[4:7], v[64:67], v[140:143], a[4:7]
    ds_read_b64_tr_b16 v[36:37], v15 offset:49152
    ds_read_b64_tr_b16 v[38:39], v15 offset:53248
    v_mfma_f32_16x16x32_bf16 a[8:11], v[68:71], v[136:139], a[8:11]
    ds_read_b64_tr_b16 v[40:41], v16 offset:49152
    ds_read_b64_tr_b16 v[42:43], v16 offset:53248
    v_mfma_f32_16x16x32_bf16 a[12:15], v[68:71], v[140:143], a[12:15]
    ds_read_b64_tr_b16 v[44:45], v17 offset:49152
    ds_read_b64_tr_b16 v[46:47], v17 offset:53248
    v_mfma_f32_16x16x32_bf16 a[16:19], v[72:75], v[136:139], a[16:19]
    ds_read_b64_tr_b16 v[48:49], v18 offset:49152
    ds_read_b64_tr_b16 v[50:51], v18 offset:53248
    v_mfma_f32_16x16x32_bf16 a[20:23], v[72:75], v[140:143], a[20:23]
    ds_read_b64_tr_b16 v[52:53], v19 offset:49152
    ds_read_b64_tr_b16 v[54:55], v19 offset:53248
    v_mfma_f32_16x16x32_bf16 a[24:27], v[76:79], v[136:139], a[24:27]
    ds_read_b64_tr_b16 v[56:57], v20 offset:49152
    ds_read_b64_tr_b16 v[58:59], v20 offset:53248
    v_mfma_f32_16x16x32_bf16 a[28:31], v[76:79], v[140:143], a[28:31]
    ds_read_b64_tr_b16 v[60:61], v21 offset:49152
    ds_read_b64_tr_b16 v[62:63], v21 offset:53248
    v_mfma_f32_16x16x32_bf16 a[32:35], v[80:83], v[136:139], a[32:35]
    buffer_load_dwordx4 v[128:131], v12, s[8:11], s25 offen sc1
    buffer_load_dwordx4 v[132:135], v13, s[8:11], s25 offen sc1
    v_mfma_f32_16x16x32_bf16 a[36:39], v[80:83], v[140:143], a[36:39]
    s_add_u32 s25, s25, 1024
    s_add_u32 m0, s28, 32768
    v_mfma_f32_16x16x32_bf16 a[40:43], v[84:87], v[136:139], a[40:43]
    s_nop 0
    buffer_load_dwordx4 v8, s[12:15], s26 offen offset:0 lds
    v_mfma_f32_16x16x32_bf16 a[44:47], v[84:87], v[140:143], a[44:47]
    buffer_load_dwordx4 v9, s[12:15], s26 offen offset:1024 lds
    buffer_load_dwordx4 v10, s[12:15], s26 offen offset:2048 lds
    v_mfma_f32_16x16x32_bf16 a[48:51], v[88:91], v[136:139], a[48:51]
    buffer_load_dwordx4 v11, s[12:15], s26 offen offset:3072 lds
    s_add_u32 s26, s26, 524288
    v_mfma_f32_16x16x32_bf16 a[52:55], v[88:91], v[140:143], a[52:55]
    v_mfma_f32_16x16x32_bf16 a[56:59], v[92:95], v[136:139], a[56:59]
    v_mfma_f32_16x16x32_bf16 a[60:63], v[92:95], v[140:143], a[60:63]
    s_waitcnt vmcnt(56) lgkmcnt(0)
    v_mfma_f32_16x16x32_bf16 a[0:3], v[32:35], v[144:147], a[0:3]
    ds_read_b64_tr_b16 v[64:65], v14 offset:57344
    ds_read_b64_tr_b16 v[66:67], v14 offset:61440
    v_mfma_f32_16x16x32_bf16 a[4:7], v[32:35], v[148:151], a[4:7]
    ds_read_b64_tr_b16 v[68:69], v15 offset:57344
    ds_read_b64_tr_b16 v[70:71], v15 offset:61440
    v_mfma_f32_16x16x32_bf16 a[8:11], v[36:39], v[144:147], a[8:11]
    ds_read_b64_tr_b16 v[72:73], v16 offset:57344
    ds_read_b64_tr_b16 v[74:75], v16 offset:61440
    v_mfma_f32_16x16x32_bf16 a[12:15], v[36:39], v[148:151], a[12:15]
    ds_read_b64_tr_b16 v[76:77], v17 offset:57344
    ds_read_b64_tr_b16 v[78:79], v17 offset:61440
    v_mfma_f32_16x16x32_bf16 a[16:19], v[40:43], v[144:147], a[16:19]
    ds_read_b64_tr_b16 v[80:81], v18 offset:57344
    ds_read_b64_tr_b16 v[82:83], v18 offset:61440
    v_mfma_f32_16x16x32_bf16 a[20:23], v[40:43], v[148:151], a[20:23]
    ds_read_b64_tr_b16 v[84:85], v19 offset:57344
    ds_read_b64_tr_b16 v[86:87], v19 offset:61440
    v_mfma_f32_16x16x32_bf16 a[24:27], v[44:47], v[144:147], a[24:27]
    ds_read_b64_tr_b16 v[88:89], v20 offset:57344
    ds_read_b64_tr_b16 v[90:91], v20 offset:61440
    v_mfma_f32_16x16x32_bf16 a[28:31], v[44:47], v[148:151], a[28:31]
    ds_read_b64_tr_b16 v[92:93], v21 offset:57344
    ds_read_b64_tr_b16 v[94:95], v21 offset:61440
    v_mfma_f32_16x16x32_bf16 a[32:35], v[48:51], v[144:147], a[32:35]
    buffer_load_dwordx4 v[136:139], v12, s[8:11], s25 offen sc1
    buffer_load_dwordx4 v[140:143], v13, s[8:11], s25 offen sc1
    v_mfma_f32_16x16x32_bf16 a[36:39], v[48:51], v[148:151], a[36:39]
    s_add_u32 s25, s25, 1024
    v_mfma_f32_16x16x32_bf16 a[40:43], v[52:55], v[144:147], a[40:43]
    v_mfma_f32_16x16x32_bf16 a[44:47], v[52:55], v[148:151], a[44:47]
    v_mfma_f32_16x16x32_bf16 a[48:51], v[56:59], v[144:147], a[48:51]
    v_mfma_f32_16x16x32_bf16 a[52:55], v[56:59], v[148:151], a[52:55]
    v_mfma_f32_16x16x32_bf16 a[56:59], v[60:63], v[144:147], a[56:59]
    v_mfma_f32_16x16x32_bf16 a[60:63], v[60:63], v[148:151], a[60:63]
    s_waitcnt vmcnt(50) lgkmcnt(0)
    s_barrier
    v_mfma_f32_16x16x32_bf16 a[0:3], v[64:67], v[152:155], a[0:3]
    ds_read_b64_tr_b16 v[32:33], v22 offset:0
    ds_read_b64_tr_b16 v[34:35], v22 offset:4096
    v_mfma_f32_16x16x32_bf16 a[4:7], v[64:67], v[156:159], a[4:7]
    ds_read_b64_tr_b16 v[36:37], v23 offset:0
    ds_read_b64_tr_b16 v[38:39], v23 offset:4096
    v_mfma_f32_16x16x32_bf16 a[8:11], v[68:71], v[152:155], a[8:11]
    ds_read_b64_tr_b16 v[40:41], v24 offset:0
    ds_read_b64_tr_b16 v[42:43], v24 offset:4096
    v_mfma_f32_16x16x32_bf16 a[12:15], v[68:71], v[156:159], a[12:15]
    ds_read_b64_tr_b16 v[44:45], v25 offset:0
    ds_read_b64_tr_b16 v[46:47], v25 offset:4096
    v_mfma_f32_16x16x32_bf16 a[16:19], v[72:75], v[152:155], a[16:19]
    ds_read_b64_tr_b16 v[48:49], v26 offset:0
    ds_read_b64_tr_b16 v[50:51], v26 offset:4096
    v_mfma_f32_16x16x32_bf16 a[20:23], v[72:75], v[156:159], a[20:23]
    ds_read_b64_tr_b16 v[52:53], v27 offset:0
    ds_read_b64_tr_b16 v[54:55], v27 offset:4096
    v_mfma_f32_16x16x32_bf16 a[24:27], v[76:79], v[152:155], a[24:27]
    ds_read_b64_tr_b16 v[56:57], v28 offset:0
    ds_read_b64_tr_b16 v[58:59], v28 offset:4096
    v_mfma_f32_16x16x32_bf16 a[28:31], v[76:79], v[156:159], a[28:31]
    ds_read_b64_tr_b16 v[60:61], v29 offset:0
    ds_read_b64_tr_b16 v[62:63], v29 offset:4096
    v_mfma_f32_16x16x32_bf16 a[32:35], v[80:83], v[152:155], a[32:35]
    buffer_load_dwordx4 v[144:147], v12, s[8:11], s25 offen sc1
    buffer_load_dwordx4 v[148:151], v13, s[8:11], s25 offen sc1
    v_mfma_f32_16x16x32_bf16 a[36:39], v[80:83], v[156:159], a[36:39]
    s_add_u32 s25, s25, 1024
    s_add_u32 m0, s28, 49152
    v_mfma_f32_16x16x32_bf16 a[40:43], v[84:87], v[152:155], a[40:43]
    s_nop 0
    buffer_load_dwordx4 v8, s[12:15], s26 offen offset:0 lds
    v_mfma_f32_16x16x32_bf16 a[44:47], v[84:87], v[156:159], a[44:47]
    buffer_load_dwordx4 v9, s[12:15], s26 offen offset:1024 lds
    buffer_load_dwordx4 v10, s[12:15], s26 offen offset:2048 lds
    v_mfma_f32_16x16x32_bf16 a[48:51], v[88:91], v[152:155], a[48:51]
    buffer_load_dwordx4 v11, s[12:15], s26 offen offset:3072 lds
    s_add_u32 s26, s26, 524288
    v_mfma_f32_16x16x32_bf16 a[52:55], v[88:91], v[156:159], a[52:55]
    v_mfma_f32_16x16x32_bf16 a[56:59], v[92:95], v[152:155], a[56:59]
    v_mfma_f32_16x16x32_bf16 a[60:63], v[92:95], v[156:159], a[60:63]
    s_waitcnt vmcnt(56) lgkmcnt(0)
    v_mfma_f32_16x16x32_bf16 a[0:3], v[32:35], v[160:163], a[0:3]
    ds_read_b64_tr_b16 v[64:65], v22 offset:8192
    ds_read_b64_tr_b16 v[66:67], v22 offset:12288
    v_mfma_f32_16x16x32_bf16 a[4:7], v[32:35], v[164:167], a[4:7]
    ds_read_b64_tr_b16 v[68:69], v23 offset:8192
    ds_read_b64_tr_b16 v[70:71], v23 offset:12288
    v_mfma_f32_16x16x32_bf16 a[8:11], v[36:39], v[160:163], a[8:11]
    ds_read_b64_tr_b16 v[72:73], v24 offset:8192
    ds_read_b64_tr_b16 v[74:75], v24 offset:12288
    v_mfma_f32_16x16x32_bf16 a[12:15], v[36:39], v[164:167], a[12:15]
    ds_read_b64_tr_b16 v[76:77], v25 offset:8192
    ds_read_b64_tr_b16 v[78:79], v25 offset:12288
    v_mfma_f32_16x16x32_bf16 a[16:19], v[40:43], v[160:163], a[16:19]
    ds_read_b64_tr_b16 v[80:81], v26 offset:8192
    ds_read_b64_tr_b16 v[82:83], v26 offset:12288
    v_mfma_f32_16x16x32_bf16 a[20:23], v[40:43], v[164:167], a[20:23]
    ds_read_b64_tr_b16 v[84:85], v27 offset:8192
    ds_read_b64_tr_b16 v[86:87], v27 offset:12288
    v_mfma_f32_16x16x32_bf16 a[24:27], v[44:47], v[160:163], a[24:27]
    ds_read_b64_tr_b16 v[88:89], v28 offset:8192
    ds_read_b64_tr_b16 v[90:91], v28 offset:12288
    v_mfma_f32_16x16x32_bf16 a[28:31], v[44:47], v[164:167], a[28:31]
    ds_read_b64_tr_b16 v[92:93], v29 offset:8192
    ds_read_b64_tr_b16 v[94:95], v29 offset:12288
    v_mfma_f32_16x16x32_bf16 a[32:35], v[48:51], v[160:163], a[32:35]
    buffer_load_dwordx4 v[152:155], v12, s[8:11], s25 offen sc1
    buffer_load_dwordx4 v[156:159], v13, s[8:11], s25 offen sc1
    v_mfma_f32_16x16x32_bf16 a[36:39], v[48:51], v[164:167], a[36:39]
    s_add_u32 s25, s25, 1024
    v_mfma_f32_16x16x32_bf16 a[40:43], v[52:55], v[160:163], a[40:43]
    v_mfma_f32_16x16x32_bf16 a[44:47], v[52:55], v[164:167], a[44:47]
    v_mfma_f32_16x16x32_bf16 a[48:51], v[56:59], v[160:163], a[48:51]
    v_mfma_f32_16x16x32_bf16 a[52:55], v[56:59], v[164:167], a[52:55]
    v_mfma_f32_16x16x32_bf16 a[56:59], v[60:63], v[160:163], a[56:59]
    v_mfma_f32_16x16x32_bf16 a[60:63], v[60:63], v[164:167], a[60:63]
    s_waitcnt vmcnt(50) lgkmcnt(0)
    s_barrier
    v_mfma_f32_16x16x32_bf16 a[0:3], v[64:67], v[168:171], a[0:3]
    ds_read_b64_tr_b16 v[32:33], v22 offset:16384
    ds_read_b64_tr_b16 v[34:35], v22 offset:20480
    v_mfma_f32_16x16x32_bf16 a[4:7], v[64:67], v[172:175], a[4:7]
    ds_read_b64_tr_b16 v[36:37], v23 offset:16384
    ds_read_b64_tr_b16 v[38:39], v23 offset:20480
    v_mfma_f32_16x16x32_bf16 a[8:11], v[68:71], v[168:171], a[8:11]
    ds_read_b64_tr_b16 v[40:41], v24 offset:16384
    ds_read_b64_tr_b16 v[42:43], v24 offset:20480
    v_mfma_f32_16x16x32_bf16 a[12:15], v[68:71], v[172:175], a[12:15]
    ds_read_b64_tr_b16 v[44:45], v25 offset:16384
    ds_read_b64_tr_b16 v[46:47], v25 offset:20480
    v_mfma_f32_16x16x32_bf16 a[16:19], v[72:75], v[168:171], a[16:19]
    ds_read_b64_tr_b16 v[48:49], v26 offset:16384
    ds_read_b64_tr_b16 v[50:51], v26 offset:20480
    v_mfma_f32_16x16x32_bf16 a[20:23], v[72:75], v[172:175], a[20:23]
    ds_read_b64_tr_b16 v[52:53], v27 offset:16384
    ds_read_b64_tr_b16 v[54:55], v27 offset:20480
    v_mfma_f32_16x16x32_bf16 a[24:27], v[76:79], v[168:171], a[24:27]
    ds_read_b64_tr_b16 v[56:57], v28 offset:16384
    ds_read_b64_tr_b16 v[58:59], v28 offset:20480
    v_mfma_f32_16x16x32_bf16 a[28:31], v[76:79], v[172:175], a[28:31]
    ds_read_b64_tr_b16 v[60:61], v29 offset:16384
    ds_read_b64_tr_b16 v[62:63], v29 offset:20480
    v_mfma_f32_16x16x32_bf16 a[32:35], v[80:83], v[168:171], a[32:35]
    buffer_load_dwordx4 v[160:163], v12, s[8:11], s25 offen sc1
    buffer_load_dwordx4 v[164:167], v13, s[8:11], s25 offen sc1
    v_mfma_f32_16x16x32_bf16 a[36:39], v[80:83], v[172:175], a[36:39]
    s_add_u32 s25, s25, 1024
    s_add_u32 m0, s28, 65536
    v_mfma_f32_16x16x32_bf16 a[40:43], v[84:87], v[168:171], a[40:43]
    s_nop 0
    buffer_load_dwordx4 v8, s[12:15], s26 offen offset:0 lds
    v_mfma_f32_16x16x32_bf16 a[44:47], v[84:87], v[172:175], a[44:47]
    buffer_load_dwordx4 v9, s[12:15], s26 offen offset:1024 lds
    buffer_load_dwordx4 v10, s[12:15], s26 offen offset:2048 lds
    v_mfma_f32_16x16x32_bf16 a[48:51], v[88:91], v[168:171], a[48:51]
    buffer_load_dwordx4 v11, s[12:15], s26 offen offset:3072 lds
    s_add_u32 s26, s26, 524288
    v_mfma_f32_16x16x32_bf16 a[52:55], v[88:91], v[172:175], a[52:55]
    v_mfma_f32_16x16x32_bf16 a[56:59], v[92:95], v[168:171], a[56:59]
    v_mfma_f32_16x16x32_bf16 a[60:63], v[92:95], v[172:175], a[60:63]
    s_waitcnt vmcnt(56) lgkmcnt(0)
    v_mfma_f32_16x16x32_bf16 a[0:3], v[32:35], v[176:179], a[0:3]
    ds_read_b64_tr_b16 v[64:65], v22 offset:24576
    ds_read_b64_tr_b16 v[66:67], v22 offset:28672
    v_mfma_f32_16x16x32_bf16 a[4:7], v[32:35], v[180:183], a[4:7]
    ds_read_b64_tr_b16 v[68:69], v23 offset:24576
    ds_read_b64_tr_b16 v[70:71], v23 offset:28672
    v_mfma_f32_16x16x32_bf16 a[8:11], v[36:39], v[176:179], a[8:11]
    ds_read_b64_tr_b16 v[72:73], v24 offset:24576
    ds_read_b64_tr_b16 v[74:75], v24 offset:28672
    v_mfma_f32_16x16x32_bf16 a[12:15], v[36:39], v[180:183], a[12:15]
    ds_read_b64_tr_b16 v[76:77], v25 offset:24576
    ds_read_b64_tr_b16 v[78:79], v25 offset:28672
    v_mfma_f32_16x16x32_bf16 a[16:19], v[40:43], v[176:179], a[16:19]
    ds_read_b64_tr_b16 v[80:81], v26 offset:24576
    ds_read_b64_tr_b16 v[82:83], v26 offset:28672
    v_mfma_f32_16x16x32_bf16 a[20:23], v[40:43], v[180:183], a[20:23]
    ds_read_b64_tr_b16 v[84:85], v27 offset:24576
    ds_read_b64_tr_b16 v[86:87], v27 offset:28672
    v_mfma_f32_16x16x32_bf16 a[24:27], v[44:47], v[176:179], a[24:27]
    ds_read_b64_tr_b16 v[88:89], v28 offset:24576
    ds_read_b64_tr_b16 v[90:91], v28 offset:28672
    v_mfma_f32_16x16x32_bf16 a[28:31], v[44:47], v[180:183], a[28:31]
    ds_read_b64_tr_b16 v[92:93], v29 offset:24576
    ds_read_b64_tr_b16 v[94:95], v29 offset:28672
    v_mfma_f32_16x16x32_bf16 a[32:35], v[48:51], v[176:179], a[32:35]
    buffer_load_dwordx4 v[168:171], v12, s[8:11], s25 offen sc1
    buffer_load_dwordx4 v[172:175], v13, s[8:11], s25 offen sc1
    v_mfma_f32_16x16x32_bf16 a[36:39], v[48:51], v[180:183], a[36:39]
    s_add_u32 s25, s25, 1024
    v_mfma_f32_16x16x32_bf16 a[40:43], v[52:55], v[176:179], a[40:43]
    v_mfma_f32_16x16x32_bf16 a[44:47], v[52:55], v[180:183], a[44:47]
    v_mfma_f32_16x16x32_bf16 a[48:51], v[56:59], v[176:179], a[48:51]
    v_mfma_f32_16x16x32_bf16 a[52:55], v[56:59], v[180:183], a[52:55]
    v_mfma_f32_16x16x32_bf16 a[56:59], v[60:63], v[176:179], a[56:59]
    v_mfma_f32_16x16x32_bf16 a[60:63], v[60:63], v[180:183], a[60:63]
    s_waitcnt vmcnt(50) lgkmcnt(0)
    s_barrier
    v_mfma_f32_16x16x32_bf16 a[0:3], v[64:67], v[184:187], a[0:3]
    ds_read_b64_tr_b16 v[32:33], v22 offset:32768
    ds_read_b64_tr_b16 v[34:35], v22 offset:36864
    v_mfma_f32_16x16x32_bf16 a[4:7], v[64:67], v[188:191], a[4:7]
    ds_read_b64_tr_b16 v[36:37], v23 offset:32768
    ds_read_b64_tr_b16 v[38:39], v23 offset:36864
    v_mfma_f32_16x16x32_bf16 a[8:11], v[68:71], v[184:187], a[8:11]
    ds_read_b64_tr_b16 v[40:41], v24 offset:32768
    ds_read_b64_tr_b16 v[42:43], v24 offset:36864
    v_mfma_f32_16x16x32_bf16 a[12:15], v[68:71], v[188:191], a[12:15]
    ds_read_b64_tr_b16 v[44:45], v25 offset:32768
    ds_read_b64_tr_b16 v[46:47], v25 offset:36864
    v_mfma_f32_16x16x32_bf16 a[16:19], v[72:75], v[184:187], a[16:19]
    ds_read_b64_tr_b16 v[48:49], v26 offset:32768
    ds_read_b64_tr_b16 v[50:51], v26 offset:36864
    v_mfma_f32_16x16x32_bf16 a[20:23], v[72:75], v[188:191], a[20:23]
    ds_read_b64_tr_b16 v[52:53], v27 offset:32768
    ds_read_b64_tr_b16 v[54:55], v27 offset:36864
    v_mfma_f32_16x16x32_bf16 a[24:27], v[76:79], v[184:187], a[24:27]
    ds_read_b64_tr_b16 v[56:57], v28 offset:32768
    ds_read_b64_tr_b16 v[58:59], v28 offset:36864
    v_mfma_f32_16x16x32_bf16 a[28:31], v[76:79], v[188:191], a[28:31]
    ds_read_b64_tr_b16 v[60:61], v29 offset:32768
    ds_read_b64_tr_b16 v[62:63], v29 offset:36864
    v_mfma_f32_16x16x32_bf16 a[32:35], v[80:83], v[184:187], a[32:35]
    buffer_load_dwordx4 v[176:179], v12, s[8:11], s25 offen sc1
    buffer_load_dwordx4 v[180:183], v13, s[8:11], s25 offen sc1
    v_mfma_f32_16x16x32_bf16 a[36:39], v[80:83], v[188:191], a[36:39]
    s_add_u32 s25, s25, 1024
    s_add_u32 m0, s28, 81920
    v_mfma_f32_16x16x32_bf16 a[40:43], v[84:87], v[184:187], a[40:43]
    s_nop 0
    buffer_load_dwordx4 v8, s[12:15], s26 offen offset:0 lds
    v_mfma_f32_16x16x32_bf16 a[44:47], v[84:87], v[188:191], a[44:47]
    buffer_load_dwordx4 v9, s[12:15], s26 offen offset:1024 lds
    buffer_load_dwordx4 v10, s[12:15], s26 offen offset:2048 lds
    v_mfma_f32_16x16x32_bf16 a[48:51], v[88:91], v[184:187], a[48:51]
    buffer_load_dwordx4 v11, s[12:15], s26 offen offset:3072 lds
    s_add_u32 s26, s26, 524288
    v_mfma_f32_16x16x32_bf16 a[52:55], v[88:91], v[188:191], a[52:55]
    v_mfma_f32_16x16x32_bf16 a[56:59], v[92:95], v[184:187], a[56:59]
    v_mfma_f32_16x16x32_bf16 a[60:63], v[92:95], v[188:191], a[60:63]
    s_waitcnt vmcnt(56) lgkmcnt(0)
    v_mfma_f32_16x16x32_bf16 a[0:3], v[32:35], v[192:195], a[0:3]
    ds_read_b64_tr_b16 v[64:65], v22 offset:40960
    ds_read_b64_tr_b16 v[66:67], v22 offset:45056
    v_mfma_f32_16x16x32_bf16 a[4:7], v[32:35], v[196:199], a[4:7]
    ds_read_b64_tr_b16 v[68:69], v23 offset:40960
    ds_read_b64_tr_b16 v[70:71], v23 offset:45056
    v_mfma_f32_16x16x32_bf16 a[8:11], v[36:39], v[192:195], a[8:11]
    ds_read_b64_tr_b16 v[72:73], v24 offset:40960
    ds_read_b64_tr_b16 v[74:75], v24 offset:45056
    v_mfma_f32_16x16x32_bf16 a[12:15], v[36:39], v[196:199], a[12:15]
    ds_read_b64_tr_b16 v[76:77], v25 offset:40960
    ds_read_b64_tr_b16 v[78:79], v25 offset:45056
    v_mfma_f32_16x16x32_bf16 a[16:19], v[40:43], v[192:195], a[16:19]
    ds_read_b64_tr_b16 v[80:81], v26 offset:40960
    ds_read_b64_tr_b16 v[82:83], v26 offset:45056
    v_mfma_f32_16x16x32_bf16 a[20:23], v[40:43], v[196:199], a[20:23]
    ds_read_b64_tr_b16 v[84:85], v27 offset:40960
    ds_read_b64_tr_b16 v[86:87], v27 offset:45056
    v_mfma_f32_16x16x32_bf16 a[24:27], v[44:47], v[192:195], a[24:27]
    ds_read_b64_tr_b16 v[88:89], v28 offset:40960
    ds_read_b64_tr_b16 v[90:91], v28 offset:45056
    v_mfma_f32_16x16x32_bf16 a[28:31], v[44:47], v[196:199], a[28:31]
    ds_read_b64_tr_b16 v[92:93], v29 offset:40960
    ds_read_b64_tr_b16 v[94:95], v29 offset:45056
    v_mfma_f32_16x16x32_bf16 a[32:35], v[48:51], v[192:195], a[32:35]
    buffer_load_dwordx4 v[184:187], v12, s[8:11], s25 offen sc1
    buffer_load_dwordx4 v[188:191], v13, s[8:11], s25 offen sc1
    v_mfma_f32_16x16x32_bf16 a[36:39], v[48:51], v[196:199], a[36:39]
    s_add_u32 s25, s25, 1024
    v_mfma_f32_16x16x32_bf16 a[40:43], v[52:55], v[192:195], a[40:43]
    v_mfma_f32_16x16x32_bf16 a[44:47], v[52:55], v[196:199], a[44:47]
    v_mfma_f32_16x16x32_bf16 a[48:51], v[56:59], v[192:195], a[48:51]
    v_mfma_f32_16x16x32_bf16 a[52:55], v[56:59], v[196:199], a[52:55]
    v_mfma_f32_16x16x32_bf16 a[56:59], v[60:63], v[192:195], a[56:59]
    v_mfma_f32_16x16x32_bf16 a[60:63], v[60:63], v[196:199], a[60:63]
    s_waitcnt vmcnt(50) lgkmcnt(0)
    s_barrier
    v_mfma_f32_16x16x32_bf16 a[0:3], v[64:67], v[200:203], a[0:3]
    ds_read_b64_tr_b16 v[32:33], v22 offset:49152
    ds_read_b64_tr_b16 v[34:35], v22 offset:53248
    v_mfma_f32_16x16x32_bf16 a[4:7], v[64:67], v[204:207], a[4:7]
    ds_read_b64_tr_b16 v[36:37], v23 offset:49152
    ds_read_b64_tr_b16 v[38:39], v23 offset:53248
    v_mfma_f32_16x16x32_bf16 a[8:11], v[68:71], v[200:203], a[8:11]
    ds_read_b64_tr_b16 v[40:41], v24 offset:49152
    ds_read_b64_tr_b16 v[42:43], v24 offset:53248
    v_mfma_f32_16x16x32_bf16 a[12:15], v[68:71], v[204:207], a[12:15]
    ds_read_b64_tr_b16 v[44:45], v25 offset:49152
    ds_read_b64_tr_b16 v[46:47], v25 offset:53248
    v_mfma_f32_16x16x32_bf16 a[16:19], v[72:75], v[200:203], a[16:19]
    ds_read_b64_tr_b16 v[48:49], v26 offset:49152
    ds_read_b64_tr_b16 v[50:51], v26 offset:53248
    v_mfma_f32_16x16x32_bf16 a[20:23], v[72:75], v[204:207], a[20:23]
    ds_read_b64_tr_b16 v[52:53], v27 offset:49152
    ds_read_b64_tr_b16 v[54:55], v27 offset:53248
    v_mfma_f32_16x16x32_bf16 a[24:27], v[76:79], v[200:203], a[24:27]
    ds_read_b64_tr_b16 v[56:57], v28 offset:49152
    ds_read_b64_tr_b16 v[58:59], v28 offset:53248
    v_mfma_f32_16x16x32_bf16 a[28:31], v[76:79], v[204:207], a[28:31]
    ds_read_b64_tr_b16 v[60:61], v29 offset:49152
    ds_read_b64_tr_b16 v[62:63], v29 offset:53248
    v_mfma_f32_16x16x32_bf16 a[32:35], v[80:83], v[200:203], a[32:35]
    buffer_load_dwordx4 v[192:195], v12, s[8:11], s25 offen sc1
    buffer_load_dwordx4 v[196:199], v13, s[8:11], s25 offen sc1
    v_mfma_f32_16x16x32_bf16 a[36:39], v[80:83], v[204:207], a[36:39]
    s_add_u32 s25, s25, 1024
    s_add_u32 m0, s28, 98304
    v_mfma_f32_16x16x32_bf16 a[40:43], v[84:87], v[200:203], a[40:43]
    s_nop 0
    buffer_load_dwordx4 v8, s[12:15], s26 offen offset:0 lds
    v_mfma_f32_16x16x32_bf16 a[44:47], v[84:87], v[204:207], a[44:47]
    buffer_load_dwordx4 v9, s[12:15], s26 offen offset:1024 lds
    buffer_load_dwordx4 v10, s[12:15], s26 offen offset:2048 lds
    v_mfma_f32_16x16x32_bf16 a[48:51], v[88:91], v[200:203], a[48:51]
    buffer_load_dwordx4 v11, s[12:15], s26 offen offset:3072 lds
    s_add_u32 s26, s26, 524288
    v_mfma_f32_16x16x32_bf16 a[52:55], v[88:91], v[204:207], a[52:55]
    v_mfma_f32_16x16x32_bf16 a[56:59], v[92:95], v[200:203], a[56:59]
    v_mfma_f32_16x16x32_bf16 a[60:63], v[92:95], v[204:207], a[60:63]
    s_waitcnt vmcnt(56) lgkmcnt(0)
    v_mfma_f32_16x16x32_bf16 a[0:3], v[32:35], v[208:211], a[0:3]
    ds_read_b64_tr_b16 v[64:65], v22 offset:57344
    ds_read_b64_tr_b16 v[66:67], v22 offset:61440
    v_mfma_f32_16x16x32_bf16 a[4:7], v[32:35], v[212:215], a[4:7]
    ds_read_b64_tr_b16 v[68:69], v23 offset:57344
    ds_read_b64_tr_b16 v[70:71], v23 offset:61440
    v_mfma_f32_16x16x32_bf16 a[8:11], v[36:39], v[208:211], a[8:11]
    ds_read_b64_tr_b16 v[72:73], v24 offset:57344
    ds_read_b64_tr_b16 v[74:75], v24 offset:61440
    v_mfma_f32_16x16x32_bf16 a[12:15], v[36:39], v[212:215], a[12:15]
    ds_read_b64_tr_b16 v[76:77], v25 offset:57344
    ds_read_b64_tr_b16 v[78:79], v25 offset:61440
    v_mfma_f32_16x16x32_bf16 a[16:19], v[40:43], v[208:211], a[16:19]
    ds_read_b64_tr_b16 v[80:81], v26 offset:57344
    ds_read_b64_tr_b16 v[82:83], v26 offset:61440
    v_mfma_f32_16x16x32_bf16 a[20:23], v[40:43], v[212:215], a[20:23]
    ds_read_b64_tr_b16 v[84:85], v27 offset:57344
    ds_read_b64_tr_b16 v[86:87], v27 offset:61440
    v_mfma_f32_16x16x32_bf16 a[24:27], v[44:47], v[208:211], a[24:27]
    ds_read_b64_tr_b16 v[88:89], v28 offset:57344
    ds_read_b64_tr_b16 v[90:91], v28 offset:61440
    v_mfma_f32_16x16x32_bf16 a[28:31], v[44:47], v[212:215], a[28:31]
    ds_read_b64_tr_b16 v[92:93], v29 offset:57344
    ds_read_b64_tr_b16 v[94:95], v29 offset:61440
    v_mfma_f32_16x16x32_bf16 a[32:35], v[48:51], v[208:211], a[32:35]
    buffer_load_dwordx4 v[200:203], v12, s[8:11], s25 offen sc1
    buffer_load_dwordx4 v[204:207], v13, s[8:11], s25 offen sc1
    v_mfma_f32_16x16x32_bf16 a[36:39], v[48:51], v[212:215], a[36:39]
    s_add_u32 s25, s25, 1024
    v_mfma_f32_16x16x32_bf16 a[40:43], v[52:55], v[208:211], a[40:43]
    v_mfma_f32_16x16x32_bf16 a[44:47], v[52:55], v[212:215], a[44:47]
    v_mfma_f32_16x16x32_bf16 a[48:51], v[56:59], v[208:211], a[48:51]
    v_mfma_f32_16x16x32_bf16 a[52:55], v[56:59], v[212:215], a[52:55]
    v_mfma_f32_16x16x32_bf16 a[56:59], v[60:63], v[208:211], a[56:59]
    v_mfma_f32_16x16x32_bf16 a[60:63], v[60:63], v[212:215], a[60:63]
    s_waitcnt vmcnt(50) lgkmcnt(0)
    s_barrier
    v_mfma_f32_16x16x32_bf16 a[0:3], v[64:67], v[216:219], a[0:3]
    ds_read_b64_tr_b16 v[32:33], v14 offset:0
    ds_read_b64_tr_b16 v[34:35], v14 offset:4096
    v_mfma_f32_16x16x32_bf16 a[4:7], v[64:67], v[220:223], a[4:7]
    ds_read_b64_tr_b16 v[36:37], v15 offset:0
    ds_read_b64_tr_b16 v[38:39], v15 offset:4096
    v_mfma_f32_16x16x32_bf16 a[8:11], v[68:71], v[216:219], a[8:11]
    ds_read_b64_tr_b16 v[40:41], v16 offset:0
    ds_read_b64_tr_b16 v[42:43], v16 offset:4096
    v_mfma_f32_16x16x32_bf16 a[12:15], v[68:71], v[220:223], a[12:15]
    ds_read_b64_tr_b16 v[44:45], v17 offset:0
    ds_read_b64_tr_b16 v[46:47], v17 offset:4096
    v_mfma_f32_16x16x32_bf16 a[16:19], v[72:75], v[216:219], a[16:19]
    ds_read_b64_tr_b16 v[48:49], v18 offset:0
    ds_read_b64_tr_b16 v[50:51], v18 offset:4096
    v_mfma_f32_16x16x32_bf16 a[20:23], v[72:75], v[220:223], a[20:23]
    ds_read_b64_tr_b16 v[52:53], v19 offset:0
    ds_read_b64_tr_b16 v[54:55], v19 offset:4096
    v_mfma_f32_16x16x32_bf16 a[24:27], v[76:79], v[216:219], a[24:27]
    ds_read_b64_tr_b16 v[56:57], v20 offset:0
    ds_read_b64_tr_b16 v[58:59], v20 offset:4096
    v_mfma_f32_16x16x32_bf16 a[28:31], v[76:79], v[220:223], a[28:31]
    ds_read_b64_tr_b16 v[60:61], v21 offset:0
    ds_read_b64_tr_b16 v[62:63], v21 offset:4096
    v_mfma_f32_16x16x32_bf16 a[32:35], v[80:83], v[216:219], a[32:35]
    buffer_load_dwordx4 v[208:211], v12, s[8:11], s25 offen sc1
    buffer_load_dwordx4 v[212:215], v13, s[8:11], s25 offen sc1
    v_mfma_f32_16x16x32_bf16 a[36:39], v[80:83], v[220:223], a[36:39]
    s_add_u32 s25, s25, 1024
    s_add_u32 m0, s28, 114688
    v_mfma_f32_16x16x32_bf16 a[40:43], v[84:87], v[216:219], a[40:43]
    s_nop 0
    buffer_load_dwordx4 v8, s[12:15], s26 offen offset:0 lds
    v_mfma_f32_16x16x32_bf16 a[44:47], v[84:87], v[220:223], a[44:47]
    buffer_load_dwordx4 v9, s[12:15], s26 offen offset:1024 lds
    buffer_load_dwordx4 v10, s[12:15], s26 offen offset:2048 lds
    v_mfma_f32_16x16x32_bf16 a[48:51], v[88:91], v[216:219], a[48:51]
    buffer_load_dwordx4 v11, s[12:15], s26 offen offset:3072 lds
    s_add_u32 s26, s26, 524288
    v_mfma_f32_16x16x32_bf16 a[52:55], v[88:91], v[220:223], a[52:55]
    v_mfma_f32_16x16x32_bf16 a[56:59], v[92:95], v[216:219], a[56:59]
    v_mfma_f32_16x16x32_bf16 a[60:63], v[92:95], v[220:223], a[60:63]
    s_sub_u32 s27, s27, 1
    s_cmp_lg_u32 s27, 0
    s_cbranch_scc1 mega_kernel_w_sk_loop
mega_kernel_w_sk_done:
    s_nop 7
    s_lshr_b32 s34, s24, 1
    s_add_u32 s34, s34, s20
    s_lshl_b32 s35, s34, 5
    s_add_u32 s35, s35, s33
    s_lshl_b32 s35, s35, 13

    s_lshl_b32 s30, s32, 24
    s_add_u32 s35, s35, s30
    s_add_u32 s35, s35, 6717440
    s_add_u32 s30, s35, 0
    v_accvgpr_read_b32 v32, a0
    v_accvgpr_read_b32 v33, a1
    v_accvgpr_read_b32 v34, a2
    v_accvgpr_read_b32 v35, a3
    v_accvgpr_read_b32 v36, a8
    v_accvgpr_read_b32 v37, a9
    v_accvgpr_read_b32 v38, a10
    v_accvgpr_read_b32 v39, a11
    v_cvt_pk_bf16_f32 v32, v32, v33
    v_cvt_pk_bf16_f32 v33, v34, v35
    v_cvt_pk_bf16_f32 v34, v36, v37
    v_cvt_pk_bf16_f32 v35, v38, v39
    buffer_store_dwordx4 v[32:35], v4, s[8:11], s30 offen offset:0 sc1
    v_accvgpr_read_b32 v40, a16
    v_accvgpr_read_b32 v41, a17
    v_accvgpr_read_b32 v42, a18
    v_accvgpr_read_b32 v43, a19
    v_accvgpr_read_b32 v44, a24
    v_accvgpr_read_b32 v45, a25
    v_accvgpr_read_b32 v46, a26
    v_accvgpr_read_b32 v47, a27
    v_cvt_pk_bf16_f32 v40, v40, v41
    v_cvt_pk_bf16_f32 v41, v42, v43
    v_cvt_pk_bf16_f32 v42, v44, v45
    v_cvt_pk_bf16_f32 v43, v46, v47
    buffer_store_dwordx4 v[40:43], v4, s[8:11], s30 offen offset:1024 sc1
    v_accvgpr_read_b32 v48, a32
    v_accvgpr_read_b32 v49, a33
    v_accvgpr_read_b32 v50, a34
    v_accvgpr_read_b32 v51, a35
    v_accvgpr_read_b32 v52, a40
    v_accvgpr_read_b32 v53, a41
    v_accvgpr_read_b32 v54, a42
    v_accvgpr_read_b32 v55, a43
    v_cvt_pk_bf16_f32 v48, v48, v49
    v_cvt_pk_bf16_f32 v49, v50, v51
    v_cvt_pk_bf16_f32 v50, v52, v53
    v_cvt_pk_bf16_f32 v51, v54, v55
    buffer_store_dwordx4 v[48:51], v4, s[8:11], s30 offen offset:2048 sc1
    v_accvgpr_read_b32 v56, a48
    v_accvgpr_read_b32 v57, a49
    v_accvgpr_read_b32 v58, a50
    v_accvgpr_read_b32 v59, a51
    v_accvgpr_read_b32 v60, a56
    v_accvgpr_read_b32 v61, a57
    v_accvgpr_read_b32 v62, a58
    v_accvgpr_read_b32 v63, a59
    v_cvt_pk_bf16_f32 v56, v56, v57
    v_cvt_pk_bf16_f32 v57, v58, v59
    v_cvt_pk_bf16_f32 v58, v60, v61
    v_cvt_pk_bf16_f32 v59, v62, v63
    buffer_store_dwordx4 v[56:59], v4, s[8:11], s30 offen offset:3072 sc1
    s_add_u32 s30, s35, 4096
    v_accvgpr_read_b32 v32, a4
    v_accvgpr_read_b32 v33, a5
    v_accvgpr_read_b32 v34, a6
    v_accvgpr_read_b32 v35, a7
    v_accvgpr_read_b32 v36, a12
    v_accvgpr_read_b32 v37, a13
    v_accvgpr_read_b32 v38, a14
    v_accvgpr_read_b32 v39, a15
    v_cvt_pk_bf16_f32 v32, v32, v33
    v_cvt_pk_bf16_f32 v33, v34, v35
    v_cvt_pk_bf16_f32 v34, v36, v37
    v_cvt_pk_bf16_f32 v35, v38, v39
    buffer_store_dwordx4 v[32:35], v4, s[8:11], s30 offen offset:0 sc1
    v_accvgpr_read_b32 v40, a20
    v_accvgpr_read_b32 v41, a21
    v_accvgpr_read_b32 v42, a22
    v_accvgpr_read_b32 v43, a23
    v_accvgpr_read_b32 v44, a28
    v_accvgpr_read_b32 v45, a29
    v_accvgpr_read_b32 v46, a30
    v_accvgpr_read_b32 v47, a31
    v_cvt_pk_bf16_f32 v40, v40, v41
    v_cvt_pk_bf16_f32 v41, v42, v43
    v_cvt_pk_bf16_f32 v42, v44, v45
    v_cvt_pk_bf16_f32 v43, v46, v47
    buffer_store_dwordx4 v[40:43], v4, s[8:11], s30 offen offset:1024 sc1
    v_accvgpr_read_b32 v48, a36
    v_accvgpr_read_b32 v49, a37
    v_accvgpr_read_b32 v50, a38
    v_accvgpr_read_b32 v51, a39
    v_accvgpr_read_b32 v52, a44
    v_accvgpr_read_b32 v53, a45
    v_accvgpr_read_b32 v54, a46
    v_accvgpr_read_b32 v55, a47
    v_cvt_pk_bf16_f32 v48, v48, v49
    v_cvt_pk_bf16_f32 v49, v50, v51
    v_cvt_pk_bf16_f32 v50, v52, v53
    v_cvt_pk_bf16_f32 v51, v54, v55
    buffer_store_dwordx4 v[48:51], v4, s[8:11], s30 offen offset:2048 sc1
    v_accvgpr_read_b32 v56, a52
    v_accvgpr_read_b32 v57, a53
    v_accvgpr_read_b32 v58, a54
    v_accvgpr_read_b32 v59, a55
    v_accvgpr_read_b32 v60, a60
    v_accvgpr_read_b32 v61, a61
    v_accvgpr_read_b32 v62, a62
    v_accvgpr_read_b32 v63, a63
    v_cvt_pk_bf16_f32 v56, v56, v57
    v_cvt_pk_bf16_f32 v57, v58, v59
    v_cvt_pk_bf16_f32 v58, v60, v61
    v_cvt_pk_bf16_f32 v59, v62, v63
    buffer_store_dwordx4 v[56:59], v4, s[8:11], s30 offen offset:3072 sc1
    s_branch mega_kernel_w_next
mega_kernel_w_kvs_v:
    s_mov_b32 s12, s48
    s_mov_b32 s13, s49
    s_mov_b32 s14, 8388608
    s_mov_b32 s15, 0x20000
    s_lshl_b32 s28, s20, 12
    v_lshrrev_b32 v5, 4, v1
    s_lshl_b32 s30, s20, 4
    v_add_u32 v5, s30, v5
    v_and_b32 v6, 15, v1
    s_mov_b32 s31, 8192
    v_add_u32 v7, 0, v5
    v_and_b32 v8, 7, v7
    v_lshlrev_b32 v8, 1, v8
    v_xor_b32 v8, v8, v6
    v_lshlrev_b32 v8, 4, v8
    v_mul_lo_u32 v7, v7, s31
    v_add_u32 v8, v8, v7
    v_add_u32 v7, 4, v5
    v_and_b32 v9, 7, v7
    v_lshlrev_b32 v9, 1, v9
    v_xor_b32 v9, v9, v6
    v_lshlrev_b32 v9, 4, v9
    v_mul_lo_u32 v7, v7, s31
    v_add_u32 v9, v9, v7
    v_subrev_u32 v9, 1024, v9
    v_add_u32 v7, 8, v5
    v_and_b32 v10, 7, v7
    v_lshlrev_b32 v10, 1, v10
    v_xor_b32 v10, v10, v6
    v_lshlrev_b32 v10, 4, v10
    v_mul_lo_u32 v7, v7, s31
    v_add_u32 v10, v10, v7
    v_subrev_u32 v10, 2048, v10
    v_add_u32 v7, 12, v5
    v_and_b32 v11, 7, v7
    v_lshlrev_b32 v11, 1, v11
    v_xor_b32 v11, v11, v6
    v_lshlrev_b32 v11, 4, v11
    v_mul_lo_u32 v7, v7, s31
    v_add_u32 v11, v11, v7
    v_subrev_u32 v11, 3072, v11
    v_lshrrev_b32 v5, 2, v2
    v_lshl_add_u32 v5, v3, 2, v5
    v_and_b32 v6, 7, v5
    v_lshlrev_b32 v6, 5, v6
    v_lshlrev_b32 v5, 8, v5
    v_and_b32 v7, 3, v2
    v_lshl_add_u32 v5, v7, 3, v5
    v_xor_b32 v14, 0, v6
    v_add_u32 v14, v14, v5
    v_add_u32 v22, 0x10000, v14
    v_xor_b32 v15, 32, v6
    v_add_u32 v15, v15, v5
    v_add_u32 v23, 0x10000, v15
    v_xor_b32 v16, 64, v6
    v_add_u32 v16, v16, v5
    v_add_u32 v24, 0x10000, v16
    v_xor_b32 v17, 96, v6
    v_add_u32 v17, v17, v5
    v_add_u32 v25, 0x10000, v17
    v_xor_b32 v18, 128, v6
    v_add_u32 v18, v18, v5
    v_add_u32 v26, 0x10000, v18
    v_xor_b32 v19, 160, v6
    v_add_u32 v19, v19, v5
    v_add_u32 v27, 0x10000, v19
    v_xor_b32 v20, 192, v6
    v_add_u32 v20, v20, v5
    v_add_u32 v28, 0x10000, v20
    v_xor_b32 v21, 224, v6
    v_add_u32 v21, v21, v5
    v_add_u32 v29, 0x10000, v21
    s_mul_i32 s30, s20, 65536
    v_add_u32 v12, s30, v4
    v_add_u32 v13, 32768, v12
    s_lshl_b32 s25, s24, 15
    s_add_u32 s25, s25, 2523136
    s_lshl_b32 s26, s33, 8

    s_add_u32 m0, s28, 0
    s_nop 0
    buffer_load_dwordx4 v8, s[12:15], s26 offen offset:0 lds
    buffer_load_dwordx4 v9, s[12:15], s26 offen offset:1024 lds
    buffer_load_dwordx4 v10, s[12:15], s26 offen offset:2048 lds
    buffer_load_dwordx4 v11, s[12:15], s26 offen offset:3072 lds
    s_add_u32 s26, s26, 524288
    buffer_load_dwordx4 v[96:99], v12, s[8:11], s25 offen sc1
    buffer_load_dwordx4 v[100:103], v13, s[8:11], s25 offen sc1
    s_add_u32 s25, s25, 1024
    buffer_load_dwordx4 v[104:107], v12, s[8:11], s25 offen sc1
    buffer_load_dwordx4 v[108:111], v13, s[8:11], s25 offen sc1
    s_add_u32 s25, s25, 1024
    s_add_u32 m0, s28, 16384
    s_nop 0
    buffer_load_dwordx4 v8, s[12:15], s26 offen offset:0 lds
    buffer_load_dwordx4 v9, s[12:15], s26 offen offset:1024 lds
    buffer_load_dwordx4 v10, s[12:15], s26 offen offset:2048 lds
    buffer_load_dwordx4 v11, s[12:15], s26 offen offset:3072 lds
    s_add_u32 s26, s26, 524288
    buffer_load_dwordx4 v[112:115], v12, s[8:11], s25 offen sc1
    buffer_load_dwordx4 v[116:119], v13, s[8:11], s25 offen sc1
    s_add_u32 s25, s25, 1024
    buffer_load_dwordx4 v[120:123], v12, s[8:11], s25 offen sc1
    buffer_load_dwordx4 v[124:127], v13, s[8:11], s25 offen sc1
    s_add_u32 s25, s25, 1024
    s_add_u32 m0, s28, 32768
    s_nop 0
    buffer_load_dwordx4 v8, s[12:15], s26 offen offset:0 lds
    buffer_load_dwordx4 v9, s[12:15], s26 offen offset:1024 lds
    buffer_load_dwordx4 v10, s[12:15], s26 offen offset:2048 lds
    buffer_load_dwordx4 v11, s[12:15], s26 offen offset:3072 lds
    s_add_u32 s26, s26, 524288
    buffer_load_dwordx4 v[128:131], v12, s[8:11], s25 offen sc1
    buffer_load_dwordx4 v[132:135], v13, s[8:11], s25 offen sc1
    s_add_u32 s25, s25, 1024
    buffer_load_dwordx4 v[136:139], v12, s[8:11], s25 offen sc1
    buffer_load_dwordx4 v[140:143], v13, s[8:11], s25 offen sc1
    s_add_u32 s25, s25, 1024
    s_add_u32 m0, s28, 49152
    s_nop 0
    buffer_load_dwordx4 v8, s[12:15], s26 offen offset:0 lds
    buffer_load_dwordx4 v9, s[12:15], s26 offen offset:1024 lds
    buffer_load_dwordx4 v10, s[12:15], s26 offen offset:2048 lds
    buffer_load_dwordx4 v11, s[12:15], s26 offen offset:3072 lds
    s_add_u32 s26, s26, 524288
    buffer_load_dwordx4 v[144:147], v12, s[8:11], s25 offen sc1
    buffer_load_dwordx4 v[148:151], v13, s[8:11], s25 offen sc1
    s_add_u32 s25, s25, 1024
    buffer_load_dwordx4 v[152:155], v12, s[8:11], s25 offen sc1
    buffer_load_dwordx4 v[156:159], v13, s[8:11], s25 offen sc1
    s_add_u32 s25, s25, 1024
    s_add_u32 m0, s28, 65536
    s_nop 0
    buffer_load_dwordx4 v8, s[12:15], s26 offen offset:0 lds
    buffer_load_dwordx4 v9, s[12:15], s26 offen offset:1024 lds
    buffer_load_dwordx4 v10, s[12:15], s26 offen offset:2048 lds
    buffer_load_dwordx4 v11, s[12:15], s26 offen offset:3072 lds
    s_add_u32 s26, s26, 524288
    buffer_load_dwordx4 v[160:163], v12, s[8:11], s25 offen sc1
    buffer_load_dwordx4 v[164:167], v13, s[8:11], s25 offen sc1
    s_add_u32 s25, s25, 1024
    buffer_load_dwordx4 v[168:171], v12, s[8:11], s25 offen sc1
    buffer_load_dwordx4 v[172:175], v13, s[8:11], s25 offen sc1
    s_add_u32 s25, s25, 1024
    s_add_u32 m0, s28, 81920
    s_nop 0
    buffer_load_dwordx4 v8, s[12:15], s26 offen offset:0 lds
    buffer_load_dwordx4 v9, s[12:15], s26 offen offset:1024 lds
    buffer_load_dwordx4 v10, s[12:15], s26 offen offset:2048 lds
    buffer_load_dwordx4 v11, s[12:15], s26 offen offset:3072 lds
    s_add_u32 s26, s26, 524288
    buffer_load_dwordx4 v[176:179], v12, s[8:11], s25 offen sc1
    buffer_load_dwordx4 v[180:183], v13, s[8:11], s25 offen sc1
    s_add_u32 s25, s25, 1024
    buffer_load_dwordx4 v[184:187], v12, s[8:11], s25 offen sc1
    buffer_load_dwordx4 v[188:191], v13, s[8:11], s25 offen sc1
    s_add_u32 s25, s25, 1024
    s_add_u32 m0, s28, 98304
    s_nop 0
    buffer_load_dwordx4 v8, s[12:15], s26 offen offset:0 lds
    buffer_load_dwordx4 v9, s[12:15], s26 offen offset:1024 lds
    buffer_load_dwordx4 v10, s[12:15], s26 offen offset:2048 lds
    buffer_load_dwordx4 v11, s[12:15], s26 offen offset:3072 lds
    s_add_u32 s26, s26, 524288
    buffer_load_dwordx4 v[192:195], v12, s[8:11], s25 offen sc1
    buffer_load_dwordx4 v[196:199], v13, s[8:11], s25 offen sc1
    s_add_u32 s25, s25, 1024
    buffer_load_dwordx4 v[200:203], v12, s[8:11], s25 offen sc1
    buffer_load_dwordx4 v[204:207], v13, s[8:11], s25 offen sc1
    s_add_u32 s25, s25, 1024
    s_add_u32 m0, s28, 114688
    s_nop 0
    buffer_load_dwordx4 v8, s[12:15], s26 offen offset:0 lds
    buffer_load_dwordx4 v9, s[12:15], s26 offen offset:1024 lds
    buffer_load_dwordx4 v10, s[12:15], s26 offen offset:2048 lds
    buffer_load_dwordx4 v11, s[12:15], s26 offen offset:3072 lds
    s_add_u32 s26, s26, 524288
    buffer_load_dwordx4 v[208:211], v12, s[8:11], s25 offen sc1
    buffer_load_dwordx4 v[212:215], v13, s[8:11], s25 offen sc1
    s_add_u32 s25, s25, 1024
    v_accvgpr_write_b32 a0, 0
    v_accvgpr_write_b32 a1, 0
    v_accvgpr_write_b32 a2, 0
    v_accvgpr_write_b32 a3, 0
    v_accvgpr_write_b32 a4, 0
    v_accvgpr_write_b32 a5, 0
    v_accvgpr_write_b32 a6, 0
    v_accvgpr_write_b32 a7, 0
    v_accvgpr_write_b32 a8, 0
    v_accvgpr_write_b32 a9, 0
    v_accvgpr_write_b32 a10, 0
    v_accvgpr_write_b32 a11, 0
    v_accvgpr_write_b32 a12, 0
    v_accvgpr_write_b32 a13, 0
    v_accvgpr_write_b32 a14, 0
    v_accvgpr_write_b32 a15, 0
    v_accvgpr_write_b32 a16, 0
    v_accvgpr_write_b32 a17, 0
    v_accvgpr_write_b32 a18, 0
    v_accvgpr_write_b32 a19, 0
    v_accvgpr_write_b32 a20, 0
    v_accvgpr_write_b32 a21, 0
    v_accvgpr_write_b32 a22, 0
    v_accvgpr_write_b32 a23, 0
    v_accvgpr_write_b32 a24, 0
    v_accvgpr_write_b32 a25, 0
    v_accvgpr_write_b32 a26, 0
    v_accvgpr_write_b32 a27, 0
    v_accvgpr_write_b32 a28, 0
    v_accvgpr_write_b32 a29, 0
    v_accvgpr_write_b32 a30, 0
    v_accvgpr_write_b32 a31, 0
    v_accvgpr_write_b32 a32, 0
    v_accvgpr_write_b32 a33, 0
    v_accvgpr_write_b32 a34, 0
    v_accvgpr_write_b32 a35, 0
    v_accvgpr_write_b32 a36, 0
    v_accvgpr_write_b32 a37, 0
    v_accvgpr_write_b32 a38, 0
    v_accvgpr_write_b32 a39, 0
    v_accvgpr_write_b32 a40, 0
    v_accvgpr_write_b32 a41, 0
    v_accvgpr_write_b32 a42, 0
    v_accvgpr_write_b32 a43, 0
    v_accvgpr_write_b32 a44, 0
    v_accvgpr_write_b32 a45, 0
    v_accvgpr_write_b32 a46, 0
    v_accvgpr_write_b32 a47, 0
    v_accvgpr_write_b32 a48, 0
    v_accvgpr_write_b32 a49, 0
    v_accvgpr_write_b32 a50, 0
    v_accvgpr_write_b32 a51, 0
    v_accvgpr_write_b32 a52, 0
    v_accvgpr_write_b32 a53, 0
    v_accvgpr_write_b32 a54, 0
    v_accvgpr_write_b32 a55, 0
    v_accvgpr_write_b32 a56, 0
    v_accvgpr_write_b32 a57, 0
    v_accvgpr_write_b32 a58, 0
    v_accvgpr_write_b32 a59, 0
    v_accvgpr_write_b32 a60, 0
    v_accvgpr_write_b32 a61, 0
    v_accvgpr_write_b32 a62, 0
    v_accvgpr_write_b32 a63, 0
    s_mov_b32 s27, 2
    s_waitcnt vmcnt(58)
    s_barrier
    ds_read_b64_tr_b16 v[32:33], v14 offset:0
    ds_read_b64_tr_b16 v[34:35], v14 offset:4096
    ds_read_b64_tr_b16 v[36:37], v15 offset:0
    ds_read_b64_tr_b16 v[38:39], v15 offset:4096
    ds_read_b64_tr_b16 v[40:41], v16 offset:0
    ds_read_b64_tr_b16 v[42:43], v16 offset:4096
    ds_read_b64_tr_b16 v[44:45], v17 offset:0
    ds_read_b64_tr_b16 v[46:47], v17 offset:4096
    ds_read_b64_tr_b16 v[48:49], v18 offset:0
    ds_read_b64_tr_b16 v[50:51], v18 offset:4096
    ds_read_b64_tr_b16 v[52:53], v19 offset:0
    ds_read_b64_tr_b16 v[54:55], v19 offset:4096
    ds_read_b64_tr_b16 v[56:57], v20 offset:0
    ds_read_b64_tr_b16 v[58:59], v20 offset:4096
    ds_read_b64_tr_b16 v[60:61], v21 offset:0
    ds_read_b64_tr_b16 v[62:63], v21 offset:4096
mega_kernel_w_sv_loop:
    s_waitcnt vmcnt(56) lgkmcnt(0)
    v_mfma_f32_16x16x32_bf16 a[0:3], v[96:99], v[32:35], a[0:3]
    ds_read_b64_tr_b16 v[64:65], v14 offset:8192
    ds_read_b64_tr_b16 v[66:67], v14 offset:12288
    v_mfma_f32_16x16x32_bf16 a[32:35], v[100:103], v[32:35], a[32:35]
    ds_read_b64_tr_b16 v[68:69], v15 offset:8192
    ds_read_b64_tr_b16 v[70:71], v15 offset:12288
    v_mfma_f32_16x16x32_bf16 a[4:7], v[96:99], v[36:39], a[4:7]
    ds_read_b64_tr_b16 v[72:73], v16 offset:8192
    ds_read_b64_tr_b16 v[74:75], v16 offset:12288
    v_mfma_f32_16x16x32_bf16 a[36:39], v[100:103], v[36:39], a[36:39]
    ds_read_b64_tr_b16 v[76:77], v17 offset:8192
    ds_read_b64_tr_b16 v[78:79], v17 offset:12288
    v_mfma_f32_16x16x32_bf16 a[8:11], v[96:99], v[40:43], a[8:11]
    ds_read_b64_tr_b16 v[80:81], v18 offset:8192
    ds_read_b64_tr_b16 v[82:83], v18 offset:12288
    v_mfma_f32_16x16x32_bf16 a[40:43], v[100:103], v[40:43], a[40:43]
    ds_read_b64_tr_b16 v[84:85], v19 offset:8192
    ds_read_b64_tr_b16 v[86:87], v19 offset:12288
    v_mfma_f32_16x16x32_bf16 a[12:15], v[96:99], v[44:47], a[12:15]
    ds_read_b64_tr_b16 v[88:89], v20 offset:8192
    ds_read_b64_tr_b16 v[90:91], v20 offset:12288
    v_mfma_f32_16x16x32_bf16 a[44:47], v[100:103], v[44:47], a[44:47]
    ds_read_b64_tr_b16 v[92:93], v21 offset:8192
    ds_read_b64_tr_b16 v[94:95], v21 offset:12288
    v_mfma_f32_16x16x32_bf16 a[16:19], v[96:99], v[48:51], a[16:19]
    buffer_load_dwordx4 v[216:219], v12, s[8:11], s25 offen sc1
    buffer_load_dwordx4 v[220:223], v13, s[8:11], s25 offen sc1
    v_mfma_f32_16x16x32_bf16 a[48:51], v[100:103], v[48:51], a[48:51]
    s_add_u32 s25, s25, 1024
    v_mfma_f32_16x16x32_bf16 a[20:23], v[96:99], v[52:55], a[20:23]
    v_mfma_f32_16x16x32_bf16 a[52:55], v[100:103], v[52:55], a[52:55]
    v_mfma_f32_16x16x32_bf16 a[24:27], v[96:99], v[56:59], a[24:27]
    v_mfma_f32_16x16x32_bf16 a[56:59], v[100:103], v[56:59], a[56:59]
    v_mfma_f32_16x16x32_bf16 a[28:31], v[96:99], v[60:63], a[28:31]
    v_mfma_f32_16x16x32_bf16 a[60:63], v[100:103], v[60:63], a[60:63]
    s_waitcnt vmcnt(50) lgkmcnt(0)
    s_barrier
    v_mfma_f32_16x16x32_bf16 a[0:3], v[104:107], v[64:67], a[0:3]
    ds_read_b64_tr_b16 v[32:33], v14 offset:16384
    ds_read_b64_tr_b16 v[34:35], v14 offset:20480
    v_mfma_f32_16x16x32_bf16 a[32:35], v[108:111], v[64:67], a[32:35]
    ds_read_b64_tr_b16 v[36:37], v15 offset:16384
    ds_read_b64_tr_b16 v[38:39], v15 offset:20480
    v_mfma_f32_16x16x32_bf16 a[4:7], v[104:107], v[68:71], a[4:7]
    ds_read_b64_tr_b16 v[40:41], v16 offset:16384
    ds_read_b64_tr_b16 v[42:43], v16 offset:20480
    v_mfma_f32_16x16x32_bf16 a[36:39], v[108:111], v[68:71], a[36:39]
    ds_read_b64_tr_b16 v[44:45], v17 offset:16384
    ds_read_b64_tr_b16 v[46:47], v17 offset:20480
    v_mfma_f32_16x16x32_bf16 a[8:11], v[104:107], v[72:75], a[8:11]
    ds_read_b64_tr_b16 v[48:49], v18 offset:16384
    ds_read_b64_tr_b16 v[50:51], v18 offset:20480
    v_mfma_f32_16x16x32_bf16 a[40:43], v[108:111], v[72:75], a[40:43]
    ds_read_b64_tr_b16 v[52:53], v19 offset:16384
    ds_read_b64_tr_b16 v[54:55], v19 offset:20480
    v_mfma_f32_16x16x32_bf16 a[12:15], v[104:107], v[76:79], a[12:15]
    ds_read_b64_tr_b16 v[56:57], v20 offset:16384
    ds_read_b64_tr_b16 v[58:59], v20 offset:20480
    v_mfma_f32_16x16x32_bf16 a[44:47], v[108:111], v[76:79], a[44:47]
    ds_read_b64_tr_b16 v[60:61], v21 offset:16384
    ds_read_b64_tr_b16 v[62:63], v21 offset:20480
    v_mfma_f32_16x16x32_bf16 a[16:19], v[104:107], v[80:83], a[16:19]
    buffer_load_dwordx4 v[96:99], v12, s[8:11], s25 offen sc1
    buffer_load_dwordx4 v[100:103], v13, s[8:11], s25 offen sc1
    v_mfma_f32_16x16x32_bf16 a[48:51], v[108:111], v[80:83], a[48:51]
    s_add_u32 s25, s25, 1024
    s_add_u32 m0, s28, 0
    v_mfma_f32_16x16x32_bf16 a[20:23], v[104:107], v[84:87], a[20:23]
    s_nop 0
    buffer_load_dwordx4 v8, s[12:15], s26 offen offset:0 lds
    v_mfma_f32_16x16x32_bf16 a[52:55], v[108:111], v[84:87], a[52:55]
    buffer_load_dwordx4 v9, s[12:15], s26 offen offset:1024 lds
    buffer_load_dwordx4 v10, s[12:15], s26 offen offset:2048 lds
    v_mfma_f32_16x16x32_bf16 a[24:27], v[104:107], v[88:91], a[24:27]
    buffer_load_dwordx4 v11, s[12:15], s26 offen offset:3072 lds
    s_add_u32 s26, s26, 524288
    v_mfma_f32_16x16x32_bf16 a[56:59], v[108:111], v[88:91], a[56:59]
    v_mfma_f32_16x16x32_bf16 a[28:31], v[104:107], v[92:95], a[28:31]
    v_mfma_f32_16x16x32_bf16 a[60:63], v[108:111], v[92:95], a[60:63]
    s_waitcnt vmcnt(56) lgkmcnt(0)
    v_mfma_f32_16x16x32_bf16 a[0:3], v[112:115], v[32:35], a[0:3]
    ds_read_b64_tr_b16 v[64:65], v14 offset:24576
    ds_read_b64_tr_b16 v[66:67], v14 offset:28672
    v_mfma_f32_16x16x32_bf16 a[32:35], v[116:119], v[32:35], a[32:35]
    ds_read_b64_tr_b16 v[68:69], v15 offset:24576
    ds_read_b64_tr_b16 v[70:71], v15 offset:28672
    v_mfma_f32_16x16x32_bf16 a[4:7], v[112:115], v[36:39], a[4:7]
    ds_read_b64_tr_b16 v[72:73], v16 offset:24576
    ds_read_b64_tr_b16 v[74:75], v16 offset:28672
    v_mfma_f32_16x16x32_bf16 a[36:39], v[116:119], v[36:39], a[36:39]
    ds_read_b64_tr_b16 v[76:77], v17 offset:24576
    ds_read_b64_tr_b16 v[78:79], v17 offset:28672
    v_mfma_f32_16x16x32_bf16 a[8:11], v[112:115], v[40:43], a[8:11]
    ds_read_b64_tr_b16 v[80:81], v18 offset:24576
    ds_read_b64_tr_b16 v[82:83], v18 offset:28672
    v_mfma_f32_16x16x32_bf16 a[40:43], v[116:119], v[40:43], a[40:43]
    ds_read_b64_tr_b16 v[84:85], v19 offset:24576
    ds_read_b64_tr_b16 v[86:87], v19 offset:28672
    v_mfma_f32_16x16x32_bf16 a[12:15], v[112:115], v[44:47], a[12:15]
    ds_read_b64_tr_b16 v[88:89], v20 offset:24576
    ds_read_b64_tr_b16 v[90:91], v20 offset:28672
    v_mfma_f32_16x16x32_bf16 a[44:47], v[116:119], v[44:47], a[44:47]
    ds_read_b64_tr_b16 v[92:93], v21 offset:24576
    ds_read_b64_tr_b16 v[94:95], v21 offset:28672
    v_mfma_f32_16x16x32_bf16 a[16:19], v[112:115], v[48:51], a[16:19]
    buffer_load_dwordx4 v[104:107], v12, s[8:11], s25 offen sc1
    buffer_load_dwordx4 v[108:111], v13, s[8:11], s25 offen sc1
    v_mfma_f32_16x16x32_bf16 a[48:51], v[116:119], v[48:51], a[48:51]
    s_add_u32 s25, s25, 1024
    v_mfma_f32_16x16x32_bf16 a[20:23], v[112:115], v[52:55], a[20:23]
    v_mfma_f32_16x16x32_bf16 a[52:55], v[116:119], v[52:55], a[52:55]
    v_mfma_f32_16x16x32_bf16 a[24:27], v[112:115], v[56:59], a[24:27]
    v_mfma_f32_16x16x32_bf16 a[56:59], v[116:119], v[56:59], a[56:59]
    v_mfma_f32_16x16x32_bf16 a[28:31], v[112:115], v[60:63], a[28:31]
    v_mfma_f32_16x16x32_bf16 a[60:63], v[116:119], v[60:63], a[60:63]
    s_waitcnt vmcnt(50) lgkmcnt(0)
    s_barrier
    v_mfma_f32_16x16x32_bf16 a[0:3], v[120:123], v[64:67], a[0:3]
    ds_read_b64_tr_b16 v[32:33], v14 offset:32768
    ds_read_b64_tr_b16 v[34:35], v14 offset:36864
    v_mfma_f32_16x16x32_bf16 a[32:35], v[124:127], v[64:67], a[32:35]
    ds_read_b64_tr_b16 v[36:37], v15 offset:32768
    ds_read_b64_tr_b16 v[38:39], v15 offset:36864
    v_mfma_f32_16x16x32_bf16 a[4:7], v[120:123], v[68:71], a[4:7]
    ds_read_b64_tr_b16 v[40:41], v16 offset:32768
    ds_read_b64_tr_b16 v[42:43], v16 offset:36864
    v_mfma_f32_16x16x32_bf16 a[36:39], v[124:127], v[68:71], a[36:39]
    ds_read_b64_tr_b16 v[44:45], v17 offset:32768
    ds_read_b64_tr_b16 v[46:47], v17 offset:36864
    v_mfma_f32_16x16x32_bf16 a[8:11], v[120:123], v[72:75], a[8:11]
    ds_read_b64_tr_b16 v[48:49], v18 offset:32768
    ds_read_b64_tr_b16 v[50:51], v18 offset:36864
    v_mfma_f32_16x16x32_bf16 a[40:43], v[124:127], v[72:75], a[40:43]
    ds_read_b64_tr_b16 v[52:53], v19 offset:32768
    ds_read_b64_tr_b16 v[54:55], v19 offset:36864
    v_mfma_f32_16x16x32_bf16 a[12:15], v[120:123], v[76:79], a[12:15]
    ds_read_b64_tr_b16 v[56:57], v20 offset:32768
    ds_read_b64_tr_b16 v[58:59], v20 offset:36864
    v_mfma_f32_16x16x32_bf16 a[44:47], v[124:127], v[76:79], a[44:47]
    ds_read_b64_tr_b16 v[60:61], v21 offset:32768
    ds_read_b64_tr_b16 v[62:63], v21 offset:36864
    v_mfma_f32_16x16x32_bf16 a[16:19], v[120:123], v[80:83], a[16:19]
    buffer_load_dwordx4 v[112:115], v12, s[8:11], s25 offen sc1
    buffer_load_dwordx4 v[116:119], v13, s[8:11], s25 offen sc1
    v_mfma_f32_16x16x32_bf16 a[48:51], v[124:127], v[80:83], a[48:51]
    s_add_u32 s25, s25, 1024
    s_add_u32 m0, s28, 16384
    v_mfma_f32_16x16x32_bf16 a[20:23], v[120:123], v[84:87], a[20:23]
    s_nop 0
    buffer_load_dwordx4 v8, s[12:15], s26 offen offset:0 lds
    v_mfma_f32_16x16x32_bf16 a[52:55], v[124:127], v[84:87], a[52:55]
    buffer_load_dwordx4 v9, s[12:15], s26 offen offset:1024 lds
    buffer_load_dwordx4 v10, s[12:15], s26 offen offset:2048 lds
    v_mfma_f32_16x16x32_bf16 a[24:27], v[120:123], v[88:91], a[24:27]
    buffer_load_dwordx4 v11, s[12:15], s26 offen offset:3072 lds
    s_add_u32 s26, s26, 524288
    v_mfma_f32_16x16x32_bf16 a[56:59], v[124:127], v[88:91], a[56:59]
    v_mfma_f32_16x16x32_bf16 a[28:31], v[120:123], v[92:95], a[28:31]
    v_mfma_f32_16x16x32_bf16 a[60:63], v[124:127], v[92:95], a[60:63]
    s_waitcnt vmcnt(56) lgkmcnt(0)
    v_mfma_f32_16x16x32_bf16 a[0:3], v[128:131], v[32:35], a[0:3]
    ds_read_b64_tr_b16 v[64:65], v14 offset:40960
    ds_read_b64_tr_b16 v[66:67], v14 offset:45056
    v_mfma_f32_16x16x32_bf16 a[32:35], v[132:135], v[32:35], a[32:35]
    ds_read_b64_tr_b16 v[68:69], v15 offset:40960
    ds_read_b64_tr_b16 v[70:71], v15 offset:45056
    v_mfma_f32_16x16x32_bf16 a[4:7], v[128:131], v[36:39], a[4:7]
    ds_read_b64_tr_b16 v[72:73], v16 offset:40960
    ds_read_b64_tr_b16 v[74:75], v16 offset:45056
    v_mfma_f32_16x16x32_bf16 a[36:39], v[132:135], v[36:39], a[36:39]
    ds_read_b64_tr_b16 v[76:77], v17 offset:40960
    ds_read_b64_tr_b16 v[78:79], v17 offset:45056
    v_mfma_f32_16x16x32_bf16 a[8:11], v[128:131], v[40:43], a[8:11]
    ds_read_b64_tr_b16 v[80:81], v18 offset:40960
    ds_read_b64_tr_b16 v[82:83], v18 offset:45056
    v_mfma_f32_16x16x32_bf16 a[40:43], v[132:135], v[40:43], a[40:43]
    ds_read_b64_tr_b16 v[84:85], v19 offset:40960
    ds_read_b64_tr_b16 v[86:87], v19 offset:45056
    v_mfma_f32_16x16x32_bf16 a[12:15], v[128:131], v[44:47], a[12:15]
    ds_read_b64_tr_b16 v[88:89], v20 offset:40960
    ds_read_b64_tr_b16 v[90:91], v20 offset:45056
    v_mfma_f32_16x16x32_bf16 a[44:47], v[132:135], v[44:47], a[44:47]
    ds_read_b64_tr_b16 v[92:93], v21 offset:40960
    ds_read_b64_tr_b16 v[94:95], v21 offset:45056
    v_mfma_f32_16x16x32_bf16 a[16:19], v[128:131], v[48:51], a[16:19]
    buffer_load_dwordx4 v[120:123], v12, s[8:11], s25 offen sc1
    buffer_load_dwordx4 v[124:127], v13, s[8:11], s25 offen sc1
    v_mfma_f32_16x16x32_bf16 a[48:51], v[132:135], v[48:51], a[48:51]
    s_add_u32 s25, s25, 1024
    v_mfma_f32_16x16x32_bf16 a[20:23], v[128:131], v[52:55], a[20:23]
    v_mfma_f32_16x16x32_bf16 a[52:55], v[132:135], v[52:55], a[52:55]
    v_mfma_f32_16x16x32_bf16 a[24:27], v[128:131], v[56:59], a[24:27]
    v_mfma_f32_16x16x32_bf16 a[56:59], v[132:135], v[56:59], a[56:59]
    v_mfma_f32_16x16x32_bf16 a[28:31], v[128:131], v[60:63], a[28:31]
    v_mfma_f32_16x16x32_bf16 a[60:63], v[132:135], v[60:63], a[60:63]
    s_waitcnt vmcnt(50) lgkmcnt(0)
    s_barrier
    v_mfma_f32_16x16x32_bf16 a[0:3], v[136:139], v[64:67], a[0:3]
    ds_read_b64_tr_b16 v[32:33], v14 offset:49152
    ds_read_b64_tr_b16 v[34:35], v14 offset:53248
    v_mfma_f32_16x16x32_bf16 a[32:35], v[140:143], v[64:67], a[32:35]
    ds_read_b64_tr_b16 v[36:37], v15 offset:49152
    ds_read_b64_tr_b16 v[38:39], v15 offset:53248
    v_mfma_f32_16x16x32_bf16 a[4:7], v[136:139], v[68:71], a[4:7]
    ds_read_b64_tr_b16 v[40:41], v16 offset:49152
    ds_read_b64_tr_b16 v[42:43], v16 offset:53248
    v_mfma_f32_16x16x32_bf16 a[36:39], v[140:143], v[68:71], a[36:39]
    ds_read_b64_tr_b16 v[44:45], v17 offset:49152
    ds_read_b64_tr_b16 v[46:47], v17 offset:53248
    v_mfma_f32_16x16x32_bf16 a[8:11], v[136:139], v[72:75], a[8:11]
    ds_read_b64_tr_b16 v[48:49], v18 offset:49152
    ds_read_b64_tr_b16 v[50:51], v18 offset:53248
    v_mfma_f32_16x16x32_bf16 a[40:43], v[140:143], v[72:75], a[40:43]
    ds_read_b64_tr_b16 v[52:53], v19 offset:49152
    ds_read_b64_tr_b16 v[54:55], v19 offset:53248
    v_mfma_f32_16x16x32_bf16 a[12:15], v[136:139], v[76:79], a[12:15]
    ds_read_b64_tr_b16 v[56:57], v20 offset:49152
    ds_read_b64_tr_b16 v[58:59], v20 offset:53248
    v_mfma_f32_16x16x32_bf16 a[44:47], v[140:143], v[76:79], a[44:47]
    ds_read_b64_tr_b16 v[60:61], v21 offset:49152
    ds_read_b64_tr_b16 v[62:63], v21 offset:53248
    v_mfma_f32_16x16x32_bf16 a[16:19], v[136:139], v[80:83], a[16:19]
    buffer_load_dwordx4 v[128:131], v12, s[8:11], s25 offen sc1
    buffer_load_dwordx4 v[132:135], v13, s[8:11], s25 offen sc1
    v_mfma_f32_16x16x32_bf16 a[48:51], v[140:143], v[80:83], a[48:51]
    s_add_u32 s25, s25, 1024
    s_add_u32 m0, s28, 32768
    v_mfma_f32_16x16x32_bf16 a[20:23], v[136:139], v[84:87], a[20:23]
    s_nop 0
    buffer_load_dwordx4 v8, s[12:15], s26 offen offset:0 lds
    v_mfma_f32_16x16x32_bf16 a[52:55], v[140:143], v[84:87], a[52:55]
    buffer_load_dwordx4 v9, s[12:15], s26 offen offset:1024 lds
    buffer_load_dwordx4 v10, s[12:15], s26 offen offset:2048 lds
    v_mfma_f32_16x16x32_bf16 a[24:27], v[136:139], v[88:91], a[24:27]
    buffer_load_dwordx4 v11, s[12:15], s26 offen offset:3072 lds
    s_add_u32 s26, s26, 524288
    v_mfma_f32_16x16x32_bf16 a[56:59], v[140:143], v[88:91], a[56:59]
    v_mfma_f32_16x16x32_bf16 a[28:31], v[136:139], v[92:95], a[28:31]
    v_mfma_f32_16x16x32_bf16 a[60:63], v[140:143], v[92:95], a[60:63]
    s_waitcnt vmcnt(56) lgkmcnt(0)
    v_mfma_f32_16x16x32_bf16 a[0:3], v[144:147], v[32:35], a[0:3]
    ds_read_b64_tr_b16 v[64:65], v14 offset:57344
    ds_read_b64_tr_b16 v[66:67], v14 offset:61440
    v_mfma_f32_16x16x32_bf16 a[32:35], v[148:151], v[32:35], a[32:35]
    ds_read_b64_tr_b16 v[68:69], v15 offset:57344
    ds_read_b64_tr_b16 v[70:71], v15 offset:61440
    v_mfma_f32_16x16x32_bf16 a[4:7], v[144:147], v[36:39], a[4:7]
    ds_read_b64_tr_b16 v[72:73], v16 offset:57344
    ds_read_b64_tr_b16 v[74:75], v16 offset:61440
    v_mfma_f32_16x16x32_bf16 a[36:39], v[148:151], v[36:39], a[36:39]
    ds_read_b64_tr_b16 v[76:77], v17 offset:57344
    ds_read_b64_tr_b16 v[78:79], v17 offset:61440
    v_mfma_f32_16x16x32_bf16 a[8:11], v[144:147], v[40:43], a[8:11]
    ds_read_b64_tr_b16 v[80:81], v18 offset:57344
    ds_read_b64_tr_b16 v[82:83], v18 offset:61440
    v_mfma_f32_16x16x32_bf16 a[40:43], v[148:151], v[40:43], a[40:43]
    ds_read_b64_tr_b16 v[84:85], v19 offset:57344
    ds_read_b64_tr_b16 v[86:87], v19 offset:61440
    v_mfma_f32_16x16x32_bf16 a[12:15], v[144:147], v[44:47], a[12:15]
    ds_read_b64_tr_b16 v[88:89], v20 offset:57344
    ds_read_b64_tr_b16 v[90:91], v20 offset:61440
    v_mfma_f32_16x16x32_bf16 a[44:47], v[148:151], v[44:47], a[44:47]
    ds_read_b64_tr_b16 v[92:93], v21 offset:57344
    ds_read_b64_tr_b16 v[94:95], v21 offset:61440
    v_mfma_f32_16x16x32_bf16 a[16:19], v[144:147], v[48:51], a[16:19]
    buffer_load_dwordx4 v[136:139], v12, s[8:11], s25 offen sc1
    buffer_load_dwordx4 v[140:143], v13, s[8:11], s25 offen sc1
    v_mfma_f32_16x16x32_bf16 a[48:51], v[148:151], v[48:51], a[48:51]
    s_add_u32 s25, s25, 1024
    v_mfma_f32_16x16x32_bf16 a[20:23], v[144:147], v[52:55], a[20:23]
    v_mfma_f32_16x16x32_bf16 a[52:55], v[148:151], v[52:55], a[52:55]
    v_mfma_f32_16x16x32_bf16 a[24:27], v[144:147], v[56:59], a[24:27]
    v_mfma_f32_16x16x32_bf16 a[56:59], v[148:151], v[56:59], a[56:59]
    v_mfma_f32_16x16x32_bf16 a[28:31], v[144:147], v[60:63], a[28:31]
    v_mfma_f32_16x16x32_bf16 a[60:63], v[148:151], v[60:63], a[60:63]
    s_waitcnt vmcnt(50) lgkmcnt(0)
    s_barrier
    v_mfma_f32_16x16x32_bf16 a[0:3], v[152:155], v[64:67], a[0:3]
    ds_read_b64_tr_b16 v[32:33], v22 offset:0
    ds_read_b64_tr_b16 v[34:35], v22 offset:4096
    v_mfma_f32_16x16x32_bf16 a[32:35], v[156:159], v[64:67], a[32:35]
    ds_read_b64_tr_b16 v[36:37], v23 offset:0
    ds_read_b64_tr_b16 v[38:39], v23 offset:4096
    v_mfma_f32_16x16x32_bf16 a[4:7], v[152:155], v[68:71], a[4:7]
    ds_read_b64_tr_b16 v[40:41], v24 offset:0
    ds_read_b64_tr_b16 v[42:43], v24 offset:4096
    v_mfma_f32_16x16x32_bf16 a[36:39], v[156:159], v[68:71], a[36:39]
    ds_read_b64_tr_b16 v[44:45], v25 offset:0
    ds_read_b64_tr_b16 v[46:47], v25 offset:4096
    v_mfma_f32_16x16x32_bf16 a[8:11], v[152:155], v[72:75], a[8:11]
    ds_read_b64_tr_b16 v[48:49], v26 offset:0
    ds_read_b64_tr_b16 v[50:51], v26 offset:4096
    v_mfma_f32_16x16x32_bf16 a[40:43], v[156:159], v[72:75], a[40:43]
    ds_read_b64_tr_b16 v[52:53], v27 offset:0
    ds_read_b64_tr_b16 v[54:55], v27 offset:4096
    v_mfma_f32_16x16x32_bf16 a[12:15], v[152:155], v[76:79], a[12:15]
    ds_read_b64_tr_b16 v[56:57], v28 offset:0
    ds_read_b64_tr_b16 v[58:59], v28 offset:4096
    v_mfma_f32_16x16x32_bf16 a[44:47], v[156:159], v[76:79], a[44:47]
    ds_read_b64_tr_b16 v[60:61], v29 offset:0
    ds_read_b64_tr_b16 v[62:63], v29 offset:4096
    v_mfma_f32_16x16x32_bf16 a[16:19], v[152:155], v[80:83], a[16:19]
    buffer_load_dwordx4 v[144:147], v12, s[8:11], s25 offen sc1
    buffer_load_dwordx4 v[148:151], v13, s[8:11], s25 offen sc1
    v_mfma_f32_16x16x32_bf16 a[48:51], v[156:159], v[80:83], a[48:51]
    s_add_u32 s25, s25, 1024
    s_add_u32 m0, s28, 49152
    v_mfma_f32_16x16x32_bf16 a[20:23], v[152:155], v[84:87], a[20:23]
    s_nop 0
    buffer_load_dwordx4 v8, s[12:15], s26 offen offset:0 lds
    v_mfma_f32_16x16x32_bf16 a[52:55], v[156:159], v[84:87], a[52:55]
    buffer_load_dwordx4 v9, s[12:15], s26 offen offset:1024 lds
    buffer_load_dwordx4 v10, s[12:15], s26 offen offset:2048 lds
    v_mfma_f32_16x16x32_bf16 a[24:27], v[152:155], v[88:91], a[24:27]
    buffer_load_dwordx4 v11, s[12:15], s26 offen offset:3072 lds
    s_add_u32 s26, s26, 524288
    v_mfma_f32_16x16x32_bf16 a[56:59], v[156:159], v[88:91], a[56:59]
    v_mfma_f32_16x16x32_bf16 a[28:31], v[152:155], v[92:95], a[28:31]
    v_mfma_f32_16x16x32_bf16 a[60:63], v[156:159], v[92:95], a[60:63]
    s_waitcnt vmcnt(56) lgkmcnt(0)
    v_mfma_f32_16x16x32_bf16 a[0:3], v[160:163], v[32:35], a[0:3]
    ds_read_b64_tr_b16 v[64:65], v22 offset:8192
    ds_read_b64_tr_b16 v[66:67], v22 offset:12288
    v_mfma_f32_16x16x32_bf16 a[32:35], v[164:167], v[32:35], a[32:35]
    ds_read_b64_tr_b16 v[68:69], v23 offset:8192
    ds_read_b64_tr_b16 v[70:71], v23 offset:12288
    v_mfma_f32_16x16x32_bf16 a[4:7], v[160:163], v[36:39], a[4:7]
    ds_read_b64_tr_b16 v[72:73], v24 offset:8192
    ds_read_b64_tr_b16 v[74:75], v24 offset:12288
    v_mfma_f32_16x16x32_bf16 a[36:39], v[164:167], v[36:39], a[36:39]
    ds_read_b64_tr_b16 v[76:77], v25 offset:8192
    ds_read_b64_tr_b16 v[78:79], v25 offset:12288
    v_mfma_f32_16x16x32_bf16 a[8:11], v[160:163], v[40:43], a[8:11]
    ds_read_b64_tr_b16 v[80:81], v26 offset:8192
    ds_read_b64_tr_b16 v[82:83], v26 offset:12288
    v_mfma_f32_16x16x32_bf16 a[40:43], v[164:167], v[40:43], a[40:43]
    ds_read_b64_tr_b16 v[84:85], v27 offset:8192
    ds_read_b64_tr_b16 v[86:87], v27 offset:12288
    v_mfma_f32_16x16x32_bf16 a[12:15], v[160:163], v[44:47], a[12:15]
    ds_read_b64_tr_b16 v[88:89], v28 offset:8192
    ds_read_b64_tr_b16 v[90:91], v28 offset:12288
    v_mfma_f32_16x16x32_bf16 a[44:47], v[164:167], v[44:47], a[44:47]
    ds_read_b64_tr_b16 v[92:93], v29 offset:8192
    ds_read_b64_tr_b16 v[94:95], v29 offset:12288
    v_mfma_f32_16x16x32_bf16 a[16:19], v[160:163], v[48:51], a[16:19]
    buffer_load_dwordx4 v[152:155], v12, s[8:11], s25 offen sc1
    buffer_load_dwordx4 v[156:159], v13, s[8:11], s25 offen sc1
    v_mfma_f32_16x16x32_bf16 a[48:51], v[164:167], v[48:51], a[48:51]
    s_add_u32 s25, s25, 1024
    v_mfma_f32_16x16x32_bf16 a[20:23], v[160:163], v[52:55], a[20:23]
    v_mfma_f32_16x16x32_bf16 a[52:55], v[164:167], v[52:55], a[52:55]
    v_mfma_f32_16x16x32_bf16 a[24:27], v[160:163], v[56:59], a[24:27]
    v_mfma_f32_16x16x32_bf16 a[56:59], v[164:167], v[56:59], a[56:59]
    v_mfma_f32_16x16x32_bf16 a[28:31], v[160:163], v[60:63], a[28:31]
    v_mfma_f32_16x16x32_bf16 a[60:63], v[164:167], v[60:63], a[60:63]
    s_waitcnt vmcnt(50) lgkmcnt(0)
    s_barrier
    v_mfma_f32_16x16x32_bf16 a[0:3], v[168:171], v[64:67], a[0:3]
    ds_read_b64_tr_b16 v[32:33], v22 offset:16384
    ds_read_b64_tr_b16 v[34:35], v22 offset:20480
    v_mfma_f32_16x16x32_bf16 a[32:35], v[172:175], v[64:67], a[32:35]
    ds_read_b64_tr_b16 v[36:37], v23 offset:16384
    ds_read_b64_tr_b16 v[38:39], v23 offset:20480
    v_mfma_f32_16x16x32_bf16 a[4:7], v[168:171], v[68:71], a[4:7]
    ds_read_b64_tr_b16 v[40:41], v24 offset:16384
    ds_read_b64_tr_b16 v[42:43], v24 offset:20480
    v_mfma_f32_16x16x32_bf16 a[36:39], v[172:175], v[68:71], a[36:39]
    ds_read_b64_tr_b16 v[44:45], v25 offset:16384
    ds_read_b64_tr_b16 v[46:47], v25 offset:20480
    v_mfma_f32_16x16x32_bf16 a[8:11], v[168:171], v[72:75], a[8:11]
    ds_read_b64_tr_b16 v[48:49], v26 offset:16384
    ds_read_b64_tr_b16 v[50:51], v26 offset:20480
    v_mfma_f32_16x16x32_bf16 a[40:43], v[172:175], v[72:75], a[40:43]
    ds_read_b64_tr_b16 v[52:53], v27 offset:16384
    ds_read_b64_tr_b16 v[54:55], v27 offset:20480
    v_mfma_f32_16x16x32_bf16 a[12:15], v[168:171], v[76:79], a[12:15]
    ds_read_b64_tr_b16 v[56:57], v28 offset:16384
    ds_read_b64_tr_b16 v[58:59], v28 offset:20480
    v_mfma_f32_16x16x32_bf16 a[44:47], v[172:175], v[76:79], a[44:47]
    ds_read_b64_tr_b16 v[60:61], v29 offset:16384
    ds_read_b64_tr_b16 v[62:63], v29 offset:20480
    v_mfma_f32_16x16x32_bf16 a[16:19], v[168:171], v[80:83], a[16:19]
    buffer_load_dwordx4 v[160:163], v12, s[8:11], s25 offen sc1
    buffer_load_dwordx4 v[164:167], v13, s[8:11], s25 offen sc1
    v_mfma_f32_16x16x32_bf16 a[48:51], v[172:175], v[80:83], a[48:51]
    s_add_u32 s25, s25, 1024
    s_add_u32 m0, s28, 65536
    v_mfma_f32_16x16x32_bf16 a[20:23], v[168:171], v[84:87], a[20:23]
    s_nop 0
    buffer_load_dwordx4 v8, s[12:15], s26 offen offset:0 lds
    v_mfma_f32_16x16x32_bf16 a[52:55], v[172:175], v[84:87], a[52:55]
    buffer_load_dwordx4 v9, s[12:15], s26 offen offset:1024 lds
    buffer_load_dwordx4 v10, s[12:15], s26 offen offset:2048 lds
    v_mfma_f32_16x16x32_bf16 a[24:27], v[168:171], v[88:91], a[24:27]
    buffer_load_dwordx4 v11, s[12:15], s26 offen offset:3072 lds
    s_add_u32 s26, s26, 524288
    v_mfma_f32_16x16x32_bf16 a[56:59], v[172:175], v[88:91], a[56:59]
    v_mfma_f32_16x16x32_bf16 a[28:31], v[168:171], v[92:95], a[28:31]
    v_mfma_f32_16x16x32_bf16 a[60:63], v[172:175], v[92:95], a[60:63]
    s_waitcnt vmcnt(56) lgkmcnt(0)
    v_mfma_f32_16x16x32_bf16 a[0:3], v[176:179], v[32:35], a[0:3]
    ds_read_b64_tr_b16 v[64:65], v22 offset:24576
    ds_read_b64_tr_b16 v[66:67], v22 offset:28672
    v_mfma_f32_16x16x32_bf16 a[32:35], v[180:183], v[32:35], a[32:35]
    ds_read_b64_tr_b16 v[68:69], v23 offset:24576
    ds_read_b64_tr_b16 v[70:71], v23 offset:28672
    v_mfma_f32_16x16x32_bf16 a[4:7], v[176:179], v[36:39], a[4:7]
    ds_read_b64_tr_b16 v[72:73], v24 offset:24576
    ds_read_b64_tr_b16 v[74:75], v24 offset:28672
    v_mfma_f32_16x16x32_bf16 a[36:39], v[180:183], v[36:39], a[36:39]
    ds_read_b64_tr_b16 v[76:77], v25 offset:24576
    ds_read_b64_tr_b16 v[78:79], v25 offset:28672
    v_mfma_f32_16x16x32_bf16 a[8:11], v[176:179], v[40:43], a[8:11]
    ds_read_b64_tr_b16 v[80:81], v26 offset:24576
    ds_read_b64_tr_b16 v[82:83], v26 offset:28672
    v_mfma_f32_16x16x32_bf16 a[40:43], v[180:183], v[40:43], a[40:43]
    ds_read_b64_tr_b16 v[84:85], v27 offset:24576
    ds_read_b64_tr_b16 v[86:87], v27 offset:28672
    v_mfma_f32_16x16x32_bf16 a[12:15], v[176:179], v[44:47], a[12:15]
    ds_read_b64_tr_b16 v[88:89], v28 offset:24576
    ds_read_b64_tr_b16 v[90:91], v28 offset:28672
    v_mfma_f32_16x16x32_bf16 a[44:47], v[180:183], v[44:47], a[44:47]
    ds_read_b64_tr_b16 v[92:93], v29 offset:24576
    ds_read_b64_tr_b16 v[94:95], v29 offset:28672
    v_mfma_f32_16x16x32_bf16 a[16:19], v[176:179], v[48:51], a[16:19]
    buffer_load_dwordx4 v[168:171], v12, s[8:11], s25 offen sc1
    buffer_load_dwordx4 v[172:175], v13, s[8:11], s25 offen sc1
    v_mfma_f32_16x16x32_bf16 a[48:51], v[180:183], v[48:51], a[48:51]
    s_add_u32 s25, s25, 1024
    v_mfma_f32_16x16x32_bf16 a[20:23], v[176:179], v[52:55], a[20:23]
    v_mfma_f32_16x16x32_bf16 a[52:55], v[180:183], v[52:55], a[52:55]
    v_mfma_f32_16x16x32_bf16 a[24:27], v[176:179], v[56:59], a[24:27]
    v_mfma_f32_16x16x32_bf16 a[56:59], v[180:183], v[56:59], a[56:59]
    v_mfma_f32_16x16x32_bf16 a[28:31], v[176:179], v[60:63], a[28:31]
    v_mfma_f32_16x16x32_bf16 a[60:63], v[180:183], v[60:63], a[60:63]
    s_waitcnt vmcnt(50) lgkmcnt(0)
    s_barrier
    v_mfma_f32_16x16x32_bf16 a[0:3], v[184:187], v[64:67], a[0:3]
    ds_read_b64_tr_b16 v[32:33], v22 offset:32768
    ds_read_b64_tr_b16 v[34:35], v22 offset:36864
    v_mfma_f32_16x16x32_bf16 a[32:35], v[188:191], v[64:67], a[32:35]
    ds_read_b64_tr_b16 v[36:37], v23 offset:32768
    ds_read_b64_tr_b16 v[38:39], v23 offset:36864
    v_mfma_f32_16x16x32_bf16 a[4:7], v[184:187], v[68:71], a[4:7]
    ds_read_b64_tr_b16 v[40:41], v24 offset:32768
    ds_read_b64_tr_b16 v[42:43], v24 offset:36864
    v_mfma_f32_16x16x32_bf16 a[36:39], v[188:191], v[68:71], a[36:39]
    ds_read_b64_tr_b16 v[44:45], v25 offset:32768
    ds_read_b64_tr_b16 v[46:47], v25 offset:36864
    v_mfma_f32_16x16x32_bf16 a[8:11], v[184:187], v[72:75], a[8:11]
    ds_read_b64_tr_b16 v[48:49], v26 offset:32768
    ds_read_b64_tr_b16 v[50:51], v26 offset:36864
    v_mfma_f32_16x16x32_bf16 a[40:43], v[188:191], v[72:75], a[40:43]
    ds_read_b64_tr_b16 v[52:53], v27 offset:32768
    ds_read_b64_tr_b16 v[54:55], v27 offset:36864
    v_mfma_f32_16x16x32_bf16 a[12:15], v[184:187], v[76:79], a[12:15]
    ds_read_b64_tr_b16 v[56:57], v28 offset:32768
    ds_read_b64_tr_b16 v[58:59], v28 offset:36864
    v_mfma_f32_16x16x32_bf16 a[44:47], v[188:191], v[76:79], a[44:47]
    ds_read_b64_tr_b16 v[60:61], v29 offset:32768
    ds_read_b64_tr_b16 v[62:63], v29 offset:36864
    v_mfma_f32_16x16x32_bf16 a[16:19], v[184:187], v[80:83], a[16:19]
    buffer_load_dwordx4 v[176:179], v12, s[8:11], s25 offen sc1
    buffer_load_dwordx4 v[180:183], v13, s[8:11], s25 offen sc1
    v_mfma_f32_16x16x32_bf16 a[48:51], v[188:191], v[80:83], a[48:51]
    s_add_u32 s25, s25, 1024
    s_add_u32 m0, s28, 81920
    v_mfma_f32_16x16x32_bf16 a[20:23], v[184:187], v[84:87], a[20:23]
    s_nop 0
    buffer_load_dwordx4 v8, s[12:15], s26 offen offset:0 lds
    v_mfma_f32_16x16x32_bf16 a[52:55], v[188:191], v[84:87], a[52:55]
    buffer_load_dwordx4 v9, s[12:15], s26 offen offset:1024 lds
    buffer_load_dwordx4 v10, s[12:15], s26 offen offset:2048 lds
    v_mfma_f32_16x16x32_bf16 a[24:27], v[184:187], v[88:91], a[24:27]
    buffer_load_dwordx4 v11, s[12:15], s26 offen offset:3072 lds
    s_add_u32 s26, s26, 524288
    v_mfma_f32_16x16x32_bf16 a[56:59], v[188:191], v[88:91], a[56:59]
    v_mfma_f32_16x16x32_bf16 a[28:31], v[184:187], v[92:95], a[28:31]
    v_mfma_f32_16x16x32_bf16 a[60:63], v[188:191], v[92:95], a[60:63]
    s_waitcnt vmcnt(56) lgkmcnt(0)
    v_mfma_f32_16x16x32_bf16 a[0:3], v[192:195], v[32:35], a[0:3]
    ds_read_b64_tr_b16 v[64:65], v22 offset:40960
    ds_read_b64_tr_b16 v[66:67], v22 offset:45056
    v_mfma_f32_16x16x32_bf16 a[32:35], v[196:199], v[32:35], a[32:35]
    ds_read_b64_tr_b16 v[68:69], v23 offset:40960
    ds_read_b64_tr_b16 v[70:71], v23 offset:45056
    v_mfma_f32_16x16x32_bf16 a[4:7], v[192:195], v[36:39], a[4:7]
    ds_read_b64_tr_b16 v[72:73], v24 offset:40960
    ds_read_b64_tr_b16 v[74:75], v24 offset:45056
    v_mfma_f32_16x16x32_bf16 a[36:39], v[196:199], v[36:39], a[36:39]
    ds_read_b64_tr_b16 v[76:77], v25 offset:40960
    ds_read_b64_tr_b16 v[78:79], v25 offset:45056
    v_mfma_f32_16x16x32_bf16 a[8:11], v[192:195], v[40:43], a[8:11]
    ds_read_b64_tr_b16 v[80:81], v26 offset:40960
    ds_read_b64_tr_b16 v[82:83], v26 offset:45056
    v_mfma_f32_16x16x32_bf16 a[40:43], v[196:199], v[40:43], a[40:43]
    ds_read_b64_tr_b16 v[84:85], v27 offset:40960
    ds_read_b64_tr_b16 v[86:87], v27 offset:45056
    v_mfma_f32_16x16x32_bf16 a[12:15], v[192:195], v[44:47], a[12:15]
    ds_read_b64_tr_b16 v[88:89], v28 offset:40960
    ds_read_b64_tr_b16 v[90:91], v28 offset:45056
    v_mfma_f32_16x16x32_bf16 a[44:47], v[196:199], v[44:47], a[44:47]
    ds_read_b64_tr_b16 v[92:93], v29 offset:40960
    ds_read_b64_tr_b16 v[94:95], v29 offset:45056
    v_mfma_f32_16x16x32_bf16 a[16:19], v[192:195], v[48:51], a[16:19]
    buffer_load_dwordx4 v[184:187], v12, s[8:11], s25 offen sc1
    buffer_load_dwordx4 v[188:191], v13, s[8:11], s25 offen sc1
    v_mfma_f32_16x16x32_bf16 a[48:51], v[196:199], v[48:51], a[48:51]
    s_add_u32 s25, s25, 1024
    v_mfma_f32_16x16x32_bf16 a[20:23], v[192:195], v[52:55], a[20:23]
    v_mfma_f32_16x16x32_bf16 a[52:55], v[196:199], v[52:55], a[52:55]
    v_mfma_f32_16x16x32_bf16 a[24:27], v[192:195], v[56:59], a[24:27]
    v_mfma_f32_16x16x32_bf16 a[56:59], v[196:199], v[56:59], a[56:59]
    v_mfma_f32_16x16x32_bf16 a[28:31], v[192:195], v[60:63], a[28:31]
    v_mfma_f32_16x16x32_bf16 a[60:63], v[196:199], v[60:63], a[60:63]
    s_waitcnt vmcnt(50) lgkmcnt(0)
    s_barrier
    v_mfma_f32_16x16x32_bf16 a[0:3], v[200:203], v[64:67], a[0:3]
    ds_read_b64_tr_b16 v[32:33], v22 offset:49152
    ds_read_b64_tr_b16 v[34:35], v22 offset:53248
    v_mfma_f32_16x16x32_bf16 a[32:35], v[204:207], v[64:67], a[32:35]
    ds_read_b64_tr_b16 v[36:37], v23 offset:49152
    ds_read_b64_tr_b16 v[38:39], v23 offset:53248
    v_mfma_f32_16x16x32_bf16 a[4:7], v[200:203], v[68:71], a[4:7]
    ds_read_b64_tr_b16 v[40:41], v24 offset:49152
    ds_read_b64_tr_b16 v[42:43], v24 offset:53248
    v_mfma_f32_16x16x32_bf16 a[36:39], v[204:207], v[68:71], a[36:39]
    ds_read_b64_tr_b16 v[44:45], v25 offset:49152
    ds_read_b64_tr_b16 v[46:47], v25 offset:53248
    v_mfma_f32_16x16x32_bf16 a[8:11], v[200:203], v[72:75], a[8:11]
    ds_read_b64_tr_b16 v[48:49], v26 offset:49152
    ds_read_b64_tr_b16 v[50:51], v26 offset:53248
    v_mfma_f32_16x16x32_bf16 a[40:43], v[204:207], v[72:75], a[40:43]
    ds_read_b64_tr_b16 v[52:53], v27 offset:49152
    ds_read_b64_tr_b16 v[54:55], v27 offset:53248
    v_mfma_f32_16x16x32_bf16 a[12:15], v[200:203], v[76:79], a[12:15]
    ds_read_b64_tr_b16 v[56:57], v28 offset:49152
    ds_read_b64_tr_b16 v[58:59], v28 offset:53248
    v_mfma_f32_16x16x32_bf16 a[44:47], v[204:207], v[76:79], a[44:47]
    ds_read_b64_tr_b16 v[60:61], v29 offset:49152
    ds_read_b64_tr_b16 v[62:63], v29 offset:53248
    v_mfma_f32_16x16x32_bf16 a[16:19], v[200:203], v[80:83], a[16:19]
    buffer_load_dwordx4 v[192:195], v12, s[8:11], s25 offen sc1
    buffer_load_dwordx4 v[196:199], v13, s[8:11], s25 offen sc1
    v_mfma_f32_16x16x32_bf16 a[48:51], v[204:207], v[80:83], a[48:51]
    s_add_u32 s25, s25, 1024
    s_add_u32 m0, s28, 98304
    v_mfma_f32_16x16x32_bf16 a[20:23], v[200:203], v[84:87], a[20:23]
    s_nop 0
    buffer_load_dwordx4 v8, s[12:15], s26 offen offset:0 lds
    v_mfma_f32_16x16x32_bf16 a[52:55], v[204:207], v[84:87], a[52:55]
    buffer_load_dwordx4 v9, s[12:15], s26 offen offset:1024 lds
    buffer_load_dwordx4 v10, s[12:15], s26 offen offset:2048 lds
    v_mfma_f32_16x16x32_bf16 a[24:27], v[200:203], v[88:91], a[24:27]
    buffer_load_dwordx4 v11, s[12:15], s26 offen offset:3072 lds
    s_add_u32 s26, s26, 524288
    v_mfma_f32_16x16x32_bf16 a[56:59], v[204:207], v[88:91], a[56:59]
    v_mfma_f32_16x16x32_bf16 a[28:31], v[200:203], v[92:95], a[28:31]
    v_mfma_f32_16x16x32_bf16 a[60:63], v[204:207], v[92:95], a[60:63]
    s_waitcnt vmcnt(56) lgkmcnt(0)
    v_mfma_f32_16x16x32_bf16 a[0:3], v[208:211], v[32:35], a[0:3]
    ds_read_b64_tr_b16 v[64:65], v22 offset:57344
    ds_read_b64_tr_b16 v[66:67], v22 offset:61440
    v_mfma_f32_16x16x32_bf16 a[32:35], v[212:215], v[32:35], a[32:35]
    ds_read_b64_tr_b16 v[68:69], v23 offset:57344
    ds_read_b64_tr_b16 v[70:71], v23 offset:61440
    v_mfma_f32_16x16x32_bf16 a[4:7], v[208:211], v[36:39], a[4:7]
    ds_read_b64_tr_b16 v[72:73], v24 offset:57344
    ds_read_b64_tr_b16 v[74:75], v24 offset:61440
    v_mfma_f32_16x16x32_bf16 a[36:39], v[212:215], v[36:39], a[36:39]
    ds_read_b64_tr_b16 v[76:77], v25 offset:57344
    ds_read_b64_tr_b16 v[78:79], v25 offset:61440
    v_mfma_f32_16x16x32_bf16 a[8:11], v[208:211], v[40:43], a[8:11]
    ds_read_b64_tr_b16 v[80:81], v26 offset:57344
    ds_read_b64_tr_b16 v[82:83], v26 offset:61440
    v_mfma_f32_16x16x32_bf16 a[40:43], v[212:215], v[40:43], a[40:43]
    ds_read_b64_tr_b16 v[84:85], v27 offset:57344
    ds_read_b64_tr_b16 v[86:87], v27 offset:61440
    v_mfma_f32_16x16x32_bf16 a[12:15], v[208:211], v[44:47], a[12:15]
    ds_read_b64_tr_b16 v[88:89], v28 offset:57344
    ds_read_b64_tr_b16 v[90:91], v28 offset:61440
    v_mfma_f32_16x16x32_bf16 a[44:47], v[212:215], v[44:47], a[44:47]
    ds_read_b64_tr_b16 v[92:93], v29 offset:57344
    ds_read_b64_tr_b16 v[94:95], v29 offset:61440
    v_mfma_f32_16x16x32_bf16 a[16:19], v[208:211], v[48:51], a[16:19]
    buffer_load_dwordx4 v[200:203], v12, s[8:11], s25 offen sc1
    buffer_load_dwordx4 v[204:207], v13, s[8:11], s25 offen sc1
    v_mfma_f32_16x16x32_bf16 a[48:51], v[212:215], v[48:51], a[48:51]
    s_add_u32 s25, s25, 1024
    v_mfma_f32_16x16x32_bf16 a[20:23], v[208:211], v[52:55], a[20:23]
    v_mfma_f32_16x16x32_bf16 a[52:55], v[212:215], v[52:55], a[52:55]
    v_mfma_f32_16x16x32_bf16 a[24:27], v[208:211], v[56:59], a[24:27]
    v_mfma_f32_16x16x32_bf16 a[56:59], v[212:215], v[56:59], a[56:59]
    v_mfma_f32_16x16x32_bf16 a[28:31], v[208:211], v[60:63], a[28:31]
    v_mfma_f32_16x16x32_bf16 a[60:63], v[212:215], v[60:63], a[60:63]
    s_waitcnt vmcnt(50) lgkmcnt(0)
    s_barrier
    v_mfma_f32_16x16x32_bf16 a[0:3], v[216:219], v[64:67], a[0:3]
    ds_read_b64_tr_b16 v[32:33], v14 offset:0
    ds_read_b64_tr_b16 v[34:35], v14 offset:4096
    v_mfma_f32_16x16x32_bf16 a[32:35], v[220:223], v[64:67], a[32:35]
    ds_read_b64_tr_b16 v[36:37], v15 offset:0
    ds_read_b64_tr_b16 v[38:39], v15 offset:4096
    v_mfma_f32_16x16x32_bf16 a[4:7], v[216:219], v[68:71], a[4:7]
    ds_read_b64_tr_b16 v[40:41], v16 offset:0
    ds_read_b64_tr_b16 v[42:43], v16 offset:4096
    v_mfma_f32_16x16x32_bf16 a[36:39], v[220:223], v[68:71], a[36:39]
    ds_read_b64_tr_b16 v[44:45], v17 offset:0
    ds_read_b64_tr_b16 v[46:47], v17 offset:4096
    v_mfma_f32_16x16x32_bf16 a[8:11], v[216:219], v[72:75], a[8:11]
    ds_read_b64_tr_b16 v[48:49], v18 offset:0
    ds_read_b64_tr_b16 v[50:51], v18 offset:4096
    v_mfma_f32_16x16x32_bf16 a[40:43], v[220:223], v[72:75], a[40:43]
    ds_read_b64_tr_b16 v[52:53], v19 offset:0
    ds_read_b64_tr_b16 v[54:55], v19 offset:4096
    v_mfma_f32_16x16x32_bf16 a[12:15], v[216:219], v[76:79], a[12:15]
    ds_read_b64_tr_b16 v[56:57], v20 offset:0
    ds_read_b64_tr_b16 v[58:59], v20 offset:4096
    v_mfma_f32_16x16x32_bf16 a[44:47], v[220:223], v[76:79], a[44:47]
    ds_read_b64_tr_b16 v[60:61], v21 offset:0
    ds_read_b64_tr_b16 v[62:63], v21 offset:4096
    v_mfma_f32_16x16x32_bf16 a[16:19], v[216:219], v[80:83], a[16:19]
    buffer_load_dwordx4 v[208:211], v12, s[8:11], s25 offen sc1
    buffer_load_dwordx4 v[212:215], v13, s[8:11], s25 offen sc1
    v_mfma_f32_16x16x32_bf16 a[48:51], v[220:223], v[80:83], a[48:51]
    s_add_u32 s25, s25, 1024
    s_add_u32 m0, s28, 114688
    v_mfma_f32_16x16x32_bf16 a[20:23], v[216:219], v[84:87], a[20:23]
    s_nop 0
    buffer_load_dwordx4 v8, s[12:15], s26 offen offset:0 lds
    v_mfma_f32_16x16x32_bf16 a[52:55], v[220:223], v[84:87], a[52:55]
    buffer_load_dwordx4 v9, s[12:15], s26 offen offset:1024 lds
    buffer_load_dwordx4 v10, s[12:15], s26 offen offset:2048 lds
    v_mfma_f32_16x16x32_bf16 a[24:27], v[216:219], v[88:91], a[24:27]
    buffer_load_dwordx4 v11, s[12:15], s26 offen offset:3072 lds
    s_add_u32 s26, s26, 524288
    v_mfma_f32_16x16x32_bf16 a[56:59], v[220:223], v[88:91], a[56:59]
    v_mfma_f32_16x16x32_bf16 a[28:31], v[216:219], v[92:95], a[28:31]
    v_mfma_f32_16x16x32_bf16 a[60:63], v[220:223], v[92:95], a[60:63]
    s_sub_u32 s27, s27, 1
    s_cmp_lg_u32 s27, 0
    s_cbranch_scc1 mega_kernel_w_sv_loop
mega_kernel_w_sv_done:
    s_nop 7
    s_lshr_b32 s34, s24, 1
    s_add_u32 s34, s34, s20
    s_lshl_b32 s35, s34, 5
    s_add_u32 s35, s35, s33
    s_lshl_b32 s35, s35, 13

    s_add_u32 s35, s35, 40271872
    s_add_u32 s30, s35, 0
    v_accvgpr_read_b32 v32, a0
    v_accvgpr_read_b32 v33, a1
    v_accvgpr_read_b32 v34, a2
    v_accvgpr_read_b32 v35, a3
    v_accvgpr_read_b32 v36, a32
    v_accvgpr_read_b32 v37, a33
    v_accvgpr_read_b32 v38, a34
    v_accvgpr_read_b32 v39, a35
    v_cvt_pk_bf16_f32 v32, v32, v33
    v_cvt_pk_bf16_f32 v33, v34, v35
    v_cvt_pk_bf16_f32 v34, v36, v37
    v_cvt_pk_bf16_f32 v35, v38, v39
    buffer_store_dwordx4 v[32:35], v4, s[8:11], s30 offen offset:0 sc1
    v_accvgpr_read_b32 v40, a4
    v_accvgpr_read_b32 v41, a5
    v_accvgpr_read_b32 v42, a6
    v_accvgpr_read_b32 v43, a7
    v_accvgpr_read_b32 v44, a36
    v_accvgpr_read_b32 v45, a37
    v_accvgpr_read_b32 v46, a38
    v_accvgpr_read_b32 v47, a39
    v_cvt_pk_bf16_f32 v40, v40, v41
    v_cvt_pk_bf16_f32 v41, v42, v43
    v_cvt_pk_bf16_f32 v42, v44, v45
    v_cvt_pk_bf16_f32 v43, v46, v47
    buffer_store_dwordx4 v[40:43], v4, s[8:11], s30 offen offset:1024 sc1
    v_accvgpr_read_b32 v48, a8
    v_accvgpr_read_b32 v49, a9
    v_accvgpr_read_b32 v50, a10
    v_accvgpr_read_b32 v51, a11
    v_accvgpr_read_b32 v52, a40
    v_accvgpr_read_b32 v53, a41
    v_accvgpr_read_b32 v54, a42
    v_accvgpr_read_b32 v55, a43
    v_cvt_pk_bf16_f32 v48, v48, v49
    v_cvt_pk_bf16_f32 v49, v50, v51
    v_cvt_pk_bf16_f32 v50, v52, v53
    v_cvt_pk_bf16_f32 v51, v54, v55
    buffer_store_dwordx4 v[48:51], v4, s[8:11], s30 offen offset:2048 sc1
    v_accvgpr_read_b32 v56, a12
    v_accvgpr_read_b32 v57, a13
    v_accvgpr_read_b32 v58, a14
    v_accvgpr_read_b32 v59, a15
    v_accvgpr_read_b32 v60, a44
    v_accvgpr_read_b32 v61, a45
    v_accvgpr_read_b32 v62, a46
    v_accvgpr_read_b32 v63, a47
    v_cvt_pk_bf16_f32 v56, v56, v57
    v_cvt_pk_bf16_f32 v57, v58, v59
    v_cvt_pk_bf16_f32 v58, v60, v61
    v_cvt_pk_bf16_f32 v59, v62, v63
    buffer_store_dwordx4 v[56:59], v4, s[8:11], s30 offen offset:3072 sc1
    s_add_u32 s30, s35, 4096
    v_accvgpr_read_b32 v32, a16
    v_accvgpr_read_b32 v33, a17
    v_accvgpr_read_b32 v34, a18
    v_accvgpr_read_b32 v35, a19
    v_accvgpr_read_b32 v36, a48
    v_accvgpr_read_b32 v37, a49
    v_accvgpr_read_b32 v38, a50
    v_accvgpr_read_b32 v39, a51
    v_cvt_pk_bf16_f32 v32, v32, v33
    v_cvt_pk_bf16_f32 v33, v34, v35
    v_cvt_pk_bf16_f32 v34, v36, v37
    v_cvt_pk_bf16_f32 v35, v38, v39
    buffer_store_dwordx4 v[32:35], v4, s[8:11], s30 offen offset:0 sc1
    v_accvgpr_read_b32 v40, a20
    v_accvgpr_read_b32 v41, a21
    v_accvgpr_read_b32 v42, a22
    v_accvgpr_read_b32 v43, a23
    v_accvgpr_read_b32 v44, a52
    v_accvgpr_read_b32 v45, a53
    v_accvgpr_read_b32 v46, a54
    v_accvgpr_read_b32 v47, a55
    v_cvt_pk_bf16_f32 v40, v40, v41
    v_cvt_pk_bf16_f32 v41, v42, v43
    v_cvt_pk_bf16_f32 v42, v44, v45
    v_cvt_pk_bf16_f32 v43, v46, v47
    buffer_store_dwordx4 v[40:43], v4, s[8:11], s30 offen offset:1024 sc1
    v_accvgpr_read_b32 v48, a24
    v_accvgpr_read_b32 v49, a25
    v_accvgpr_read_b32 v50, a26
    v_accvgpr_read_b32 v51, a27
    v_accvgpr_read_b32 v52, a56
    v_accvgpr_read_b32 v53, a57
    v_accvgpr_read_b32 v54, a58
    v_accvgpr_read_b32 v55, a59
    v_cvt_pk_bf16_f32 v48, v48, v49
    v_cvt_pk_bf16_f32 v49, v50, v51
    v_cvt_pk_bf16_f32 v50, v52, v53
    v_cvt_pk_bf16_f32 v51, v54, v55
    buffer_store_dwordx4 v[48:51], v4, s[8:11], s30 offen offset:2048 sc1
    v_accvgpr_read_b32 v56, a28
    v_accvgpr_read_b32 v57, a29
    v_accvgpr_read_b32 v58, a30
    v_accvgpr_read_b32 v59, a31
    v_accvgpr_read_b32 v60, a60
    v_accvgpr_read_b32 v61, a61
    v_accvgpr_read_b32 v62, a62
    v_accvgpr_read_b32 v63, a63
    v_cvt_pk_bf16_f32 v56, v56, v57
    v_cvt_pk_bf16_f32 v57, v58, v59
    v_cvt_pk_bf16_f32 v58, v60, v61
    v_cvt_pk_bf16_f32 v59, v62, v63
    buffer_store_dwordx4 v[56:59], v4, s[8:11], s30 offen offset:3072 sc1
    s_branch mega_kernel_w_next
mega_kernel_w_kvb:
    s_sub_u32 s31, s39, 16
    s_lshr_b32 s36, s31, 2
    s_add_u32 s36, s36, 1
    s_lshl_b32 s24, s36, 4
    s_lshr_b32 s32, s31, 1
    s_and_b32 s32, s32, 1
    s_add_u32 s32, s32, 1
    s_and_b32 s33, s31, 1
    s_lshl_b32 s33, s33, 1
    s_lshl_b32 s30, s38, 2
    s_add_u32 s33, s33, s30
    s_lshl_b32 s41, s38, 4
    s_lshl_b32 s36, s36, 1
    s_add_u32 s41, s41, s36
    s_lshl_b32 s41, s41, 7
    s_add_u32 s41, s41, 33793

    s_cmp_eq_u32 s32, 2
    s_cbranch_scc1 mega_kernel_w_kvb_v

    s_mov_b32 s12, s46
    s_mov_b32 s13, s47
    s_mov_b32 s14, 8388608
    s_mov_b32 s15, 0x20000
mega_kernel_w_bqk:
    s_mul_i32 s28, s20, 4096
    s_add_u32 s28, s28, 0
    v_lshrrev_b32 v5, 5, v1
    s_mul_i32 s30, s20, 8
    v_add_u32 v5, s30, v5
    v_and_b32 v6, 31, v1
    s_mov_b32 s31, 8192
    v_add_u32 v7, 0, v5
    v_and_b32 v8, 7, v7
    v_lshlrev_b32 v8, 1, v8
    v_xor_b32 v8, v8, v6
    v_lshlrev_b32 v8, 4, v8
    v_mul_lo_u32 v7, v7, s31
    v_add_u32 v8, v8, v7
    v_add_u32 v7, 2, v5
    v_and_b32 v9, 7, v7
    v_lshlrev_b32 v9, 1, v9
    v_xor_b32 v9, v9, v6
    v_lshlrev_b32 v9, 4, v9
    v_mul_lo_u32 v7, v7, s31
    v_add_u32 v9, v9, v7
    v_subrev_u32 v9, 1024, v9
    v_add_u32 v7, 4, v5
    v_and_b32 v10, 7, v7
    v_lshlrev_b32 v10, 1, v10
    v_xor_b32 v10, v10, v6
    v_lshlrev_b32 v10, 4, v10
    v_mul_lo_u32 v7, v7, s31
    v_add_u32 v10, v10, v7
    v_subrev_u32 v10, 2048, v10
    v_add_u32 v7, 6, v5
    v_and_b32 v11, 7, v7
    v_lshlrev_b32 v11, 1, v11
    v_xor_b32 v11, v11, v6
    v_lshlrev_b32 v11, 4, v11
    v_mul_lo_u32 v7, v7, s31
    v_add_u32 v11, v11, v7
    v_subrev_u32 v11, 3072, v11
    v_lshrrev_b32 v5, 2, v2
    v_lshl_add_u32 v5, v3, 2, v5
    v_and_b32 v6, 7, v5
    v_lshlrev_b32 v6, 5, v6
    v_mul_u32_u24 v5, 512, v5
    v_and_b32 v7, 3, v2
    v_lshl_add_u32 v5, v7, 3, v5
    v_add_u32 v5, 0, v5
    s_mul_i32 s30, s21, 8
    s_add_u32 s31, s30, 0
    s_lshl_b32 s31, s31, 5
    v_xor_b32 v16, s31, v6
    v_add_u32 v16, v16, v5
    s_add_u32 s31, s30, 1
    s_lshl_b32 s31, s31, 5
    v_xor_b32 v17, s31, v6
    v_add_u32 v17, v17, v5
    s_add_u32 s31, s30, 2
    s_lshl_b32 s31, s31, 5
    v_xor_b32 v18, s31, v6
    v_add_u32 v18, v18, v5
    s_add_u32 s31, s30, 3
    s_lshl_b32 s31, s31, 5
    v_xor_b32 v19, s31, v6
    v_add_u32 v19, v19, v5
    s_add_u32 s31, s30, 4
    s_lshl_b32 s31, s31, 5
    v_xor_b32 v20, s31, v6
    v_add_u32 v20, v20, v5
    s_add_u32 s31, s30, 5
    s_lshl_b32 s31, s31, 5
    v_xor_b32 v21, s31, v6
    v_add_u32 v21, v21, v5
    s_add_u32 s31, s30, 6
    s_lshl_b32 s31, s31, 5
    v_xor_b32 v22, s31, v6
    v_add_u32 v22, v22, v5
    s_add_u32 s31, s30, 7
    s_lshl_b32 s31, s31, 5
    v_xor_b32 v23, s31, v6
    v_add_u32 v23, v23, v5
    s_mul_i32 s29, s20, 4096
    s_add_u32 s29, s29, 65536
    v_lshlrev_b32 v5, 4, v1
    s_mul_i32 s30, s20, 131072
    v_add_u32 v5, s30, v5
    v_add_u32 v12, 0, v5
    v_add_u32 v13, 31744, v5
    v_add_u32 v14, 63488, v5
    v_add_u32 v15, 95232, v5
    s_mul_i32 s30, s22, 8192
    s_add_u32 s30, s30, 65536
    v_lshlrev_b32 v24, 4, v1
    v_add_u32 v24, s30, v24
    s_lshl_b32 s26, s24, 15
    s_add_u32 s26, s26, 2523136
    s_lshl_b32 s25, s33, 8

    s_add_u32 m0, s28, 0
    s_nop 0
    buffer_load_dwordx4 v8, s[12:15], s25 offen offset:0 lds
    buffer_load_dwordx4 v9, s[12:15], s25 offen offset:1024 lds
    buffer_load_dwordx4 v10, s[12:15], s25 offen offset:2048 lds
    buffer_load_dwordx4 v11, s[12:15], s25 offen offset:3072 lds
    s_add_u32 s25, s25, 262144
    s_add_u32 m0, s29, 0
    s_nop 0
    buffer_load_dwordx4 v12, s[8:11], s26 offen offset:0 sc1 lds
    buffer_load_dwordx4 v13, s[8:11], s26 offen offset:1024 sc1 lds
    buffer_load_dwordx4 v14, s[8:11], s26 offen offset:2048 sc1 lds
    buffer_load_dwordx4 v15, s[8:11], s26 offen offset:3072 sc1 lds
    s_add_u32 s26, s26, 1024
    s_add_u32 m0, s28, 16384
    s_nop 0
    buffer_load_dwordx4 v8, s[12:15], s25 offen offset:0 lds
    buffer_load_dwordx4 v9, s[12:15], s25 offen offset:1024 lds
    buffer_load_dwordx4 v10, s[12:15], s25 offen offset:2048 lds
    buffer_load_dwordx4 v11, s[12:15], s25 offen offset:3072 lds
    s_add_u32 s25, s25, 262144
    s_add_u32 m0, s29, 16384
    s_nop 0
    buffer_load_dwordx4 v12, s[8:11], s26 offen offset:0 sc1 lds
    buffer_load_dwordx4 v13, s[8:11], s26 offen offset:1024 sc1 lds
    buffer_load_dwordx4 v14, s[8:11], s26 offen offset:2048 sc1 lds
    buffer_load_dwordx4 v15, s[8:11], s26 offen offset:3072 sc1 lds
    s_add_u32 s26, s26, 1024
    s_add_u32 m0, s28, 32768
    s_nop 0
    buffer_load_dwordx4 v8, s[12:15], s25 offen offset:0 lds
    buffer_load_dwordx4 v9, s[12:15], s25 offen offset:1024 lds
    buffer_load_dwordx4 v10, s[12:15], s25 offen offset:2048 lds
    buffer_load_dwordx4 v11, s[12:15], s25 offen offset:3072 lds
    s_add_u32 s25, s25, 262144
    s_add_u32 m0, s29, 32768
    s_nop 0
    buffer_load_dwordx4 v12, s[8:11], s26 offen offset:0 sc1 lds
    buffer_load_dwordx4 v13, s[8:11], s26 offen offset:1024 sc1 lds
    buffer_load_dwordx4 v14, s[8:11], s26 offen offset:2048 sc1 lds
    buffer_load_dwordx4 v15, s[8:11], s26 offen offset:3072 sc1 lds
    s_add_u32 s26, s26, 1024
    s_add_u32 m0, s28, 49152
    s_nop 0
    buffer_load_dwordx4 v8, s[12:15], s25 offen offset:0 lds
    buffer_load_dwordx4 v9, s[12:15], s25 offen offset:1024 lds
    buffer_load_dwordx4 v10, s[12:15], s25 offen offset:2048 lds
    buffer_load_dwordx4 v11, s[12:15], s25 offen offset:3072 lds
    s_add_u32 s25, s25, 262144
    s_add_u32 m0, s29, 49152
    s_nop 0
    buffer_load_dwordx4 v12, s[8:11], s26 offen offset:0 sc1 lds
    buffer_load_dwordx4 v13, s[8:11], s26 offen offset:1024 sc1 lds
    buffer_load_dwordx4 v14, s[8:11], s26 offen offset:2048 sc1 lds
    buffer_load_dwordx4 v15, s[8:11], s26 offen offset:3072 sc1 lds
    s_add_u32 s26, s26, 1024
    v_accvgpr_write_b32 a0, 0
    v_accvgpr_write_b32 a1, 0
    v_accvgpr_write_b32 a2, 0
    v_accvgpr_write_b32 a3, 0
    v_accvgpr_write_b32 a4, 0
    v_accvgpr_write_b32 a5, 0
    v_accvgpr_write_b32 a6, 0
    v_accvgpr_write_b32 a7, 0
    v_accvgpr_write_b32 a8, 0
    v_accvgpr_write_b32 a9, 0
    v_accvgpr_write_b32 a10, 0
    v_accvgpr_write_b32 a11, 0
    v_accvgpr_write_b32 a12, 0
    v_accvgpr_write_b32 a13, 0
    v_accvgpr_write_b32 a14, 0
    v_accvgpr_write_b32 a15, 0
    v_accvgpr_write_b32 a16, 0
    v_accvgpr_write_b32 a17, 0
    v_accvgpr_write_b32 a18, 0
    v_accvgpr_write_b32 a19, 0
    v_accvgpr_write_b32 a20, 0
    v_accvgpr_write_b32 a21, 0
    v_accvgpr_write_b32 a22, 0
    v_accvgpr_write_b32 a23, 0
    v_accvgpr_write_b32 a24, 0
    v_accvgpr_write_b32 a25, 0
    v_accvgpr_write_b32 a26, 0
    v_accvgpr_write_b32 a27, 0
    v_accvgpr_write_b32 a28, 0
    v_accvgpr_write_b32 a29, 0
    v_accvgpr_write_b32 a30, 0
    v_accvgpr_write_b32 a31, 0
    v_accvgpr_write_b32 a32, 0
    v_accvgpr_write_b32 a33, 0
    v_accvgpr_write_b32 a34, 0
    v_accvgpr_write_b32 a35, 0
    v_accvgpr_write_b32 a36, 0
    v_accvgpr_write_b32 a37, 0
    v_accvgpr_write_b32 a38, 0
    v_accvgpr_write_b32 a39, 0
    v_accvgpr_write_b32 a40, 0
    v_accvgpr_write_b32 a41, 0
    v_accvgpr_write_b32 a42, 0
    v_accvgpr_write_b32 a43, 0
    v_accvgpr_write_b32 a44, 0
    v_accvgpr_write_b32 a45, 0
    v_accvgpr_write_b32 a46, 0
    v_accvgpr_write_b32 a47, 0
    v_accvgpr_write_b32 a48, 0
    v_accvgpr_write_b32 a49, 0
    v_accvgpr_write_b32 a50, 0
    v_accvgpr_write_b32 a51, 0
    v_accvgpr_write_b32 a52, 0
    v_accvgpr_write_b32 a53, 0
    v_accvgpr_write_b32 a54, 0
    v_accvgpr_write_b32 a55, 0
    v_accvgpr_write_b32 a56, 0
    v_accvgpr_write_b32 a57, 0
    v_accvgpr_write_b32 a58, 0
    v_accvgpr_write_b32 a59, 0
    v_accvgpr_write_b32 a60, 0
    v_accvgpr_write_b32 a61, 0
    v_accvgpr_write_b32 a62, 0
    v_accvgpr_write_b32 a63, 0
    v_accvgpr_write_b32 a64, 0
    v_accvgpr_write_b32 a65, 0
    v_accvgpr_write_b32 a66, 0
    v_accvgpr_write_b32 a67, 0
    v_accvgpr_write_b32 a68, 0
    v_accvgpr_write_b32 a69, 0
    v_accvgpr_write_b32 a70, 0
    v_accvgpr_write_b32 a71, 0
    v_accvgpr_write_b32 a72, 0
    v_accvgpr_write_b32 a73, 0
    v_accvgpr_write_b32 a74, 0
    v_accvgpr_write_b32 a75, 0
    v_accvgpr_write_b32 a76, 0
    v_accvgpr_write_b32 a77, 0
    v_accvgpr_write_b32 a78, 0
    v_accvgpr_write_b32 a79, 0
    v_accvgpr_write_b32 a80, 0
    v_accvgpr_write_b32 a81, 0
    v_accvgpr_write_b32 a82, 0
    v_accvgpr_write_b32 a83, 0
    v_accvgpr_write_b32 a84, 0
    v_accvgpr_write_b32 a85, 0
    v_accvgpr_write_b32 a86, 0
    v_accvgpr_write_b32 a87, 0
    v_accvgpr_write_b32 a88, 0
    v_accvgpr_write_b32 a89, 0
    v_accvgpr_write_b32 a90, 0
    v_accvgpr_write_b32 a91, 0
    v_accvgpr_write_b32 a92, 0
    v_accvgpr_write_b32 a93, 0
    v_accvgpr_write_b32 a94, 0
    v_accvgpr_write_b32 a95, 0
    v_accvgpr_write_b32 a96, 0
    v_accvgpr_write_b32 a97, 0
    v_accvgpr_write_b32 a98, 0
    v_accvgpr_write_b32 a99, 0
    v_accvgpr_write_b32 a100, 0
    v_accvgpr_write_b32 a101, 0
    v_accvgpr_write_b32 a102, 0
    v_accvgpr_write_b32 a103, 0
    v_accvgpr_write_b32 a104, 0
    v_accvgpr_write_b32 a105, 0
    v_accvgpr_write_b32 a106, 0
    v_accvgpr_write_b32 a107, 0
    v_accvgpr_write_b32 a108, 0
    v_accvgpr_write_b32 a109, 0
    v_accvgpr_write_b32 a110, 0
    v_accvgpr_write_b32 a111, 0
    v_accvgpr_write_b32 a112, 0
    v_accvgpr_write_b32 a113, 0
    v_accvgpr_write_b32 a114, 0
    v_accvgpr_write_b32 a115, 0
    v_accvgpr_write_b32 a116, 0
    v_accvgpr_write_b32 a117, 0
    v_accvgpr_write_b32 a118, 0
    v_accvgpr_write_b32 a119, 0
    v_accvgpr_write_b32 a120, 0
    v_accvgpr_write_b32 a121, 0
    v_accvgpr_write_b32 a122, 0
    v_accvgpr_write_b32 a123, 0
    v_accvgpr_write_b32 a124, 0
    v_accvgpr_write_b32 a125, 0
    v_accvgpr_write_b32 a126, 0
    v_accvgpr_write_b32 a127, 0
    v_accvgpr_write_b32 a128, 0
    v_accvgpr_write_b32 a129, 0
    v_accvgpr_write_b32 a130, 0
    v_accvgpr_write_b32 a131, 0
    v_accvgpr_write_b32 a132, 0
    v_accvgpr_write_b32 a133, 0
    v_accvgpr_write_b32 a134, 0
    v_accvgpr_write_b32 a135, 0
    v_accvgpr_write_b32 a136, 0
    v_accvgpr_write_b32 a137, 0
    v_accvgpr_write_b32 a138, 0
    v_accvgpr_write_b32 a139, 0
    v_accvgpr_write_b32 a140, 0
    v_accvgpr_write_b32 a141, 0
    v_accvgpr_write_b32 a142, 0
    v_accvgpr_write_b32 a143, 0
    v_accvgpr_write_b32 a144, 0
    v_accvgpr_write_b32 a145, 0
    v_accvgpr_write_b32 a146, 0
    v_accvgpr_write_b32 a147, 0
    v_accvgpr_write_b32 a148, 0
    v_accvgpr_write_b32 a149, 0
    v_accvgpr_write_b32 a150, 0
    v_accvgpr_write_b32 a151, 0
    v_accvgpr_write_b32 a152, 0
    v_accvgpr_write_b32 a153, 0
    v_accvgpr_write_b32 a154, 0
    v_accvgpr_write_b32 a155, 0
    v_accvgpr_write_b32 a156, 0
    v_accvgpr_write_b32 a157, 0
    v_accvgpr_write_b32 a158, 0
    v_accvgpr_write_b32 a159, 0
    v_accvgpr_write_b32 a160, 0
    v_accvgpr_write_b32 a161, 0
    v_accvgpr_write_b32 a162, 0
    v_accvgpr_write_b32 a163, 0
    v_accvgpr_write_b32 a164, 0
    v_accvgpr_write_b32 a165, 0
    v_accvgpr_write_b32 a166, 0
    v_accvgpr_write_b32 a167, 0
    v_accvgpr_write_b32 a168, 0
    v_accvgpr_write_b32 a169, 0
    v_accvgpr_write_b32 a170, 0
    v_accvgpr_write_b32 a171, 0
    v_accvgpr_write_b32 a172, 0
    v_accvgpr_write_b32 a173, 0
    v_accvgpr_write_b32 a174, 0
    v_accvgpr_write_b32 a175, 0
    v_accvgpr_write_b32 a176, 0
    v_accvgpr_write_b32 a177, 0
    v_accvgpr_write_b32 a178, 0
    v_accvgpr_write_b32 a179, 0
    v_accvgpr_write_b32 a180, 0
    v_accvgpr_write_b32 a181, 0
    v_accvgpr_write_b32 a182, 0
    v_accvgpr_write_b32 a183, 0
    v_accvgpr_write_b32 a184, 0
    v_accvgpr_write_b32 a185, 0
    v_accvgpr_write_b32 a186, 0
    v_accvgpr_write_b32 a187, 0
    v_accvgpr_write_b32 a188, 0
    v_accvgpr_write_b32 a189, 0
    v_accvgpr_write_b32 a190, 0
    v_accvgpr_write_b32 a191, 0
    v_accvgpr_write_b32 a192, 0
    v_accvgpr_write_b32 a193, 0
    v_accvgpr_write_b32 a194, 0
    v_accvgpr_write_b32 a195, 0
    v_accvgpr_write_b32 a196, 0
    v_accvgpr_write_b32 a197, 0
    v_accvgpr_write_b32 a198, 0
    v_accvgpr_write_b32 a199, 0
    v_accvgpr_write_b32 a200, 0
    v_accvgpr_write_b32 a201, 0
    v_accvgpr_write_b32 a202, 0
    v_accvgpr_write_b32 a203, 0
    v_accvgpr_write_b32 a204, 0
    v_accvgpr_write_b32 a205, 0
    v_accvgpr_write_b32 a206, 0
    v_accvgpr_write_b32 a207, 0
    v_accvgpr_write_b32 a208, 0
    v_accvgpr_write_b32 a209, 0
    v_accvgpr_write_b32 a210, 0
    v_accvgpr_write_b32 a211, 0
    v_accvgpr_write_b32 a212, 0
    v_accvgpr_write_b32 a213, 0
    v_accvgpr_write_b32 a214, 0
    v_accvgpr_write_b32 a215, 0
    v_accvgpr_write_b32 a216, 0
    v_accvgpr_write_b32 a217, 0
    v_accvgpr_write_b32 a218, 0
    v_accvgpr_write_b32 a219, 0
    v_accvgpr_write_b32 a220, 0
    v_accvgpr_write_b32 a221, 0
    v_accvgpr_write_b32 a222, 0
    v_accvgpr_write_b32 a223, 0
    v_accvgpr_write_b32 a224, 0
    v_accvgpr_write_b32 a225, 0
    v_accvgpr_write_b32 a226, 0
    v_accvgpr_write_b32 a227, 0
    v_accvgpr_write_b32 a228, 0
    v_accvgpr_write_b32 a229, 0
    v_accvgpr_write_b32 a230, 0
    v_accvgpr_write_b32 a231, 0
    v_accvgpr_write_b32 a232, 0
    v_accvgpr_write_b32 a233, 0
    v_accvgpr_write_b32 a234, 0
    v_accvgpr_write_b32 a235, 0
    v_accvgpr_write_b32 a236, 0
    v_accvgpr_write_b32 a237, 0
    v_accvgpr_write_b32 a238, 0
    v_accvgpr_write_b32 a239, 0
    v_accvgpr_write_b32 a240, 0
    v_accvgpr_write_b32 a241, 0
    v_accvgpr_write_b32 a242, 0
    v_accvgpr_write_b32 a243, 0
    v_accvgpr_write_b32 a244, 0
    v_accvgpr_write_b32 a245, 0
    v_accvgpr_write_b32 a246, 0
    v_accvgpr_write_b32 a247, 0
    v_accvgpr_write_b32 a248, 0
    v_accvgpr_write_b32 a249, 0
    v_accvgpr_write_b32 a250, 0
    v_accvgpr_write_b32 a251, 0
    v_accvgpr_write_b32 a252, 0
    v_accvgpr_write_b32 a253, 0
    v_accvgpr_write_b32 a254, 0
    v_accvgpr_write_b32 a255, 0
    s_mov_b32 s27, 8
    s_waitcnt vmcnt(24)
    s_barrier
    ds_read_b64_tr_b16 v[28:29], v16 offset:0
    ds_read_b64_tr_b16 v[30:31], v16 offset:8192
    ds_read_b128 v[92:95], v24 offset:0
    ds_read_b128 v[96:99], v24 offset:1024
    ds_read_b128 v[100:103], v24 offset:2048
    ds_read_b128 v[104:107], v24 offset:3072
    ds_read_b128 v[108:111], v24 offset:4096
    ds_read_b128 v[112:115], v24 offset:5120
    ds_read_b128 v[116:119], v24 offset:6144
    ds_read_b128 v[120:123], v24 offset:7168
    ds_read_b64_tr_b16 v[32:33], v17 offset:0
    ds_read_b64_tr_b16 v[34:35], v17 offset:8192
    ds_read_b64_tr_b16 v[36:37], v18 offset:0
    ds_read_b64_tr_b16 v[38:39], v18 offset:8192
    ds_read_b64_tr_b16 v[40:41], v19 offset:0
    ds_read_b64_tr_b16 v[42:43], v19 offset:8192
    ds_read_b64_tr_b16 v[44:45], v20 offset:0
    ds_read_b64_tr_b16 v[46:47], v20 offset:8192
    ds_read_b64_tr_b16 v[48:49], v21 offset:0
    ds_read_b64_tr_b16 v[50:51], v21 offset:8192
    ds_read_b64_tr_b16 v[52:53], v22 offset:0
    ds_read_b64_tr_b16 v[54:55], v22 offset:8192
    ds_read_b64_tr_b16 v[56:57], v23 offset:0
    ds_read_b64_tr_b16 v[58:59], v23 offset:8192
mega_kernel_w_bk_loop:
    s_waitcnt lgkmcnt(0)
    s_waitcnt vmcnt(16)
    s_barrier
    v_mfma_f32_16x16x32_bf16 a[0:3], v[28:31], v[92:95], a[0:3]
    ds_read_b64_tr_b16 v[60:61], v16 offset:16384
    v_mfma_f32_16x16x32_bf16 a[4:7], v[28:31], v[96:99], a[4:7]
    ds_read_b64_tr_b16 v[62:63], v16 offset:24576
    v_mfma_f32_16x16x32_bf16 a[8:11], v[28:31], v[100:103], a[8:11]
    ds_read_b128 v[124:127], v24 offset:16384
    v_mfma_f32_16x16x32_bf16 a[12:15], v[28:31], v[104:107], a[12:15]
    ds_read_b128 v[128:131], v24 offset:17408
    v_mfma_f32_16x16x32_bf16 a[16:19], v[28:31], v[108:111], a[16:19]
    ds_read_b128 v[132:135], v24 offset:18432
    v_mfma_f32_16x16x32_bf16 a[20:23], v[28:31], v[112:115], a[20:23]
    ds_read_b128 v[136:139], v24 offset:19456
    v_mfma_f32_16x16x32_bf16 a[24:27], v[28:31], v[116:119], a[24:27]
    ds_read_b128 v[140:143], v24 offset:20480
    v_mfma_f32_16x16x32_bf16 a[28:31], v[28:31], v[120:123], a[28:31]
    ds_read_b128 v[144:147], v24 offset:21504
    v_mfma_f32_16x16x32_bf16 a[32:35], v[32:35], v[92:95], a[32:35]
    ds_read_b128 v[148:151], v24 offset:22528
    v_mfma_f32_16x16x32_bf16 a[36:39], v[32:35], v[96:99], a[36:39]
    ds_read_b128 v[152:155], v24 offset:23552
    v_mfma_f32_16x16x32_bf16 a[40:43], v[32:35], v[100:103], a[40:43]
    ds_read_b64_tr_b16 v[64:65], v17 offset:16384
    v_mfma_f32_16x16x32_bf16 a[44:47], v[32:35], v[104:107], a[44:47]
    ds_read_b64_tr_b16 v[66:67], v17 offset:24576
    v_mfma_f32_16x16x32_bf16 a[48:51], v[32:35], v[108:111], a[48:51]
    ds_read_b64_tr_b16 v[68:69], v18 offset:16384
    v_mfma_f32_16x16x32_bf16 a[52:55], v[32:35], v[112:115], a[52:55]
    ds_read_b64_tr_b16 v[70:71], v18 offset:24576
    v_mfma_f32_16x16x32_bf16 a[56:59], v[32:35], v[116:119], a[56:59]
    ds_read_b64_tr_b16 v[72:73], v19 offset:16384
    v_mfma_f32_16x16x32_bf16 a[60:63], v[32:35], v[120:123], a[60:63]
    ds_read_b64_tr_b16 v[74:75], v19 offset:24576
    v_mfma_f32_16x16x32_bf16 a[64:67], v[36:39], v[92:95], a[64:67]
    ds_read_b64_tr_b16 v[76:77], v20 offset:16384
    v_mfma_f32_16x16x32_bf16 a[68:71], v[36:39], v[96:99], a[68:71]
    ds_read_b64_tr_b16 v[78:79], v20 offset:24576
    v_mfma_f32_16x16x32_bf16 a[72:75], v[36:39], v[100:103], a[72:75]
    ds_read_b64_tr_b16 v[80:81], v21 offset:16384
    v_mfma_f32_16x16x32_bf16 a[76:79], v[36:39], v[104:107], a[76:79]
    ds_read_b64_tr_b16 v[82:83], v21 offset:24576
    v_mfma_f32_16x16x32_bf16 a[80:83], v[36:39], v[108:111], a[80:83]
    ds_read_b64_tr_b16 v[84:85], v22 offset:16384
    v_mfma_f32_16x16x32_bf16 a[84:87], v[36:39], v[112:115], a[84:87]
    ds_read_b64_tr_b16 v[86:87], v22 offset:24576
    v_mfma_f32_16x16x32_bf16 a[88:91], v[36:39], v[116:119], a[88:91]
    ds_read_b64_tr_b16 v[88:89], v23 offset:16384
    v_mfma_f32_16x16x32_bf16 a[92:95], v[36:39], v[120:123], a[92:95]
    ds_read_b64_tr_b16 v[90:91], v23 offset:24576
    v_mfma_f32_16x16x32_bf16 a[96:99], v[40:43], v[92:95], a[96:99]
    s_add_u32 m0, s28, 0
    v_mfma_f32_16x16x32_bf16 a[100:103], v[40:43], v[96:99], a[100:103]
    s_nop 0
    v_mfma_f32_16x16x32_bf16 a[104:107], v[40:43], v[100:103], a[104:107]
    buffer_load_dwordx4 v8, s[12:15], s25 offen offset:0 lds
    v_mfma_f32_16x16x32_bf16 a[108:111], v[40:43], v[104:107], a[108:111]
    buffer_load_dwordx4 v9, s[12:15], s25 offen offset:1024 lds
    v_mfma_f32_16x16x32_bf16 a[112:115], v[40:43], v[108:111], a[112:115]
    buffer_load_dwordx4 v10, s[12:15], s25 offen offset:2048 lds
    v_mfma_f32_16x16x32_bf16 a[116:119], v[40:43], v[112:115], a[116:119]
    buffer_load_dwordx4 v11, s[12:15], s25 offen offset:3072 lds
    v_mfma_f32_16x16x32_bf16 a[120:123], v[40:43], v[116:119], a[120:123]
    s_add_u32 s25, s25, 262144
    v_mfma_f32_16x16x32_bf16 a[124:127], v[40:43], v[120:123], a[124:127]
    s_add_u32 m0, s29, 0
    v_mfma_f32_16x16x32_bf16 a[128:131], v[44:47], v[92:95], a[128:131]
    s_nop 0
    v_mfma_f32_16x16x32_bf16 a[132:135], v[44:47], v[96:99], a[132:135]
    buffer_load_dwordx4 v12, s[8:11], s26 offen offset:0 sc1 lds
    v_mfma_f32_16x16x32_bf16 a[136:139], v[44:47], v[100:103], a[136:139]
    buffer_load_dwordx4 v13, s[8:11], s26 offen offset:1024 sc1 lds
    v_mfma_f32_16x16x32_bf16 a[140:143], v[44:47], v[104:107], a[140:143]
    buffer_load_dwordx4 v14, s[8:11], s26 offen offset:2048 sc1 lds
    v_mfma_f32_16x16x32_bf16 a[144:147], v[44:47], v[108:111], a[144:147]
    buffer_load_dwordx4 v15, s[8:11], s26 offen offset:3072 sc1 lds
    v_mfma_f32_16x16x32_bf16 a[148:151], v[44:47], v[112:115], a[148:151]
    s_add_u32 s26, s26, 1024
    v_mfma_f32_16x16x32_bf16 a[152:155], v[44:47], v[116:119], a[152:155]
    v_mfma_f32_16x16x32_bf16 a[156:159], v[44:47], v[120:123], a[156:159]
    v_mfma_f32_16x16x32_bf16 a[160:163], v[48:51], v[92:95], a[160:163]
    v_mfma_f32_16x16x32_bf16 a[164:167], v[48:51], v[96:99], a[164:167]
    v_mfma_f32_16x16x32_bf16 a[168:171], v[48:51], v[100:103], a[168:171]
    v_mfma_f32_16x16x32_bf16 a[172:175], v[48:51], v[104:107], a[172:175]
    v_mfma_f32_16x16x32_bf16 a[176:179], v[48:51], v[108:111], a[176:179]
    v_mfma_f32_16x16x32_bf16 a[180:183], v[48:51], v[112:115], a[180:183]
    v_mfma_f32_16x16x32_bf16 a[184:187], v[48:51], v[116:119], a[184:187]
    v_mfma_f32_16x16x32_bf16 a[188:191], v[48:51], v[120:123], a[188:191]
    v_mfma_f32_16x16x32_bf16 a[192:195], v[52:55], v[92:95], a[192:195]
    v_mfma_f32_16x16x32_bf16 a[196:199], v[52:55], v[96:99], a[196:199]
    v_mfma_f32_16x16x32_bf16 a[200:203], v[52:55], v[100:103], a[200:203]
    v_mfma_f32_16x16x32_bf16 a[204:207], v[52:55], v[104:107], a[204:207]
    v_mfma_f32_16x16x32_bf16 a[208:211], v[52:55], v[108:111], a[208:211]
    v_mfma_f32_16x16x32_bf16 a[212:215], v[52:55], v[112:115], a[212:215]
    v_mfma_f32_16x16x32_bf16 a[216:219], v[52:55], v[116:119], a[216:219]
    v_mfma_f32_16x16x32_bf16 a[220:223], v[52:55], v[120:123], a[220:223]
    v_mfma_f32_16x16x32_bf16 a[224:227], v[56:59], v[92:95], a[224:227]
    v_mfma_f32_16x16x32_bf16 a[228:231], v[56:59], v[96:99], a[228:231]
    v_mfma_f32_16x16x32_bf16 a[232:235], v[56:59], v[100:103], a[232:235]
    v_mfma_f32_16x16x32_bf16 a[236:239], v[56:59], v[104:107], a[236:239]
    v_mfma_f32_16x16x32_bf16 a[240:243], v[56:59], v[108:111], a[240:243]
    v_mfma_f32_16x16x32_bf16 a[244:247], v[56:59], v[112:115], a[244:247]
    v_mfma_f32_16x16x32_bf16 a[248:251], v[56:59], v[116:119], a[248:251]
    v_mfma_f32_16x16x32_bf16 a[252:255], v[56:59], v[120:123], a[252:255]
    s_waitcnt lgkmcnt(0)
    s_waitcnt vmcnt(16)
    s_barrier
    v_mfma_f32_16x16x32_bf16 a[0:3], v[60:63], v[124:127], a[0:3]
    ds_read_b64_tr_b16 v[28:29], v16 offset:32768
    v_mfma_f32_16x16x32_bf16 a[4:7], v[60:63], v[128:131], a[4:7]
    ds_read_b64_tr_b16 v[30:31], v16 offset:40960
    v_mfma_f32_16x16x32_bf16 a[8:11], v[60:63], v[132:135], a[8:11]
    ds_read_b128 v[92:95], v24 offset:32768
    v_mfma_f32_16x16x32_bf16 a[12:15], v[60:63], v[136:139], a[12:15]
    ds_read_b128 v[96:99], v24 offset:33792
    v_mfma_f32_16x16x32_bf16 a[16:19], v[60:63], v[140:143], a[16:19]
    ds_read_b128 v[100:103], v24 offset:34816
    v_mfma_f32_16x16x32_bf16 a[20:23], v[60:63], v[144:147], a[20:23]
    ds_read_b128 v[104:107], v24 offset:35840
    v_mfma_f32_16x16x32_bf16 a[24:27], v[60:63], v[148:151], a[24:27]
    ds_read_b128 v[108:111], v24 offset:36864
    v_mfma_f32_16x16x32_bf16 a[28:31], v[60:63], v[152:155], a[28:31]
    ds_read_b128 v[112:115], v24 offset:37888
    v_mfma_f32_16x16x32_bf16 a[32:35], v[64:67], v[124:127], a[32:35]
    ds_read_b128 v[116:119], v24 offset:38912
    v_mfma_f32_16x16x32_bf16 a[36:39], v[64:67], v[128:131], a[36:39]
    ds_read_b128 v[120:123], v24 offset:39936
    v_mfma_f32_16x16x32_bf16 a[40:43], v[64:67], v[132:135], a[40:43]
    ds_read_b64_tr_b16 v[32:33], v17 offset:32768
    v_mfma_f32_16x16x32_bf16 a[44:47], v[64:67], v[136:139], a[44:47]
    ds_read_b64_tr_b16 v[34:35], v17 offset:40960
    v_mfma_f32_16x16x32_bf16 a[48:51], v[64:67], v[140:143], a[48:51]
    ds_read_b64_tr_b16 v[36:37], v18 offset:32768
    v_mfma_f32_16x16x32_bf16 a[52:55], v[64:67], v[144:147], a[52:55]
    ds_read_b64_tr_b16 v[38:39], v18 offset:40960
    v_mfma_f32_16x16x32_bf16 a[56:59], v[64:67], v[148:151], a[56:59]
    ds_read_b64_tr_b16 v[40:41], v19 offset:32768
    v_mfma_f32_16x16x32_bf16 a[60:63], v[64:67], v[152:155], a[60:63]
    ds_read_b64_tr_b16 v[42:43], v19 offset:40960
    v_mfma_f32_16x16x32_bf16 a[64:67], v[68:71], v[124:127], a[64:67]
    ds_read_b64_tr_b16 v[44:45], v20 offset:32768
    v_mfma_f32_16x16x32_bf16 a[68:71], v[68:71], v[128:131], a[68:71]
    ds_read_b64_tr_b16 v[46:47], v20 offset:40960
    v_mfma_f32_16x16x32_bf16 a[72:75], v[68:71], v[132:135], a[72:75]
    ds_read_b64_tr_b16 v[48:49], v21 offset:32768
    v_mfma_f32_16x16x32_bf16 a[76:79], v[68:71], v[136:139], a[76:79]
    ds_read_b64_tr_b16 v[50:51], v21 offset:40960
    v_mfma_f32_16x16x32_bf16 a[80:83], v[68:71], v[140:143], a[80:83]
    ds_read_b64_tr_b16 v[52:53], v22 offset:32768
    v_mfma_f32_16x16x32_bf16 a[84:87], v[68:71], v[144:147], a[84:87]
    ds_read_b64_tr_b16 v[54:55], v22 offset:40960
    v_mfma_f32_16x16x32_bf16 a[88:91], v[68:71], v[148:151], a[88:91]
    ds_read_b64_tr_b16 v[56:57], v23 offset:32768
    v_mfma_f32_16x16x32_bf16 a[92:95], v[68:71], v[152:155], a[92:95]
    ds_read_b64_tr_b16 v[58:59], v23 offset:40960
    v_mfma_f32_16x16x32_bf16 a[96:99], v[72:75], v[124:127], a[96:99]
    s_add_u32 m0, s28, 16384
    v_mfma_f32_16x16x32_bf16 a[100:103], v[72:75], v[128:131], a[100:103]
    s_nop 0
    v_mfma_f32_16x16x32_bf16 a[104:107], v[72:75], v[132:135], a[104:107]
    buffer_load_dwordx4 v8, s[12:15], s25 offen offset:0 lds
    v_mfma_f32_16x16x32_bf16 a[108:111], v[72:75], v[136:139], a[108:111]
    buffer_load_dwordx4 v9, s[12:15], s25 offen offset:1024 lds
    v_mfma_f32_16x16x32_bf16 a[112:115], v[72:75], v[140:143], a[112:115]
    buffer_load_dwordx4 v10, s[12:15], s25 offen offset:2048 lds
    v_mfma_f32_16x16x32_bf16 a[116:119], v[72:75], v[144:147], a[116:119]
    buffer_load_dwordx4 v11, s[12:15], s25 offen offset:3072 lds
    v_mfma_f32_16x16x32_bf16 a[120:123], v[72:75], v[148:151], a[120:123]
    s_add_u32 s25, s25, 262144
    v_mfma_f32_16x16x32_bf16 a[124:127], v[72:75], v[152:155], a[124:127]
    s_add_u32 m0, s29, 16384
    v_mfma_f32_16x16x32_bf16 a[128:131], v[76:79], v[124:127], a[128:131]
    s_nop 0
    v_mfma_f32_16x16x32_bf16 a[132:135], v[76:79], v[128:131], a[132:135]
    buffer_load_dwordx4 v12, s[8:11], s26 offen offset:0 sc1 lds
    v_mfma_f32_16x16x32_bf16 a[136:139], v[76:79], v[132:135], a[136:139]
    buffer_load_dwordx4 v13, s[8:11], s26 offen offset:1024 sc1 lds
    v_mfma_f32_16x16x32_bf16 a[140:143], v[76:79], v[136:139], a[140:143]
    buffer_load_dwordx4 v14, s[8:11], s26 offen offset:2048 sc1 lds
    v_mfma_f32_16x16x32_bf16 a[144:147], v[76:79], v[140:143], a[144:147]
    buffer_load_dwordx4 v15, s[8:11], s26 offen offset:3072 sc1 lds
    v_mfma_f32_16x16x32_bf16 a[148:151], v[76:79], v[144:147], a[148:151]
    s_add_u32 s26, s26, 1024
    v_mfma_f32_16x16x32_bf16 a[152:155], v[76:79], v[148:151], a[152:155]
    v_mfma_f32_16x16x32_bf16 a[156:159], v[76:79], v[152:155], a[156:159]
    v_mfma_f32_16x16x32_bf16 a[160:163], v[80:83], v[124:127], a[160:163]
    v_mfma_f32_16x16x32_bf16 a[164:167], v[80:83], v[128:131], a[164:167]
    v_mfma_f32_16x16x32_bf16 a[168:171], v[80:83], v[132:135], a[168:171]
    v_mfma_f32_16x16x32_bf16 a[172:175], v[80:83], v[136:139], a[172:175]
    v_mfma_f32_16x16x32_bf16 a[176:179], v[80:83], v[140:143], a[176:179]
    v_mfma_f32_16x16x32_bf16 a[180:183], v[80:83], v[144:147], a[180:183]
    v_mfma_f32_16x16x32_bf16 a[184:187], v[80:83], v[148:151], a[184:187]
    v_mfma_f32_16x16x32_bf16 a[188:191], v[80:83], v[152:155], a[188:191]
    v_mfma_f32_16x16x32_bf16 a[192:195], v[84:87], v[124:127], a[192:195]
    v_mfma_f32_16x16x32_bf16 a[196:199], v[84:87], v[128:131], a[196:199]
    v_mfma_f32_16x16x32_bf16 a[200:203], v[84:87], v[132:135], a[200:203]
    v_mfma_f32_16x16x32_bf16 a[204:207], v[84:87], v[136:139], a[204:207]
    v_mfma_f32_16x16x32_bf16 a[208:211], v[84:87], v[140:143], a[208:211]
    v_mfma_f32_16x16x32_bf16 a[212:215], v[84:87], v[144:147], a[212:215]
    v_mfma_f32_16x16x32_bf16 a[216:219], v[84:87], v[148:151], a[216:219]
    v_mfma_f32_16x16x32_bf16 a[220:223], v[84:87], v[152:155], a[220:223]
    v_mfma_f32_16x16x32_bf16 a[224:227], v[88:91], v[124:127], a[224:227]
    v_mfma_f32_16x16x32_bf16 a[228:231], v[88:91], v[128:131], a[228:231]
    v_mfma_f32_16x16x32_bf16 a[232:235], v[88:91], v[132:135], a[232:235]
    v_mfma_f32_16x16x32_bf16 a[236:239], v[88:91], v[136:139], a[236:239]
    v_mfma_f32_16x16x32_bf16 a[240:243], v[88:91], v[140:143], a[240:243]
    v_mfma_f32_16x16x32_bf16 a[244:247], v[88:91], v[144:147], a[244:247]
    v_mfma_f32_16x16x32_bf16 a[248:251], v[88:91], v[148:151], a[248:251]
    v_mfma_f32_16x16x32_bf16 a[252:255], v[88:91], v[152:155], a[252:255]
    s_waitcnt lgkmcnt(0)
    s_waitcnt vmcnt(16)
    s_barrier
    v_mfma_f32_16x16x32_bf16 a[0:3], v[28:31], v[92:95], a[0:3]
    ds_read_b64_tr_b16 v[60:61], v16 offset:49152
    v_mfma_f32_16x16x32_bf16 a[4:7], v[28:31], v[96:99], a[4:7]
    ds_read_b64_tr_b16 v[62:63], v16 offset:57344
    v_mfma_f32_16x16x32_bf16 a[8:11], v[28:31], v[100:103], a[8:11]
    ds_read_b128 v[124:127], v24 offset:49152
    v_mfma_f32_16x16x32_bf16 a[12:15], v[28:31], v[104:107], a[12:15]
    ds_read_b128 v[128:131], v24 offset:50176
    v_mfma_f32_16x16x32_bf16 a[16:19], v[28:31], v[108:111], a[16:19]
    ds_read_b128 v[132:135], v24 offset:51200
    v_mfma_f32_16x16x32_bf16 a[20:23], v[28:31], v[112:115], a[20:23]
    ds_read_b128 v[136:139], v24 offset:52224
    v_mfma_f32_16x16x32_bf16 a[24:27], v[28:31], v[116:119], a[24:27]
    ds_read_b128 v[140:143], v24 offset:53248
    v_mfma_f32_16x16x32_bf16 a[28:31], v[28:31], v[120:123], a[28:31]
    ds_read_b128 v[144:147], v24 offset:54272
    v_mfma_f32_16x16x32_bf16 a[32:35], v[32:35], v[92:95], a[32:35]
    ds_read_b128 v[148:151], v24 offset:55296
    v_mfma_f32_16x16x32_bf16 a[36:39], v[32:35], v[96:99], a[36:39]
    ds_read_b128 v[152:155], v24 offset:56320
    v_mfma_f32_16x16x32_bf16 a[40:43], v[32:35], v[100:103], a[40:43]
    ds_read_b64_tr_b16 v[64:65], v17 offset:49152
    v_mfma_f32_16x16x32_bf16 a[44:47], v[32:35], v[104:107], a[44:47]
    ds_read_b64_tr_b16 v[66:67], v17 offset:57344
    v_mfma_f32_16x16x32_bf16 a[48:51], v[32:35], v[108:111], a[48:51]
    ds_read_b64_tr_b16 v[68:69], v18 offset:49152
    v_mfma_f32_16x16x32_bf16 a[52:55], v[32:35], v[112:115], a[52:55]
    ds_read_b64_tr_b16 v[70:71], v18 offset:57344
    v_mfma_f32_16x16x32_bf16 a[56:59], v[32:35], v[116:119], a[56:59]
    ds_read_b64_tr_b16 v[72:73], v19 offset:49152
    v_mfma_f32_16x16x32_bf16 a[60:63], v[32:35], v[120:123], a[60:63]
    ds_read_b64_tr_b16 v[74:75], v19 offset:57344
    v_mfma_f32_16x16x32_bf16 a[64:67], v[36:39], v[92:95], a[64:67]
    ds_read_b64_tr_b16 v[76:77], v20 offset:49152
    v_mfma_f32_16x16x32_bf16 a[68:71], v[36:39], v[96:99], a[68:71]
    ds_read_b64_tr_b16 v[78:79], v20 offset:57344
    v_mfma_f32_16x16x32_bf16 a[72:75], v[36:39], v[100:103], a[72:75]
    ds_read_b64_tr_b16 v[80:81], v21 offset:49152
    v_mfma_f32_16x16x32_bf16 a[76:79], v[36:39], v[104:107], a[76:79]
    ds_read_b64_tr_b16 v[82:83], v21 offset:57344
    v_mfma_f32_16x16x32_bf16 a[80:83], v[36:39], v[108:111], a[80:83]
    ds_read_b64_tr_b16 v[84:85], v22 offset:49152
    v_mfma_f32_16x16x32_bf16 a[84:87], v[36:39], v[112:115], a[84:87]
    ds_read_b64_tr_b16 v[86:87], v22 offset:57344
    v_mfma_f32_16x16x32_bf16 a[88:91], v[36:39], v[116:119], a[88:91]
    ds_read_b64_tr_b16 v[88:89], v23 offset:49152
    v_mfma_f32_16x16x32_bf16 a[92:95], v[36:39], v[120:123], a[92:95]
    ds_read_b64_tr_b16 v[90:91], v23 offset:57344
    v_mfma_f32_16x16x32_bf16 a[96:99], v[40:43], v[92:95], a[96:99]
    s_add_u32 m0, s28, 32768
    v_mfma_f32_16x16x32_bf16 a[100:103], v[40:43], v[96:99], a[100:103]
    s_nop 0
    v_mfma_f32_16x16x32_bf16 a[104:107], v[40:43], v[100:103], a[104:107]
    buffer_load_dwordx4 v8, s[12:15], s25 offen offset:0 lds
    v_mfma_f32_16x16x32_bf16 a[108:111], v[40:43], v[104:107], a[108:111]
    buffer_load_dwordx4 v9, s[12:15], s25 offen offset:1024 lds
    v_mfma_f32_16x16x32_bf16 a[112:115], v[40:43], v[108:111], a[112:115]
    buffer_load_dwordx4 v10, s[12:15], s25 offen offset:2048 lds
    v_mfma_f32_16x16x32_bf16 a[116:119], v[40:43], v[112:115], a[116:119]
    buffer_load_dwordx4 v11, s[12:15], s25 offen offset:3072 lds
    v_mfma_f32_16x16x32_bf16 a[120:123], v[40:43], v[116:119], a[120:123]
    s_add_u32 s25, s25, 262144
    v_mfma_f32_16x16x32_bf16 a[124:127], v[40:43], v[120:123], a[124:127]
    s_add_u32 m0, s29, 32768
    v_mfma_f32_16x16x32_bf16 a[128:131], v[44:47], v[92:95], a[128:131]
    s_nop 0
    v_mfma_f32_16x16x32_bf16 a[132:135], v[44:47], v[96:99], a[132:135]
    buffer_load_dwordx4 v12, s[8:11], s26 offen offset:0 sc1 lds
    v_mfma_f32_16x16x32_bf16 a[136:139], v[44:47], v[100:103], a[136:139]
    buffer_load_dwordx4 v13, s[8:11], s26 offen offset:1024 sc1 lds
    v_mfma_f32_16x16x32_bf16 a[140:143], v[44:47], v[104:107], a[140:143]
    buffer_load_dwordx4 v14, s[8:11], s26 offen offset:2048 sc1 lds
    v_mfma_f32_16x16x32_bf16 a[144:147], v[44:47], v[108:111], a[144:147]
    buffer_load_dwordx4 v15, s[8:11], s26 offen offset:3072 sc1 lds
    v_mfma_f32_16x16x32_bf16 a[148:151], v[44:47], v[112:115], a[148:151]
    s_add_u32 s26, s26, 1024
    v_mfma_f32_16x16x32_bf16 a[152:155], v[44:47], v[116:119], a[152:155]
    v_mfma_f32_16x16x32_bf16 a[156:159], v[44:47], v[120:123], a[156:159]
    v_mfma_f32_16x16x32_bf16 a[160:163], v[48:51], v[92:95], a[160:163]
    v_mfma_f32_16x16x32_bf16 a[164:167], v[48:51], v[96:99], a[164:167]
    v_mfma_f32_16x16x32_bf16 a[168:171], v[48:51], v[100:103], a[168:171]
    v_mfma_f32_16x16x32_bf16 a[172:175], v[48:51], v[104:107], a[172:175]
    v_mfma_f32_16x16x32_bf16 a[176:179], v[48:51], v[108:111], a[176:179]
    v_mfma_f32_16x16x32_bf16 a[180:183], v[48:51], v[112:115], a[180:183]
    v_mfma_f32_16x16x32_bf16 a[184:187], v[48:51], v[116:119], a[184:187]
    v_mfma_f32_16x16x32_bf16 a[188:191], v[48:51], v[120:123], a[188:191]
    v_mfma_f32_16x16x32_bf16 a[192:195], v[52:55], v[92:95], a[192:195]
    v_mfma_f32_16x16x32_bf16 a[196:199], v[52:55], v[96:99], a[196:199]
    v_mfma_f32_16x16x32_bf16 a[200:203], v[52:55], v[100:103], a[200:203]
    v_mfma_f32_16x16x32_bf16 a[204:207], v[52:55], v[104:107], a[204:207]
    v_mfma_f32_16x16x32_bf16 a[208:211], v[52:55], v[108:111], a[208:211]
    v_mfma_f32_16x16x32_bf16 a[212:215], v[52:55], v[112:115], a[212:215]
    v_mfma_f32_16x16x32_bf16 a[216:219], v[52:55], v[116:119], a[216:219]
    v_mfma_f32_16x16x32_bf16 a[220:223], v[52:55], v[120:123], a[220:223]
    v_mfma_f32_16x16x32_bf16 a[224:227], v[56:59], v[92:95], a[224:227]
    v_mfma_f32_16x16x32_bf16 a[228:231], v[56:59], v[96:99], a[228:231]
    v_mfma_f32_16x16x32_bf16 a[232:235], v[56:59], v[100:103], a[232:235]
    v_mfma_f32_16x16x32_bf16 a[236:239], v[56:59], v[104:107], a[236:239]
    v_mfma_f32_16x16x32_bf16 a[240:243], v[56:59], v[108:111], a[240:243]
    v_mfma_f32_16x16x32_bf16 a[244:247], v[56:59], v[112:115], a[244:247]
    v_mfma_f32_16x16x32_bf16 a[248:251], v[56:59], v[116:119], a[248:251]
    v_mfma_f32_16x16x32_bf16 a[252:255], v[56:59], v[120:123], a[252:255]
    s_waitcnt lgkmcnt(0)
    s_waitcnt vmcnt(16)
    s_barrier
    v_mfma_f32_16x16x32_bf16 a[0:3], v[60:63], v[124:127], a[0:3]
    ds_read_b64_tr_b16 v[28:29], v16 offset:0
    v_mfma_f32_16x16x32_bf16 a[4:7], v[60:63], v[128:131], a[4:7]
    ds_read_b64_tr_b16 v[30:31], v16 offset:8192
    v_mfma_f32_16x16x32_bf16 a[8:11], v[60:63], v[132:135], a[8:11]
    ds_read_b128 v[92:95], v24 offset:0
    v_mfma_f32_16x16x32_bf16 a[12:15], v[60:63], v[136:139], a[12:15]
    ds_read_b128 v[96:99], v24 offset:1024
    v_mfma_f32_16x16x32_bf16 a[16:19], v[60:63], v[140:143], a[16:19]
    ds_read_b128 v[100:103], v24 offset:2048
    v_mfma_f32_16x16x32_bf16 a[20:23], v[60:63], v[144:147], a[20:23]
    ds_read_b128 v[104:107], v24 offset:3072
    v_mfma_f32_16x16x32_bf16 a[24:27], v[60:63], v[148:151], a[24:27]
    ds_read_b128 v[108:111], v24 offset:4096
    v_mfma_f32_16x16x32_bf16 a[28:31], v[60:63], v[152:155], a[28:31]
    ds_read_b128 v[112:115], v24 offset:5120
    v_mfma_f32_16x16x32_bf16 a[32:35], v[64:67], v[124:127], a[32:35]
    ds_read_b128 v[116:119], v24 offset:6144
    v_mfma_f32_16x16x32_bf16 a[36:39], v[64:67], v[128:131], a[36:39]
    ds_read_b128 v[120:123], v24 offset:7168
    v_mfma_f32_16x16x32_bf16 a[40:43], v[64:67], v[132:135], a[40:43]
    ds_read_b64_tr_b16 v[32:33], v17 offset:0
    v_mfma_f32_16x16x32_bf16 a[44:47], v[64:67], v[136:139], a[44:47]
    ds_read_b64_tr_b16 v[34:35], v17 offset:8192
    v_mfma_f32_16x16x32_bf16 a[48:51], v[64:67], v[140:143], a[48:51]
    ds_read_b64_tr_b16 v[36:37], v18 offset:0
    v_mfma_f32_16x16x32_bf16 a[52:55], v[64:67], v[144:147], a[52:55]
    ds_read_b64_tr_b16 v[38:39], v18 offset:8192
    v_mfma_f32_16x16x32_bf16 a[56:59], v[64:67], v[148:151], a[56:59]
    ds_read_b64_tr_b16 v[40:41], v19 offset:0
    v_mfma_f32_16x16x32_bf16 a[60:63], v[64:67], v[152:155], a[60:63]
    ds_read_b64_tr_b16 v[42:43], v19 offset:8192
    v_mfma_f32_16x16x32_bf16 a[64:67], v[68:71], v[124:127], a[64:67]
    ds_read_b64_tr_b16 v[44:45], v20 offset:0
    v_mfma_f32_16x16x32_bf16 a[68:71], v[68:71], v[128:131], a[68:71]
    ds_read_b64_tr_b16 v[46:47], v20 offset:8192
    v_mfma_f32_16x16x32_bf16 a[72:75], v[68:71], v[132:135], a[72:75]
    ds_read_b64_tr_b16 v[48:49], v21 offset:0
    v_mfma_f32_16x16x32_bf16 a[76:79], v[68:71], v[136:139], a[76:79]
    ds_read_b64_tr_b16 v[50:51], v21 offset:8192
    v_mfma_f32_16x16x32_bf16 a[80:83], v[68:71], v[140:143], a[80:83]
    ds_read_b64_tr_b16 v[52:53], v22 offset:0
    v_mfma_f32_16x16x32_bf16 a[84:87], v[68:71], v[144:147], a[84:87]
    ds_read_b64_tr_b16 v[54:55], v22 offset:8192
    v_mfma_f32_16x16x32_bf16 a[88:91], v[68:71], v[148:151], a[88:91]
    ds_read_b64_tr_b16 v[56:57], v23 offset:0
    v_mfma_f32_16x16x32_bf16 a[92:95], v[68:71], v[152:155], a[92:95]
    ds_read_b64_tr_b16 v[58:59], v23 offset:8192
    v_mfma_f32_16x16x32_bf16 a[96:99], v[72:75], v[124:127], a[96:99]
    s_add_u32 m0, s28, 49152
    v_mfma_f32_16x16x32_bf16 a[100:103], v[72:75], v[128:131], a[100:103]
    s_nop 0
    v_mfma_f32_16x16x32_bf16 a[104:107], v[72:75], v[132:135], a[104:107]
    buffer_load_dwordx4 v8, s[12:15], s25 offen offset:0 lds
    v_mfma_f32_16x16x32_bf16 a[108:111], v[72:75], v[136:139], a[108:111]
    buffer_load_dwordx4 v9, s[12:15], s25 offen offset:1024 lds
    v_mfma_f32_16x16x32_bf16 a[112:115], v[72:75], v[140:143], a[112:115]
    buffer_load_dwordx4 v10, s[12:15], s25 offen offset:2048 lds
    v_mfma_f32_16x16x32_bf16 a[116:119], v[72:75], v[144:147], a[116:119]
    buffer_load_dwordx4 v11, s[12:15], s25 offen offset:3072 lds
    v_mfma_f32_16x16x32_bf16 a[120:123], v[72:75], v[148:151], a[120:123]
    s_add_u32 s25, s25, 262144
    v_mfma_f32_16x16x32_bf16 a[124:127], v[72:75], v[152:155], a[124:127]
    s_add_u32 m0, s29, 49152
    v_mfma_f32_16x16x32_bf16 a[128:131], v[76:79], v[124:127], a[128:131]
    s_nop 0
    v_mfma_f32_16x16x32_bf16 a[132:135], v[76:79], v[128:131], a[132:135]
    buffer_load_dwordx4 v12, s[8:11], s26 offen offset:0 sc1 lds
    v_mfma_f32_16x16x32_bf16 a[136:139], v[76:79], v[132:135], a[136:139]
    buffer_load_dwordx4 v13, s[8:11], s26 offen offset:1024 sc1 lds
    v_mfma_f32_16x16x32_bf16 a[140:143], v[76:79], v[136:139], a[140:143]
    buffer_load_dwordx4 v14, s[8:11], s26 offen offset:2048 sc1 lds
    v_mfma_f32_16x16x32_bf16 a[144:147], v[76:79], v[140:143], a[144:147]
    buffer_load_dwordx4 v15, s[8:11], s26 offen offset:3072 sc1 lds
    v_mfma_f32_16x16x32_bf16 a[148:151], v[76:79], v[144:147], a[148:151]
    s_add_u32 s26, s26, 1024
    v_mfma_f32_16x16x32_bf16 a[152:155], v[76:79], v[148:151], a[152:155]
    v_mfma_f32_16x16x32_bf16 a[156:159], v[76:79], v[152:155], a[156:159]
    v_mfma_f32_16x16x32_bf16 a[160:163], v[80:83], v[124:127], a[160:163]
    v_mfma_f32_16x16x32_bf16 a[164:167], v[80:83], v[128:131], a[164:167]
    v_mfma_f32_16x16x32_bf16 a[168:171], v[80:83], v[132:135], a[168:171]
    v_mfma_f32_16x16x32_bf16 a[172:175], v[80:83], v[136:139], a[172:175]
    v_mfma_f32_16x16x32_bf16 a[176:179], v[80:83], v[140:143], a[176:179]
    v_mfma_f32_16x16x32_bf16 a[180:183], v[80:83], v[144:147], a[180:183]
    v_mfma_f32_16x16x32_bf16 a[184:187], v[80:83], v[148:151], a[184:187]
    v_mfma_f32_16x16x32_bf16 a[188:191], v[80:83], v[152:155], a[188:191]
    v_mfma_f32_16x16x32_bf16 a[192:195], v[84:87], v[124:127], a[192:195]
    v_mfma_f32_16x16x32_bf16 a[196:199], v[84:87], v[128:131], a[196:199]
    v_mfma_f32_16x16x32_bf16 a[200:203], v[84:87], v[132:135], a[200:203]
    v_mfma_f32_16x16x32_bf16 a[204:207], v[84:87], v[136:139], a[204:207]
    v_mfma_f32_16x16x32_bf16 a[208:211], v[84:87], v[140:143], a[208:211]
    v_mfma_f32_16x16x32_bf16 a[212:215], v[84:87], v[144:147], a[212:215]
    v_mfma_f32_16x16x32_bf16 a[216:219], v[84:87], v[148:151], a[216:219]
    v_mfma_f32_16x16x32_bf16 a[220:223], v[84:87], v[152:155], a[220:223]
    v_mfma_f32_16x16x32_bf16 a[224:227], v[88:91], v[124:127], a[224:227]
    v_mfma_f32_16x16x32_bf16 a[228:231], v[88:91], v[128:131], a[228:231]
    v_mfma_f32_16x16x32_bf16 a[232:235], v[88:91], v[132:135], a[232:235]
    v_mfma_f32_16x16x32_bf16 a[236:239], v[88:91], v[136:139], a[236:239]
    v_mfma_f32_16x16x32_bf16 a[240:243], v[88:91], v[140:143], a[240:243]
    v_mfma_f32_16x16x32_bf16 a[244:247], v[88:91], v[144:147], a[244:247]
    v_mfma_f32_16x16x32_bf16 a[248:251], v[88:91], v[148:151], a[248:251]
    v_mfma_f32_16x16x32_bf16 a[252:255], v[88:91], v[152:155], a[252:255]
    s_sub_u32 s27, s27, 1
    s_cmp_lg_u32 s27, 0
    s_cbranch_scc1 mega_kernel_w_bk_loop
    s_nop 7
    s_lshr_b32 s34, s24, 1
    s_mul_i32 s30, s22, 4
    s_add_u32 s34, s34, s30
    s_lshl_b32 s35, s34, 5
    s_add_u32 s35, s35, s33

    s_add_u32 s35, s35, s21
    s_lshl_b32 s35, s35, 13
    s_lshl_b32 s30, s32, 24
    s_add_u32 s35, s35, s30
    s_add_u32 s35, s35, 6717440
    s_add_u32 s30, s35, 0
    v_accvgpr_read_b32 v156, a0
    v_accvgpr_read_b32 v157, a1
    v_accvgpr_read_b32 v158, a2
    v_accvgpr_read_b32 v159, a3
    v_accvgpr_read_b32 v160, a32
    v_accvgpr_read_b32 v161, a33
    v_accvgpr_read_b32 v162, a34
    v_accvgpr_read_b32 v163, a35
    v_cvt_pk_bf16_f32 v156, v156, v157
    v_cvt_pk_bf16_f32 v157, v158, v159
    v_cvt_pk_bf16_f32 v158, v160, v161
    v_cvt_pk_bf16_f32 v159, v162, v163
    buffer_store_dwordx4 v[156:159], v4, s[8:11], s30 offen offset:0 sc1
    v_accvgpr_read_b32 v164, a64
    v_accvgpr_read_b32 v165, a65
    v_accvgpr_read_b32 v166, a66
    v_accvgpr_read_b32 v167, a67
    v_accvgpr_read_b32 v168, a96
    v_accvgpr_read_b32 v169, a97
    v_accvgpr_read_b32 v170, a98
    v_accvgpr_read_b32 v171, a99
    v_cvt_pk_bf16_f32 v164, v164, v165
    v_cvt_pk_bf16_f32 v165, v166, v167
    v_cvt_pk_bf16_f32 v166, v168, v169
    v_cvt_pk_bf16_f32 v167, v170, v171
    buffer_store_dwordx4 v[164:167], v4, s[8:11], s30 offen offset:1024 sc1
    v_accvgpr_read_b32 v172, a128
    v_accvgpr_read_b32 v173, a129
    v_accvgpr_read_b32 v174, a130
    v_accvgpr_read_b32 v175, a131
    v_accvgpr_read_b32 v176, a160
    v_accvgpr_read_b32 v177, a161
    v_accvgpr_read_b32 v178, a162
    v_accvgpr_read_b32 v179, a163
    v_cvt_pk_bf16_f32 v172, v172, v173
    v_cvt_pk_bf16_f32 v173, v174, v175
    v_cvt_pk_bf16_f32 v174, v176, v177
    v_cvt_pk_bf16_f32 v175, v178, v179
    buffer_store_dwordx4 v[172:175], v4, s[8:11], s30 offen offset:2048 sc1
    v_accvgpr_read_b32 v180, a192
    v_accvgpr_read_b32 v181, a193
    v_accvgpr_read_b32 v182, a194
    v_accvgpr_read_b32 v183, a195
    v_accvgpr_read_b32 v184, a224
    v_accvgpr_read_b32 v185, a225
    v_accvgpr_read_b32 v186, a226
    v_accvgpr_read_b32 v187, a227
    v_cvt_pk_bf16_f32 v180, v180, v181
    v_cvt_pk_bf16_f32 v181, v182, v183
    v_cvt_pk_bf16_f32 v182, v184, v185
    v_cvt_pk_bf16_f32 v183, v186, v187
    buffer_store_dwordx4 v[180:183], v4, s[8:11], s30 offen offset:3072 sc1
    s_add_u32 s30, s35, 4096
    v_accvgpr_read_b32 v156, a4
    v_accvgpr_read_b32 v157, a5
    v_accvgpr_read_b32 v158, a6
    v_accvgpr_read_b32 v159, a7
    v_accvgpr_read_b32 v160, a36
    v_accvgpr_read_b32 v161, a37
    v_accvgpr_read_b32 v162, a38
    v_accvgpr_read_b32 v163, a39
    v_cvt_pk_bf16_f32 v156, v156, v157
    v_cvt_pk_bf16_f32 v157, v158, v159
    v_cvt_pk_bf16_f32 v158, v160, v161
    v_cvt_pk_bf16_f32 v159, v162, v163
    buffer_store_dwordx4 v[156:159], v4, s[8:11], s30 offen offset:0 sc1
    v_accvgpr_read_b32 v164, a68
    v_accvgpr_read_b32 v165, a69
    v_accvgpr_read_b32 v166, a70
    v_accvgpr_read_b32 v167, a71
    v_accvgpr_read_b32 v168, a100
    v_accvgpr_read_b32 v169, a101
    v_accvgpr_read_b32 v170, a102
    v_accvgpr_read_b32 v171, a103
    v_cvt_pk_bf16_f32 v164, v164, v165
    v_cvt_pk_bf16_f32 v165, v166, v167
    v_cvt_pk_bf16_f32 v166, v168, v169
    v_cvt_pk_bf16_f32 v167, v170, v171
    buffer_store_dwordx4 v[164:167], v4, s[8:11], s30 offen offset:1024 sc1
    v_accvgpr_read_b32 v172, a132
    v_accvgpr_read_b32 v173, a133
    v_accvgpr_read_b32 v174, a134
    v_accvgpr_read_b32 v175, a135
    v_accvgpr_read_b32 v176, a164
    v_accvgpr_read_b32 v177, a165
    v_accvgpr_read_b32 v178, a166
    v_accvgpr_read_b32 v179, a167
    v_cvt_pk_bf16_f32 v172, v172, v173
    v_cvt_pk_bf16_f32 v173, v174, v175
    v_cvt_pk_bf16_f32 v174, v176, v177
    v_cvt_pk_bf16_f32 v175, v178, v179
    buffer_store_dwordx4 v[172:175], v4, s[8:11], s30 offen offset:2048 sc1
    v_accvgpr_read_b32 v180, a196
    v_accvgpr_read_b32 v181, a197
    v_accvgpr_read_b32 v182, a198
    v_accvgpr_read_b32 v183, a199
    v_accvgpr_read_b32 v184, a228
    v_accvgpr_read_b32 v185, a229
    v_accvgpr_read_b32 v186, a230
    v_accvgpr_read_b32 v187, a231
    v_cvt_pk_bf16_f32 v180, v180, v181
    v_cvt_pk_bf16_f32 v181, v182, v183
    v_cvt_pk_bf16_f32 v182, v184, v185
    v_cvt_pk_bf16_f32 v183, v186, v187
    buffer_store_dwordx4 v[180:183], v4, s[8:11], s30 offen offset:3072 sc1
    s_add_u32 s30, s35, 262144
    v_accvgpr_read_b32 v156, a8
    v_accvgpr_read_b32 v157, a9
    v_accvgpr_read_b32 v158, a10
    v_accvgpr_read_b32 v159, a11
    v_accvgpr_read_b32 v160, a40
    v_accvgpr_read_b32 v161, a41
    v_accvgpr_read_b32 v162, a42
    v_accvgpr_read_b32 v163, a43
    v_cvt_pk_bf16_f32 v156, v156, v157
    v_cvt_pk_bf16_f32 v157, v158, v159
    v_cvt_pk_bf16_f32 v158, v160, v161
    v_cvt_pk_bf16_f32 v159, v162, v163
    buffer_store_dwordx4 v[156:159], v4, s[8:11], s30 offen offset:0 sc1
    v_accvgpr_read_b32 v164, a72
    v_accvgpr_read_b32 v165, a73
    v_accvgpr_read_b32 v166, a74
    v_accvgpr_read_b32 v167, a75
    v_accvgpr_read_b32 v168, a104
    v_accvgpr_read_b32 v169, a105
    v_accvgpr_read_b32 v170, a106
    v_accvgpr_read_b32 v171, a107
    v_cvt_pk_bf16_f32 v164, v164, v165
    v_cvt_pk_bf16_f32 v165, v166, v167
    v_cvt_pk_bf16_f32 v166, v168, v169
    v_cvt_pk_bf16_f32 v167, v170, v171
    buffer_store_dwordx4 v[164:167], v4, s[8:11], s30 offen offset:1024 sc1
    v_accvgpr_read_b32 v172, a136
    v_accvgpr_read_b32 v173, a137
    v_accvgpr_read_b32 v174, a138
    v_accvgpr_read_b32 v175, a139
    v_accvgpr_read_b32 v176, a168
    v_accvgpr_read_b32 v177, a169
    v_accvgpr_read_b32 v178, a170
    v_accvgpr_read_b32 v179, a171
    v_cvt_pk_bf16_f32 v172, v172, v173
    v_cvt_pk_bf16_f32 v173, v174, v175
    v_cvt_pk_bf16_f32 v174, v176, v177
    v_cvt_pk_bf16_f32 v175, v178, v179
    buffer_store_dwordx4 v[172:175], v4, s[8:11], s30 offen offset:2048 sc1
    v_accvgpr_read_b32 v180, a200
    v_accvgpr_read_b32 v181, a201
    v_accvgpr_read_b32 v182, a202
    v_accvgpr_read_b32 v183, a203
    v_accvgpr_read_b32 v184, a232
    v_accvgpr_read_b32 v185, a233
    v_accvgpr_read_b32 v186, a234
    v_accvgpr_read_b32 v187, a235
    v_cvt_pk_bf16_f32 v180, v180, v181
    v_cvt_pk_bf16_f32 v181, v182, v183
    v_cvt_pk_bf16_f32 v182, v184, v185
    v_cvt_pk_bf16_f32 v183, v186, v187
    buffer_store_dwordx4 v[180:183], v4, s[8:11], s30 offen offset:3072 sc1
    s_add_u32 s30, s35, 266240
    v_accvgpr_read_b32 v156, a12
    v_accvgpr_read_b32 v157, a13
    v_accvgpr_read_b32 v158, a14
    v_accvgpr_read_b32 v159, a15
    v_accvgpr_read_b32 v160, a44
    v_accvgpr_read_b32 v161, a45
    v_accvgpr_read_b32 v162, a46
    v_accvgpr_read_b32 v163, a47
    v_cvt_pk_bf16_f32 v156, v156, v157
    v_cvt_pk_bf16_f32 v157, v158, v159
    v_cvt_pk_bf16_f32 v158, v160, v161
    v_cvt_pk_bf16_f32 v159, v162, v163
    buffer_store_dwordx4 v[156:159], v4, s[8:11], s30 offen offset:0 sc1
    v_accvgpr_read_b32 v164, a76
    v_accvgpr_read_b32 v165, a77
    v_accvgpr_read_b32 v166, a78
    v_accvgpr_read_b32 v167, a79
    v_accvgpr_read_b32 v168, a108
    v_accvgpr_read_b32 v169, a109
    v_accvgpr_read_b32 v170, a110
    v_accvgpr_read_b32 v171, a111
    v_cvt_pk_bf16_f32 v164, v164, v165
    v_cvt_pk_bf16_f32 v165, v166, v167
    v_cvt_pk_bf16_f32 v166, v168, v169
    v_cvt_pk_bf16_f32 v167, v170, v171
    buffer_store_dwordx4 v[164:167], v4, s[8:11], s30 offen offset:1024 sc1
    v_accvgpr_read_b32 v172, a140
    v_accvgpr_read_b32 v173, a141
    v_accvgpr_read_b32 v174, a142
    v_accvgpr_read_b32 v175, a143
    v_accvgpr_read_b32 v176, a172
    v_accvgpr_read_b32 v177, a173
    v_accvgpr_read_b32 v178, a174
    v_accvgpr_read_b32 v179, a175
    v_cvt_pk_bf16_f32 v172, v172, v173
    v_cvt_pk_bf16_f32 v173, v174, v175
    v_cvt_pk_bf16_f32 v174, v176, v177
    v_cvt_pk_bf16_f32 v175, v178, v179
    buffer_store_dwordx4 v[172:175], v4, s[8:11], s30 offen offset:2048 sc1
    v_accvgpr_read_b32 v180, a204
    v_accvgpr_read_b32 v181, a205
    v_accvgpr_read_b32 v182, a206
    v_accvgpr_read_b32 v183, a207
    v_accvgpr_read_b32 v184, a236
    v_accvgpr_read_b32 v185, a237
    v_accvgpr_read_b32 v186, a238
    v_accvgpr_read_b32 v187, a239
    v_cvt_pk_bf16_f32 v180, v180, v181
    v_cvt_pk_bf16_f32 v181, v182, v183
    v_cvt_pk_bf16_f32 v182, v184, v185
    v_cvt_pk_bf16_f32 v183, v186, v187
    buffer_store_dwordx4 v[180:183], v4, s[8:11], s30 offen offset:3072 sc1
    s_add_u32 s30, s35, 524288
    v_accvgpr_read_b32 v156, a16
    v_accvgpr_read_b32 v157, a17
    v_accvgpr_read_b32 v158, a18
    v_accvgpr_read_b32 v159, a19
    v_accvgpr_read_b32 v160, a48
    v_accvgpr_read_b32 v161, a49
    v_accvgpr_read_b32 v162, a50
    v_accvgpr_read_b32 v163, a51
    v_cvt_pk_bf16_f32 v156, v156, v157
    v_cvt_pk_bf16_f32 v157, v158, v159
    v_cvt_pk_bf16_f32 v158, v160, v161
    v_cvt_pk_bf16_f32 v159, v162, v163
    buffer_store_dwordx4 v[156:159], v4, s[8:11], s30 offen offset:0 sc1
    v_accvgpr_read_b32 v164, a80
    v_accvgpr_read_b32 v165, a81
    v_accvgpr_read_b32 v166, a82
    v_accvgpr_read_b32 v167, a83
    v_accvgpr_read_b32 v168, a112
    v_accvgpr_read_b32 v169, a113
    v_accvgpr_read_b32 v170, a114
    v_accvgpr_read_b32 v171, a115
    v_cvt_pk_bf16_f32 v164, v164, v165
    v_cvt_pk_bf16_f32 v165, v166, v167
    v_cvt_pk_bf16_f32 v166, v168, v169
    v_cvt_pk_bf16_f32 v167, v170, v171
    buffer_store_dwordx4 v[164:167], v4, s[8:11], s30 offen offset:1024 sc1
    v_accvgpr_read_b32 v172, a144
    v_accvgpr_read_b32 v173, a145
    v_accvgpr_read_b32 v174, a146
    v_accvgpr_read_b32 v175, a147
    v_accvgpr_read_b32 v176, a176
    v_accvgpr_read_b32 v177, a177
    v_accvgpr_read_b32 v178, a178
    v_accvgpr_read_b32 v179, a179
    v_cvt_pk_bf16_f32 v172, v172, v173
    v_cvt_pk_bf16_f32 v173, v174, v175
    v_cvt_pk_bf16_f32 v174, v176, v177
    v_cvt_pk_bf16_f32 v175, v178, v179
    buffer_store_dwordx4 v[172:175], v4, s[8:11], s30 offen offset:2048 sc1
    v_accvgpr_read_b32 v180, a208
    v_accvgpr_read_b32 v181, a209
    v_accvgpr_read_b32 v182, a210
    v_accvgpr_read_b32 v183, a211
    v_accvgpr_read_b32 v184, a240
    v_accvgpr_read_b32 v185, a241
    v_accvgpr_read_b32 v186, a242
    v_accvgpr_read_b32 v187, a243
    v_cvt_pk_bf16_f32 v180, v180, v181
    v_cvt_pk_bf16_f32 v181, v182, v183
    v_cvt_pk_bf16_f32 v182, v184, v185
    v_cvt_pk_bf16_f32 v183, v186, v187
    buffer_store_dwordx4 v[180:183], v4, s[8:11], s30 offen offset:3072 sc1
    s_add_u32 s30, s35, 528384
    v_accvgpr_read_b32 v156, a20
    v_accvgpr_read_b32 v157, a21
    v_accvgpr_read_b32 v158, a22
    v_accvgpr_read_b32 v159, a23
    v_accvgpr_read_b32 v160, a52
    v_accvgpr_read_b32 v161, a53
    v_accvgpr_read_b32 v162, a54
    v_accvgpr_read_b32 v163, a55
    v_cvt_pk_bf16_f32 v156, v156, v157
    v_cvt_pk_bf16_f32 v157, v158, v159
    v_cvt_pk_bf16_f32 v158, v160, v161
    v_cvt_pk_bf16_f32 v159, v162, v163
    buffer_store_dwordx4 v[156:159], v4, s[8:11], s30 offen offset:0 sc1
    v_accvgpr_read_b32 v164, a84
    v_accvgpr_read_b32 v165, a85
    v_accvgpr_read_b32 v166, a86
    v_accvgpr_read_b32 v167, a87
    v_accvgpr_read_b32 v168, a116
    v_accvgpr_read_b32 v169, a117
    v_accvgpr_read_b32 v170, a118
    v_accvgpr_read_b32 v171, a119
    v_cvt_pk_bf16_f32 v164, v164, v165
    v_cvt_pk_bf16_f32 v165, v166, v167
    v_cvt_pk_bf16_f32 v166, v168, v169
    v_cvt_pk_bf16_f32 v167, v170, v171
    buffer_store_dwordx4 v[164:167], v4, s[8:11], s30 offen offset:1024 sc1
    v_accvgpr_read_b32 v172, a148
    v_accvgpr_read_b32 v173, a149
    v_accvgpr_read_b32 v174, a150
    v_accvgpr_read_b32 v175, a151
    v_accvgpr_read_b32 v176, a180
    v_accvgpr_read_b32 v177, a181
    v_accvgpr_read_b32 v178, a182
    v_accvgpr_read_b32 v179, a183
    v_cvt_pk_bf16_f32 v172, v172, v173
    v_cvt_pk_bf16_f32 v173, v174, v175
    v_cvt_pk_bf16_f32 v174, v176, v177
    v_cvt_pk_bf16_f32 v175, v178, v179
    buffer_store_dwordx4 v[172:175], v4, s[8:11], s30 offen offset:2048 sc1
    v_accvgpr_read_b32 v180, a212
    v_accvgpr_read_b32 v181, a213
    v_accvgpr_read_b32 v182, a214
    v_accvgpr_read_b32 v183, a215
    v_accvgpr_read_b32 v184, a244
    v_accvgpr_read_b32 v185, a245
    v_accvgpr_read_b32 v186, a246
    v_accvgpr_read_b32 v187, a247
    v_cvt_pk_bf16_f32 v180, v180, v181
    v_cvt_pk_bf16_f32 v181, v182, v183
    v_cvt_pk_bf16_f32 v182, v184, v185
    v_cvt_pk_bf16_f32 v183, v186, v187
    buffer_store_dwordx4 v[180:183], v4, s[8:11], s30 offen offset:3072 sc1
    s_add_u32 s30, s35, 786432
    v_accvgpr_read_b32 v156, a24
    v_accvgpr_read_b32 v157, a25
    v_accvgpr_read_b32 v158, a26
    v_accvgpr_read_b32 v159, a27
    v_accvgpr_read_b32 v160, a56
    v_accvgpr_read_b32 v161, a57
    v_accvgpr_read_b32 v162, a58
    v_accvgpr_read_b32 v163, a59
    v_cvt_pk_bf16_f32 v156, v156, v157
    v_cvt_pk_bf16_f32 v157, v158, v159
    v_cvt_pk_bf16_f32 v158, v160, v161
    v_cvt_pk_bf16_f32 v159, v162, v163
    buffer_store_dwordx4 v[156:159], v4, s[8:11], s30 offen offset:0 sc1
    v_accvgpr_read_b32 v164, a88
    v_accvgpr_read_b32 v165, a89
    v_accvgpr_read_b32 v166, a90
    v_accvgpr_read_b32 v167, a91
    v_accvgpr_read_b32 v168, a120
    v_accvgpr_read_b32 v169, a121
    v_accvgpr_read_b32 v170, a122
    v_accvgpr_read_b32 v171, a123
    v_cvt_pk_bf16_f32 v164, v164, v165
    v_cvt_pk_bf16_f32 v165, v166, v167
    v_cvt_pk_bf16_f32 v166, v168, v169
    v_cvt_pk_bf16_f32 v167, v170, v171
    buffer_store_dwordx4 v[164:167], v4, s[8:11], s30 offen offset:1024 sc1
    v_accvgpr_read_b32 v172, a152
    v_accvgpr_read_b32 v173, a153
    v_accvgpr_read_b32 v174, a154
    v_accvgpr_read_b32 v175, a155
    v_accvgpr_read_b32 v176, a184
    v_accvgpr_read_b32 v177, a185
    v_accvgpr_read_b32 v178, a186
    v_accvgpr_read_b32 v179, a187
    v_cvt_pk_bf16_f32 v172, v172, v173
    v_cvt_pk_bf16_f32 v173, v174, v175
    v_cvt_pk_bf16_f32 v174, v176, v177
    v_cvt_pk_bf16_f32 v175, v178, v179
    buffer_store_dwordx4 v[172:175], v4, s[8:11], s30 offen offset:2048 sc1
    v_accvgpr_read_b32 v180, a216
    v_accvgpr_read_b32 v181, a217
    v_accvgpr_read_b32 v182, a218
    v_accvgpr_read_b32 v183, a219
    v_accvgpr_read_b32 v184, a248
    v_accvgpr_read_b32 v185, a249
    v_accvgpr_read_b32 v186, a250
    v_accvgpr_read_b32 v187, a251
    v_cvt_pk_bf16_f32 v180, v180, v181
    v_cvt_pk_bf16_f32 v181, v182, v183
    v_cvt_pk_bf16_f32 v182, v184, v185
    v_cvt_pk_bf16_f32 v183, v186, v187
    buffer_store_dwordx4 v[180:183], v4, s[8:11], s30 offen offset:3072 sc1
    s_add_u32 s30, s35, 790528
    v_accvgpr_read_b32 v156, a28
    v_accvgpr_read_b32 v157, a29
    v_accvgpr_read_b32 v158, a30
    v_accvgpr_read_b32 v159, a31
    v_accvgpr_read_b32 v160, a60
    v_accvgpr_read_b32 v161, a61
    v_accvgpr_read_b32 v162, a62
    v_accvgpr_read_b32 v163, a63
    v_cvt_pk_bf16_f32 v156, v156, v157
    v_cvt_pk_bf16_f32 v157, v158, v159
    v_cvt_pk_bf16_f32 v158, v160, v161
    v_cvt_pk_bf16_f32 v159, v162, v163
    buffer_store_dwordx4 v[156:159], v4, s[8:11], s30 offen offset:0 sc1
    v_accvgpr_read_b32 v164, a92
    v_accvgpr_read_b32 v165, a93
    v_accvgpr_read_b32 v166, a94
    v_accvgpr_read_b32 v167, a95
    v_accvgpr_read_b32 v168, a124
    v_accvgpr_read_b32 v169, a125
    v_accvgpr_read_b32 v170, a126
    v_accvgpr_read_b32 v171, a127
    v_cvt_pk_bf16_f32 v164, v164, v165
    v_cvt_pk_bf16_f32 v165, v166, v167
    v_cvt_pk_bf16_f32 v166, v168, v169
    v_cvt_pk_bf16_f32 v167, v170, v171
    buffer_store_dwordx4 v[164:167], v4, s[8:11], s30 offen offset:1024 sc1
    v_accvgpr_read_b32 v172, a156
    v_accvgpr_read_b32 v173, a157
    v_accvgpr_read_b32 v174, a158
    v_accvgpr_read_b32 v175, a159
    v_accvgpr_read_b32 v176, a188
    v_accvgpr_read_b32 v177, a189
    v_accvgpr_read_b32 v178, a190
    v_accvgpr_read_b32 v179, a191
    v_cvt_pk_bf16_f32 v172, v172, v173
    v_cvt_pk_bf16_f32 v173, v174, v175
    v_cvt_pk_bf16_f32 v174, v176, v177
    v_cvt_pk_bf16_f32 v175, v178, v179
    buffer_store_dwordx4 v[172:175], v4, s[8:11], s30 offen offset:2048 sc1
    v_accvgpr_read_b32 v180, a220
    v_accvgpr_read_b32 v181, a221
    v_accvgpr_read_b32 v182, a222
    v_accvgpr_read_b32 v183, a223
    v_accvgpr_read_b32 v184, a252
    v_accvgpr_read_b32 v185, a253
    v_accvgpr_read_b32 v186, a254
    v_accvgpr_read_b32 v187, a255
    v_cvt_pk_bf16_f32 v180, v180, v181
    v_cvt_pk_bf16_f32 v181, v182, v183
    v_cvt_pk_bf16_f32 v182, v184, v185
    v_cvt_pk_bf16_f32 v183, v186, v187
    buffer_store_dwordx4 v[180:183], v4, s[8:11], s30 offen offset:3072 sc1
    s_branch mega_kernel_w_next
mega_kernel_w_kvb_v:
    s_mov_b32 s12, s48
    s_mov_b32 s13, s49
    s_mov_b32 s14, 8388608
    s_mov_b32 s15, 0x20000
    s_mul_i32 s28, s20, 4096
    s_add_u32 s28, s28, 0
    v_lshlrev_b32 v5, 4, v1
    s_mul_i32 s30, s20, 131072
    v_add_u32 v5, s30, v5
    v_add_u32 v8, 0, v5
    v_add_u32 v9, 31744, v5
    v_add_u32 v10, 63488, v5
    v_add_u32 v11, 95232, v5
    s_mul_i32 s30, s21, 8192
    s_add_u32 s30, s30, 0
    v_lshlrev_b32 v16, 4, v1
    v_add_u32 v16, s30, v16
    s_mul_i32 s29, s20, 4096
    s_add_u32 s29, s29, 65536
    v_lshrrev_b32 v5, 5, v1
    s_mul_i32 s30, s20, 8
    v_add_u32 v5, s30, v5
    v_and_b32 v6, 31, v1
    s_mov_b32 s31, 8192
    v_add_u32 v7, 0, v5
    v_and_b32 v12, 7, v7
    v_lshlrev_b32 v12, 1, v12
    v_xor_b32 v12, v12, v6
    v_lshlrev_b32 v12, 4, v12
    v_mul_lo_u32 v7, v7, s31
    v_add_u32 v12, v12, v7
    v_add_u32 v7, 2, v5
    v_and_b32 v13, 7, v7
    v_lshlrev_b32 v13, 1, v13
    v_xor_b32 v13, v13, v6
    v_lshlrev_b32 v13, 4, v13
    v_mul_lo_u32 v7, v7, s31
    v_add_u32 v13, v13, v7
    v_subrev_u32 v13, 1024, v13
    v_add_u32 v7, 4, v5
    v_and_b32 v14, 7, v7
    v_lshlrev_b32 v14, 1, v14
    v_xor_b32 v14, v14, v6
    v_lshlrev_b32 v14, 4, v14
    v_mul_lo_u32 v7, v7, s31
    v_add_u32 v14, v14, v7
    v_subrev_u32 v14, 2048, v14
    v_add_u32 v7, 6, v5
    v_and_b32 v15, 7, v7
    v_lshlrev_b32 v15, 1, v15
    v_xor_b32 v15, v15, v6
    v_lshlrev_b32 v15, 4, v15
    v_mul_lo_u32 v7, v7, s31
    v_add_u32 v15, v15, v7
    v_subrev_u32 v15, 3072, v15
    v_lshrrev_b32 v5, 2, v2
    v_lshl_add_u32 v5, v3, 2, v5
    v_and_b32 v6, 7, v5
    v_lshlrev_b32 v6, 5, v6
    v_mul_u32_u24 v5, 512, v5
    v_and_b32 v7, 3, v2
    v_lshl_add_u32 v5, v7, 3, v5
    v_add_u32 v5, 65536, v5
    s_mul_i32 s30, s22, 8
    s_add_u32 s31, s30, 0
    s_lshl_b32 s31, s31, 5
    v_xor_b32 v17, s31, v6
    v_add_u32 v17, v17, v5
    s_add_u32 s31, s30, 1
    s_lshl_b32 s31, s31, 5
    v_xor_b32 v18, s31, v6
    v_add_u32 v18, v18, v5
    s_add_u32 s31, s30, 2
    s_lshl_b32 s31, s31, 5
    v_xor_b32 v19, s31, v6
    v_add_u32 v19, v19, v5
    s_add_u32 s31, s30, 3
    s_lshl_b32 s31, s31, 5
    v_xor_b32 v20, s31, v6
    v_add_u32 v20, v20, v5
    s_add_u32 s31, s30, 4
    s_lshl_b32 s31, s31, 5
    v_xor_b32 v21, s31, v6
    v_add_u32 v21, v21, v5
    s_add_u32 s31, s30, 5
    s_lshl_b32 s31, s31, 5
    v_xor_b32 v22, s31, v6
    v_add_u32 v22, v22, v5
    s_add_u32 s31, s30, 6
    s_lshl_b32 s31, s31, 5
    v_xor_b32 v23, s31, v6
    v_add_u32 v23, v23, v5
    s_add_u32 s31, s30, 7
    s_lshl_b32 s31, s31, 5
    v_xor_b32 v24, s31, v6
    v_add_u32 v24, v24, v5
    s_lshl_b32 s25, s24, 15
    s_add_u32 s25, s25, 2523136
    s_lshl_b32 s26, s33, 8

    s_add_u32 m0, s28, 0
    s_nop 0
    buffer_load_dwordx4 v8, s[8:11], s25 offen offset:0 sc1 lds
    buffer_load_dwordx4 v9, s[8:11], s25 offen offset:1024 sc1 lds
    buffer_load_dwordx4 v10, s[8:11], s25 offen offset:2048 sc1 lds
    buffer_load_dwordx4 v11, s[8:11], s25 offen offset:3072 sc1 lds
    s_add_u32 s25, s25, 1024
    s_add_u32 m0, s29, 0
    s_nop 0
    buffer_load_dwordx4 v12, s[12:15], s26 offen offset:0 lds
    buffer_load_dwordx4 v13, s[12:15], s26 offen offset:1024 lds
    buffer_load_dwordx4 v14, s[12:15], s26 offen offset:2048 lds
    buffer_load_dwordx4 v15, s[12:15], s26 offen offset:3072 lds
    s_add_u32 s26, s26, 262144
    s_add_u32 m0, s28, 16384
    s_nop 0
    buffer_load_dwordx4 v8, s[8:11], s25 offen offset:0 sc1 lds
    buffer_load_dwordx4 v9, s[8:11], s25 offen offset:1024 sc1 lds
    buffer_load_dwordx4 v10, s[8:11], s25 offen offset:2048 sc1 lds
    buffer_load_dwordx4 v11, s[8:11], s25 offen offset:3072 sc1 lds
    s_add_u32 s25, s25, 1024
    s_add_u32 m0, s29, 16384
    s_nop 0
    buffer_load_dwordx4 v12, s[12:15], s26 offen offset:0 lds
    buffer_load_dwordx4 v13, s[12:15], s26 offen offset:1024 lds
    buffer_load_dwordx4 v14, s[12:15], s26 offen offset:2048 lds
    buffer_load_dwordx4 v15, s[12:15], s26 offen offset:3072 lds
    s_add_u32 s26, s26, 262144
    s_add_u32 m0, s28, 32768
    s_nop 0
    buffer_load_dwordx4 v8, s[8:11], s25 offen offset:0 sc1 lds
    buffer_load_dwordx4 v9, s[8:11], s25 offen offset:1024 sc1 lds
    buffer_load_dwordx4 v10, s[8:11], s25 offen offset:2048 sc1 lds
    buffer_load_dwordx4 v11, s[8:11], s25 offen offset:3072 sc1 lds
    s_add_u32 s25, s25, 1024
    s_add_u32 m0, s29, 32768
    s_nop 0
    buffer_load_dwordx4 v12, s[12:15], s26 offen offset:0 lds
    buffer_load_dwordx4 v13, s[12:15], s26 offen offset:1024 lds
    buffer_load_dwordx4 v14, s[12:15], s26 offen offset:2048 lds
    buffer_load_dwordx4 v15, s[12:15], s26 offen offset:3072 lds
    s_add_u32 s26, s26, 262144
    s_add_u32 m0, s28, 49152
    s_nop 0
    buffer_load_dwordx4 v8, s[8:11], s25 offen offset:0 sc1 lds
    buffer_load_dwordx4 v9, s[8:11], s25 offen offset:1024 sc1 lds
    buffer_load_dwordx4 v10, s[8:11], s25 offen offset:2048 sc1 lds
    buffer_load_dwordx4 v11, s[8:11], s25 offen offset:3072 sc1 lds
    s_add_u32 s25, s25, 1024
    s_add_u32 m0, s29, 49152
    s_nop 0
    buffer_load_dwordx4 v12, s[12:15], s26 offen offset:0 lds
    buffer_load_dwordx4 v13, s[12:15], s26 offen offset:1024 lds
    buffer_load_dwordx4 v14, s[12:15], s26 offen offset:2048 lds
    buffer_load_dwordx4 v15, s[12:15], s26 offen offset:3072 lds
    s_add_u32 s26, s26, 262144
    v_accvgpr_write_b32 a0, 0
    v_accvgpr_write_b32 a1, 0
    v_accvgpr_write_b32 a2, 0
    v_accvgpr_write_b32 a3, 0
    v_accvgpr_write_b32 a4, 0
    v_accvgpr_write_b32 a5, 0
    v_accvgpr_write_b32 a6, 0
    v_accvgpr_write_b32 a7, 0
    v_accvgpr_write_b32 a8, 0
    v_accvgpr_write_b32 a9, 0
    v_accvgpr_write_b32 a10, 0
    v_accvgpr_write_b32 a11, 0
    v_accvgpr_write_b32 a12, 0
    v_accvgpr_write_b32 a13, 0
    v_accvgpr_write_b32 a14, 0
    v_accvgpr_write_b32 a15, 0
    v_accvgpr_write_b32 a16, 0
    v_accvgpr_write_b32 a17, 0
    v_accvgpr_write_b32 a18, 0
    v_accvgpr_write_b32 a19, 0
    v_accvgpr_write_b32 a20, 0
    v_accvgpr_write_b32 a21, 0
    v_accvgpr_write_b32 a22, 0
    v_accvgpr_write_b32 a23, 0
    v_accvgpr_write_b32 a24, 0
    v_accvgpr_write_b32 a25, 0
    v_accvgpr_write_b32 a26, 0
    v_accvgpr_write_b32 a27, 0
    v_accvgpr_write_b32 a28, 0
    v_accvgpr_write_b32 a29, 0
    v_accvgpr_write_b32 a30, 0
    v_accvgpr_write_b32 a31, 0
    v_accvgpr_write_b32 a32, 0
    v_accvgpr_write_b32 a33, 0
    v_accvgpr_write_b32 a34, 0
    v_accvgpr_write_b32 a35, 0
    v_accvgpr_write_b32 a36, 0
    v_accvgpr_write_b32 a37, 0
    v_accvgpr_write_b32 a38, 0
    v_accvgpr_write_b32 a39, 0
    v_accvgpr_write_b32 a40, 0
    v_accvgpr_write_b32 a41, 0
    v_accvgpr_write_b32 a42, 0
    v_accvgpr_write_b32 a43, 0
    v_accvgpr_write_b32 a44, 0
    v_accvgpr_write_b32 a45, 0
    v_accvgpr_write_b32 a46, 0
    v_accvgpr_write_b32 a47, 0
    v_accvgpr_write_b32 a48, 0
    v_accvgpr_write_b32 a49, 0
    v_accvgpr_write_b32 a50, 0
    v_accvgpr_write_b32 a51, 0
    v_accvgpr_write_b32 a52, 0
    v_accvgpr_write_b32 a53, 0
    v_accvgpr_write_b32 a54, 0
    v_accvgpr_write_b32 a55, 0
    v_accvgpr_write_b32 a56, 0
    v_accvgpr_write_b32 a57, 0
    v_accvgpr_write_b32 a58, 0
    v_accvgpr_write_b32 a59, 0
    v_accvgpr_write_b32 a60, 0
    v_accvgpr_write_b32 a61, 0
    v_accvgpr_write_b32 a62, 0
    v_accvgpr_write_b32 a63, 0
    v_accvgpr_write_b32 a64, 0
    v_accvgpr_write_b32 a65, 0
    v_accvgpr_write_b32 a66, 0
    v_accvgpr_write_b32 a67, 0
    v_accvgpr_write_b32 a68, 0
    v_accvgpr_write_b32 a69, 0
    v_accvgpr_write_b32 a70, 0
    v_accvgpr_write_b32 a71, 0
    v_accvgpr_write_b32 a72, 0
    v_accvgpr_write_b32 a73, 0
    v_accvgpr_write_b32 a74, 0
    v_accvgpr_write_b32 a75, 0
    v_accvgpr_write_b32 a76, 0
    v_accvgpr_write_b32 a77, 0
    v_accvgpr_write_b32 a78, 0
    v_accvgpr_write_b32 a79, 0
    v_accvgpr_write_b32 a80, 0
    v_accvgpr_write_b32 a81, 0
    v_accvgpr_write_b32 a82, 0
    v_accvgpr_write_b32 a83, 0
    v_accvgpr_write_b32 a84, 0
    v_accvgpr_write_b32 a85, 0
    v_accvgpr_write_b32 a86, 0
    v_accvgpr_write_b32 a87, 0
    v_accvgpr_write_b32 a88, 0
    v_accvgpr_write_b32 a89, 0
    v_accvgpr_write_b32 a90, 0
    v_accvgpr_write_b32 a91, 0
    v_accvgpr_write_b32 a92, 0
    v_accvgpr_write_b32 a93, 0
    v_accvgpr_write_b32 a94, 0
    v_accvgpr_write_b32 a95, 0
    v_accvgpr_write_b32 a96, 0
    v_accvgpr_write_b32 a97, 0
    v_accvgpr_write_b32 a98, 0
    v_accvgpr_write_b32 a99, 0
    v_accvgpr_write_b32 a100, 0
    v_accvgpr_write_b32 a101, 0
    v_accvgpr_write_b32 a102, 0
    v_accvgpr_write_b32 a103, 0
    v_accvgpr_write_b32 a104, 0
    v_accvgpr_write_b32 a105, 0
    v_accvgpr_write_b32 a106, 0
    v_accvgpr_write_b32 a107, 0
    v_accvgpr_write_b32 a108, 0
    v_accvgpr_write_b32 a109, 0
    v_accvgpr_write_b32 a110, 0
    v_accvgpr_write_b32 a111, 0
    v_accvgpr_write_b32 a112, 0
    v_accvgpr_write_b32 a113, 0
    v_accvgpr_write_b32 a114, 0
    v_accvgpr_write_b32 a115, 0
    v_accvgpr_write_b32 a116, 0
    v_accvgpr_write_b32 a117, 0
    v_accvgpr_write_b32 a118, 0
    v_accvgpr_write_b32 a119, 0
    v_accvgpr_write_b32 a120, 0
    v_accvgpr_write_b32 a121, 0
    v_accvgpr_write_b32 a122, 0
    v_accvgpr_write_b32 a123, 0
    v_accvgpr_write_b32 a124, 0
    v_accvgpr_write_b32 a125, 0
    v_accvgpr_write_b32 a126, 0
    v_accvgpr_write_b32 a127, 0
    v_accvgpr_write_b32 a128, 0
    v_accvgpr_write_b32 a129, 0
    v_accvgpr_write_b32 a130, 0
    v_accvgpr_write_b32 a131, 0
    v_accvgpr_write_b32 a132, 0
    v_accvgpr_write_b32 a133, 0
    v_accvgpr_write_b32 a134, 0
    v_accvgpr_write_b32 a135, 0
    v_accvgpr_write_b32 a136, 0
    v_accvgpr_write_b32 a137, 0
    v_accvgpr_write_b32 a138, 0
    v_accvgpr_write_b32 a139, 0
    v_accvgpr_write_b32 a140, 0
    v_accvgpr_write_b32 a141, 0
    v_accvgpr_write_b32 a142, 0
    v_accvgpr_write_b32 a143, 0
    v_accvgpr_write_b32 a144, 0
    v_accvgpr_write_b32 a145, 0
    v_accvgpr_write_b32 a146, 0
    v_accvgpr_write_b32 a147, 0
    v_accvgpr_write_b32 a148, 0
    v_accvgpr_write_b32 a149, 0
    v_accvgpr_write_b32 a150, 0
    v_accvgpr_write_b32 a151, 0
    v_accvgpr_write_b32 a152, 0
    v_accvgpr_write_b32 a153, 0
    v_accvgpr_write_b32 a154, 0
    v_accvgpr_write_b32 a155, 0
    v_accvgpr_write_b32 a156, 0
    v_accvgpr_write_b32 a157, 0
    v_accvgpr_write_b32 a158, 0
    v_accvgpr_write_b32 a159, 0
    v_accvgpr_write_b32 a160, 0
    v_accvgpr_write_b32 a161, 0
    v_accvgpr_write_b32 a162, 0
    v_accvgpr_write_b32 a163, 0
    v_accvgpr_write_b32 a164, 0
    v_accvgpr_write_b32 a165, 0
    v_accvgpr_write_b32 a166, 0
    v_accvgpr_write_b32 a167, 0
    v_accvgpr_write_b32 a168, 0
    v_accvgpr_write_b32 a169, 0
    v_accvgpr_write_b32 a170, 0
    v_accvgpr_write_b32 a171, 0
    v_accvgpr_write_b32 a172, 0
    v_accvgpr_write_b32 a173, 0
    v_accvgpr_write_b32 a174, 0
    v_accvgpr_write_b32 a175, 0
    v_accvgpr_write_b32 a176, 0
    v_accvgpr_write_b32 a177, 0
    v_accvgpr_write_b32 a178, 0
    v_accvgpr_write_b32 a179, 0
    v_accvgpr_write_b32 a180, 0
    v_accvgpr_write_b32 a181, 0
    v_accvgpr_write_b32 a182, 0
    v_accvgpr_write_b32 a183, 0
    v_accvgpr_write_b32 a184, 0
    v_accvgpr_write_b32 a185, 0
    v_accvgpr_write_b32 a186, 0
    v_accvgpr_write_b32 a187, 0
    v_accvgpr_write_b32 a188, 0
    v_accvgpr_write_b32 a189, 0
    v_accvgpr_write_b32 a190, 0
    v_accvgpr_write_b32 a191, 0
    v_accvgpr_write_b32 a192, 0
    v_accvgpr_write_b32 a193, 0
    v_accvgpr_write_b32 a194, 0
    v_accvgpr_write_b32 a195, 0
    v_accvgpr_write_b32 a196, 0
    v_accvgpr_write_b32 a197, 0
    v_accvgpr_write_b32 a198, 0
    v_accvgpr_write_b32 a199, 0
    v_accvgpr_write_b32 a200, 0
    v_accvgpr_write_b32 a201, 0
    v_accvgpr_write_b32 a202, 0
    v_accvgpr_write_b32 a203, 0
    v_accvgpr_write_b32 a204, 0
    v_accvgpr_write_b32 a205, 0
    v_accvgpr_write_b32 a206, 0
    v_accvgpr_write_b32 a207, 0
    v_accvgpr_write_b32 a208, 0
    v_accvgpr_write_b32 a209, 0
    v_accvgpr_write_b32 a210, 0
    v_accvgpr_write_b32 a211, 0
    v_accvgpr_write_b32 a212, 0
    v_accvgpr_write_b32 a213, 0
    v_accvgpr_write_b32 a214, 0
    v_accvgpr_write_b32 a215, 0
    v_accvgpr_write_b32 a216, 0
    v_accvgpr_write_b32 a217, 0
    v_accvgpr_write_b32 a218, 0
    v_accvgpr_write_b32 a219, 0
    v_accvgpr_write_b32 a220, 0
    v_accvgpr_write_b32 a221, 0
    v_accvgpr_write_b32 a222, 0
    v_accvgpr_write_b32 a223, 0
    v_accvgpr_write_b32 a224, 0
    v_accvgpr_write_b32 a225, 0
    v_accvgpr_write_b32 a226, 0
    v_accvgpr_write_b32 a227, 0
    v_accvgpr_write_b32 a228, 0
    v_accvgpr_write_b32 a229, 0
    v_accvgpr_write_b32 a230, 0
    v_accvgpr_write_b32 a231, 0
    v_accvgpr_write_b32 a232, 0
    v_accvgpr_write_b32 a233, 0
    v_accvgpr_write_b32 a234, 0
    v_accvgpr_write_b32 a235, 0
    v_accvgpr_write_b32 a236, 0
    v_accvgpr_write_b32 a237, 0
    v_accvgpr_write_b32 a238, 0
    v_accvgpr_write_b32 a239, 0
    v_accvgpr_write_b32 a240, 0
    v_accvgpr_write_b32 a241, 0
    v_accvgpr_write_b32 a242, 0
    v_accvgpr_write_b32 a243, 0
    v_accvgpr_write_b32 a244, 0
    v_accvgpr_write_b32 a245, 0
    v_accvgpr_write_b32 a246, 0
    v_accvgpr_write_b32 a247, 0
    v_accvgpr_write_b32 a248, 0
    v_accvgpr_write_b32 a249, 0
    v_accvgpr_write_b32 a250, 0
    v_accvgpr_write_b32 a251, 0
    v_accvgpr_write_b32 a252, 0
    v_accvgpr_write_b32 a253, 0
    v_accvgpr_write_b32 a254, 0
    v_accvgpr_write_b32 a255, 0
    s_mov_b32 s27, 8
    s_waitcnt vmcnt(24)
    s_barrier
    ds_read_b128 v[28:31], v16 offset:0
    ds_read_b64_tr_b16 v[92:93], v17 offset:0
    ds_read_b64_tr_b16 v[94:95], v17 offset:8192
    ds_read_b64_tr_b16 v[96:97], v18 offset:0
    ds_read_b64_tr_b16 v[98:99], v18 offset:8192
    ds_read_b64_tr_b16 v[100:101], v19 offset:0
    ds_read_b64_tr_b16 v[102:103], v19 offset:8192
    ds_read_b64_tr_b16 v[104:105], v20 offset:0
    ds_read_b64_tr_b16 v[106:107], v20 offset:8192
    ds_read_b64_tr_b16 v[108:109], v21 offset:0
    ds_read_b64_tr_b16 v[110:111], v21 offset:8192
    ds_read_b64_tr_b16 v[112:113], v22 offset:0
    ds_read_b64_tr_b16 v[114:115], v22 offset:8192
    ds_read_b64_tr_b16 v[116:117], v23 offset:0
    ds_read_b64_tr_b16 v[118:119], v23 offset:8192
    ds_read_b64_tr_b16 v[120:121], v24 offset:0
    ds_read_b64_tr_b16 v[122:123], v24 offset:8192
    ds_read_b128 v[32:35], v16 offset:1024
    ds_read_b128 v[36:39], v16 offset:2048
    ds_read_b128 v[40:43], v16 offset:3072
    ds_read_b128 v[44:47], v16 offset:4096
    ds_read_b128 v[48:51], v16 offset:5120
    ds_read_b128 v[52:55], v16 offset:6144
    ds_read_b128 v[56:59], v16 offset:7168
mega_kernel_w_bv_loop:
    s_waitcnt lgkmcnt(0)
    s_waitcnt vmcnt(16)
    s_barrier
    v_mfma_f32_16x16x32_bf16 a[0:3], v[28:31], v[92:95], a[0:3]
    ds_read_b128 v[60:63], v16 offset:16384
    v_mfma_f32_16x16x32_bf16 a[4:7], v[28:31], v[96:99], a[4:7]
    ds_read_b64_tr_b16 v[124:125], v17 offset:16384
    v_mfma_f32_16x16x32_bf16 a[8:11], v[28:31], v[100:103], a[8:11]
    ds_read_b64_tr_b16 v[126:127], v17 offset:24576
    v_mfma_f32_16x16x32_bf16 a[12:15], v[28:31], v[104:107], a[12:15]
    ds_read_b64_tr_b16 v[128:129], v18 offset:16384
    v_mfma_f32_16x16x32_bf16 a[16:19], v[28:31], v[108:111], a[16:19]
    ds_read_b64_tr_b16 v[130:131], v18 offset:24576
    v_mfma_f32_16x16x32_bf16 a[20:23], v[28:31], v[112:115], a[20:23]
    ds_read_b64_tr_b16 v[132:133], v19 offset:16384
    v_mfma_f32_16x16x32_bf16 a[24:27], v[28:31], v[116:119], a[24:27]
    ds_read_b64_tr_b16 v[134:135], v19 offset:24576
    v_mfma_f32_16x16x32_bf16 a[28:31], v[28:31], v[120:123], a[28:31]
    ds_read_b64_tr_b16 v[136:137], v20 offset:16384
    v_mfma_f32_16x16x32_bf16 a[32:35], v[32:35], v[92:95], a[32:35]
    ds_read_b64_tr_b16 v[138:139], v20 offset:24576
    v_mfma_f32_16x16x32_bf16 a[36:39], v[32:35], v[96:99], a[36:39]
    ds_read_b64_tr_b16 v[140:141], v21 offset:16384
    v_mfma_f32_16x16x32_bf16 a[40:43], v[32:35], v[100:103], a[40:43]
    ds_read_b64_tr_b16 v[142:143], v21 offset:24576
    v_mfma_f32_16x16x32_bf16 a[44:47], v[32:35], v[104:107], a[44:47]
    ds_read_b64_tr_b16 v[144:145], v22 offset:16384
    v_mfma_f32_16x16x32_bf16 a[48:51], v[32:35], v[108:111], a[48:51]
    ds_read_b64_tr_b16 v[146:147], v22 offset:24576
    v_mfma_f32_16x16x32_bf16 a[52:55], v[32:35], v[112:115], a[52:55]
    ds_read_b64_tr_b16 v[148:149], v23 offset:16384
    v_mfma_f32_16x16x32_bf16 a[56:59], v[32:35], v[116:119], a[56:59]
    ds_read_b64_tr_b16 v[150:151], v23 offset:24576
    v_mfma_f32_16x16x32_bf16 a[60:63], v[32:35], v[120:123], a[60:63]
    ds_read_b64_tr_b16 v[152:153], v24 offset:16384
    v_mfma_f32_16x16x32_bf16 a[64:67], v[36:39], v[92:95], a[64:67]
    ds_read_b64_tr_b16 v[154:155], v24 offset:24576
    v_mfma_f32_16x16x32_bf16 a[68:71], v[36:39], v[96:99], a[68:71]
    ds_read_b128 v[64:67], v16 offset:17408
    v_mfma_f32_16x16x32_bf16 a[72:75], v[36:39], v[100:103], a[72:75]
    ds_read_b128 v[68:71], v16 offset:18432
    v_mfma_f32_16x16x32_bf16 a[76:79], v[36:39], v[104:107], a[76:79]
    ds_read_b128 v[72:75], v16 offset:19456
    v_mfma_f32_16x16x32_bf16 a[80:83], v[36:39], v[108:111], a[80:83]
    ds_read_b128 v[76:79], v16 offset:20480
    v_mfma_f32_16x16x32_bf16 a[84:87], v[36:39], v[112:115], a[84:87]
    ds_read_b128 v[80:83], v16 offset:21504
    v_mfma_f32_16x16x32_bf16 a[88:91], v[36:39], v[116:119], a[88:91]
    ds_read_b128 v[84:87], v16 offset:22528
    v_mfma_f32_16x16x32_bf16 a[92:95], v[36:39], v[120:123], a[92:95]
    ds_read_b128 v[88:91], v16 offset:23552
    v_mfma_f32_16x16x32_bf16 a[96:99], v[40:43], v[92:95], a[96:99]
    s_add_u32 m0, s28, 0
    v_mfma_f32_16x16x32_bf16 a[100:103], v[40:43], v[96:99], a[100:103]
    s_nop 0
    v_mfma_f32_16x16x32_bf16 a[104:107], v[40:43], v[100:103], a[104:107]
    buffer_load_dwordx4 v8, s[8:11], s25 offen offset:0 sc1 lds
    v_mfma_f32_16x16x32_bf16 a[108:111], v[40:43], v[104:107], a[108:111]
    buffer_load_dwordx4 v9, s[8:11], s25 offen offset:1024 sc1 lds
    v_mfma_f32_16x16x32_bf16 a[112:115], v[40:43], v[108:111], a[112:115]
    buffer_load_dwordx4 v10, s[8:11], s25 offen offset:2048 sc1 lds
    v_mfma_f32_16x16x32_bf16 a[116:119], v[40:43], v[112:115], a[116:119]
    buffer_load_dwordx4 v11, s[8:11], s25 offen offset:3072 sc1 lds
    v_mfma_f32_16x16x32_bf16 a[120:123], v[40:43], v[116:119], a[120:123]
    s_add_u32 s25, s25, 1024
    v_mfma_f32_16x16x32_bf16 a[124:127], v[40:43], v[120:123], a[124:127]
    s_add_u32 m0, s29, 0
    v_mfma_f32_16x16x32_bf16 a[128:131], v[44:47], v[92:95], a[128:131]
    s_nop 0
    v_mfma_f32_16x16x32_bf16 a[132:135], v[44:47], v[96:99], a[132:135]
    buffer_load_dwordx4 v12, s[12:15], s26 offen offset:0 lds
    v_mfma_f32_16x16x32_bf16 a[136:139], v[44:47], v[100:103], a[136:139]
    buffer_load_dwordx4 v13, s[12:15], s26 offen offset:1024 lds
    v_mfma_f32_16x16x32_bf16 a[140:143], v[44:47], v[104:107], a[140:143]
    buffer_load_dwordx4 v14, s[12:15], s26 offen offset:2048 lds
    v_mfma_f32_16x16x32_bf16 a[144:147], v[44:47], v[108:111], a[144:147]
    buffer_load_dwordx4 v15, s[12:15], s26 offen offset:3072 lds
    v_mfma_f32_16x16x32_bf16 a[148:151], v[44:47], v[112:115], a[148:151]
    s_add_u32 s26, s26, 262144
    v_mfma_f32_16x16x32_bf16 a[152:155], v[44:47], v[116:119], a[152:155]
    v_mfma_f32_16x16x32_bf16 a[156:159], v[44:47], v[120:123], a[156:159]
    v_mfma_f32_16x16x32_bf16 a[160:163], v[48:51], v[92:95], a[160:163]
    v_mfma_f32_16x16x32_bf16 a[164:167], v[48:51], v[96:99], a[164:167]
    v_mfma_f32_16x16x32_bf16 a[168:171], v[48:51], v[100:103], a[168:171]
    v_mfma_f32_16x16x32_bf16 a[172:175], v[48:51], v[104:107], a[172:175]
    v_mfma_f32_16x16x32_bf16 a[176:179], v[48:51], v[108:111], a[176:179]
    v_mfma_f32_16x16x32_bf16 a[180:183], v[48:51], v[112:115], a[180:183]
    v_mfma_f32_16x16x32_bf16 a[184:187], v[48:51], v[116:119], a[184:187]
    v_mfma_f32_16x16x32_bf16 a[188:191], v[48:51], v[120:123], a[188:191]
    v_mfma_f32_16x16x32_bf16 a[192:195], v[52:55], v[92:95], a[192:195]
    v_mfma_f32_16x16x32_bf16 a[196:199], v[52:55], v[96:99], a[196:199]
    v_mfma_f32_16x16x32_bf16 a[200:203], v[52:55], v[100:103], a[200:203]
    v_mfma_f32_16x16x32_bf16 a[204:207], v[52:55], v[104:107], a[204:207]
    v_mfma_f32_16x16x32_bf16 a[208:211], v[52:55], v[108:111], a[208:211]
    v_mfma_f32_16x16x32_bf16 a[212:215], v[52:55], v[112:115], a[212:215]
    v_mfma_f32_16x16x32_bf16 a[216:219], v[52:55], v[116:119], a[216:219]
    v_mfma_f32_16x16x32_bf16 a[220:223], v[52:55], v[120:123], a[220:223]
    v_mfma_f32_16x16x32_bf16 a[224:227], v[56:59], v[92:95], a[224:227]
    v_mfma_f32_16x16x32_bf16 a[228:231], v[56:59], v[96:99], a[228:231]
    v_mfma_f32_16x16x32_bf16 a[232:235], v[56:59], v[100:103], a[232:235]
    v_mfma_f32_16x16x32_bf16 a[236:239], v[56:59], v[104:107], a[236:239]
    v_mfma_f32_16x16x32_bf16 a[240:243], v[56:59], v[108:111], a[240:243]
    v_mfma_f32_16x16x32_bf16 a[244:247], v[56:59], v[112:115], a[244:247]
    v_mfma_f32_16x16x32_bf16 a[248:251], v[56:59], v[116:119], a[248:251]
    v_mfma_f32_16x16x32_bf16 a[252:255], v[56:59], v[120:123], a[252:255]
    s_waitcnt lgkmcnt(0)
    s_waitcnt vmcnt(16)
    s_barrier
    v_mfma_f32_16x16x32_bf16 a[0:3], v[60:63], v[124:127], a[0:3]
    ds_read_b128 v[28:31], v16 offset:32768
    v_mfma_f32_16x16x32_bf16 a[4:7], v[60:63], v[128:131], a[4:7]
    ds_read_b64_tr_b16 v[92:93], v17 offset:32768
    v_mfma_f32_16x16x32_bf16 a[8:11], v[60:63], v[132:135], a[8:11]
    ds_read_b64_tr_b16 v[94:95], v17 offset:40960
    v_mfma_f32_16x16x32_bf16 a[12:15], v[60:63], v[136:139], a[12:15]
    ds_read_b64_tr_b16 v[96:97], v18 offset:32768
    v_mfma_f32_16x16x32_bf16 a[16:19], v[60:63], v[140:143], a[16:19]
    ds_read_b64_tr_b16 v[98:99], v18 offset:40960
    v_mfma_f32_16x16x32_bf16 a[20:23], v[60:63], v[144:147], a[20:23]
    ds_read_b64_tr_b16 v[100:101], v19 offset:32768
    v_mfma_f32_16x16x32_bf16 a[24:27], v[60:63], v[148:151], a[24:27]
    ds_read_b64_tr_b16 v[102:103], v19 offset:40960
    v_mfma_f32_16x16x32_bf16 a[28:31], v[60:63], v[152:155], a[28:31]
    ds_read_b64_tr_b16 v[104:105], v20 offset:32768
    v_mfma_f32_16x16x32_bf16 a[32:35], v[64:67], v[124:127], a[32:35]
    ds_read_b64_tr_b16 v[106:107], v20 offset:40960
    v_mfma_f32_16x16x32_bf16 a[36:39], v[64:67], v[128:131], a[36:39]
    ds_read_b64_tr_b16 v[108:109], v21 offset:32768
    v_mfma_f32_16x16x32_bf16 a[40:43], v[64:67], v[132:135], a[40:43]
    ds_read_b64_tr_b16 v[110:111], v21 offset:40960
    v_mfma_f32_16x16x32_bf16 a[44:47], v[64:67], v[136:139], a[44:47]
    ds_read_b64_tr_b16 v[112:113], v22 offset:32768
    v_mfma_f32_16x16x32_bf16 a[48:51], v[64:67], v[140:143], a[48:51]
    ds_read_b64_tr_b16 v[114:115], v22 offset:40960
    v_mfma_f32_16x16x32_bf16 a[52:55], v[64:67], v[144:147], a[52:55]
    ds_read_b64_tr_b16 v[116:117], v23 offset:32768
    v_mfma_f32_16x16x32_bf16 a[56:59], v[64:67], v[148:151], a[56:59]
    ds_read_b64_tr_b16 v[118:119], v23 offset:40960
    v_mfma_f32_16x16x32_bf16 a[60:63], v[64:67], v[152:155], a[60:63]
    ds_read_b64_tr_b16 v[120:121], v24 offset:32768
    v_mfma_f32_16x16x32_bf16 a[64:67], v[68:71], v[124:127], a[64:67]
    ds_read_b64_tr_b16 v[122:123], v24 offset:40960
    v_mfma_f32_16x16x32_bf16 a[68:71], v[68:71], v[128:131], a[68:71]
    ds_read_b128 v[32:35], v16 offset:33792
    v_mfma_f32_16x16x32_bf16 a[72:75], v[68:71], v[132:135], a[72:75]
    ds_read_b128 v[36:39], v16 offset:34816
    v_mfma_f32_16x16x32_bf16 a[76:79], v[68:71], v[136:139], a[76:79]
    ds_read_b128 v[40:43], v16 offset:35840
    v_mfma_f32_16x16x32_bf16 a[80:83], v[68:71], v[140:143], a[80:83]
    ds_read_b128 v[44:47], v16 offset:36864
    v_mfma_f32_16x16x32_bf16 a[84:87], v[68:71], v[144:147], a[84:87]
    ds_read_b128 v[48:51], v16 offset:37888
    v_mfma_f32_16x16x32_bf16 a[88:91], v[68:71], v[148:151], a[88:91]
    ds_read_b128 v[52:55], v16 offset:38912
    v_mfma_f32_16x16x32_bf16 a[92:95], v[68:71], v[152:155], a[92:95]
    ds_read_b128 v[56:59], v16 offset:39936
    v_mfma_f32_16x16x32_bf16 a[96:99], v[72:75], v[124:127], a[96:99]
    s_add_u32 m0, s28, 16384
    v_mfma_f32_16x16x32_bf16 a[100:103], v[72:75], v[128:131], a[100:103]
    s_nop 0
    v_mfma_f32_16x16x32_bf16 a[104:107], v[72:75], v[132:135], a[104:107]
    buffer_load_dwordx4 v8, s[8:11], s25 offen offset:0 sc1 lds
    v_mfma_f32_16x16x32_bf16 a[108:111], v[72:75], v[136:139], a[108:111]
    buffer_load_dwordx4 v9, s[8:11], s25 offen offset:1024 sc1 lds
    v_mfma_f32_16x16x32_bf16 a[112:115], v[72:75], v[140:143], a[112:115]
    buffer_load_dwordx4 v10, s[8:11], s25 offen offset:2048 sc1 lds
    v_mfma_f32_16x16x32_bf16 a[116:119], v[72:75], v[144:147], a[116:119]
    buffer_load_dwordx4 v11, s[8:11], s25 offen offset:3072 sc1 lds
    v_mfma_f32_16x16x32_bf16 a[120:123], v[72:75], v[148:151], a[120:123]
    s_add_u32 s25, s25, 1024
    v_mfma_f32_16x16x32_bf16 a[124:127], v[72:75], v[152:155], a[124:127]
    s_add_u32 m0, s29, 16384
    v_mfma_f32_16x16x32_bf16 a[128:131], v[76:79], v[124:127], a[128:131]
    s_nop 0
    v_mfma_f32_16x16x32_bf16 a[132:135], v[76:79], v[128:131], a[132:135]
    buffer_load_dwordx4 v12, s[12:15], s26 offen offset:0 lds
    v_mfma_f32_16x16x32_bf16 a[136:139], v[76:79], v[132:135], a[136:139]
    buffer_load_dwordx4 v13, s[12:15], s26 offen offset:1024 lds
    v_mfma_f32_16x16x32_bf16 a[140:143], v[76:79], v[136:139], a[140:143]
    buffer_load_dwordx4 v14, s[12:15], s26 offen offset:2048 lds
    v_mfma_f32_16x16x32_bf16 a[144:147], v[76:79], v[140:143], a[144:147]
    buffer_load_dwordx4 v15, s[12:15], s26 offen offset:3072 lds
    v_mfma_f32_16x16x32_bf16 a[148:151], v[76:79], v[144:147], a[148:151]
    s_add_u32 s26, s26, 262144
    v_mfma_f32_16x16x32_bf16 a[152:155], v[76:79], v[148:151], a[152:155]
    v_mfma_f32_16x16x32_bf16 a[156:159], v[76:79], v[152:155], a[156:159]
    v_mfma_f32_16x16x32_bf16 a[160:163], v[80:83], v[124:127], a[160:163]
    v_mfma_f32_16x16x32_bf16 a[164:167], v[80:83], v[128:131], a[164:167]
    v_mfma_f32_16x16x32_bf16 a[168:171], v[80:83], v[132:135], a[168:171]
    v_mfma_f32_16x16x32_bf16 a[172:175], v[80:83], v[136:139], a[172:175]
    v_mfma_f32_16x16x32_bf16 a[176:179], v[80:83], v[140:143], a[176:179]
    v_mfma_f32_16x16x32_bf16 a[180:183], v[80:83], v[144:147], a[180:183]
    v_mfma_f32_16x16x32_bf16 a[184:187], v[80:83], v[148:151], a[184:187]
    v_mfma_f32_16x16x32_bf16 a[188:191], v[80:83], v[152:155], a[188:191]
    v_mfma_f32_16x16x32_bf16 a[192:195], v[84:87], v[124:127], a[192:195]
    v_mfma_f32_16x16x32_bf16 a[196:199], v[84:87], v[128:131], a[196:199]
    v_mfma_f32_16x16x32_bf16 a[200:203], v[84:87], v[132:135], a[200:203]
    v_mfma_f32_16x16x32_bf16 a[204:207], v[84:87], v[136:139], a[204:207]
    v_mfma_f32_16x16x32_bf16 a[208:211], v[84:87], v[140:143], a[208:211]
    v_mfma_f32_16x16x32_bf16 a[212:215], v[84:87], v[144:147], a[212:215]
    v_mfma_f32_16x16x32_bf16 a[216:219], v[84:87], v[148:151], a[216:219]
    v_mfma_f32_16x16x32_bf16 a[220:223], v[84:87], v[152:155], a[220:223]
    v_mfma_f32_16x16x32_bf16 a[224:227], v[88:91], v[124:127], a[224:227]
    v_mfma_f32_16x16x32_bf16 a[228:231], v[88:91], v[128:131], a[228:231]
    v_mfma_f32_16x16x32_bf16 a[232:235], v[88:91], v[132:135], a[232:235]
    v_mfma_f32_16x16x32_bf16 a[236:239], v[88:91], v[136:139], a[236:239]
    v_mfma_f32_16x16x32_bf16 a[240:243], v[88:91], v[140:143], a[240:243]
    v_mfma_f32_16x16x32_bf16 a[244:247], v[88:91], v[144:147], a[244:247]
    v_mfma_f32_16x16x32_bf16 a[248:251], v[88:91], v[148:151], a[248:251]
    v_mfma_f32_16x16x32_bf16 a[252:255], v[88:91], v[152:155], a[252:255]
    s_waitcnt lgkmcnt(0)
    s_waitcnt vmcnt(16)
    s_barrier
    v_mfma_f32_16x16x32_bf16 a[0:3], v[28:31], v[92:95], a[0:3]
    ds_read_b128 v[60:63], v16 offset:49152
    v_mfma_f32_16x16x32_bf16 a[4:7], v[28:31], v[96:99], a[4:7]
    ds_read_b64_tr_b16 v[124:125], v17 offset:49152
    v_mfma_f32_16x16x32_bf16 a[8:11], v[28:31], v[100:103], a[8:11]
    ds_read_b64_tr_b16 v[126:127], v17 offset:57344
    v_mfma_f32_16x16x32_bf16 a[12:15], v[28:31], v[104:107], a[12:15]
    ds_read_b64_tr_b16 v[128:129], v18 offset:49152
    v_mfma_f32_16x16x32_bf16 a[16:19], v[28:31], v[108:111], a[16:19]
    ds_read_b64_tr_b16 v[130:131], v18 offset:57344
    v_mfma_f32_16x16x32_bf16 a[20:23], v[28:31], v[112:115], a[20:23]
    ds_read_b64_tr_b16 v[132:133], v19 offset:49152
    v_mfma_f32_16x16x32_bf16 a[24:27], v[28:31], v[116:119], a[24:27]
    ds_read_b64_tr_b16 v[134:135], v19 offset:57344
    v_mfma_f32_16x16x32_bf16 a[28:31], v[28:31], v[120:123], a[28:31]
    ds_read_b64_tr_b16 v[136:137], v20 offset:49152
    v_mfma_f32_16x16x32_bf16 a[32:35], v[32:35], v[92:95], a[32:35]
    ds_read_b64_tr_b16 v[138:139], v20 offset:57344
    v_mfma_f32_16x16x32_bf16 a[36:39], v[32:35], v[96:99], a[36:39]
    ds_read_b64_tr_b16 v[140:141], v21 offset:49152
    v_mfma_f32_16x16x32_bf16 a[40:43], v[32:35], v[100:103], a[40:43]
    ds_read_b64_tr_b16 v[142:143], v21 offset:57344
    v_mfma_f32_16x16x32_bf16 a[44:47], v[32:35], v[104:107], a[44:47]
    ds_read_b64_tr_b16 v[144:145], v22 offset:49152
    v_mfma_f32_16x16x32_bf16 a[48:51], v[32:35], v[108:111], a[48:51]
    ds_read_b64_tr_b16 v[146:147], v22 offset:57344
    v_mfma_f32_16x16x32_bf16 a[52:55], v[32:35], v[112:115], a[52:55]
    ds_read_b64_tr_b16 v[148:149], v23 offset:49152
    v_mfma_f32_16x16x32_bf16 a[56:59], v[32:35], v[116:119], a[56:59]
    ds_read_b64_tr_b16 v[150:151], v23 offset:57344
    v_mfma_f32_16x16x32_bf16 a[60:63], v[32:35], v[120:123], a[60:63]
    ds_read_b64_tr_b16 v[152:153], v24 offset:49152
    v_mfma_f32_16x16x32_bf16 a[64:67], v[36:39], v[92:95], a[64:67]
    ds_read_b64_tr_b16 v[154:155], v24 offset:57344
    v_mfma_f32_16x16x32_bf16 a[68:71], v[36:39], v[96:99], a[68:71]
    ds_read_b128 v[64:67], v16 offset:50176
    v_mfma_f32_16x16x32_bf16 a[72:75], v[36:39], v[100:103], a[72:75]
    ds_read_b128 v[68:71], v16 offset:51200
    v_mfma_f32_16x16x32_bf16 a[76:79], v[36:39], v[104:107], a[76:79]
    ds_read_b128 v[72:75], v16 offset:52224
    v_mfma_f32_16x16x32_bf16 a[80:83], v[36:39], v[108:111], a[80:83]
    ds_read_b128 v[76:79], v16 offset:53248
    v_mfma_f32_16x16x32_bf16 a[84:87], v[36:39], v[112:115], a[84:87]
    ds_read_b128 v[80:83], v16 offset:54272
    v_mfma_f32_16x16x32_bf16 a[88:91], v[36:39], v[116:119], a[88:91]
    ds_read_b128 v[84:87], v16 offset:55296
    v_mfma_f32_16x16x32_bf16 a[92:95], v[36:39], v[120:123], a[92:95]
    ds_read_b128 v[88:91], v16 offset:56320
    v_mfma_f32_16x16x32_bf16 a[96:99], v[40:43], v[92:95], a[96:99]
    s_add_u32 m0, s28, 32768
    v_mfma_f32_16x16x32_bf16 a[100:103], v[40:43], v[96:99], a[100:103]
    s_nop 0
    v_mfma_f32_16x16x32_bf16 a[104:107], v[40:43], v[100:103], a[104:107]
    buffer_load_dwordx4 v8, s[8:11], s25 offen offset:0 sc1 lds
    v_mfma_f32_16x16x32_bf16 a[108:111], v[40:43], v[104:107], a[108:111]
    buffer_load_dwordx4 v9, s[8:11], s25 offen offset:1024 sc1 lds
    v_mfma_f32_16x16x32_bf16 a[112:115], v[40:43], v[108:111], a[112:115]
    buffer_load_dwordx4 v10, s[8:11], s25 offen offset:2048 sc1 lds
    v_mfma_f32_16x16x32_bf16 a[116:119], v[40:43], v[112:115], a[116:119]
    buffer_load_dwordx4 v11, s[8:11], s25 offen offset:3072 sc1 lds
    v_mfma_f32_16x16x32_bf16 a[120:123], v[40:43], v[116:119], a[120:123]
    s_add_u32 s25, s25, 1024
    v_mfma_f32_16x16x32_bf16 a[124:127], v[40:43], v[120:123], a[124:127]
    s_add_u32 m0, s29, 32768
    v_mfma_f32_16x16x32_bf16 a[128:131], v[44:47], v[92:95], a[128:131]
    s_nop 0
    v_mfma_f32_16x16x32_bf16 a[132:135], v[44:47], v[96:99], a[132:135]
    buffer_load_dwordx4 v12, s[12:15], s26 offen offset:0 lds
    v_mfma_f32_16x16x32_bf16 a[136:139], v[44:47], v[100:103], a[136:139]
    buffer_load_dwordx4 v13, s[12:15], s26 offen offset:1024 lds
    v_mfma_f32_16x16x32_bf16 a[140:143], v[44:47], v[104:107], a[140:143]
    buffer_load_dwordx4 v14, s[12:15], s26 offen offset:2048 lds
    v_mfma_f32_16x16x32_bf16 a[144:147], v[44:47], v[108:111], a[144:147]
    buffer_load_dwordx4 v15, s[12:15], s26 offen offset:3072 lds
    v_mfma_f32_16x16x32_bf16 a[148:151], v[44:47], v[112:115], a[148:151]
    s_add_u32 s26, s26, 262144
    v_mfma_f32_16x16x32_bf16 a[152:155], v[44:47], v[116:119], a[152:155]
    v_mfma_f32_16x16x32_bf16 a[156:159], v[44:47], v[120:123], a[156:159]
    v_mfma_f32_16x16x32_bf16 a[160:163], v[48:51], v[92:95], a[160:163]
    v_mfma_f32_16x16x32_bf16 a[164:167], v[48:51], v[96:99], a[164:167]
    v_mfma_f32_16x16x32_bf16 a[168:171], v[48:51], v[100:103], a[168:171]
    v_mfma_f32_16x16x32_bf16 a[172:175], v[48:51], v[104:107], a[172:175]
    v_mfma_f32_16x16x32_bf16 a[176:179], v[48:51], v[108:111], a[176:179]
    v_mfma_f32_16x16x32_bf16 a[180:183], v[48:51], v[112:115], a[180:183]
    v_mfma_f32_16x16x32_bf16 a[184:187], v[48:51], v[116:119], a[184:187]
    v_mfma_f32_16x16x32_bf16 a[188:191], v[48:51], v[120:123], a[188:191]
    v_mfma_f32_16x16x32_bf16 a[192:195], v[52:55], v[92:95], a[192:195]
    v_mfma_f32_16x16x32_bf16 a[196:199], v[52:55], v[96:99], a[196:199]
    v_mfma_f32_16x16x32_bf16 a[200:203], v[52:55], v[100:103], a[200:203]
    v_mfma_f32_16x16x32_bf16 a[204:207], v[52:55], v[104:107], a[204:207]
    v_mfma_f32_16x16x32_bf16 a[208:211], v[52:55], v[108:111], a[208:211]
    v_mfma_f32_16x16x32_bf16 a[212:215], v[52:55], v[112:115], a[212:215]
    v_mfma_f32_16x16x32_bf16 a[216:219], v[52:55], v[116:119], a[216:219]
    v_mfma_f32_16x16x32_bf16 a[220:223], v[52:55], v[120:123], a[220:223]
    v_mfma_f32_16x16x32_bf16 a[224:227], v[56:59], v[92:95], a[224:227]
    v_mfma_f32_16x16x32_bf16 a[228:231], v[56:59], v[96:99], a[228:231]
    v_mfma_f32_16x16x32_bf16 a[232:235], v[56:59], v[100:103], a[232:235]
    v_mfma_f32_16x16x32_bf16 a[236:239], v[56:59], v[104:107], a[236:239]
    v_mfma_f32_16x16x32_bf16 a[240:243], v[56:59], v[108:111], a[240:243]
    v_mfma_f32_16x16x32_bf16 a[244:247], v[56:59], v[112:115], a[244:247]
    v_mfma_f32_16x16x32_bf16 a[248:251], v[56:59], v[116:119], a[248:251]
    v_mfma_f32_16x16x32_bf16 a[252:255], v[56:59], v[120:123], a[252:255]
    s_waitcnt lgkmcnt(0)
    s_waitcnt vmcnt(16)
    s_barrier
    v_mfma_f32_16x16x32_bf16 a[0:3], v[60:63], v[124:127], a[0:3]
    ds_read_b128 v[28:31], v16 offset:0
    v_mfma_f32_16x16x32_bf16 a[4:7], v[60:63], v[128:131], a[4:7]
    ds_read_b64_tr_b16 v[92:93], v17 offset:0
    v_mfma_f32_16x16x32_bf16 a[8:11], v[60:63], v[132:135], a[8:11]
    ds_read_b64_tr_b16 v[94:95], v17 offset:8192
    v_mfma_f32_16x16x32_bf16 a[12:15], v[60:63], v[136:139], a[12:15]
    ds_read_b64_tr_b16 v[96:97], v18 offset:0
    v_mfma_f32_16x16x32_bf16 a[16:19], v[60:63], v[140:143], a[16:19]
    ds_read_b64_tr_b16 v[98:99], v18 offset:8192
    v_mfma_f32_16x16x32_bf16 a[20:23], v[60:63], v[144:147], a[20:23]
    ds_read_b64_tr_b16 v[100:101], v19 offset:0
    v_mfma_f32_16x16x32_bf16 a[24:27], v[60:63], v[148:151], a[24:27]
    ds_read_b64_tr_b16 v[102:103], v19 offset:8192
    v_mfma_f32_16x16x32_bf16 a[28:31], v[60:63], v[152:155], a[28:31]
    ds_read_b64_tr_b16 v[104:105], v20 offset:0
    v_mfma_f32_16x16x32_bf16 a[32:35], v[64:67], v[124:127], a[32:35]
    ds_read_b64_tr_b16 v[106:107], v20 offset:8192
    v_mfma_f32_16x16x32_bf16 a[36:39], v[64:67], v[128:131], a[36:39]
    ds_read_b64_tr_b16 v[108:109], v21 offset:0
    v_mfma_f32_16x16x32_bf16 a[40:43], v[64:67], v[132:135], a[40:43]
    ds_read_b64_tr_b16 v[110:111], v21 offset:8192
    v_mfma_f32_16x16x32_bf16 a[44:47], v[64:67], v[136:139], a[44:47]
    ds_read_b64_tr_b16 v[112:113], v22 offset:0
    v_mfma_f32_16x16x32_bf16 a[48:51], v[64:67], v[140:143], a[48:51]
    ds_read_b64_tr_b16 v[114:115], v22 offset:8192
    v_mfma_f32_16x16x32_bf16 a[52:55], v[64:67], v[144:147], a[52:55]
    ds_read_b64_tr_b16 v[116:117], v23 offset:0
    v_mfma_f32_16x16x32_bf16 a[56:59], v[64:67], v[148:151], a[56:59]
    ds_read_b64_tr_b16 v[118:119], v23 offset:8192
    v_mfma_f32_16x16x32_bf16 a[60:63], v[64:67], v[152:155], a[60:63]
    ds_read_b64_tr_b16 v[120:121], v24 offset:0
    v_mfma_f32_16x16x32_bf16 a[64:67], v[68:71], v[124:127], a[64:67]
    ds_read_b64_tr_b16 v[122:123], v24 offset:8192
    v_mfma_f32_16x16x32_bf16 a[68:71], v[68:71], v[128:131], a[68:71]
    ds_read_b128 v[32:35], v16 offset:1024
    v_mfma_f32_16x16x32_bf16 a[72:75], v[68:71], v[132:135], a[72:75]
    ds_read_b128 v[36:39], v16 offset:2048
    v_mfma_f32_16x16x32_bf16 a[76:79], v[68:71], v[136:139], a[76:79]
    ds_read_b128 v[40:43], v16 offset:3072
    v_mfma_f32_16x16x32_bf16 a[80:83], v[68:71], v[140:143], a[80:83]
    ds_read_b128 v[44:47], v16 offset:4096
    v_mfma_f32_16x16x32_bf16 a[84:87], v[68:71], v[144:147], a[84:87]
    ds_read_b128 v[48:51], v16 offset:5120
    v_mfma_f32_16x16x32_bf16 a[88:91], v[68:71], v[148:151], a[88:91]
    ds_read_b128 v[52:55], v16 offset:6144
    v_mfma_f32_16x16x32_bf16 a[92:95], v[68:71], v[152:155], a[92:95]
    ds_read_b128 v[56:59], v16 offset:7168
    v_mfma_f32_16x16x32_bf16 a[96:99], v[72:75], v[124:127], a[96:99]
    s_add_u32 m0, s28, 49152
    v_mfma_f32_16x16x32_bf16 a[100:103], v[72:75], v[128:131], a[100:103]
    s_nop 0
    v_mfma_f32_16x16x32_bf16 a[104:107], v[72:75], v[132:135], a[104:107]
    buffer_load_dwordx4 v8, s[8:11], s25 offen offset:0 sc1 lds
    v_mfma_f32_16x16x32_bf16 a[108:111], v[72:75], v[136:139], a[108:111]
    buffer_load_dwordx4 v9, s[8:11], s25 offen offset:1024 sc1 lds
    v_mfma_f32_16x16x32_bf16 a[112:115], v[72:75], v[140:143], a[112:115]
    buffer_load_dwordx4 v10, s[8:11], s25 offen offset:2048 sc1 lds
    v_mfma_f32_16x16x32_bf16 a[116:119], v[72:75], v[144:147], a[116:119]
    buffer_load_dwordx4 v11, s[8:11], s25 offen offset:3072 sc1 lds
    v_mfma_f32_16x16x32_bf16 a[120:123], v[72:75], v[148:151], a[120:123]
    s_add_u32 s25, s25, 1024
    v_mfma_f32_16x16x32_bf16 a[124:127], v[72:75], v[152:155], a[124:127]
    s_add_u32 m0, s29, 49152
    v_mfma_f32_16x16x32_bf16 a[128:131], v[76:79], v[124:127], a[128:131]
    s_nop 0
    v_mfma_f32_16x16x32_bf16 a[132:135], v[76:79], v[128:131], a[132:135]
    buffer_load_dwordx4 v12, s[12:15], s26 offen offset:0 lds
    v_mfma_f32_16x16x32_bf16 a[136:139], v[76:79], v[132:135], a[136:139]
    buffer_load_dwordx4 v13, s[12:15], s26 offen offset:1024 lds
    v_mfma_f32_16x16x32_bf16 a[140:143], v[76:79], v[136:139], a[140:143]
    buffer_load_dwordx4 v14, s[12:15], s26 offen offset:2048 lds
    v_mfma_f32_16x16x32_bf16 a[144:147], v[76:79], v[140:143], a[144:147]
    buffer_load_dwordx4 v15, s[12:15], s26 offen offset:3072 lds
    v_mfma_f32_16x16x32_bf16 a[148:151], v[76:79], v[144:147], a[148:151]
    s_add_u32 s26, s26, 262144
    v_mfma_f32_16x16x32_bf16 a[152:155], v[76:79], v[148:151], a[152:155]
    v_mfma_f32_16x16x32_bf16 a[156:159], v[76:79], v[152:155], a[156:159]
    v_mfma_f32_16x16x32_bf16 a[160:163], v[80:83], v[124:127], a[160:163]
    v_mfma_f32_16x16x32_bf16 a[164:167], v[80:83], v[128:131], a[164:167]
    v_mfma_f32_16x16x32_bf16 a[168:171], v[80:83], v[132:135], a[168:171]
    v_mfma_f32_16x16x32_bf16 a[172:175], v[80:83], v[136:139], a[172:175]
    v_mfma_f32_16x16x32_bf16 a[176:179], v[80:83], v[140:143], a[176:179]
    v_mfma_f32_16x16x32_bf16 a[180:183], v[80:83], v[144:147], a[180:183]
    v_mfma_f32_16x16x32_bf16 a[184:187], v[80:83], v[148:151], a[184:187]
    v_mfma_f32_16x16x32_bf16 a[188:191], v[80:83], v[152:155], a[188:191]
    v_mfma_f32_16x16x32_bf16 a[192:195], v[84:87], v[124:127], a[192:195]
    v_mfma_f32_16x16x32_bf16 a[196:199], v[84:87], v[128:131], a[196:199]
    v_mfma_f32_16x16x32_bf16 a[200:203], v[84:87], v[132:135], a[200:203]
    v_mfma_f32_16x16x32_bf16 a[204:207], v[84:87], v[136:139], a[204:207]
    v_mfma_f32_16x16x32_bf16 a[208:211], v[84:87], v[140:143], a[208:211]
    v_mfma_f32_16x16x32_bf16 a[212:215], v[84:87], v[144:147], a[212:215]
    v_mfma_f32_16x16x32_bf16 a[216:219], v[84:87], v[148:151], a[216:219]
    v_mfma_f32_16x16x32_bf16 a[220:223], v[84:87], v[152:155], a[220:223]
    v_mfma_f32_16x16x32_bf16 a[224:227], v[88:91], v[124:127], a[224:227]
    v_mfma_f32_16x16x32_bf16 a[228:231], v[88:91], v[128:131], a[228:231]
    v_mfma_f32_16x16x32_bf16 a[232:235], v[88:91], v[132:135], a[232:235]
    v_mfma_f32_16x16x32_bf16 a[236:239], v[88:91], v[136:139], a[236:239]
    v_mfma_f32_16x16x32_bf16 a[240:243], v[88:91], v[140:143], a[240:243]
    v_mfma_f32_16x16x32_bf16 a[244:247], v[88:91], v[144:147], a[244:247]
    v_mfma_f32_16x16x32_bf16 a[248:251], v[88:91], v[148:151], a[248:251]
    v_mfma_f32_16x16x32_bf16 a[252:255], v[88:91], v[152:155], a[252:255]
    s_sub_u32 s27, s27, 1
    s_cmp_lg_u32 s27, 0
    s_cbranch_scc1 mega_kernel_w_bv_loop
    s_nop 7
    s_lshr_b32 s34, s24, 1
    s_mul_i32 s30, s21, 4
    s_add_u32 s34, s34, s30
    s_lshl_b32 s35, s34, 5
    s_add_u32 s35, s35, s33

    s_add_u32 s35, s35, s22
    s_lshl_b32 s35, s35, 13
    s_add_u32 s35, s35, 40271872
    s_add_u32 s30, s35, 0
    v_accvgpr_read_b32 v156, a0
    v_accvgpr_read_b32 v157, a1
    v_accvgpr_read_b32 v158, a2
    v_accvgpr_read_b32 v159, a3
    v_accvgpr_read_b32 v160, a32
    v_accvgpr_read_b32 v161, a33
    v_accvgpr_read_b32 v162, a34
    v_accvgpr_read_b32 v163, a35
    v_cvt_pk_bf16_f32 v156, v156, v157
    v_cvt_pk_bf16_f32 v157, v158, v159
    v_cvt_pk_bf16_f32 v158, v160, v161
    v_cvt_pk_bf16_f32 v159, v162, v163
    buffer_store_dwordx4 v[156:159], v4, s[8:11], s30 offen offset:0 sc1
    v_accvgpr_read_b32 v164, a4
    v_accvgpr_read_b32 v165, a5
    v_accvgpr_read_b32 v166, a6
    v_accvgpr_read_b32 v167, a7
    v_accvgpr_read_b32 v168, a36
    v_accvgpr_read_b32 v169, a37
    v_accvgpr_read_b32 v170, a38
    v_accvgpr_read_b32 v171, a39
    v_cvt_pk_bf16_f32 v164, v164, v165
    v_cvt_pk_bf16_f32 v165, v166, v167
    v_cvt_pk_bf16_f32 v166, v168, v169
    v_cvt_pk_bf16_f32 v167, v170, v171
    buffer_store_dwordx4 v[164:167], v4, s[8:11], s30 offen offset:1024 sc1
    v_accvgpr_read_b32 v172, a8
    v_accvgpr_read_b32 v173, a9
    v_accvgpr_read_b32 v174, a10
    v_accvgpr_read_b32 v175, a11
    v_accvgpr_read_b32 v176, a40
    v_accvgpr_read_b32 v177, a41
    v_accvgpr_read_b32 v178, a42
    v_accvgpr_read_b32 v179, a43
    v_cvt_pk_bf16_f32 v172, v172, v173
    v_cvt_pk_bf16_f32 v173, v174, v175
    v_cvt_pk_bf16_f32 v174, v176, v177
    v_cvt_pk_bf16_f32 v175, v178, v179
    buffer_store_dwordx4 v[172:175], v4, s[8:11], s30 offen offset:2048 sc1
    v_accvgpr_read_b32 v180, a12
    v_accvgpr_read_b32 v181, a13
    v_accvgpr_read_b32 v182, a14
    v_accvgpr_read_b32 v183, a15
    v_accvgpr_read_b32 v184, a44
    v_accvgpr_read_b32 v185, a45
    v_accvgpr_read_b32 v186, a46
    v_accvgpr_read_b32 v187, a47
    v_cvt_pk_bf16_f32 v180, v180, v181
    v_cvt_pk_bf16_f32 v181, v182, v183
    v_cvt_pk_bf16_f32 v182, v184, v185
    v_cvt_pk_bf16_f32 v183, v186, v187
    buffer_store_dwordx4 v[180:183], v4, s[8:11], s30 offen offset:3072 sc1
    s_add_u32 s30, s35, 4096
    v_accvgpr_read_b32 v156, a16
    v_accvgpr_read_b32 v157, a17
    v_accvgpr_read_b32 v158, a18
    v_accvgpr_read_b32 v159, a19
    v_accvgpr_read_b32 v160, a48
    v_accvgpr_read_b32 v161, a49
    v_accvgpr_read_b32 v162, a50
    v_accvgpr_read_b32 v163, a51
    v_cvt_pk_bf16_f32 v156, v156, v157
    v_cvt_pk_bf16_f32 v157, v158, v159
    v_cvt_pk_bf16_f32 v158, v160, v161
    v_cvt_pk_bf16_f32 v159, v162, v163
    buffer_store_dwordx4 v[156:159], v4, s[8:11], s30 offen offset:0 sc1
    v_accvgpr_read_b32 v164, a20
    v_accvgpr_read_b32 v165, a21
    v_accvgpr_read_b32 v166, a22
    v_accvgpr_read_b32 v167, a23
    v_accvgpr_read_b32 v168, a52
    v_accvgpr_read_b32 v169, a53
    v_accvgpr_read_b32 v170, a54
    v_accvgpr_read_b32 v171, a55
    v_cvt_pk_bf16_f32 v164, v164, v165
    v_cvt_pk_bf16_f32 v165, v166, v167
    v_cvt_pk_bf16_f32 v166, v168, v169
    v_cvt_pk_bf16_f32 v167, v170, v171
    buffer_store_dwordx4 v[164:167], v4, s[8:11], s30 offen offset:1024 sc1
    v_accvgpr_read_b32 v172, a24
    v_accvgpr_read_b32 v173, a25
    v_accvgpr_read_b32 v174, a26
    v_accvgpr_read_b32 v175, a27
    v_accvgpr_read_b32 v176, a56
    v_accvgpr_read_b32 v177, a57
    v_accvgpr_read_b32 v178, a58
    v_accvgpr_read_b32 v179, a59
    v_cvt_pk_bf16_f32 v172, v172, v173
    v_cvt_pk_bf16_f32 v173, v174, v175
    v_cvt_pk_bf16_f32 v174, v176, v177
    v_cvt_pk_bf16_f32 v175, v178, v179
    buffer_store_dwordx4 v[172:175], v4, s[8:11], s30 offen offset:2048 sc1
    v_accvgpr_read_b32 v180, a28
    v_accvgpr_read_b32 v181, a29
    v_accvgpr_read_b32 v182, a30
    v_accvgpr_read_b32 v183, a31
    v_accvgpr_read_b32 v184, a60
    v_accvgpr_read_b32 v185, a61
    v_accvgpr_read_b32 v186, a62
    v_accvgpr_read_b32 v187, a63
    v_cvt_pk_bf16_f32 v180, v180, v181
    v_cvt_pk_bf16_f32 v181, v182, v183
    v_cvt_pk_bf16_f32 v182, v184, v185
    v_cvt_pk_bf16_f32 v183, v186, v187
    buffer_store_dwordx4 v[180:183], v4, s[8:11], s30 offen offset:3072 sc1
    s_add_u32 s30, s35, 262144
    v_accvgpr_read_b32 v156, a64
    v_accvgpr_read_b32 v157, a65
    v_accvgpr_read_b32 v158, a66
    v_accvgpr_read_b32 v159, a67
    v_accvgpr_read_b32 v160, a96
    v_accvgpr_read_b32 v161, a97
    v_accvgpr_read_b32 v162, a98
    v_accvgpr_read_b32 v163, a99
    v_cvt_pk_bf16_f32 v156, v156, v157
    v_cvt_pk_bf16_f32 v157, v158, v159
    v_cvt_pk_bf16_f32 v158, v160, v161
    v_cvt_pk_bf16_f32 v159, v162, v163
    buffer_store_dwordx4 v[156:159], v4, s[8:11], s30 offen offset:0 sc1
    v_accvgpr_read_b32 v164, a68
    v_accvgpr_read_b32 v165, a69
    v_accvgpr_read_b32 v166, a70
    v_accvgpr_read_b32 v167, a71
    v_accvgpr_read_b32 v168, a100
    v_accvgpr_read_b32 v169, a101
    v_accvgpr_read_b32 v170, a102
    v_accvgpr_read_b32 v171, a103
    v_cvt_pk_bf16_f32 v164, v164, v165
    v_cvt_pk_bf16_f32 v165, v166, v167
    v_cvt_pk_bf16_f32 v166, v168, v169
    v_cvt_pk_bf16_f32 v167, v170, v171
    buffer_store_dwordx4 v[164:167], v4, s[8:11], s30 offen offset:1024 sc1
    v_accvgpr_read_b32 v172, a72
    v_accvgpr_read_b32 v173, a73
    v_accvgpr_read_b32 v174, a74
    v_accvgpr_read_b32 v175, a75
    v_accvgpr_read_b32 v176, a104
    v_accvgpr_read_b32 v177, a105
    v_accvgpr_read_b32 v178, a106
    v_accvgpr_read_b32 v179, a107
    v_cvt_pk_bf16_f32 v172, v172, v173
    v_cvt_pk_bf16_f32 v173, v174, v175
    v_cvt_pk_bf16_f32 v174, v176, v177
    v_cvt_pk_bf16_f32 v175, v178, v179
    buffer_store_dwordx4 v[172:175], v4, s[8:11], s30 offen offset:2048 sc1
    v_accvgpr_read_b32 v180, a76
    v_accvgpr_read_b32 v181, a77
    v_accvgpr_read_b32 v182, a78
    v_accvgpr_read_b32 v183, a79
    v_accvgpr_read_b32 v184, a108
    v_accvgpr_read_b32 v185, a109
    v_accvgpr_read_b32 v186, a110
    v_accvgpr_read_b32 v187, a111
    v_cvt_pk_bf16_f32 v180, v180, v181
    v_cvt_pk_bf16_f32 v181, v182, v183
    v_cvt_pk_bf16_f32 v182, v184, v185
    v_cvt_pk_bf16_f32 v183, v186, v187
    buffer_store_dwordx4 v[180:183], v4, s[8:11], s30 offen offset:3072 sc1
    s_add_u32 s30, s35, 266240
    v_accvgpr_read_b32 v156, a80
    v_accvgpr_read_b32 v157, a81
    v_accvgpr_read_b32 v158, a82
    v_accvgpr_read_b32 v159, a83
    v_accvgpr_read_b32 v160, a112
    v_accvgpr_read_b32 v161, a113
    v_accvgpr_read_b32 v162, a114
    v_accvgpr_read_b32 v163, a115
    v_cvt_pk_bf16_f32 v156, v156, v157
    v_cvt_pk_bf16_f32 v157, v158, v159
    v_cvt_pk_bf16_f32 v158, v160, v161
    v_cvt_pk_bf16_f32 v159, v162, v163
    buffer_store_dwordx4 v[156:159], v4, s[8:11], s30 offen offset:0 sc1
    v_accvgpr_read_b32 v164, a84
    v_accvgpr_read_b32 v165, a85
    v_accvgpr_read_b32 v166, a86
    v_accvgpr_read_b32 v167, a87
    v_accvgpr_read_b32 v168, a116
    v_accvgpr_read_b32 v169, a117
    v_accvgpr_read_b32 v170, a118
    v_accvgpr_read_b32 v171, a119
    v_cvt_pk_bf16_f32 v164, v164, v165
    v_cvt_pk_bf16_f32 v165, v166, v167
    v_cvt_pk_bf16_f32 v166, v168, v169
    v_cvt_pk_bf16_f32 v167, v170, v171
    buffer_store_dwordx4 v[164:167], v4, s[8:11], s30 offen offset:1024 sc1
    v_accvgpr_read_b32 v172, a88
    v_accvgpr_read_b32 v173, a89
    v_accvgpr_read_b32 v174, a90
    v_accvgpr_read_b32 v175, a91
    v_accvgpr_read_b32 v176, a120
    v_accvgpr_read_b32 v177, a121
    v_accvgpr_read_b32 v178, a122
    v_accvgpr_read_b32 v179, a123
    v_cvt_pk_bf16_f32 v172, v172, v173
    v_cvt_pk_bf16_f32 v173, v174, v175
    v_cvt_pk_bf16_f32 v174, v176, v177
    v_cvt_pk_bf16_f32 v175, v178, v179
    buffer_store_dwordx4 v[172:175], v4, s[8:11], s30 offen offset:2048 sc1
    v_accvgpr_read_b32 v180, a92
    v_accvgpr_read_b32 v181, a93
    v_accvgpr_read_b32 v182, a94
    v_accvgpr_read_b32 v183, a95
    v_accvgpr_read_b32 v184, a124
    v_accvgpr_read_b32 v185, a125
    v_accvgpr_read_b32 v186, a126
    v_accvgpr_read_b32 v187, a127
    v_cvt_pk_bf16_f32 v180, v180, v181
    v_cvt_pk_bf16_f32 v181, v182, v183
    v_cvt_pk_bf16_f32 v182, v184, v185
    v_cvt_pk_bf16_f32 v183, v186, v187
    buffer_store_dwordx4 v[180:183], v4, s[8:11], s30 offen offset:3072 sc1
    s_add_u32 s30, s35, 524288
    v_accvgpr_read_b32 v156, a128
    v_accvgpr_read_b32 v157, a129
    v_accvgpr_read_b32 v158, a130
    v_accvgpr_read_b32 v159, a131
    v_accvgpr_read_b32 v160, a160
    v_accvgpr_read_b32 v161, a161
    v_accvgpr_read_b32 v162, a162
    v_accvgpr_read_b32 v163, a163
    v_cvt_pk_bf16_f32 v156, v156, v157
    v_cvt_pk_bf16_f32 v157, v158, v159
    v_cvt_pk_bf16_f32 v158, v160, v161
    v_cvt_pk_bf16_f32 v159, v162, v163
    buffer_store_dwordx4 v[156:159], v4, s[8:11], s30 offen offset:0 sc1
    v_accvgpr_read_b32 v164, a132
    v_accvgpr_read_b32 v165, a133
    v_accvgpr_read_b32 v166, a134
    v_accvgpr_read_b32 v167, a135
    v_accvgpr_read_b32 v168, a164
    v_accvgpr_read_b32 v169, a165
    v_accvgpr_read_b32 v170, a166
    v_accvgpr_read_b32 v171, a167
    v_cvt_pk_bf16_f32 v164, v164, v165
    v_cvt_pk_bf16_f32 v165, v166, v167
    v_cvt_pk_bf16_f32 v166, v168, v169
    v_cvt_pk_bf16_f32 v167, v170, v171
    buffer_store_dwordx4 v[164:167], v4, s[8:11], s30 offen offset:1024 sc1
    v_accvgpr_read_b32 v172, a136
    v_accvgpr_read_b32 v173, a137
    v_accvgpr_read_b32 v174, a138
    v_accvgpr_read_b32 v175, a139
    v_accvgpr_read_b32 v176, a168
    v_accvgpr_read_b32 v177, a169
    v_accvgpr_read_b32 v178, a170
    v_accvgpr_read_b32 v179, a171
    v_cvt_pk_bf16_f32 v172, v172, v173
    v_cvt_pk_bf16_f32 v173, v174, v175
    v_cvt_pk_bf16_f32 v174, v176, v177
    v_cvt_pk_bf16_f32 v175, v178, v179
    buffer_store_dwordx4 v[172:175], v4, s[8:11], s30 offen offset:2048 sc1
    v_accvgpr_read_b32 v180, a140
    v_accvgpr_read_b32 v181, a141
    v_accvgpr_read_b32 v182, a142
    v_accvgpr_read_b32 v183, a143
    v_accvgpr_read_b32 v184, a172
    v_accvgpr_read_b32 v185, a173
    v_accvgpr_read_b32 v186, a174
    v_accvgpr_read_b32 v187, a175
    v_cvt_pk_bf16_f32 v180, v180, v181
    v_cvt_pk_bf16_f32 v181, v182, v183
    v_cvt_pk_bf16_f32 v182, v184, v185
    v_cvt_pk_bf16_f32 v183, v186, v187
    buffer_store_dwordx4 v[180:183], v4, s[8:11], s30 offen offset:3072 sc1
    s_add_u32 s30, s35, 528384
    v_accvgpr_read_b32 v156, a144
    v_accvgpr_read_b32 v157, a145
    v_accvgpr_read_b32 v158, a146
    v_accvgpr_read_b32 v159, a147
    v_accvgpr_read_b32 v160, a176
    v_accvgpr_read_b32 v161, a177
    v_accvgpr_read_b32 v162, a178
    v_accvgpr_read_b32 v163, a179
    v_cvt_pk_bf16_f32 v156, v156, v157
    v_cvt_pk_bf16_f32 v157, v158, v159
    v_cvt_pk_bf16_f32 v158, v160, v161
    v_cvt_pk_bf16_f32 v159, v162, v163
    buffer_store_dwordx4 v[156:159], v4, s[8:11], s30 offen offset:0 sc1
    v_accvgpr_read_b32 v164, a148
    v_accvgpr_read_b32 v165, a149
    v_accvgpr_read_b32 v166, a150
    v_accvgpr_read_b32 v167, a151
    v_accvgpr_read_b32 v168, a180
    v_accvgpr_read_b32 v169, a181
    v_accvgpr_read_b32 v170, a182
    v_accvgpr_read_b32 v171, a183
    v_cvt_pk_bf16_f32 v164, v164, v165
    v_cvt_pk_bf16_f32 v165, v166, v167
    v_cvt_pk_bf16_f32 v166, v168, v169
    v_cvt_pk_bf16_f32 v167, v170, v171
    buffer_store_dwordx4 v[164:167], v4, s[8:11], s30 offen offset:1024 sc1
    v_accvgpr_read_b32 v172, a152
    v_accvgpr_read_b32 v173, a153
    v_accvgpr_read_b32 v174, a154
    v_accvgpr_read_b32 v175, a155
    v_accvgpr_read_b32 v176, a184
    v_accvgpr_read_b32 v177, a185
    v_accvgpr_read_b32 v178, a186
    v_accvgpr_read_b32 v179, a187
    v_cvt_pk_bf16_f32 v172, v172, v173
    v_cvt_pk_bf16_f32 v173, v174, v175
    v_cvt_pk_bf16_f32 v174, v176, v177
    v_cvt_pk_bf16_f32 v175, v178, v179
    buffer_store_dwordx4 v[172:175], v4, s[8:11], s30 offen offset:2048 sc1
    v_accvgpr_read_b32 v180, a156
    v_accvgpr_read_b32 v181, a157
    v_accvgpr_read_b32 v182, a158
    v_accvgpr_read_b32 v183, a159
    v_accvgpr_read_b32 v184, a188
    v_accvgpr_read_b32 v185, a189
    v_accvgpr_read_b32 v186, a190
    v_accvgpr_read_b32 v187, a191
    v_cvt_pk_bf16_f32 v180, v180, v181
    v_cvt_pk_bf16_f32 v181, v182, v183
    v_cvt_pk_bf16_f32 v182, v184, v185
    v_cvt_pk_bf16_f32 v183, v186, v187
    buffer_store_dwordx4 v[180:183], v4, s[8:11], s30 offen offset:3072 sc1
    s_add_u32 s30, s35, 786432
    v_accvgpr_read_b32 v156, a192
    v_accvgpr_read_b32 v157, a193
    v_accvgpr_read_b32 v158, a194
    v_accvgpr_read_b32 v159, a195
    v_accvgpr_read_b32 v160, a224
    v_accvgpr_read_b32 v161, a225
    v_accvgpr_read_b32 v162, a226
    v_accvgpr_read_b32 v163, a227
    v_cvt_pk_bf16_f32 v156, v156, v157
    v_cvt_pk_bf16_f32 v157, v158, v159
    v_cvt_pk_bf16_f32 v158, v160, v161
    v_cvt_pk_bf16_f32 v159, v162, v163
    buffer_store_dwordx4 v[156:159], v4, s[8:11], s30 offen offset:0 sc1
    v_accvgpr_read_b32 v164, a196
    v_accvgpr_read_b32 v165, a197
    v_accvgpr_read_b32 v166, a198
    v_accvgpr_read_b32 v167, a199
    v_accvgpr_read_b32 v168, a228
    v_accvgpr_read_b32 v169, a229
    v_accvgpr_read_b32 v170, a230
    v_accvgpr_read_b32 v171, a231
    v_cvt_pk_bf16_f32 v164, v164, v165
    v_cvt_pk_bf16_f32 v165, v166, v167
    v_cvt_pk_bf16_f32 v166, v168, v169
    v_cvt_pk_bf16_f32 v167, v170, v171
    buffer_store_dwordx4 v[164:167], v4, s[8:11], s30 offen offset:1024 sc1
    v_accvgpr_read_b32 v172, a200
    v_accvgpr_read_b32 v173, a201
    v_accvgpr_read_b32 v174, a202
    v_accvgpr_read_b32 v175, a203
    v_accvgpr_read_b32 v176, a232
    v_accvgpr_read_b32 v177, a233
    v_accvgpr_read_b32 v178, a234
    v_accvgpr_read_b32 v179, a235
    v_cvt_pk_bf16_f32 v172, v172, v173
    v_cvt_pk_bf16_f32 v173, v174, v175
    v_cvt_pk_bf16_f32 v174, v176, v177
    v_cvt_pk_bf16_f32 v175, v178, v179
    buffer_store_dwordx4 v[172:175], v4, s[8:11], s30 offen offset:2048 sc1
    v_accvgpr_read_b32 v180, a204
    v_accvgpr_read_b32 v181, a205
    v_accvgpr_read_b32 v182, a206
    v_accvgpr_read_b32 v183, a207
    v_accvgpr_read_b32 v184, a236
    v_accvgpr_read_b32 v185, a237
    v_accvgpr_read_b32 v186, a238
    v_accvgpr_read_b32 v187, a239
    v_cvt_pk_bf16_f32 v180, v180, v181
    v_cvt_pk_bf16_f32 v181, v182, v183
    v_cvt_pk_bf16_f32 v182, v184, v185
    v_cvt_pk_bf16_f32 v183, v186, v187
    buffer_store_dwordx4 v[180:183], v4, s[8:11], s30 offen offset:3072 sc1
    s_add_u32 s30, s35, 790528
    v_accvgpr_read_b32 v156, a208
    v_accvgpr_read_b32 v157, a209
    v_accvgpr_read_b32 v158, a210
    v_accvgpr_read_b32 v159, a211
    v_accvgpr_read_b32 v160, a240
    v_accvgpr_read_b32 v161, a241
    v_accvgpr_read_b32 v162, a242
    v_accvgpr_read_b32 v163, a243
    v_cvt_pk_bf16_f32 v156, v156, v157
    v_cvt_pk_bf16_f32 v157, v158, v159
    v_cvt_pk_bf16_f32 v158, v160, v161
    v_cvt_pk_bf16_f32 v159, v162, v163
    buffer_store_dwordx4 v[156:159], v4, s[8:11], s30 offen offset:0 sc1
    v_accvgpr_read_b32 v164, a212
    v_accvgpr_read_b32 v165, a213
    v_accvgpr_read_b32 v166, a214
    v_accvgpr_read_b32 v167, a215
    v_accvgpr_read_b32 v168, a244
    v_accvgpr_read_b32 v169, a245
    v_accvgpr_read_b32 v170, a246
    v_accvgpr_read_b32 v171, a247
    v_cvt_pk_bf16_f32 v164, v164, v165
    v_cvt_pk_bf16_f32 v165, v166, v167
    v_cvt_pk_bf16_f32 v166, v168, v169
    v_cvt_pk_bf16_f32 v167, v170, v171
    buffer_store_dwordx4 v[164:167], v4, s[8:11], s30 offen offset:1024 sc1
    v_accvgpr_read_b32 v172, a216
    v_accvgpr_read_b32 v173, a217
    v_accvgpr_read_b32 v174, a218
    v_accvgpr_read_b32 v175, a219
    v_accvgpr_read_b32 v176, a248
    v_accvgpr_read_b32 v177, a249
    v_accvgpr_read_b32 v178, a250
    v_accvgpr_read_b32 v179, a251
    v_cvt_pk_bf16_f32 v172, v172, v173
    v_cvt_pk_bf16_f32 v173, v174, v175
    v_cvt_pk_bf16_f32 v174, v176, v177
    v_cvt_pk_bf16_f32 v175, v178, v179
    buffer_store_dwordx4 v[172:175], v4, s[8:11], s30 offen offset:2048 sc1
    v_accvgpr_read_b32 v180, a220
    v_accvgpr_read_b32 v181, a221
    v_accvgpr_read_b32 v182, a222
    v_accvgpr_read_b32 v183, a223
    v_accvgpr_read_b32 v184, a252
    v_accvgpr_read_b32 v185, a253
    v_accvgpr_read_b32 v186, a254
    v_accvgpr_read_b32 v187, a255
    v_cvt_pk_bf16_f32 v180, v180, v181
    v_cvt_pk_bf16_f32 v181, v182, v183
    v_cvt_pk_bf16_f32 v182, v184, v185
    v_cvt_pk_bf16_f32 v183, v186, v187
    buffer_store_dwordx4 v[180:183], v4, s[8:11], s30 offen offset:3072 sc1
    s_branch mega_kernel_w_next
mega_kernel_w_qb:
    s_sub_u32 s31, s39, 44
    s_lshr_b32 s36, s31, 1
    s_lshl_b32 s24, s36, 4
    s_mov_b32 s32, 0
    s_and_b32 s33, s31, 1
    s_lshl_b32 s33, s33, 1
    s_lshl_b32 s30, s38, 2
    s_add_u32 s33, s33, s30
    s_lshl_b32 s41, s38, 3
    s_add_u32 s41, s41, s36
    s_lshl_b32 s41, s41, 7
    s_add_u32 s41, s41, 53248

    s_mov_b32 s12, s44
    s_mov_b32 s13, s45
    s_mov_b32 s14, 8388608
    s_mov_b32 s15, 0x20000
    s_branch mega_kernel_w_bqk
mega_kernel_w_att:
    s_lshl_b32 s30, s38, 3
    s_lshr_b32 s31, s55, 1
    s_add_u32 s30, s30, s31
    s_lshl_b32 s30, s30, 7
    s_add_u32 s30, s30, 53248

    s_cmp_lg_u32 s20, 0
    s_cbranch_scc1 mega_kernel_w_wq_ok
    v_mov_b32 v5, 0
mega_kernel_w_wq:
    buffer_load_dword v6, v5, s[8:11], s30 offen sc1
    s_waitcnt vmcnt(0)
    v_readfirstlane_b32 s31, v6
    s_cmp_ge_u32 s31, 2
    s_cbranch_scc1 mega_kernel_w_wq_ok
    s_sub_u32 s40, s40, 1
    s_cbranch_scc1 mega_kernel_w_exit
    s_sleep 12
    s_branch mega_kernel_w_wq
mega_kernel_w_wq_ok:
    s_barrier

    s_lshl_b32 s30, s38, 4
    s_add_u32 s30, s30, s55
    s_lshl_b32 s30, s30, 7
    s_add_u32 s30, s30, 33792

    s_cmp_lg_u32 s20, 0
    s_cbranch_scc1 mega_kernel_w_wkv_ok
    v_mov_b32 v5, 0
mega_kernel_w_wkv:
    buffer_load_dword v6, v5, s[8:11], s30 offen sc1
    s_waitcnt vmcnt(0)
    v_readfirstlane_b32 s31, v6
    s_cmp_ge_u32 s31, 8
    s_cbranch_scc1 mega_kernel_w_wkv_ok
    s_sub_u32 s40, s40, 1
    s_cbranch_scc1 mega_kernel_w_exit
    s_sleep 12
    s_branch mega_kernel_w_wkv
mega_kernel_w_wkv_ok:
    s_barrier

    s_lshl_b32 s34, s55, 2
    s_cmp_eq_u32 s55, 15
    s_cselect_b32 s60, 2, 4
mega_kernel_w_attgo:
    s_lshl_b32 s33, s38, 2
    s_add_u32 s33, s33, s20
mega_kernel_w_attl:

    s_lshl_b32 s30, s38, 6
    s_add_u32 s30, s30, s34
    s_lshl_b32 s30, s30, 6
    s_add_u32 s30, s30, 65536

    s_cmp_lg_u32 s20, 0
    s_cbranch_scc1 mega_kernel_w_wm_ok
    v_mov_b32 v5, 0
mega_kernel_w_wm:
    buffer_load_dword v6, v5, s[8:11], s30 offen sc1
    s_waitcnt vmcnt(0)
    v_readfirstlane_b32 s31, v6
    s_cmp_ge_u32 s31, 4
    s_cbranch_scc1 mega_kernel_w_wm_ok
    s_sub_u32 s40, s40, 1
    s_cbranch_scc1 mega_kernel_w_exit
    s_sleep 12
    s_branch mega_kernel_w_wm
mega_kernel_w_wm_ok:
    s_barrier

    s_lshl_b32 s56, s34, 5
    s_add_u32 s56, s56, s33
    s_lshl_b32 s57, s56, 12
    s_add_u32 s57, s57, 57049088
    s_lshl_b32 s56, s56, 13
    s_add_u32 s58, s56, 6717440
    s_add_u32 s59, s58, 4096
    v_lshlrev_b32 v242, 3, v1

    buffer_load_dwordx4 v[8:11], v4, s[8:11], s58 offen offset:0 sc1
    buffer_load_dwordx4 v[12:15], v4, s[8:11], s58 offen offset:1024 sc1
    buffer_load_dwordx4 v[16:19], v4, s[8:11], s58 offen offset:2048 sc1
    buffer_load_dwordx4 v[20:23], v4, s[8:11], s58 offen offset:3072 sc1
    buffer_load_dwordx4 v[24:27], v4, s[8:11], s59 offen offset:0 sc1
    buffer_load_dwordx4 v[28:31], v4, s[8:11], s59 offen offset:1024 sc1
    buffer_load_dwordx4 v[32:35], v4, s[8:11], s59 offen offset:2048 sc1
    buffer_load_dwordx4 v[36:39], v4, s[8:11], s59 offen offset:3072 sc1
    s_add_u32 s58, s56, 23494656
    s_add_u32 s59, s58, 4096
    buffer_load_dwordx4 v[40:43], v4, s[8:11], s58 offen offset:0 sc1
    buffer_load_dwordx4 v[44:47], v4, s[8:11], s58 offen offset:1024 sc1
    buffer_load_dwordx4 v[48:51], v4, s[8:11], s58 offen offset:2048 sc1
    buffer_load_dwordx4 v[52:55], v4, s[8:11], s58 offen offset:3072 sc1
    buffer_load_dwordx4 v[56:59], v4, s[8:11], s59 offen offset:0 sc1
    buffer_load_dwordx4 v[60:63], v4, s[8:11], s59 offen offset:1024 sc1
    buffer_load_dwordx4 v[64:67], v4, s[8:11], s59 offen offset:2048 sc1
    buffer_load_dwordx4 v[68:71], v4, s[8:11], s59 offen offset:3072 sc1
    buffer_load_dwordx4 v[104:107], v4, s[8:11], s57 offen offset:0 sc1
    buffer_load_dwordx4 v[108:111], v4, s[8:11], s57 offen offset:1024 sc1
    buffer_load_dwordx2 v[112:113], v242, s[8:11], s57 offen offset:2048 sc1
    buffer_load_dwordx2 v[114:115], v242, s[8:11], s57 offen offset:2560 sc1
    buffer_load_dwordx2 v[116:117], v242, s[8:11], s57 offen offset:3072 sc1
    buffer_load_dwordx2 v[118:119], v242, s[8:11], s57 offen offset:3584 sc1
    s_add_u32 s58, s56, 40271872
    s_add_u32 s59, s58, 4096
    buffer_load_dwordx4 v[72:75], v4, s[8:11], s58 offen offset:0 sc1
    buffer_load_dwordx4 v[76:79], v4, s[8:11], s58 offen offset:1024 sc1
    buffer_load_dwordx4 v[80:83], v4, s[8:11], s58 offen offset:2048 sc1
    buffer_load_dwordx4 v[84:87], v4, s[8:11], s58 offen offset:3072 sc1
    buffer_load_dwordx4 v[88:91], v4, s[8:11], s59 offen offset:0 sc1
    buffer_load_dwordx4 v[92:95], v4, s[8:11], s59 offen offset:1024 sc1
    buffer_load_dwordx4 v[96:99], v4, s[8:11], s59 offen offset:2048 sc1
    buffer_load_dwordx4 v[100:103], v4, s[8:11], s59 offen offset:3072 sc1
    v_mov_b32 v148, 0
    v_lshl_add_u32 v238, v3, 2, 0
    v_cmp_le_u32 vcc, v238, v2
    v_mov_b32 v239, 0xff800000
    s_nop 1
    v_cndmask_b32 v243, v239, v148, vcc
    v_lshl_add_u32 v238, v3, 2, 1
    v_cmp_le_u32 vcc, v238, v2
    v_mov_b32 v239, 0xff800000
    s_nop 1
    v_cndmask_b32 v244, v239, v148, vcc
    v_lshl_add_u32 v238, v3, 2, 2
    v_cmp_le_u32 vcc, v238, v2
    v_mov_b32 v239, 0xff800000
    s_nop 1
    v_cndmask_b32 v245, v239, v148, vcc
    v_lshl_add_u32 v238, v3, 2, 3
    v_cmp_le_u32 vcc, v238, v2
    v_mov_b32 v239, 0xff800000
    s_nop 1
    v_cndmask_b32 v246, v239, v148, vcc
    s_waitcnt vmcnt(8)
    v_mfma_f32_16x16x32_bf16 v[120:123], v[40:43], v[8:11], 0
    v_mfma_f32_16x16x32_bf16 v[124:127], v[40:43], v[24:27], 0
    v_mfma_f32_16x16x32_bf16 v[128:131], v[56:59], v[24:27], 0
    v_mfma_f32_16x16x32_bf16 v[120:123], v[44:47], v[12:15], v[120:123]
    v_mfma_f32_16x16x32_bf16 v[124:127], v[44:47], v[28:31], v[124:127]
    v_mfma_f32_16x16x32_bf16 v[128:131], v[60:63], v[28:31], v[128:131]
    v_mfma_f32_16x16x32_bf16 v[120:123], v[48:51], v[16:19], v[120:123]
    v_mfma_f32_16x16x32_bf16 v[124:127], v[48:51], v[32:35], v[124:127]
    v_mfma_f32_16x16x32_bf16 v[128:131], v[64:67], v[32:35], v[128:131]
    v_mfma_f32_16x16x32_bf16 v[120:123], v[52:55], v[20:23], v[120:123]
    v_mfma_f32_16x16x32_bf16 v[124:127], v[52:55], v[36:39], v[124:127]
    v_mfma_f32_16x16x32_bf16 v[128:131], v[68:71], v[36:39], v[128:131]
    v_mfma_f32_16x16x32_bf16 v[132:135], v[104:107], v[8:11], 0
    v_mfma_f32_16x16x32_bf16 v[140:143], v[104:107], v[12:15], 0
    v_mfma_f32_16x16x32_bf16 v[136:139], v[104:107], v[24:27], 0
    v_mfma_f32_16x16x32_bf16 v[144:147], v[104:107], v[28:31], 0
    v_mfma_f32_16x16x32_bf16 v[132:135], v[108:111], v[16:19], v[132:135]
    v_mfma_f32_16x16x32_bf16 v[140:143], v[108:111], v[20:23], v[140:143]
    v_mfma_f32_16x16x32_bf16 v[136:139], v[108:111], v[32:35], v[136:139]
    v_mfma_f32_16x16x32_bf16 v[144:147], v[108:111], v[36:39], v[144:147]
    s_nop 7
    v_permlane32_swap_b32 v140, v148
    v_permlane32_swap_b32 v141, v149
    v_permlane32_swap_b32 v142, v150
    v_permlane32_swap_b32 v143, v151
    s_nop 1
    v_add_f32 v132, v132, v148
    v_add_f32 v133, v133, v149
    v_add_f32 v134, v134, v150
    v_add_f32 v135, v135, v151
    v_mov_b32 v148, 0xff800000
    v_mov_b32 v149, 0xff800000
    v_mov_b32 v150, 0xff800000
    v_mov_b32 v151, 0xff800000
    s_nop 1
    v_mov_b32_dpp v132, v148 quad_perm:[0,1,2,3] row_mask:0xc bank_mask:0xf
    v_mov_b32_dpp v133, v149 quad_perm:[0,1,2,3] row_mask:0xc bank_mask:0xf
    v_mov_b32_dpp v134, v150 quad_perm:[0,1,2,3] row_mask:0xc bank_mask:0xf
    v_mov_b32_dpp v135, v151 quad_perm:[0,1,2,3] row_mask:0xc bank_mask:0xf
    v_permlane32_swap_b32 v144, v148
    v_permlane32_swap_b32 v145, v149
    v_permlane32_swap_b32 v146, v150
    v_permlane32_swap_b32 v147, v151
    s_nop 1
    v_add_f32 v136, v136, v148
    v_add_f32 v137, v137, v149
    v_add_f32 v138, v138, v150
    v_add_f32 v139, v139, v151
    v_mov_b32 v148, 0xff800000
    v_mov_b32 v149, 0xff800000
    v_mov_b32 v150, 0xff800000
    v_mov_b32 v151, 0xff800000
    s_nop 1
    v_mov_b32_dpp v136, v148 quad_perm:[0,1,2,3] row_mask:0xc bank_mask:0xf
    v_mov_b32_dpp v137, v149 quad_perm:[0,1,2,3] row_mask:0xc bank_mask:0xf
    v_mov_b32_dpp v138, v150 quad_perm:[0,1,2,3] row_mask:0xc bank_mask:0xf
    v_mov_b32_dpp v139, v151 quad_perm:[0,1,2,3] row_mask:0xc bank_mask:0xf
    v_add_f32 v120, v120, v243
    v_add_f32 v128, v128, v243
    v_add_f32 v121, v121, v244
    v_add_f32 v129, v129, v244
    v_add_f32 v122, v122, v245
    v_add_f32 v130, v130, v245
    v_add_f32 v123, v123, v246
    v_add_f32 v131, v131, v246
    v_max3_f32 v236, v120, v121, v122
    v_max3_f32 v236, v236, v123, v132
    v_max3_f32 v236, v236, v133, v134
    v_max_f32 v236, v236, v135
    v_mov_b32 v238, v236
    s_nop 1
    v_permlane16_swap_b32 v236, v238
    s_nop 1
    v_max_f32 v236, v236, v238
    v_mov_b32 v238, v236
    s_nop 1
    v_permlane32_swap_b32 v236, v238
    s_nop 1
    v_max_f32 v236, v236, v238
    v_mul_f32 v236, s54, v236

    v_fma_f32 v120, v120, s54, -v236
    v_fma_f32 v121, v121, s54, -v236
    v_fma_f32 v122, v122, s54, -v236
    v_fma_f32 v123, v123, s54, -v236
    v_fma_f32 v132, v132, s54, -v236
    v_fma_f32 v133, v133, s54, -v236
    v_fma_f32 v134, v134, s54, -v236
    v_fma_f32 v135, v135, s54, -v236
    v_exp_f32 v120, v120
    v_exp_f32 v121, v121
    v_exp_f32 v122, v122
    v_exp_f32 v123, v123
    v_exp_f32 v132, v132
    v_exp_f32 v133, v133
    v_exp_f32 v134, v134
    v_exp_f32 v135, v135
    s_nop 0
    v_add_f32 v240, v120, v121
    v_add_f32 v240, v240, v122
    v_add_f32 v240, v240, v123
    v_add_f32 v240, v240, v132
    v_add_f32 v240, v240, v133
    v_add_f32 v240, v240, v134
    v_add_f32 v240, v240, v135
    v_mov_b32 v238, v240
    s_nop 1
    v_permlane16_swap_b32 v240, v238
    s_nop 1
    v_add_f32 v240, v240, v238
    v_mov_b32 v238, v240
    s_nop 1
    v_permlane32_swap_b32 v240, v238
    s_nop 1
    v_add_f32 v240, v240, v238
    v_rcp_f32 v240, v240
    s_nop 0

    v_mul_f32 v120, v120, v240
    v_mul_f32 v121, v121, v240
    v_mul_f32 v122, v122, v240
    v_mul_f32 v123, v123, v240
    v_mul_f32 v132, v132, v240
    v_mul_f32 v133, v133, v240
    v_mul_f32 v134, v134, v240
    v_mul_f32 v135, v135, v240
    v_cvt_pk_bf16_f32 v152, v120, v121
    v_cvt_pk_bf16_f32 v153, v122, v123
    v_mov_b32 v154, 0
    v_mov_b32 v155, 0
    v_cvt_pk_bf16_f32 v160, v132, v133
    v_cvt_pk_bf16_f32 v168, v132, v133
    v_mov_b32 v164, 0
    v_cvt_pk_bf16_f32 v161, v134, v135
    v_cvt_pk_bf16_f32 v169, v134, v135
    v_mov_b32 v165, 0
    s_nop 1
    v_permlane32_swap_b32 v164, v168
    v_permlane32_swap_b32 v165, v169
    v_max3_f32 v237, v124, v125, v126
    v_max3_f32 v237, v237, v127, v128
    v_max3_f32 v237, v237, v129, v130
    v_max3_f32 v237, v237, v131, v136
    v_max3_f32 v237, v237, v137, v138
    v_max_f32 v237, v237, v139
    v_mov_b32 v239, v237
    s_nop 1
    v_permlane16_swap_b32 v237, v239
    s_nop 1
    v_max_f32 v237, v237, v239
    v_mov_b32 v239, v237
    s_nop 1
    v_permlane32_swap_b32 v237, v239
    s_nop 1
    v_max_f32 v237, v237, v239
    v_mul_f32 v237, s54, v237

    v_fma_f32 v124, v124, s54, -v237
    v_fma_f32 v125, v125, s54, -v237
    v_fma_f32 v126, v126, s54, -v237
    v_fma_f32 v127, v127, s54, -v237
    v_fma_f32 v128, v128, s54, -v237
    v_fma_f32 v129, v129, s54, -v237
    v_fma_f32 v130, v130, s54, -v237
    v_fma_f32 v131, v131, s54, -v237
    v_fma_f32 v136, v136, s54, -v237
    v_fma_f32 v137, v137, s54, -v237
    v_fma_f32 v138, v138, s54, -v237
    v_fma_f32 v139, v139, s54, -v237
    v_exp_f32 v124, v124
    v_exp_f32 v125, v125
    v_exp_f32 v126, v126
    v_exp_f32 v127, v127
    v_exp_f32 v128, v128
    v_exp_f32 v129, v129
    v_exp_f32 v130, v130
    v_exp_f32 v131, v131
    v_exp_f32 v136, v136
    v_exp_f32 v137, v137
    v_exp_f32 v138, v138
    v_exp_f32 v139, v139
    s_nop 0
    v_add_f32 v241, v124, v125
    v_add_f32 v241, v241, v126
    v_add_f32 v241, v241, v127
    v_add_f32 v241, v241, v128
    v_add_f32 v241, v241, v129
    v_add_f32 v241, v241, v130
    v_add_f32 v241, v241, v131
    v_add_f32 v241, v241, v136
    v_add_f32 v241, v241, v137
    v_add_f32 v241, v241, v138
    v_add_f32 v241, v241, v139
    v_mov_b32 v239, v241
    s_nop 1
    v_permlane16_swap_b32 v241, v239
    s_nop 1
    v_add_f32 v241, v241, v239
    v_mov_b32 v239, v241
    s_nop 1
    v_permlane32_swap_b32 v241, v239
    s_nop 1
    v_add_f32 v241, v241, v239
    v_rcp_f32 v241, v241
    s_nop 0

    v_mul_f32 v124, v124, v241
    v_mul_f32 v125, v125, v241
    v_mul_f32 v126, v126, v241
    v_mul_f32 v127, v127, v241
    v_mul_f32 v128, v128, v241
    v_mul_f32 v129, v129, v241
    v_mul_f32 v130, v130, v241
    v_mul_f32 v131, v131, v241
    v_mul_f32 v136, v136, v241
    v_mul_f32 v137, v137, v241
    v_mul_f32 v138, v138, v241
    v_mul_f32 v139, v139, v241
    v_cvt_pk_bf16_f32 v156, v124, v125
    v_cvt_pk_bf16_f32 v157, v126, v127
    v_cvt_pk_bf16_f32 v158, v128, v129
    v_cvt_pk_bf16_f32 v159, v130, v131
    v_cvt_pk_bf16_f32 v162, v136, v137
    v_cvt_pk_bf16_f32 v170, v136, v137
    v_mov_b32 v166, 0
    v_cvt_pk_bf16_f32 v163, v138, v139
    v_cvt_pk_bf16_f32 v171, v138, v139
    v_mov_b32 v167, 0
    s_nop 1
    v_permlane32_swap_b32 v166, v170
    v_permlane32_swap_b32 v167, v171
    s_waitcnt vmcnt(0)
    s_nop 1
    v_mfma_f32_16x16x32_bf16 v[172:175], v[72:75], v[152:155], 0
    v_mfma_f32_16x16x32_bf16 v[176:179], v[72:75], v[156:159], 0
    v_mfma_f32_16x16x32_bf16 v[180:183], v[76:79], v[152:155], 0
    v_mfma_f32_16x16x32_bf16 v[184:187], v[76:79], v[156:159], 0
    v_mfma_f32_16x16x32_bf16 v[188:191], v[80:83], v[152:155], 0
    v_mfma_f32_16x16x32_bf16 v[192:195], v[80:83], v[156:159], 0
    v_mfma_f32_16x16x32_bf16 v[196:199], v[84:87], v[152:155], 0
    v_mfma_f32_16x16x32_bf16 v[200:203], v[84:87], v[156:159], 0
    v_mfma_f32_16x16x32_bf16 v[204:207], v[88:91], v[152:155], 0
    v_mfma_f32_16x16x32_bf16 v[208:211], v[88:91], v[156:159], 0
    v_mfma_f32_16x16x32_bf16 v[212:215], v[92:95], v[152:155], 0
    v_mfma_f32_16x16x32_bf16 v[216:219], v[92:95], v[156:159], 0
    v_mfma_f32_16x16x32_bf16 v[220:223], v[96:99], v[152:155], 0
    v_mfma_f32_16x16x32_bf16 v[224:227], v[96:99], v[156:159], 0
    v_mfma_f32_16x16x32_bf16 v[228:231], v[100:103], v[152:155], 0
    v_mfma_f32_16x16x32_bf16 v[232:235], v[100:103], v[156:159], 0
    v_mfma_f32_16x16x16_bf16 v[172:175], v[112:113], v[160:161], v[172:175]
    v_mfma_f32_16x16x16_bf16 v[176:179], v[112:113], v[162:163], v[176:179]
    v_mfma_f32_16x16x16_bf16 v[180:183], v[112:113], v[164:165], v[180:183]
    v_mfma_f32_16x16x16_bf16 v[184:187], v[112:113], v[166:167], v[184:187]
    v_mfma_f32_16x16x16_bf16 v[188:191], v[114:115], v[160:161], v[188:191]
    v_mfma_f32_16x16x16_bf16 v[192:195], v[114:115], v[162:163], v[192:195]
    v_mfma_f32_16x16x16_bf16 v[196:199], v[114:115], v[164:165], v[196:199]
    v_mfma_f32_16x16x16_bf16 v[200:203], v[114:115], v[166:167], v[200:203]
    v_mfma_f32_16x16x16_bf16 v[204:207], v[116:117], v[160:161], v[204:207]
    v_mfma_f32_16x16x16_bf16 v[208:211], v[116:117], v[162:163], v[208:211]
    v_mfma_f32_16x16x16_bf16 v[212:215], v[116:117], v[164:165], v[212:215]
    v_mfma_f32_16x16x16_bf16 v[216:219], v[116:117], v[166:167], v[216:219]
    v_mfma_f32_16x16x16_bf16 v[220:223], v[118:119], v[160:161], v[220:223]
    v_mfma_f32_16x16x16_bf16 v[224:227], v[118:119], v[162:163], v[224:227]
    v_mfma_f32_16x16x16_bf16 v[228:231], v[118:119], v[164:165], v[228:231]
    v_mfma_f32_16x16x16_bf16 v[232:235], v[118:119], v[166:167], v[232:235]
    s_lshl_b32 s56, s34, 18
    s_lshl_b32 s57, s33, 12
    s_add_u32 s56, s56, s57
    s_add_u32 s56, s56, 65437696
    s_add_u32 s57, s56, 131072

    s_nop 3
    v_cvt_pk_bf16_f32 v8, v172, v173
    v_cvt_pk_bf16_f32 v9, v174, v175
    v_cvt_pk_bf16_f32 v10, v180, v181
    v_cvt_pk_bf16_f32 v11, v182, v183
    buffer_store_dwordx4 v[8:11], v4, s[8:11], s56 offen offset:0 sc1
    v_cvt_pk_bf16_f32 v12, v176, v177
    v_cvt_pk_bf16_f32 v13, v178, v179
    v_cvt_pk_bf16_f32 v14, v184, v185
    v_cvt_pk_bf16_f32 v15, v186, v187
    buffer_store_dwordx4 v[12:15], v4, s[8:11], s57 offen offset:0 sc1
    v_cvt_pk_bf16_f32 v16, v188, v189
    v_cvt_pk_bf16_f32 v17, v190, v191
    v_cvt_pk_bf16_f32 v18, v196, v197
    v_cvt_pk_bf16_f32 v19, v198, v199
    buffer_store_dwordx4 v[16:19], v4, s[8:11], s56 offen offset:1024 sc1
    v_cvt_pk_bf16_f32 v20, v192, v193
    v_cvt_pk_bf16_f32 v21, v194, v195
    v_cvt_pk_bf16_f32 v22, v200, v201
    v_cvt_pk_bf16_f32 v23, v202, v203
    buffer_store_dwordx4 v[20:23], v4, s[8:11], s57 offen offset:1024 sc1
    v_cvt_pk_bf16_f32 v24, v204, v205
    v_cvt_pk_bf16_f32 v25, v206, v207
    v_cvt_pk_bf16_f32 v26, v212, v213
    v_cvt_pk_bf16_f32 v27, v214, v215
    buffer_store_dwordx4 v[24:27], v4, s[8:11], s56 offen offset:2048 sc1
    v_cvt_pk_bf16_f32 v28, v208, v209
    v_cvt_pk_bf16_f32 v29, v210, v211
    v_cvt_pk_bf16_f32 v30, v216, v217
    v_cvt_pk_bf16_f32 v31, v218, v219
    buffer_store_dwordx4 v[28:31], v4, s[8:11], s57 offen offset:2048 sc1
    v_cvt_pk_bf16_f32 v32, v220, v221
    v_cvt_pk_bf16_f32 v33, v222, v223
    v_cvt_pk_bf16_f32 v34, v228, v229
    v_cvt_pk_bf16_f32 v35, v230, v231
    buffer_store_dwordx4 v[32:35], v4, s[8:11], s56 offen offset:3072 sc1
    v_cvt_pk_bf16_f32 v36, v224, v225
    v_cvt_pk_bf16_f32 v37, v226, v227
    v_cvt_pk_bf16_f32 v38, v232, v233
    v_cvt_pk_bf16_f32 v39, v234, v235
    buffer_store_dwordx4 v[36:39], v4, s[8:11], s57 offen offset:3072 sc1
    s_add_u32 s34, s34, 1
    s_sub_u32 s60, s60, 1
    s_cmp_lg_u32 s60, 0
    s_cbranch_scc1 mega_kernel_w_attl
    s_cmp_eq_u32 s39, -3
    s_cselect_b32 s41, 16, s55
    s_lshl_b32 s41, s41, 7
    s_add_u32 s41, s41, 98304

    s_branch mega_kernel_w_next
mega_kernel_w_g4:
    s_lshl_b32 s30, s55, 7
    s_add_u32 s30, s30, 98304

    s_cmp_lg_u32 s20, 0
    s_cbranch_scc1 mega_kernel_w_wo_ok
    v_mov_b32 v5, 0
mega_kernel_w_wo:
    buffer_load_dword v6, v5, s[8:11], s30 offen sc1
    s_waitcnt vmcnt(0)
    v_readfirstlane_b32 s31, v6
    s_cmp_ge_u32 s31, 8
    s_cbranch_scc1 mega_kernel_w_wo_ok
    s_sub_u32 s40, s40, 1
    s_cbranch_scc1 mega_kernel_w_exit
    s_sleep 12
    s_branch mega_kernel_w_wo
mega_kernel_w_wo_ok:
    s_barrier

    s_mov_b32 s12, s50
    s_mov_b32 s13, s51
    s_mov_b32 s14, 8388608
    s_mov_b32 s15, 0x20000
    s_mov_b32 s16, s52
    s_mov_b32 s17, s53
    s_mov_b32 s18, 4194304
    s_mov_b32 s19, 0x20000
    s_lshl_b32 s28, s20, 12
    v_lshrrev_b32 v5, 4, v1
    s_lshl_b32 s30, s20, 4
    v_add_u32 v5, s30, v5
    v_and_b32 v6, 15, v1
    s_mov_b32 s31, 2048
    v_add_u32 v7, 0, v5
    v_and_b32 v8, 7, v7
    v_lshlrev_b32 v8, 1, v8
    v_xor_b32 v8, v8, v6
    v_lshlrev_b32 v8, 4, v8
    v_mul_lo_u32 v7, v7, s31
    v_add_u32 v8, v8, v7
    v_add_u32 v7, 4, v5
    v_and_b32 v9, 7, v7
    v_lshlrev_b32 v9, 1, v9
    v_xor_b32 v9, v9, v6
    v_lshlrev_b32 v9, 4, v9
    v_mul_lo_u32 v7, v7, s31
    v_add_u32 v9, v9, v7
    v_subrev_u32 v9, 1024, v9
    v_add_u32 v7, 8, v5
    v_and_b32 v10, 7, v7
    v_lshlrev_b32 v10, 1, v10
    v_xor_b32 v10, v10, v6
    v_lshlrev_b32 v10, 4, v10
    v_mul_lo_u32 v7, v7, s31
    v_add_u32 v10, v10, v7
    v_subrev_u32 v10, 2048, v10
    v_add_u32 v7, 12, v5
    v_and_b32 v11, 7, v7
    v_lshlrev_b32 v11, 1, v11
    v_xor_b32 v11, v11, v6
    v_lshlrev_b32 v11, 4, v11
    v_mul_lo_u32 v7, v7, s31
    v_add_u32 v11, v11, v7
    v_subrev_u32 v11, 3072, v11
    v_lshrrev_b32 v5, 2, v2
    v_lshl_add_u32 v5, v3, 2, v5
    v_and_b32 v6, 7, v5
    v_lshlrev_b32 v6, 5, v6
    v_lshlrev_b32 v5, 8, v5
    v_and_b32 v7, 3, v2
    v_lshl_add_u32 v5, v7, 3, v5
    v_xor_b32 v14, 0, v6
    v_add_u32 v14, v14, v5
    v_add_u32 v22, 0x10000, v14
    v_xor_b32 v15, 32, v6
    v_add_u32 v15, v15, v5
    v_add_u32 v23, 0x10000, v15
    v_xor_b32 v16, 64, v6
    v_add_u32 v16, v16, v5
    v_add_u32 v24, 0x10000, v16
    v_xor_b32 v17, 96, v6
    v_add_u32 v17, v17, v5
    v_add_u32 v25, 0x10000, v17
    v_xor_b32 v18, 128, v6
    v_add_u32 v18, v18, v5
    v_add_u32 v26, 0x10000, v18
    v_xor_b32 v19, 160, v6
    v_add_u32 v19, v19, v5
    v_add_u32 v27, 0x10000, v19
    v_xor_b32 v20, 192, v6
    v_add_u32 v20, v20, v5
    v_add_u32 v28, 0x10000, v20
    v_xor_b32 v21, 224, v6
    v_add_u32 v21, v21, v5
    v_add_u32 v29, 0x10000, v21
    s_mul_i32 s30, s20, 262144
    v_add_u32 v12, s30, v4
    v_add_u32 v13, 131072, v12
    s_lshl_b32 s26, s38, 8
    s_lshl_b32 s25, s55, 20
    s_add_u32 s25, s25, 65437696
    s_add_u32 m0, s28, 0
    s_nop 0
    buffer_load_dwordx4 v8, s[12:15], s26 offen offset:0 lds
    buffer_load_dwordx4 v9, s[12:15], s26 offen offset:1024 lds
    buffer_load_dwordx4 v10, s[12:15], s26 offen offset:2048 lds
    buffer_load_dwordx4 v11, s[12:15], s26 offen offset:3072 lds
    s_add_u32 s26, s26, 131072
    buffer_load_dwordx4 v[96:99], v12, s[8:11], s25 offen sc1
    buffer_load_dwordx4 v[100:103], v13, s[8:11], s25 offen sc1
    s_add_u32 s25, s25, 1024
    buffer_load_dwordx4 v[104:107], v12, s[8:11], s25 offen sc1
    buffer_load_dwordx4 v[108:111], v13, s[8:11], s25 offen sc1
    s_add_u32 s25, s25, 1024
    s_add_u32 m0, s28, 16384
    s_nop 0
    buffer_load_dwordx4 v8, s[12:15], s26 offen offset:0 lds
    buffer_load_dwordx4 v9, s[12:15], s26 offen offset:1024 lds
    buffer_load_dwordx4 v10, s[12:15], s26 offen offset:2048 lds
    buffer_load_dwordx4 v11, s[12:15], s26 offen offset:3072 lds
    s_add_u32 s26, s26, 131072
    buffer_load_dwordx4 v[112:115], v12, s[8:11], s25 offen sc1
    buffer_load_dwordx4 v[116:119], v13, s[8:11], s25 offen sc1
    s_add_u32 s25, s25, 1024
    buffer_load_dwordx4 v[120:123], v12, s[8:11], s25 offen sc1
    buffer_load_dwordx4 v[124:127], v13, s[8:11], s25 offen sc1
    s_add_u32 s25, s25, 1024
    s_add_u32 m0, s28, 32768
    s_nop 0
    buffer_load_dwordx4 v8, s[12:15], s26 offen offset:0 lds
    buffer_load_dwordx4 v9, s[12:15], s26 offen offset:1024 lds
    buffer_load_dwordx4 v10, s[12:15], s26 offen offset:2048 lds
    buffer_load_dwordx4 v11, s[12:15], s26 offen offset:3072 lds
    s_add_u32 s26, s26, 131072
    buffer_load_dwordx4 v[128:131], v12, s[8:11], s25 offen sc1
    buffer_load_dwordx4 v[132:135], v13, s[8:11], s25 offen sc1
    s_add_u32 s25, s25, 1024
    buffer_load_dwordx4 v[136:139], v12, s[8:11], s25 offen sc1
    buffer_load_dwordx4 v[140:143], v13, s[8:11], s25 offen sc1
    s_add_u32 s25, s25, 1024
    s_add_u32 m0, s28, 49152
    s_nop 0
    buffer_load_dwordx4 v8, s[12:15], s26 offen offset:0 lds
    buffer_load_dwordx4 v9, s[12:15], s26 offen offset:1024 lds
    buffer_load_dwordx4 v10, s[12:15], s26 offen offset:2048 lds
    buffer_load_dwordx4 v11, s[12:15], s26 offen offset:3072 lds
    s_add_u32 s26, s26, 131072
    buffer_load_dwordx4 v[144:147], v12, s[8:11], s25 offen sc1
    buffer_load_dwordx4 v[148:151], v13, s[8:11], s25 offen sc1
    s_add_u32 s25, s25, 1024
    buffer_load_dwordx4 v[152:155], v12, s[8:11], s25 offen sc1
    buffer_load_dwordx4 v[156:159], v13, s[8:11], s25 offen sc1
    s_add_u32 s25, s25, 1024
    s_add_u32 m0, s28, 65536
    s_nop 0
    buffer_load_dwordx4 v8, s[12:15], s26 offen offset:0 lds
    buffer_load_dwordx4 v9, s[12:15], s26 offen offset:1024 lds
    buffer_load_dwordx4 v10, s[12:15], s26 offen offset:2048 lds
    buffer_load_dwordx4 v11, s[12:15], s26 offen offset:3072 lds
    s_add_u32 s26, s26, 131072
    buffer_load_dwordx4 v[160:163], v12, s[8:11], s25 offen sc1
    buffer_load_dwordx4 v[164:167], v13, s[8:11], s25 offen sc1
    s_add_u32 s25, s25, 1024
    buffer_load_dwordx4 v[168:171], v12, s[8:11], s25 offen sc1
    buffer_load_dwordx4 v[172:175], v13, s[8:11], s25 offen sc1
    s_add_u32 s25, s25, 1024
    s_add_u32 m0, s28, 81920
    s_nop 0
    buffer_load_dwordx4 v8, s[12:15], s26 offen offset:0 lds
    buffer_load_dwordx4 v9, s[12:15], s26 offen offset:1024 lds
    buffer_load_dwordx4 v10, s[12:15], s26 offen offset:2048 lds
    buffer_load_dwordx4 v11, s[12:15], s26 offen offset:3072 lds
    s_add_u32 s26, s26, 131072
    buffer_load_dwordx4 v[176:179], v12, s[8:11], s25 offen sc1
    buffer_load_dwordx4 v[180:183], v13, s[8:11], s25 offen sc1
    s_add_u32 s25, s25, 1024
    buffer_load_dwordx4 v[184:187], v12, s[8:11], s25 offen sc1
    buffer_load_dwordx4 v[188:191], v13, s[8:11], s25 offen sc1
    s_add_u32 s25, s25, 1024
    s_add_u32 m0, s28, 98304
    s_nop 0
    buffer_load_dwordx4 v8, s[12:15], s26 offen offset:0 lds
    buffer_load_dwordx4 v9, s[12:15], s26 offen offset:1024 lds
    buffer_load_dwordx4 v10, s[12:15], s26 offen offset:2048 lds
    buffer_load_dwordx4 v11, s[12:15], s26 offen offset:3072 lds
    s_add_u32 s26, s26, 131072
    buffer_load_dwordx4 v[192:195], v12, s[8:11], s25 offen sc1
    buffer_load_dwordx4 v[196:199], v13, s[8:11], s25 offen sc1
    s_add_u32 s25, s25, 1024
    buffer_load_dwordx4 v[200:203], v12, s[8:11], s25 offen sc1
    buffer_load_dwordx4 v[204:207], v13, s[8:11], s25 offen sc1
    s_add_u32 s25, s25, 1024
    s_add_u32 m0, s28, 114688
    s_nop 0
    buffer_load_dwordx4 v8, s[12:15], s26 offen offset:0 lds
    buffer_load_dwordx4 v9, s[12:15], s26 offen offset:1024 lds
    buffer_load_dwordx4 v10, s[12:15], s26 offen offset:2048 lds
    buffer_load_dwordx4 v11, s[12:15], s26 offen offset:3072 lds
    s_add_u32 s26, s26, 131072
    buffer_load_dwordx4 v[208:211], v12, s[8:11], s25 offen sc1
    buffer_load_dwordx4 v[212:215], v13, s[8:11], s25 offen sc1
    s_add_u32 s25, s25, 1024
    v_accvgpr_write_b32 a0, 0
    v_accvgpr_write_b32 a1, 0
    v_accvgpr_write_b32 a2, 0
    v_accvgpr_write_b32 a3, 0
    v_accvgpr_write_b32 a4, 0
    v_accvgpr_write_b32 a5, 0
    v_accvgpr_write_b32 a6, 0
    v_accvgpr_write_b32 a7, 0
    v_accvgpr_write_b32 a8, 0
    v_accvgpr_write_b32 a9, 0
    v_accvgpr_write_b32 a10, 0
    v_accvgpr_write_b32 a11, 0
    v_accvgpr_write_b32 a12, 0
    v_accvgpr_write_b32 a13, 0
    v_accvgpr_write_b32 a14, 0
    v_accvgpr_write_b32 a15, 0
    v_accvgpr_write_b32 a16, 0
    v_accvgpr_write_b32 a17, 0
    v_accvgpr_write_b32 a18, 0
    v_accvgpr_write_b32 a19, 0
    v_accvgpr_write_b32 a20, 0
    v_accvgpr_write_b32 a21, 0
    v_accvgpr_write_b32 a22, 0
    v_accvgpr_write_b32 a23, 0
    v_accvgpr_write_b32 a24, 0
    v_accvgpr_write_b32 a25, 0
    v_accvgpr_write_b32 a26, 0
    v_accvgpr_write_b32 a27, 0
    v_accvgpr_write_b32 a28, 0
    v_accvgpr_write_b32 a29, 0
    v_accvgpr_write_b32 a30, 0
    v_accvgpr_write_b32 a31, 0
    v_accvgpr_write_b32 a32, 0
    v_accvgpr_write_b32 a33, 0
    v_accvgpr_write_b32 a34, 0
    v_accvgpr_write_b32 a35, 0
    v_accvgpr_write_b32 a36, 0
    v_accvgpr_write_b32 a37, 0
    v_accvgpr_write_b32 a38, 0
    v_accvgpr_write_b32 a39, 0
    v_accvgpr_write_b32 a40, 0
    v_accvgpr_write_b32 a41, 0
    v_accvgpr_write_b32 a42, 0
    v_accvgpr_write_b32 a43, 0
    v_accvgpr_write_b32 a44, 0
    v_accvgpr_write_b32 a45, 0
    v_accvgpr_write_b32 a46, 0
    v_accvgpr_write_b32 a47, 0
    v_accvgpr_write_b32 a48, 0
    v_accvgpr_write_b32 a49, 0
    v_accvgpr_write_b32 a50, 0
    v_accvgpr_write_b32 a51, 0
    v_accvgpr_write_b32 a52, 0
    v_accvgpr_write_b32 a53, 0
    v_accvgpr_write_b32 a54, 0
    v_accvgpr_write_b32 a55, 0
    v_accvgpr_write_b32 a56, 0
    v_accvgpr_write_b32 a57, 0
    v_accvgpr_write_b32 a58, 0
    v_accvgpr_write_b32 a59, 0
    v_accvgpr_write_b32 a60, 0
    v_accvgpr_write_b32 a61, 0
    v_accvgpr_write_b32 a62, 0
    v_accvgpr_write_b32 a63, 0
    s_mov_b32 s27, 8
    s_waitcnt vmcnt(58)
    s_barrier
    ds_read_b64_tr_b16 v[32:33], v14 offset:0
    ds_read_b64_tr_b16 v[34:35], v14 offset:4096
    ds_read_b64_tr_b16 v[36:37], v15 offset:0
    ds_read_b64_tr_b16 v[38:39], v15 offset:4096
    ds_read_b64_tr_b16 v[40:41], v16 offset:0
    ds_read_b64_tr_b16 v[42:43], v16 offset:4096
    ds_read_b64_tr_b16 v[44:45], v17 offset:0
    ds_read_b64_tr_b16 v[46:47], v17 offset:4096
    ds_read_b64_tr_b16 v[48:49], v18 offset:0
    ds_read_b64_tr_b16 v[50:51], v18 offset:4096
    ds_read_b64_tr_b16 v[52:53], v19 offset:0
    ds_read_b64_tr_b16 v[54:55], v19 offset:4096
    ds_read_b64_tr_b16 v[56:57], v20 offset:0
    ds_read_b64_tr_b16 v[58:59], v20 offset:4096
    ds_read_b64_tr_b16 v[60:61], v21 offset:0
    ds_read_b64_tr_b16 v[62:63], v21 offset:4096
mega_kernel_w_g4_loop:
    s_waitcnt vmcnt(56) lgkmcnt(0)
    v_mfma_f32_16x16x32_bf16 a[0:3], v[32:35], v[96:99], a[0:3]
    ds_read_b64_tr_b16 v[64:65], v14 offset:8192
    ds_read_b64_tr_b16 v[66:67], v14 offset:12288
    v_mfma_f32_16x16x32_bf16 a[4:7], v[32:35], v[100:103], a[4:7]
    ds_read_b64_tr_b16 v[68:69], v15 offset:8192
    ds_read_b64_tr_b16 v[70:71], v15 offset:12288
    v_mfma_f32_16x16x32_bf16 a[8:11], v[36:39], v[96:99], a[8:11]
    ds_read_b64_tr_b16 v[72:73], v16 offset:8192
    ds_read_b64_tr_b16 v[74:75], v16 offset:12288
    v_mfma_f32_16x16x32_bf16 a[12:15], v[36:39], v[100:103], a[12:15]
    ds_read_b64_tr_b16 v[76:77], v17 offset:8192
    ds_read_b64_tr_b16 v[78:79], v17 offset:12288
    v_mfma_f32_16x16x32_bf16 a[16:19], v[40:43], v[96:99], a[16:19]
    ds_read_b64_tr_b16 v[80:81], v18 offset:8192
    ds_read_b64_tr_b16 v[82:83], v18 offset:12288
    v_mfma_f32_16x16x32_bf16 a[20:23], v[40:43], v[100:103], a[20:23]
    ds_read_b64_tr_b16 v[84:85], v19 offset:8192
    ds_read_b64_tr_b16 v[86:87], v19 offset:12288
    v_mfma_f32_16x16x32_bf16 a[24:27], v[44:47], v[96:99], a[24:27]
    ds_read_b64_tr_b16 v[88:89], v20 offset:8192
    ds_read_b64_tr_b16 v[90:91], v20 offset:12288
    v_mfma_f32_16x16x32_bf16 a[28:31], v[44:47], v[100:103], a[28:31]
    ds_read_b64_tr_b16 v[92:93], v21 offset:8192
    ds_read_b64_tr_b16 v[94:95], v21 offset:12288
    v_mfma_f32_16x16x32_bf16 a[32:35], v[48:51], v[96:99], a[32:35]
    buffer_load_dwordx4 v[216:219], v12, s[8:11], s25 offen sc1
    buffer_load_dwordx4 v[220:223], v13, s[8:11], s25 offen sc1
    v_mfma_f32_16x16x32_bf16 a[36:39], v[48:51], v[100:103], a[36:39]
    s_add_u32 s25, s25, 1024
    v_mfma_f32_16x16x32_bf16 a[40:43], v[52:55], v[96:99], a[40:43]
    v_mfma_f32_16x16x32_bf16 a[44:47], v[52:55], v[100:103], a[44:47]
    v_mfma_f32_16x16x32_bf16 a[48:51], v[56:59], v[96:99], a[48:51]
    v_mfma_f32_16x16x32_bf16 a[52:55], v[56:59], v[100:103], a[52:55]
    v_mfma_f32_16x16x32_bf16 a[56:59], v[60:63], v[96:99], a[56:59]
    v_mfma_f32_16x16x32_bf16 a[60:63], v[60:63], v[100:103], a[60:63]
    s_waitcnt vmcnt(50) lgkmcnt(0)
    s_barrier
    v_mfma_f32_16x16x32_bf16 a[0:3], v[64:67], v[104:107], a[0:3]
    ds_read_b64_tr_b16 v[32:33], v14 offset:16384
    ds_read_b64_tr_b16 v[34:35], v14 offset:20480
    v_mfma_f32_16x16x32_bf16 a[4:7], v[64:67], v[108:111], a[4:7]
    ds_read_b64_tr_b16 v[36:37], v15 offset:16384
    ds_read_b64_tr_b16 v[38:39], v15 offset:20480
    v_mfma_f32_16x16x32_bf16 a[8:11], v[68:71], v[104:107], a[8:11]
    ds_read_b64_tr_b16 v[40:41], v16 offset:16384
    ds_read_b64_tr_b16 v[42:43], v16 offset:20480
    v_mfma_f32_16x16x32_bf16 a[12:15], v[68:71], v[108:111], a[12:15]
    ds_read_b64_tr_b16 v[44:45], v17 offset:16384
    ds_read_b64_tr_b16 v[46:47], v17 offset:20480
    v_mfma_f32_16x16x32_bf16 a[16:19], v[72:75], v[104:107], a[16:19]
    ds_read_b64_tr_b16 v[48:49], v18 offset:16384
    ds_read_b64_tr_b16 v[50:51], v18 offset:20480
    v_mfma_f32_16x16x32_bf16 a[20:23], v[72:75], v[108:111], a[20:23]
    ds_read_b64_tr_b16 v[52:53], v19 offset:16384
    ds_read_b64_tr_b16 v[54:55], v19 offset:20480
    v_mfma_f32_16x16x32_bf16 a[24:27], v[76:79], v[104:107], a[24:27]
    ds_read_b64_tr_b16 v[56:57], v20 offset:16384
    ds_read_b64_tr_b16 v[58:59], v20 offset:20480
    v_mfma_f32_16x16x32_bf16 a[28:31], v[76:79], v[108:111], a[28:31]
    ds_read_b64_tr_b16 v[60:61], v21 offset:16384
    ds_read_b64_tr_b16 v[62:63], v21 offset:20480
    v_mfma_f32_16x16x32_bf16 a[32:35], v[80:83], v[104:107], a[32:35]
    buffer_load_dwordx4 v[96:99], v12, s[8:11], s25 offen sc1
    buffer_load_dwordx4 v[100:103], v13, s[8:11], s25 offen sc1
    v_mfma_f32_16x16x32_bf16 a[36:39], v[80:83], v[108:111], a[36:39]
    s_add_u32 s25, s25, 1024
    s_add_u32 m0, s28, 0
    v_mfma_f32_16x16x32_bf16 a[40:43], v[84:87], v[104:107], a[40:43]
    s_nop 0
    buffer_load_dwordx4 v8, s[12:15], s26 offen offset:0 lds
    v_mfma_f32_16x16x32_bf16 a[44:47], v[84:87], v[108:111], a[44:47]
    buffer_load_dwordx4 v9, s[12:15], s26 offen offset:1024 lds
    buffer_load_dwordx4 v10, s[12:15], s26 offen offset:2048 lds
    v_mfma_f32_16x16x32_bf16 a[48:51], v[88:91], v[104:107], a[48:51]
    buffer_load_dwordx4 v11, s[12:15], s26 offen offset:3072 lds
    s_add_u32 s26, s26, 131072
    v_mfma_f32_16x16x32_bf16 a[52:55], v[88:91], v[108:111], a[52:55]
    v_mfma_f32_16x16x32_bf16 a[56:59], v[92:95], v[104:107], a[56:59]
    v_mfma_f32_16x16x32_bf16 a[60:63], v[92:95], v[108:111], a[60:63]
    s_waitcnt vmcnt(56) lgkmcnt(0)
    v_mfma_f32_16x16x32_bf16 a[0:3], v[32:35], v[112:115], a[0:3]
    ds_read_b64_tr_b16 v[64:65], v14 offset:24576
    ds_read_b64_tr_b16 v[66:67], v14 offset:28672
    v_mfma_f32_16x16x32_bf16 a[4:7], v[32:35], v[116:119], a[4:7]
    ds_read_b64_tr_b16 v[68:69], v15 offset:24576
    ds_read_b64_tr_b16 v[70:71], v15 offset:28672
    v_mfma_f32_16x16x32_bf16 a[8:11], v[36:39], v[112:115], a[8:11]
    ds_read_b64_tr_b16 v[72:73], v16 offset:24576
    ds_read_b64_tr_b16 v[74:75], v16 offset:28672
    v_mfma_f32_16x16x32_bf16 a[12:15], v[36:39], v[116:119], a[12:15]
    ds_read_b64_tr_b16 v[76:77], v17 offset:24576
    ds_read_b64_tr_b16 v[78:79], v17 offset:28672
    v_mfma_f32_16x16x32_bf16 a[16:19], v[40:43], v[112:115], a[16:19]
    ds_read_b64_tr_b16 v[80:81], v18 offset:24576
    ds_read_b64_tr_b16 v[82:83], v18 offset:28672
    v_mfma_f32_16x16x32_bf16 a[20:23], v[40:43], v[116:119], a[20:23]
    ds_read_b64_tr_b16 v[84:85], v19 offset:24576
    ds_read_b64_tr_b16 v[86:87], v19 offset:28672
    v_mfma_f32_16x16x32_bf16 a[24:27], v[44:47], v[112:115], a[24:27]
    ds_read_b64_tr_b16 v[88:89], v20 offset:24576
    ds_read_b64_tr_b16 v[90:91], v20 offset:28672
    v_mfma_f32_16x16x32_bf16 a[28:31], v[44:47], v[116:119], a[28:31]
    ds_read_b64_tr_b16 v[92:93], v21 offset:24576
    ds_read_b64_tr_b16 v[94:95], v21 offset:28672
    v_mfma_f32_16x16x32_bf16 a[32:35], v[48:51], v[112:115], a[32:35]
    buffer_load_dwordx4 v[104:107], v12, s[8:11], s25 offen sc1
    buffer_load_dwordx4 v[108:111], v13, s[8:11], s25 offen sc1
    v_mfma_f32_16x16x32_bf16 a[36:39], v[48:51], v[116:119], a[36:39]
    s_add_u32 s25, s25, 1024
    v_mfma_f32_16x16x32_bf16 a[40:43], v[52:55], v[112:115], a[40:43]
    v_mfma_f32_16x16x32_bf16 a[44:47], v[52:55], v[116:119], a[44:47]
    v_mfma_f32_16x16x32_bf16 a[48:51], v[56:59], v[112:115], a[48:51]
    v_mfma_f32_16x16x32_bf16 a[52:55], v[56:59], v[116:119], a[52:55]
    v_mfma_f32_16x16x32_bf16 a[56:59], v[60:63], v[112:115], a[56:59]
    v_mfma_f32_16x16x32_bf16 a[60:63], v[60:63], v[116:119], a[60:63]
    s_waitcnt vmcnt(50) lgkmcnt(0)
    s_barrier
    v_mfma_f32_16x16x32_bf16 a[0:3], v[64:67], v[120:123], a[0:3]
    ds_read_b64_tr_b16 v[32:33], v14 offset:32768
    ds_read_b64_tr_b16 v[34:35], v14 offset:36864
    v_mfma_f32_16x16x32_bf16 a[4:7], v[64:67], v[124:127], a[4:7]
    ds_read_b64_tr_b16 v[36:37], v15 offset:32768
    ds_read_b64_tr_b16 v[38:39], v15 offset:36864
    v_mfma_f32_16x16x32_bf16 a[8:11], v[68:71], v[120:123], a[8:11]
    ds_read_b64_tr_b16 v[40:41], v16 offset:32768
    ds_read_b64_tr_b16 v[42:43], v16 offset:36864
    v_mfma_f32_16x16x32_bf16 a[12:15], v[68:71], v[124:127], a[12:15]
    ds_read_b64_tr_b16 v[44:45], v17 offset:32768
    ds_read_b64_tr_b16 v[46:47], v17 offset:36864
    v_mfma_f32_16x16x32_bf16 a[16:19], v[72:75], v[120:123], a[16:19]
    ds_read_b64_tr_b16 v[48:49], v18 offset:32768
    ds_read_b64_tr_b16 v[50:51], v18 offset:36864
    v_mfma_f32_16x16x32_bf16 a[20:23], v[72:75], v[124:127], a[20:23]
    ds_read_b64_tr_b16 v[52:53], v19 offset:32768
    ds_read_b64_tr_b16 v[54:55], v19 offset:36864
    v_mfma_f32_16x16x32_bf16 a[24:27], v[76:79], v[120:123], a[24:27]
    ds_read_b64_tr_b16 v[56:57], v20 offset:32768
    ds_read_b64_tr_b16 v[58:59], v20 offset:36864
    v_mfma_f32_16x16x32_bf16 a[28:31], v[76:79], v[124:127], a[28:31]
    ds_read_b64_tr_b16 v[60:61], v21 offset:32768
    ds_read_b64_tr_b16 v[62:63], v21 offset:36864
    v_mfma_f32_16x16x32_bf16 a[32:35], v[80:83], v[120:123], a[32:35]
    buffer_load_dwordx4 v[112:115], v12, s[8:11], s25 offen sc1
    buffer_load_dwordx4 v[116:119], v13, s[8:11], s25 offen sc1
    v_mfma_f32_16x16x32_bf16 a[36:39], v[80:83], v[124:127], a[36:39]
    s_add_u32 s25, s25, 1024
    s_add_u32 m0, s28, 16384
    v_mfma_f32_16x16x32_bf16 a[40:43], v[84:87], v[120:123], a[40:43]
    s_nop 0
    buffer_load_dwordx4 v8, s[12:15], s26 offen offset:0 lds
    v_mfma_f32_16x16x32_bf16 a[44:47], v[84:87], v[124:127], a[44:47]
    buffer_load_dwordx4 v9, s[12:15], s26 offen offset:1024 lds
    buffer_load_dwordx4 v10, s[12:15], s26 offen offset:2048 lds
    v_mfma_f32_16x16x32_bf16 a[48:51], v[88:91], v[120:123], a[48:51]
    buffer_load_dwordx4 v11, s[12:15], s26 offen offset:3072 lds
    s_add_u32 s26, s26, 131072
    v_mfma_f32_16x16x32_bf16 a[52:55], v[88:91], v[124:127], a[52:55]
    v_mfma_f32_16x16x32_bf16 a[56:59], v[92:95], v[120:123], a[56:59]
    v_mfma_f32_16x16x32_bf16 a[60:63], v[92:95], v[124:127], a[60:63]
    s_waitcnt vmcnt(56) lgkmcnt(0)
    v_mfma_f32_16x16x32_bf16 a[0:3], v[32:35], v[128:131], a[0:3]
    ds_read_b64_tr_b16 v[64:65], v14 offset:40960
    ds_read_b64_tr_b16 v[66:67], v14 offset:45056
    v_mfma_f32_16x16x32_bf16 a[4:7], v[32:35], v[132:135], a[4:7]
    ds_read_b64_tr_b16 v[68:69], v15 offset:40960
    ds_read_b64_tr_b16 v[70:71], v15 offset:45056
    v_mfma_f32_16x16x32_bf16 a[8:11], v[36:39], v[128:131], a[8:11]
    ds_read_b64_tr_b16 v[72:73], v16 offset:40960
    ds_read_b64_tr_b16 v[74:75], v16 offset:45056
    v_mfma_f32_16x16x32_bf16 a[12:15], v[36:39], v[132:135], a[12:15]
    ds_read_b64_tr_b16 v[76:77], v17 offset:40960
    ds_read_b64_tr_b16 v[78:79], v17 offset:45056
    v_mfma_f32_16x16x32_bf16 a[16:19], v[40:43], v[128:131], a[16:19]
    ds_read_b64_tr_b16 v[80:81], v18 offset:40960
    ds_read_b64_tr_b16 v[82:83], v18 offset:45056
    v_mfma_f32_16x16x32_bf16 a[20:23], v[40:43], v[132:135], a[20:23]
    ds_read_b64_tr_b16 v[84:85], v19 offset:40960
    ds_read_b64_tr_b16 v[86:87], v19 offset:45056
    v_mfma_f32_16x16x32_bf16 a[24:27], v[44:47], v[128:131], a[24:27]
    ds_read_b64_tr_b16 v[88:89], v20 offset:40960
    ds_read_b64_tr_b16 v[90:91], v20 offset:45056
    v_mfma_f32_16x16x32_bf16 a[28:31], v[44:47], v[132:135], a[28:31]
    ds_read_b64_tr_b16 v[92:93], v21 offset:40960
    ds_read_b64_tr_b16 v[94:95], v21 offset:45056
    v_mfma_f32_16x16x32_bf16 a[32:35], v[48:51], v[128:131], a[32:35]
    buffer_load_dwordx4 v[120:123], v12, s[8:11], s25 offen sc1
    buffer_load_dwordx4 v[124:127], v13, s[8:11], s25 offen sc1
    v_mfma_f32_16x16x32_bf16 a[36:39], v[48:51], v[132:135], a[36:39]
    s_add_u32 s25, s25, 1024
    v_mfma_f32_16x16x32_bf16 a[40:43], v[52:55], v[128:131], a[40:43]
    v_mfma_f32_16x16x32_bf16 a[44:47], v[52:55], v[132:135], a[44:47]
    v_mfma_f32_16x16x32_bf16 a[48:51], v[56:59], v[128:131], a[48:51]
    v_mfma_f32_16x16x32_bf16 a[52:55], v[56:59], v[132:135], a[52:55]
    v_mfma_f32_16x16x32_bf16 a[56:59], v[60:63], v[128:131], a[56:59]
    v_mfma_f32_16x16x32_bf16 a[60:63], v[60:63], v[132:135], a[60:63]
    s_waitcnt vmcnt(50) lgkmcnt(0)
    s_barrier
    v_mfma_f32_16x16x32_bf16 a[0:3], v[64:67], v[136:139], a[0:3]
    ds_read_b64_tr_b16 v[32:33], v14 offset:49152
    ds_read_b64_tr_b16 v[34:35], v14 offset:53248
    v_mfma_f32_16x16x32_bf16 a[4:7], v[64:67], v[140:143], a[4:7]
    ds_read_b64_tr_b16 v[36:37], v15 offset:49152
    ds_read_b64_tr_b16 v[38:39], v15 offset:53248
    v_mfma_f32_16x16x32_bf16 a[8:11], v[68:71], v[136:139], a[8:11]
    ds_read_b64_tr_b16 v[40:41], v16 offset:49152
    ds_read_b64_tr_b16 v[42:43], v16 offset:53248
    v_mfma_f32_16x16x32_bf16 a[12:15], v[68:71], v[140:143], a[12:15]
    ds_read_b64_tr_b16 v[44:45], v17 offset:49152
    ds_read_b64_tr_b16 v[46:47], v17 offset:53248
    v_mfma_f32_16x16x32_bf16 a[16:19], v[72:75], v[136:139], a[16:19]
    ds_read_b64_tr_b16 v[48:49], v18 offset:49152
    ds_read_b64_tr_b16 v[50:51], v18 offset:53248
    v_mfma_f32_16x16x32_bf16 a[20:23], v[72:75], v[140:143], a[20:23]
    ds_read_b64_tr_b16 v[52:53], v19 offset:49152
    ds_read_b64_tr_b16 v[54:55], v19 offset:53248
    v_mfma_f32_16x16x32_bf16 a[24:27], v[76:79], v[136:139], a[24:27]
    ds_read_b64_tr_b16 v[56:57], v20 offset:49152
    ds_read_b64_tr_b16 v[58:59], v20 offset:53248
    v_mfma_f32_16x16x32_bf16 a[28:31], v[76:79], v[140:143], a[28:31]
    ds_read_b64_tr_b16 v[60:61], v21 offset:49152
    ds_read_b64_tr_b16 v[62:63], v21 offset:53248
    v_mfma_f32_16x16x32_bf16 a[32:35], v[80:83], v[136:139], a[32:35]
    buffer_load_dwordx4 v[128:131], v12, s[8:11], s25 offen sc1
    buffer_load_dwordx4 v[132:135], v13, s[8:11], s25 offen sc1
    v_mfma_f32_16x16x32_bf16 a[36:39], v[80:83], v[140:143], a[36:39]
    s_add_u32 s25, s25, 1024
    s_add_u32 m0, s28, 32768
    v_mfma_f32_16x16x32_bf16 a[40:43], v[84:87], v[136:139], a[40:43]
    s_nop 0
    buffer_load_dwordx4 v8, s[12:15], s26 offen offset:0 lds
    v_mfma_f32_16x16x32_bf16 a[44:47], v[84:87], v[140:143], a[44:47]
    buffer_load_dwordx4 v9, s[12:15], s26 offen offset:1024 lds
    buffer_load_dwordx4 v10, s[12:15], s26 offen offset:2048 lds
    v_mfma_f32_16x16x32_bf16 a[48:51], v[88:91], v[136:139], a[48:51]
    buffer_load_dwordx4 v11, s[12:15], s26 offen offset:3072 lds
    s_add_u32 s26, s26, 131072
    v_mfma_f32_16x16x32_bf16 a[52:55], v[88:91], v[140:143], a[52:55]
    v_mfma_f32_16x16x32_bf16 a[56:59], v[92:95], v[136:139], a[56:59]
    v_mfma_f32_16x16x32_bf16 a[60:63], v[92:95], v[140:143], a[60:63]
    s_waitcnt vmcnt(56) lgkmcnt(0)
    v_mfma_f32_16x16x32_bf16 a[0:3], v[32:35], v[144:147], a[0:3]
    ds_read_b64_tr_b16 v[64:65], v14 offset:57344
    ds_read_b64_tr_b16 v[66:67], v14 offset:61440
    v_mfma_f32_16x16x32_bf16 a[4:7], v[32:35], v[148:151], a[4:7]
    ds_read_b64_tr_b16 v[68:69], v15 offset:57344
    ds_read_b64_tr_b16 v[70:71], v15 offset:61440
    v_mfma_f32_16x16x32_bf16 a[8:11], v[36:39], v[144:147], a[8:11]
    ds_read_b64_tr_b16 v[72:73], v16 offset:57344
    ds_read_b64_tr_b16 v[74:75], v16 offset:61440
    v_mfma_f32_16x16x32_bf16 a[12:15], v[36:39], v[148:151], a[12:15]
    ds_read_b64_tr_b16 v[76:77], v17 offset:57344
    ds_read_b64_tr_b16 v[78:79], v17 offset:61440
    v_mfma_f32_16x16x32_bf16 a[16:19], v[40:43], v[144:147], a[16:19]
    ds_read_b64_tr_b16 v[80:81], v18 offset:57344
    ds_read_b64_tr_b16 v[82:83], v18 offset:61440
    v_mfma_f32_16x16x32_bf16 a[20:23], v[40:43], v[148:151], a[20:23]
    ds_read_b64_tr_b16 v[84:85], v19 offset:57344
    ds_read_b64_tr_b16 v[86:87], v19 offset:61440
    v_mfma_f32_16x16x32_bf16 a[24:27], v[44:47], v[144:147], a[24:27]
    ds_read_b64_tr_b16 v[88:89], v20 offset:57344
    ds_read_b64_tr_b16 v[90:91], v20 offset:61440
    v_mfma_f32_16x16x32_bf16 a[28:31], v[44:47], v[148:151], a[28:31]
    ds_read_b64_tr_b16 v[92:93], v21 offset:57344
    ds_read_b64_tr_b16 v[94:95], v21 offset:61440
    v_mfma_f32_16x16x32_bf16 a[32:35], v[48:51], v[144:147], a[32:35]
    buffer_load_dwordx4 v[136:139], v12, s[8:11], s25 offen sc1
    buffer_load_dwordx4 v[140:143], v13, s[8:11], s25 offen sc1
    v_mfma_f32_16x16x32_bf16 a[36:39], v[48:51], v[148:151], a[36:39]
    s_add_u32 s25, s25, 1024
    v_mfma_f32_16x16x32_bf16 a[40:43], v[52:55], v[144:147], a[40:43]
    v_mfma_f32_16x16x32_bf16 a[44:47], v[52:55], v[148:151], a[44:47]
    v_mfma_f32_16x16x32_bf16 a[48:51], v[56:59], v[144:147], a[48:51]
    v_mfma_f32_16x16x32_bf16 a[52:55], v[56:59], v[148:151], a[52:55]
    v_mfma_f32_16x16x32_bf16 a[56:59], v[60:63], v[144:147], a[56:59]
    v_mfma_f32_16x16x32_bf16 a[60:63], v[60:63], v[148:151], a[60:63]
    s_waitcnt vmcnt(50) lgkmcnt(0)
    s_barrier
    v_mfma_f32_16x16x32_bf16 a[0:3], v[64:67], v[152:155], a[0:3]
    ds_read_b64_tr_b16 v[32:33], v22 offset:0
    ds_read_b64_tr_b16 v[34:35], v22 offset:4096
    v_mfma_f32_16x16x32_bf16 a[4:7], v[64:67], v[156:159], a[4:7]
    ds_read_b64_tr_b16 v[36:37], v23 offset:0
    ds_read_b64_tr_b16 v[38:39], v23 offset:4096
    v_mfma_f32_16x16x32_bf16 a[8:11], v[68:71], v[152:155], a[8:11]
    ds_read_b64_tr_b16 v[40:41], v24 offset:0
    ds_read_b64_tr_b16 v[42:43], v24 offset:4096
    v_mfma_f32_16x16x32_bf16 a[12:15], v[68:71], v[156:159], a[12:15]
    ds_read_b64_tr_b16 v[44:45], v25 offset:0
    ds_read_b64_tr_b16 v[46:47], v25 offset:4096
    v_mfma_f32_16x16x32_bf16 a[16:19], v[72:75], v[152:155], a[16:19]
    ds_read_b64_tr_b16 v[48:49], v26 offset:0
    ds_read_b64_tr_b16 v[50:51], v26 offset:4096
    v_mfma_f32_16x16x32_bf16 a[20:23], v[72:75], v[156:159], a[20:23]
    ds_read_b64_tr_b16 v[52:53], v27 offset:0
    ds_read_b64_tr_b16 v[54:55], v27 offset:4096
    v_mfma_f32_16x16x32_bf16 a[24:27], v[76:79], v[152:155], a[24:27]
    ds_read_b64_tr_b16 v[56:57], v28 offset:0
    ds_read_b64_tr_b16 v[58:59], v28 offset:4096
    v_mfma_f32_16x16x32_bf16 a[28:31], v[76:79], v[156:159], a[28:31]
    ds_read_b64_tr_b16 v[60:61], v29 offset:0
    ds_read_b64_tr_b16 v[62:63], v29 offset:4096
    v_mfma_f32_16x16x32_bf16 a[32:35], v[80:83], v[152:155], a[32:35]
    buffer_load_dwordx4 v[144:147], v12, s[8:11], s25 offen sc1
    buffer_load_dwordx4 v[148:151], v13, s[8:11], s25 offen sc1
    v_mfma_f32_16x16x32_bf16 a[36:39], v[80:83], v[156:159], a[36:39]
    s_add_u32 s25, s25, 1024
    s_add_u32 m0, s28, 49152
    v_mfma_f32_16x16x32_bf16 a[40:43], v[84:87], v[152:155], a[40:43]
    s_nop 0
    buffer_load_dwordx4 v8, s[12:15], s26 offen offset:0 lds
    v_mfma_f32_16x16x32_bf16 a[44:47], v[84:87], v[156:159], a[44:47]
    buffer_load_dwordx4 v9, s[12:15], s26 offen offset:1024 lds
    buffer_load_dwordx4 v10, s[12:15], s26 offen offset:2048 lds
    v_mfma_f32_16x16x32_bf16 a[48:51], v[88:91], v[152:155], a[48:51]
    buffer_load_dwordx4 v11, s[12:15], s26 offen offset:3072 lds
    s_add_u32 s26, s26, 131072
    v_mfma_f32_16x16x32_bf16 a[52:55], v[88:91], v[156:159], a[52:55]
    v_mfma_f32_16x16x32_bf16 a[56:59], v[92:95], v[152:155], a[56:59]
    v_mfma_f32_16x16x32_bf16 a[60:63], v[92:95], v[156:159], a[60:63]
    s_waitcnt vmcnt(56) lgkmcnt(0)
    v_mfma_f32_16x16x32_bf16 a[0:3], v[32:35], v[160:163], a[0:3]
    ds_read_b64_tr_b16 v[64:65], v22 offset:8192
    ds_read_b64_tr_b16 v[66:67], v22 offset:12288
    v_mfma_f32_16x16x32_bf16 a[4:7], v[32:35], v[164:167], a[4:7]
    ds_read_b64_tr_b16 v[68:69], v23 offset:8192
    ds_read_b64_tr_b16 v[70:71], v23 offset:12288
    v_mfma_f32_16x16x32_bf16 a[8:11], v[36:39], v[160:163], a[8:11]
    ds_read_b64_tr_b16 v[72:73], v24 offset:8192
    ds_read_b64_tr_b16 v[74:75], v24 offset:12288
    v_mfma_f32_16x16x32_bf16 a[12:15], v[36:39], v[164:167], a[12:15]
    ds_read_b64_tr_b16 v[76:77], v25 offset:8192
    ds_read_b64_tr_b16 v[78:79], v25 offset:12288
    v_mfma_f32_16x16x32_bf16 a[16:19], v[40:43], v[160:163], a[16:19]
    ds_read_b64_tr_b16 v[80:81], v26 offset:8192
    ds_read_b64_tr_b16 v[82:83], v26 offset:12288
    v_mfma_f32_16x16x32_bf16 a[20:23], v[40:43], v[164:167], a[20:23]
    ds_read_b64_tr_b16 v[84:85], v27 offset:8192
    ds_read_b64_tr_b16 v[86:87], v27 offset:12288
    v_mfma_f32_16x16x32_bf16 a[24:27], v[44:47], v[160:163], a[24:27]
    ds_read_b64_tr_b16 v[88:89], v28 offset:8192
    ds_read_b64_tr_b16 v[90:91], v28 offset:12288
    v_mfma_f32_16x16x32_bf16 a[28:31], v[44:47], v[164:167], a[28:31]
    ds_read_b64_tr_b16 v[92:93], v29 offset:8192
    ds_read_b64_tr_b16 v[94:95], v29 offset:12288
    v_mfma_f32_16x16x32_bf16 a[32:35], v[48:51], v[160:163], a[32:35]
    buffer_load_dwordx4 v[152:155], v12, s[8:11], s25 offen sc1
    buffer_load_dwordx4 v[156:159], v13, s[8:11], s25 offen sc1
    v_mfma_f32_16x16x32_bf16 a[36:39], v[48:51], v[164:167], a[36:39]
    s_add_u32 s25, s25, 1024
    v_mfma_f32_16x16x32_bf16 a[40:43], v[52:55], v[160:163], a[40:43]
    v_mfma_f32_16x16x32_bf16 a[44:47], v[52:55], v[164:167], a[44:47]
    v_mfma_f32_16x16x32_bf16 a[48:51], v[56:59], v[160:163], a[48:51]
    v_mfma_f32_16x16x32_bf16 a[52:55], v[56:59], v[164:167], a[52:55]
    v_mfma_f32_16x16x32_bf16 a[56:59], v[60:63], v[160:163], a[56:59]
    v_mfma_f32_16x16x32_bf16 a[60:63], v[60:63], v[164:167], a[60:63]
    s_waitcnt vmcnt(50) lgkmcnt(0)
    s_barrier
    v_mfma_f32_16x16x32_bf16 a[0:3], v[64:67], v[168:171], a[0:3]
    ds_read_b64_tr_b16 v[32:33], v22 offset:16384
    ds_read_b64_tr_b16 v[34:35], v22 offset:20480
    v_mfma_f32_16x16x32_bf16 a[4:7], v[64:67], v[172:175], a[4:7]
    ds_read_b64_tr_b16 v[36:37], v23 offset:16384
    ds_read_b64_tr_b16 v[38:39], v23 offset:20480
    v_mfma_f32_16x16x32_bf16 a[8:11], v[68:71], v[168:171], a[8:11]
    ds_read_b64_tr_b16 v[40:41], v24 offset:16384
    ds_read_b64_tr_b16 v[42:43], v24 offset:20480
    v_mfma_f32_16x16x32_bf16 a[12:15], v[68:71], v[172:175], a[12:15]
    ds_read_b64_tr_b16 v[44:45], v25 offset:16384
    ds_read_b64_tr_b16 v[46:47], v25 offset:20480
    v_mfma_f32_16x16x32_bf16 a[16:19], v[72:75], v[168:171], a[16:19]
    ds_read_b64_tr_b16 v[48:49], v26 offset:16384
    ds_read_b64_tr_b16 v[50:51], v26 offset:20480
    v_mfma_f32_16x16x32_bf16 a[20:23], v[72:75], v[172:175], a[20:23]
    ds_read_b64_tr_b16 v[52:53], v27 offset:16384
    ds_read_b64_tr_b16 v[54:55], v27 offset:20480
    v_mfma_f32_16x16x32_bf16 a[24:27], v[76:79], v[168:171], a[24:27]
    ds_read_b64_tr_b16 v[56:57], v28 offset:16384
    ds_read_b64_tr_b16 v[58:59], v28 offset:20480
    v_mfma_f32_16x16x32_bf16 a[28:31], v[76:79], v[172:175], a[28:31]
    ds_read_b64_tr_b16 v[60:61], v29 offset:16384
    ds_read_b64_tr_b16 v[62:63], v29 offset:20480
    v_mfma_f32_16x16x32_bf16 a[32:35], v[80:83], v[168:171], a[32:35]
    buffer_load_dwordx4 v[160:163], v12, s[8:11], s25 offen sc1
    buffer_load_dwordx4 v[164:167], v13, s[8:11], s25 offen sc1
    v_mfma_f32_16x16x32_bf16 a[36:39], v[80:83], v[172:175], a[36:39]
    s_add_u32 s25, s25, 1024
    s_add_u32 m0, s28, 65536
    v_mfma_f32_16x16x32_bf16 a[40:43], v[84:87], v[168:171], a[40:43]
    s_nop 0
    buffer_load_dwordx4 v8, s[12:15], s26 offen offset:0 lds
    v_mfma_f32_16x16x32_bf16 a[44:47], v[84:87], v[172:175], a[44:47]
    buffer_load_dwordx4 v9, s[12:15], s26 offen offset:1024 lds
    buffer_load_dwordx4 v10, s[12:15], s26 offen offset:2048 lds
    v_mfma_f32_16x16x32_bf16 a[48:51], v[88:91], v[168:171], a[48:51]
    buffer_load_dwordx4 v11, s[12:15], s26 offen offset:3072 lds
    s_add_u32 s26, s26, 131072
    v_mfma_f32_16x16x32_bf16 a[52:55], v[88:91], v[172:175], a[52:55]
    v_mfma_f32_16x16x32_bf16 a[56:59], v[92:95], v[168:171], a[56:59]
    v_mfma_f32_16x16x32_bf16 a[60:63], v[92:95], v[172:175], a[60:63]
    s_waitcnt vmcnt(56) lgkmcnt(0)
    v_mfma_f32_16x16x32_bf16 a[0:3], v[32:35], v[176:179], a[0:3]
    ds_read_b64_tr_b16 v[64:65], v22 offset:24576
    ds_read_b64_tr_b16 v[66:67], v22 offset:28672
    v_mfma_f32_16x16x32_bf16 a[4:7], v[32:35], v[180:183], a[4:7]
    ds_read_b64_tr_b16 v[68:69], v23 offset:24576
    ds_read_b64_tr_b16 v[70:71], v23 offset:28672
    v_mfma_f32_16x16x32_bf16 a[8:11], v[36:39], v[176:179], a[8:11]
    ds_read_b64_tr_b16 v[72:73], v24 offset:24576
    ds_read_b64_tr_b16 v[74:75], v24 offset:28672
    v_mfma_f32_16x16x32_bf16 a[12:15], v[36:39], v[180:183], a[12:15]
    ds_read_b64_tr_b16 v[76:77], v25 offset:24576
    ds_read_b64_tr_b16 v[78:79], v25 offset:28672
    v_mfma_f32_16x16x32_bf16 a[16:19], v[40:43], v[176:179], a[16:19]
    ds_read_b64_tr_b16 v[80:81], v26 offset:24576
    ds_read_b64_tr_b16 v[82:83], v26 offset:28672
    v_mfma_f32_16x16x32_bf16 a[20:23], v[40:43], v[180:183], a[20:23]
    ds_read_b64_tr_b16 v[84:85], v27 offset:24576
    ds_read_b64_tr_b16 v[86:87], v27 offset:28672
    v_mfma_f32_16x16x32_bf16 a[24:27], v[44:47], v[176:179], a[24:27]
    ds_read_b64_tr_b16 v[88:89], v28 offset:24576
    ds_read_b64_tr_b16 v[90:91], v28 offset:28672
    v_mfma_f32_16x16x32_bf16 a[28:31], v[44:47], v[180:183], a[28:31]
    ds_read_b64_tr_b16 v[92:93], v29 offset:24576
    ds_read_b64_tr_b16 v[94:95], v29 offset:28672
    v_mfma_f32_16x16x32_bf16 a[32:35], v[48:51], v[176:179], a[32:35]
    buffer_load_dwordx4 v[168:171], v12, s[8:11], s25 offen sc1
    buffer_load_dwordx4 v[172:175], v13, s[8:11], s25 offen sc1
    v_mfma_f32_16x16x32_bf16 a[36:39], v[48:51], v[180:183], a[36:39]
    s_add_u32 s25, s25, 1024
    v_mfma_f32_16x16x32_bf16 a[40:43], v[52:55], v[176:179], a[40:43]
    v_mfma_f32_16x16x32_bf16 a[44:47], v[52:55], v[180:183], a[44:47]
    v_mfma_f32_16x16x32_bf16 a[48:51], v[56:59], v[176:179], a[48:51]
    v_mfma_f32_16x16x32_bf16 a[52:55], v[56:59], v[180:183], a[52:55]
    v_mfma_f32_16x16x32_bf16 a[56:59], v[60:63], v[176:179], a[56:59]
    v_mfma_f32_16x16x32_bf16 a[60:63], v[60:63], v[180:183], a[60:63]
    s_waitcnt vmcnt(50) lgkmcnt(0)
    s_barrier
    v_mfma_f32_16x16x32_bf16 a[0:3], v[64:67], v[184:187], a[0:3]
    ds_read_b64_tr_b16 v[32:33], v22 offset:32768
    ds_read_b64_tr_b16 v[34:35], v22 offset:36864
    v_mfma_f32_16x16x32_bf16 a[4:7], v[64:67], v[188:191], a[4:7]
    ds_read_b64_tr_b16 v[36:37], v23 offset:32768
    ds_read_b64_tr_b16 v[38:39], v23 offset:36864
    v_mfma_f32_16x16x32_bf16 a[8:11], v[68:71], v[184:187], a[8:11]
    ds_read_b64_tr_b16 v[40:41], v24 offset:32768
    ds_read_b64_tr_b16 v[42:43], v24 offset:36864
    v_mfma_f32_16x16x32_bf16 a[12:15], v[68:71], v[188:191], a[12:15]
    ds_read_b64_tr_b16 v[44:45], v25 offset:32768
    ds_read_b64_tr_b16 v[46:47], v25 offset:36864
    v_mfma_f32_16x16x32_bf16 a[16:19], v[72:75], v[184:187], a[16:19]
    ds_read_b64_tr_b16 v[48:49], v26 offset:32768
    ds_read_b64_tr_b16 v[50:51], v26 offset:36864
    v_mfma_f32_16x16x32_bf16 a[20:23], v[72:75], v[188:191], a[20:23]
    ds_read_b64_tr_b16 v[52:53], v27 offset:32768
    ds_read_b64_tr_b16 v[54:55], v27 offset:36864
    v_mfma_f32_16x16x32_bf16 a[24:27], v[76:79], v[184:187], a[24:27]
    ds_read_b64_tr_b16 v[56:57], v28 offset:32768
    ds_read_b64_tr_b16 v[58:59], v28 offset:36864
    v_mfma_f32_16x16x32_bf16 a[28:31], v[76:79], v[188:191], a[28:31]
    ds_read_b64_tr_b16 v[60:61], v29 offset:32768
    ds_read_b64_tr_b16 v[62:63], v29 offset:36864
    v_mfma_f32_16x16x32_bf16 a[32:35], v[80:83], v[184:187], a[32:35]
    buffer_load_dwordx4 v[176:179], v12, s[8:11], s25 offen sc1
    buffer_load_dwordx4 v[180:183], v13, s[8:11], s25 offen sc1
    v_mfma_f32_16x16x32_bf16 a[36:39], v[80:83], v[188:191], a[36:39]
    s_add_u32 s25, s25, 1024
    s_add_u32 m0, s28, 81920
    v_mfma_f32_16x16x32_bf16 a[40:43], v[84:87], v[184:187], a[40:43]
    s_nop 0
    buffer_load_dwordx4 v8, s[12:15], s26 offen offset:0 lds
    v_mfma_f32_16x16x32_bf16 a[44:47], v[84:87], v[188:191], a[44:47]
    buffer_load_dwordx4 v9, s[12:15], s26 offen offset:1024 lds
    buffer_load_dwordx4 v10, s[12:15], s26 offen offset:2048 lds
    v_mfma_f32_16x16x32_bf16 a[48:51], v[88:91], v[184:187], a[48:51]
    buffer_load_dwordx4 v11, s[12:15], s26 offen offset:3072 lds
    s_add_u32 s26, s26, 131072
    v_mfma_f32_16x16x32_bf16 a[52:55], v[88:91], v[188:191], a[52:55]
    v_mfma_f32_16x16x32_bf16 a[56:59], v[92:95], v[184:187], a[56:59]
    v_mfma_f32_16x16x32_bf16 a[60:63], v[92:95], v[188:191], a[60:63]
    s_waitcnt vmcnt(56) lgkmcnt(0)
    v_mfma_f32_16x16x32_bf16 a[0:3], v[32:35], v[192:195], a[0:3]
    ds_read_b64_tr_b16 v[64:65], v22 offset:40960
    ds_read_b64_tr_b16 v[66:67], v22 offset:45056
    v_mfma_f32_16x16x32_bf16 a[4:7], v[32:35], v[196:199], a[4:7]
    ds_read_b64_tr_b16 v[68:69], v23 offset:40960
    ds_read_b64_tr_b16 v[70:71], v23 offset:45056
    v_mfma_f32_16x16x32_bf16 a[8:11], v[36:39], v[192:195], a[8:11]
    ds_read_b64_tr_b16 v[72:73], v24 offset:40960
    ds_read_b64_tr_b16 v[74:75], v24 offset:45056
    v_mfma_f32_16x16x32_bf16 a[12:15], v[36:39], v[196:199], a[12:15]
    ds_read_b64_tr_b16 v[76:77], v25 offset:40960
    ds_read_b64_tr_b16 v[78:79], v25 offset:45056
    v_mfma_f32_16x16x32_bf16 a[16:19], v[40:43], v[192:195], a[16:19]
    ds_read_b64_tr_b16 v[80:81], v26 offset:40960
    ds_read_b64_tr_b16 v[82:83], v26 offset:45056
    v_mfma_f32_16x16x32_bf16 a[20:23], v[40:43], v[196:199], a[20:23]
    ds_read_b64_tr_b16 v[84:85], v27 offset:40960
    ds_read_b64_tr_b16 v[86:87], v27 offset:45056
    v_mfma_f32_16x16x32_bf16 a[24:27], v[44:47], v[192:195], a[24:27]
    ds_read_b64_tr_b16 v[88:89], v28 offset:40960
    ds_read_b64_tr_b16 v[90:91], v28 offset:45056
    v_mfma_f32_16x16x32_bf16 a[28:31], v[44:47], v[196:199], a[28:31]
    ds_read_b64_tr_b16 v[92:93], v29 offset:40960
    ds_read_b64_tr_b16 v[94:95], v29 offset:45056
    v_mfma_f32_16x16x32_bf16 a[32:35], v[48:51], v[192:195], a[32:35]
    buffer_load_dwordx4 v[184:187], v12, s[8:11], s25 offen sc1
    buffer_load_dwordx4 v[188:191], v13, s[8:11], s25 offen sc1
    v_mfma_f32_16x16x32_bf16 a[36:39], v[48:51], v[196:199], a[36:39]
    s_add_u32 s25, s25, 1024
    v_mfma_f32_16x16x32_bf16 a[40:43], v[52:55], v[192:195], a[40:43]
    v_mfma_f32_16x16x32_bf16 a[44:47], v[52:55], v[196:199], a[44:47]
    v_mfma_f32_16x16x32_bf16 a[48:51], v[56:59], v[192:195], a[48:51]
    v_mfma_f32_16x16x32_bf16 a[52:55], v[56:59], v[196:199], a[52:55]
    v_mfma_f32_16x16x32_bf16 a[56:59], v[60:63], v[192:195], a[56:59]
    v_mfma_f32_16x16x32_bf16 a[60:63], v[60:63], v[196:199], a[60:63]
    s_waitcnt vmcnt(50) lgkmcnt(0)
    s_barrier
    v_mfma_f32_16x16x32_bf16 a[0:3], v[64:67], v[200:203], a[0:3]
    ds_read_b64_tr_b16 v[32:33], v22 offset:49152
    ds_read_b64_tr_b16 v[34:35], v22 offset:53248
    v_mfma_f32_16x16x32_bf16 a[4:7], v[64:67], v[204:207], a[4:7]
    ds_read_b64_tr_b16 v[36:37], v23 offset:49152
    ds_read_b64_tr_b16 v[38:39], v23 offset:53248
    v_mfma_f32_16x16x32_bf16 a[8:11], v[68:71], v[200:203], a[8:11]
    ds_read_b64_tr_b16 v[40:41], v24 offset:49152
    ds_read_b64_tr_b16 v[42:43], v24 offset:53248
    v_mfma_f32_16x16x32_bf16 a[12:15], v[68:71], v[204:207], a[12:15]
    ds_read_b64_tr_b16 v[44:45], v25 offset:49152
    ds_read_b64_tr_b16 v[46:47], v25 offset:53248
    v_mfma_f32_16x16x32_bf16 a[16:19], v[72:75], v[200:203], a[16:19]
    ds_read_b64_tr_b16 v[48:49], v26 offset:49152
    ds_read_b64_tr_b16 v[50:51], v26 offset:53248
    v_mfma_f32_16x16x32_bf16 a[20:23], v[72:75], v[204:207], a[20:23]
    ds_read_b64_tr_b16 v[52:53], v27 offset:49152
    ds_read_b64_tr_b16 v[54:55], v27 offset:53248
    v_mfma_f32_16x16x32_bf16 a[24:27], v[76:79], v[200:203], a[24:27]
    ds_read_b64_tr_b16 v[56:57], v28 offset:49152
    ds_read_b64_tr_b16 v[58:59], v28 offset:53248
    v_mfma_f32_16x16x32_bf16 a[28:31], v[76:79], v[204:207], a[28:31]
    ds_read_b64_tr_b16 v[60:61], v29 offset:49152
    ds_read_b64_tr_b16 v[62:63], v29 offset:53248
    v_mfma_f32_16x16x32_bf16 a[32:35], v[80:83], v[200:203], a[32:35]
    buffer_load_dwordx4 v[192:195], v12, s[8:11], s25 offen sc1
    buffer_load_dwordx4 v[196:199], v13, s[8:11], s25 offen sc1
    v_mfma_f32_16x16x32_bf16 a[36:39], v[80:83], v[204:207], a[36:39]
    s_add_u32 s25, s25, 1024
    s_add_u32 m0, s28, 98304
    v_mfma_f32_16x16x32_bf16 a[40:43], v[84:87], v[200:203], a[40:43]
    s_nop 0
    buffer_load_dwordx4 v8, s[12:15], s26 offen offset:0 lds
    v_mfma_f32_16x16x32_bf16 a[44:47], v[84:87], v[204:207], a[44:47]
    buffer_load_dwordx4 v9, s[12:15], s26 offen offset:1024 lds
    buffer_load_dwordx4 v10, s[12:15], s26 offen offset:2048 lds
    v_mfma_f32_16x16x32_bf16 a[48:51], v[88:91], v[200:203], a[48:51]
    buffer_load_dwordx4 v11, s[12:15], s26 offen offset:3072 lds
    s_add_u32 s26, s26, 131072
    v_mfma_f32_16x16x32_bf16 a[52:55], v[88:91], v[204:207], a[52:55]
    v_mfma_f32_16x16x32_bf16 a[56:59], v[92:95], v[200:203], a[56:59]
    v_mfma_f32_16x16x32_bf16 a[60:63], v[92:95], v[204:207], a[60:63]
    s_waitcnt vmcnt(56) lgkmcnt(0)
    v_mfma_f32_16x16x32_bf16 a[0:3], v[32:35], v[208:211], a[0:3]
    ds_read_b64_tr_b16 v[64:65], v22 offset:57344
    ds_read_b64_tr_b16 v[66:67], v22 offset:61440
    v_mfma_f32_16x16x32_bf16 a[4:7], v[32:35], v[212:215], a[4:7]
    ds_read_b64_tr_b16 v[68:69], v23 offset:57344
    ds_read_b64_tr_b16 v[70:71], v23 offset:61440
    v_mfma_f32_16x16x32_bf16 a[8:11], v[36:39], v[208:211], a[8:11]
    ds_read_b64_tr_b16 v[72:73], v24 offset:57344
    ds_read_b64_tr_b16 v[74:75], v24 offset:61440
    v_mfma_f32_16x16x32_bf16 a[12:15], v[36:39], v[212:215], a[12:15]
    ds_read_b64_tr_b16 v[76:77], v25 offset:57344
    ds_read_b64_tr_b16 v[78:79], v25 offset:61440
    v_mfma_f32_16x16x32_bf16 a[16:19], v[40:43], v[208:211], a[16:19]
    ds_read_b64_tr_b16 v[80:81], v26 offset:57344
    ds_read_b64_tr_b16 v[82:83], v26 offset:61440
    v_mfma_f32_16x16x32_bf16 a[20:23], v[40:43], v[212:215], a[20:23]
    ds_read_b64_tr_b16 v[84:85], v27 offset:57344
    ds_read_b64_tr_b16 v[86:87], v27 offset:61440
    v_mfma_f32_16x16x32_bf16 a[24:27], v[44:47], v[208:211], a[24:27]
    ds_read_b64_tr_b16 v[88:89], v28 offset:57344
    ds_read_b64_tr_b16 v[90:91], v28 offset:61440
    v_mfma_f32_16x16x32_bf16 a[28:31], v[44:47], v[212:215], a[28:31]
    ds_read_b64_tr_b16 v[92:93], v29 offset:57344
    ds_read_b64_tr_b16 v[94:95], v29 offset:61440
    v_mfma_f32_16x16x32_bf16 a[32:35], v[48:51], v[208:211], a[32:35]
    buffer_load_dwordx4 v[200:203], v12, s[8:11], s25 offen sc1
    buffer_load_dwordx4 v[204:207], v13, s[8:11], s25 offen sc1
    v_mfma_f32_16x16x32_bf16 a[36:39], v[48:51], v[212:215], a[36:39]
    s_add_u32 s25, s25, 1024
    v_mfma_f32_16x16x32_bf16 a[40:43], v[52:55], v[208:211], a[40:43]
    v_mfma_f32_16x16x32_bf16 a[44:47], v[52:55], v[212:215], a[44:47]
    v_mfma_f32_16x16x32_bf16 a[48:51], v[56:59], v[208:211], a[48:51]
    v_mfma_f32_16x16x32_bf16 a[52:55], v[56:59], v[212:215], a[52:55]
    v_mfma_f32_16x16x32_bf16 a[56:59], v[60:63], v[208:211], a[56:59]
    v_mfma_f32_16x16x32_bf16 a[60:63], v[60:63], v[212:215], a[60:63]
    s_waitcnt vmcnt(50) lgkmcnt(0)
    s_barrier
    v_mfma_f32_16x16x32_bf16 a[0:3], v[64:67], v[216:219], a[0:3]
    ds_read_b64_tr_b16 v[32:33], v14 offset:0
    ds_read_b64_tr_b16 v[34:35], v14 offset:4096
    v_mfma_f32_16x16x32_bf16 a[4:7], v[64:67], v[220:223], a[4:7]
    ds_read_b64_tr_b16 v[36:37], v15 offset:0
    ds_read_b64_tr_b16 v[38:39], v15 offset:4096
    v_mfma_f32_16x16x32_bf16 a[8:11], v[68:71], v[216:219], a[8:11]
    ds_read_b64_tr_b16 v[40:41], v16 offset:0
    ds_read_b64_tr_b16 v[42:43], v16 offset:4096
    v_mfma_f32_16x16x32_bf16 a[12:15], v[68:71], v[220:223], a[12:15]
    ds_read_b64_tr_b16 v[44:45], v17 offset:0
    ds_read_b64_tr_b16 v[46:47], v17 offset:4096
    v_mfma_f32_16x16x32_bf16 a[16:19], v[72:75], v[216:219], a[16:19]
    ds_read_b64_tr_b16 v[48:49], v18 offset:0
    ds_read_b64_tr_b16 v[50:51], v18 offset:4096
    v_mfma_f32_16x16x32_bf16 a[20:23], v[72:75], v[220:223], a[20:23]
    ds_read_b64_tr_b16 v[52:53], v19 offset:0
    ds_read_b64_tr_b16 v[54:55], v19 offset:4096
    v_mfma_f32_16x16x32_bf16 a[24:27], v[76:79], v[216:219], a[24:27]
    ds_read_b64_tr_b16 v[56:57], v20 offset:0
    ds_read_b64_tr_b16 v[58:59], v20 offset:4096
    v_mfma_f32_16x16x32_bf16 a[28:31], v[76:79], v[220:223], a[28:31]
    ds_read_b64_tr_b16 v[60:61], v21 offset:0
    ds_read_b64_tr_b16 v[62:63], v21 offset:4096
    v_mfma_f32_16x16x32_bf16 a[32:35], v[80:83], v[216:219], a[32:35]
    buffer_load_dwordx4 v[208:211], v12, s[8:11], s25 offen sc1
    buffer_load_dwordx4 v[212:215], v13, s[8:11], s25 offen sc1
    v_mfma_f32_16x16x32_bf16 a[36:39], v[80:83], v[220:223], a[36:39]
    s_add_u32 s25, s25, 1024
    s_add_u32 m0, s28, 114688
    v_mfma_f32_16x16x32_bf16 a[40:43], v[84:87], v[216:219], a[40:43]
    s_nop 0
    buffer_load_dwordx4 v8, s[12:15], s26 offen offset:0 lds
    v_mfma_f32_16x16x32_bf16 a[44:47], v[84:87], v[220:223], a[44:47]
    buffer_load_dwordx4 v9, s[12:15], s26 offen offset:1024 lds
    buffer_load_dwordx4 v10, s[12:15], s26 offen offset:2048 lds
    v_mfma_f32_16x16x32_bf16 a[48:51], v[88:91], v[216:219], a[48:51]
    buffer_load_dwordx4 v11, s[12:15], s26 offen offset:3072 lds
    s_add_u32 s26, s26, 131072
    v_mfma_f32_16x16x32_bf16 a[52:55], v[88:91], v[220:223], a[52:55]
    v_mfma_f32_16x16x32_bf16 a[56:59], v[92:95], v[216:219], a[56:59]
    v_mfma_f32_16x16x32_bf16 a[60:63], v[92:95], v[220:223], a[60:63]
    s_sub_u32 s27, s27, 1
    s_cmp_lg_u32 s27, 0
    s_cbranch_scc1 mega_kernel_w_g4_loop
mega_kernel_w_g4_done:
    s_nop 7
    v_lshlrev_b32 v5, 11, v2
    v_lshl_add_u32 v5, v3, 3, v5
    v_lshlrev_b32 v6, 4, v3
    s_lshl_b32 s36, s38, 9
    s_add_u32 s36, s36, 8192

    buffer_load_dwordx4 v[160:163], v6, s[8:11], s36 offen offset:0 sc1
    buffer_load_dwordx4 v[164:167], v6, s[8:11], s36 offen offset:64 sc1
    buffer_load_dwordx4 v[168:171], v6, s[8:11], s36 offen offset:128 sc1
    buffer_load_dwordx4 v[172:175], v6, s[8:11], s36 offen offset:192 sc1
    buffer_load_dwordx4 v[176:179], v6, s[8:11], s36 offen offset:256 sc1
    buffer_load_dwordx4 v[180:183], v6, s[8:11], s36 offen offset:320 sc1
    buffer_load_dwordx4 v[184:187], v6, s[8:11], s36 offen offset:384 sc1
    buffer_load_dwordx4 v[188:191], v6, s[8:11], s36 offen offset:448 sc1
    s_lshl_b32 s31, s55, 3
    s_lshl_b32 s37, s20, 1
    s_add_u32 s31, s31, s37
    s_lshl_b32 s37, s31, 15
    s_lshl_b32 s36, s38, 8
    s_add_u32 s37, s37, s36
    s_lshl_b32 s31, s31, 15
    s_lshl_b32 s36, s38, 12
    s_add_u32 s31, s31, s36
    s_add_u32 s31, s31, 82214912

    s_add_u32 s36, s37, 0
    buffer_load_dwordx2 v[96:97], v5, s[16:19], s36 offen offset:0
    buffer_load_dwordx2 v[98:99], v5, s[16:19], s36 offen offset:32
    buffer_load_dwordx2 v[100:101], v5, s[16:19], s36 offen offset:64
    buffer_load_dwordx2 v[102:103], v5, s[16:19], s36 offen offset:96
    buffer_load_dwordx2 v[104:105], v5, s[16:19], s36 offen offset:128
    buffer_load_dwordx2 v[106:107], v5, s[16:19], s36 offen offset:160
    buffer_load_dwordx2 v[108:109], v5, s[16:19], s36 offen offset:192
    buffer_load_dwordx2 v[110:111], v5, s[16:19], s36 offen offset:224
    s_add_u32 s36, s37, 32768
    buffer_load_dwordx2 v[112:113], v5, s[16:19], s36 offen offset:0
    buffer_load_dwordx2 v[114:115], v5, s[16:19], s36 offen offset:32
    buffer_load_dwordx2 v[116:117], v5, s[16:19], s36 offen offset:64
    buffer_load_dwordx2 v[118:119], v5, s[16:19], s36 offen offset:96
    buffer_load_dwordx2 v[120:121], v5, s[16:19], s36 offen offset:128
    buffer_load_dwordx2 v[122:123], v5, s[16:19], s36 offen offset:160
    buffer_load_dwordx2 v[124:125], v5, s[16:19], s36 offen offset:192
    buffer_load_dwordx2 v[126:127], v5, s[16:19], s36 offen offset:224
    s_waitcnt vmcnt(0)
    s_add_u32 s36, s31, 0
    v_accvgpr_read_b32 v32, a0
    v_accvgpr_read_b32 v33, a1
    v_accvgpr_read_b32 v34, a2
    v_accvgpr_read_b32 v35, a3
    v_accvgpr_read_b32 v36, a8
    v_accvgpr_read_b32 v37, a9
    v_accvgpr_read_b32 v38, a10
    v_accvgpr_read_b32 v39, a11
    v_lshlrev_b32 v7, 16, v96
    v_fma_f32 v32, v32, v160, v7
    v_and_b32 v7, 0xffff0000, v96
    v_fma_f32 v33, v33, v161, v7
    v_lshlrev_b32 v7, 16, v97
    v_fma_f32 v34, v34, v162, v7
    v_and_b32 v7, 0xffff0000, v97
    v_fma_f32 v35, v35, v163, v7
    v_lshlrev_b32 v7, 16, v98
    v_fma_f32 v36, v36, v164, v7
    v_and_b32 v7, 0xffff0000, v98
    v_fma_f32 v37, v37, v165, v7
    v_lshlrev_b32 v7, 16, v99
    v_fma_f32 v38, v38, v166, v7
    v_and_b32 v7, 0xffff0000, v99
    v_fma_f32 v39, v39, v167, v7
    v_cvt_pk_bf16_f32 v32, v32, v33
    v_cvt_pk_bf16_f32 v33, v34, v35
    v_cvt_pk_bf16_f32 v34, v36, v37
    v_cvt_pk_bf16_f32 v35, v38, v39
    buffer_store_dwordx4 v[32:35], v4, s[8:11], s36 offen offset:0 sc1
    v_accvgpr_read_b32 v40, a16
    v_accvgpr_read_b32 v41, a17
    v_accvgpr_read_b32 v42, a18
    v_accvgpr_read_b32 v43, a19
    v_accvgpr_read_b32 v44, a24
    v_accvgpr_read_b32 v45, a25
    v_accvgpr_read_b32 v46, a26
    v_accvgpr_read_b32 v47, a27
    v_lshlrev_b32 v7, 16, v100
    v_fma_f32 v40, v40, v168, v7
    v_and_b32 v7, 0xffff0000, v100
    v_fma_f32 v41, v41, v169, v7
    v_lshlrev_b32 v7, 16, v101
    v_fma_f32 v42, v42, v170, v7
    v_and_b32 v7, 0xffff0000, v101
    v_fma_f32 v43, v43, v171, v7
    v_lshlrev_b32 v7, 16, v102
    v_fma_f32 v44, v44, v172, v7
    v_and_b32 v7, 0xffff0000, v102
    v_fma_f32 v45, v45, v173, v7
    v_lshlrev_b32 v7, 16, v103
    v_fma_f32 v46, v46, v174, v7
    v_and_b32 v7, 0xffff0000, v103
    v_fma_f32 v47, v47, v175, v7
    v_cvt_pk_bf16_f32 v40, v40, v41
    v_cvt_pk_bf16_f32 v41, v42, v43
    v_cvt_pk_bf16_f32 v42, v44, v45
    v_cvt_pk_bf16_f32 v43, v46, v47
    buffer_store_dwordx4 v[40:43], v4, s[8:11], s36 offen offset:1024 sc1
    v_accvgpr_read_b32 v48, a32
    v_accvgpr_read_b32 v49, a33
    v_accvgpr_read_b32 v50, a34
    v_accvgpr_read_b32 v51, a35
    v_accvgpr_read_b32 v52, a40
    v_accvgpr_read_b32 v53, a41
    v_accvgpr_read_b32 v54, a42
    v_accvgpr_read_b32 v55, a43
    v_lshlrev_b32 v7, 16, v104
    v_fma_f32 v48, v48, v176, v7
    v_and_b32 v7, 0xffff0000, v104
    v_fma_f32 v49, v49, v177, v7
    v_lshlrev_b32 v7, 16, v105
    v_fma_f32 v50, v50, v178, v7
    v_and_b32 v7, 0xffff0000, v105
    v_fma_f32 v51, v51, v179, v7
    v_lshlrev_b32 v7, 16, v106
    v_fma_f32 v52, v52, v180, v7
    v_and_b32 v7, 0xffff0000, v106
    v_fma_f32 v53, v53, v181, v7
    v_lshlrev_b32 v7, 16, v107
    v_fma_f32 v54, v54, v182, v7
    v_and_b32 v7, 0xffff0000, v107
    v_fma_f32 v55, v55, v183, v7
    v_cvt_pk_bf16_f32 v48, v48, v49
    v_cvt_pk_bf16_f32 v49, v50, v51
    v_cvt_pk_bf16_f32 v50, v52, v53
    v_cvt_pk_bf16_f32 v51, v54, v55
    buffer_store_dwordx4 v[48:51], v4, s[8:11], s36 offen offset:2048 sc1
    v_accvgpr_read_b32 v56, a48
    v_accvgpr_read_b32 v57, a49
    v_accvgpr_read_b32 v58, a50
    v_accvgpr_read_b32 v59, a51
    v_accvgpr_read_b32 v60, a56
    v_accvgpr_read_b32 v61, a57
    v_accvgpr_read_b32 v62, a58
    v_accvgpr_read_b32 v63, a59
    v_lshlrev_b32 v7, 16, v108
    v_fma_f32 v56, v56, v184, v7
    v_and_b32 v7, 0xffff0000, v108
    v_fma_f32 v57, v57, v185, v7
    v_lshlrev_b32 v7, 16, v109
    v_fma_f32 v58, v58, v186, v7
    v_and_b32 v7, 0xffff0000, v109
    v_fma_f32 v59, v59, v187, v7
    v_lshlrev_b32 v7, 16, v110
    v_fma_f32 v60, v60, v188, v7
    v_and_b32 v7, 0xffff0000, v110
    v_fma_f32 v61, v61, v189, v7
    v_lshlrev_b32 v7, 16, v111
    v_fma_f32 v62, v62, v190, v7
    v_and_b32 v7, 0xffff0000, v111
    v_fma_f32 v63, v63, v191, v7
    v_cvt_pk_bf16_f32 v56, v56, v57
    v_cvt_pk_bf16_f32 v57, v58, v59
    v_cvt_pk_bf16_f32 v58, v60, v61
    v_cvt_pk_bf16_f32 v59, v62, v63
    buffer_store_dwordx4 v[56:59], v4, s[8:11], s36 offen offset:3072 sc1
    s_add_u32 s36, s31, 32768
    v_accvgpr_read_b32 v32, a4
    v_accvgpr_read_b32 v33, a5
    v_accvgpr_read_b32 v34, a6
    v_accvgpr_read_b32 v35, a7
    v_accvgpr_read_b32 v36, a12
    v_accvgpr_read_b32 v37, a13
    v_accvgpr_read_b32 v38, a14
    v_accvgpr_read_b32 v39, a15
    v_lshlrev_b32 v7, 16, v112
    v_fma_f32 v32, v32, v160, v7
    v_and_b32 v7, 0xffff0000, v112
    v_fma_f32 v33, v33, v161, v7
    v_lshlrev_b32 v7, 16, v113
    v_fma_f32 v34, v34, v162, v7
    v_and_b32 v7, 0xffff0000, v113
    v_fma_f32 v35, v35, v163, v7
    v_lshlrev_b32 v7, 16, v114
    v_fma_f32 v36, v36, v164, v7
    v_and_b32 v7, 0xffff0000, v114
    v_fma_f32 v37, v37, v165, v7
    v_lshlrev_b32 v7, 16, v115
    v_fma_f32 v38, v38, v166, v7
    v_and_b32 v7, 0xffff0000, v115
    v_fma_f32 v39, v39, v167, v7
    v_cvt_pk_bf16_f32 v32, v32, v33
    v_cvt_pk_bf16_f32 v33, v34, v35
    v_cvt_pk_bf16_f32 v34, v36, v37
    v_cvt_pk_bf16_f32 v35, v38, v39
    buffer_store_dwordx4 v[32:35], v4, s[8:11], s36 offen offset:0 sc1
    v_accvgpr_read_b32 v40, a20
    v_accvgpr_read_b32 v41, a21
    v_accvgpr_read_b32 v42, a22
    v_accvgpr_read_b32 v43, a23
    v_accvgpr_read_b32 v44, a28
    v_accvgpr_read_b32 v45, a29
    v_accvgpr_read_b32 v46, a30
    v_accvgpr_read_b32 v47, a31
    v_lshlrev_b32 v7, 16, v116
    v_fma_f32 v40, v40, v168, v7
    v_and_b32 v7, 0xffff0000, v116
    v_fma_f32 v41, v41, v169, v7
    v_lshlrev_b32 v7, 16, v117
    v_fma_f32 v42, v42, v170, v7
    v_and_b32 v7, 0xffff0000, v117
    v_fma_f32 v43, v43, v171, v7
    v_lshlrev_b32 v7, 16, v118
    v_fma_f32 v44, v44, v172, v7
    v_and_b32 v7, 0xffff0000, v118
    v_fma_f32 v45, v45, v173, v7
    v_lshlrev_b32 v7, 16, v119
    v_fma_f32 v46, v46, v174, v7
    v_and_b32 v7, 0xffff0000, v119
    v_fma_f32 v47, v47, v175, v7
    v_cvt_pk_bf16_f32 v40, v40, v41
    v_cvt_pk_bf16_f32 v41, v42, v43
    v_cvt_pk_bf16_f32 v42, v44, v45
    v_cvt_pk_bf16_f32 v43, v46, v47
    buffer_store_dwordx4 v[40:43], v4, s[8:11], s36 offen offset:1024 sc1
    v_accvgpr_read_b32 v48, a36
    v_accvgpr_read_b32 v49, a37
    v_accvgpr_read_b32 v50, a38
    v_accvgpr_read_b32 v51, a39
    v_accvgpr_read_b32 v52, a44
    v_accvgpr_read_b32 v53, a45
    v_accvgpr_read_b32 v54, a46
    v_accvgpr_read_b32 v55, a47
    v_lshlrev_b32 v7, 16, v120
    v_fma_f32 v48, v48, v176, v7
    v_and_b32 v7, 0xffff0000, v120
    v_fma_f32 v49, v49, v177, v7
    v_lshlrev_b32 v7, 16, v121
    v_fma_f32 v50, v50, v178, v7
    v_and_b32 v7, 0xffff0000, v121
    v_fma_f32 v51, v51, v179, v7
    v_lshlrev_b32 v7, 16, v122
    v_fma_f32 v52, v52, v180, v7
    v_and_b32 v7, 0xffff0000, v122
    v_fma_f32 v53, v53, v181, v7
    v_lshlrev_b32 v7, 16, v123
    v_fma_f32 v54, v54, v182, v7
    v_and_b32 v7, 0xffff0000, v123
    v_fma_f32 v55, v55, v183, v7
    v_cvt_pk_bf16_f32 v48, v48, v49
    v_cvt_pk_bf16_f32 v49, v50, v51
    v_cvt_pk_bf16_f32 v50, v52, v53
    v_cvt_pk_bf16_f32 v51, v54, v55
    buffer_store_dwordx4 v[48:51], v4, s[8:11], s36 offen offset:2048 sc1
    v_accvgpr_read_b32 v56, a52
    v_accvgpr_read_b32 v57, a53
    v_accvgpr_read_b32 v58, a54
    v_accvgpr_read_b32 v59, a55
    v_accvgpr_read_b32 v60, a60
    v_accvgpr_read_b32 v61, a61
    v_accvgpr_read_b32 v62, a62
    v_accvgpr_read_b32 v63, a63
    v_lshlrev_b32 v7, 16, v124
    v_fma_f32 v56, v56, v184, v7
    v_and_b32 v7, 0xffff0000, v124
    v_fma_f32 v57, v57, v185, v7
    v_lshlrev_b32 v7, 16, v125
    v_fma_f32 v58, v58, v186, v7
    v_and_b32 v7, 0xffff0000, v125
    v_fma_f32 v59, v59, v187, v7
    v_lshlrev_b32 v7, 16, v126
    v_fma_f32 v60, v60, v188, v7
    v_and_b32 v7, 0xffff0000, v126
    v_fma_f32 v61, v61, v189, v7
    v_lshlrev_b32 v7, 16, v127
    v_fma_f32 v62, v62, v190, v7
    v_and_b32 v7, 0xffff0000, v127
    v_fma_f32 v63, v63, v191, v7
    v_cvt_pk_bf16_f32 v56, v56, v57
    v_cvt_pk_bf16_f32 v57, v58, v59
    v_cvt_pk_bf16_f32 v58, v60, v61
    v_cvt_pk_bf16_f32 v59, v62, v63
    buffer_store_dwordx4 v[56:59], v4, s[8:11], s36 offen offset:3072 sc1
    s_lshl_b32 s41, s55, 7
    s_add_u32 s41, s41, 123008
    s_branch mega_kernel_w_next

mega_kernel_w_ln:
    s_lshl_b32 s55, s55, 3
    s_add_u32 s55, s55, s38

    v_lshlrev_b32 v7, 4, v3
    s_lshl_b32 s30, s20, 10
    s_add_u32 s36, s30, 12288
    s_add_u32 s37, s30, 16384

    buffer_load_dwordx4 v[128:131], v7, s[8:11], s37 offen offset:0 sc1
    buffer_load_dwordx4 v[132:135], v7, s[8:11], s37 offen offset:64 sc1
    buffer_load_dwordx4 v[136:139], v7, s[8:11], s36 offen offset:0 sc1
    buffer_load_dwordx4 v[140:143], v7, s[8:11], s36 offen offset:64 sc1
    buffer_load_dwordx4 v[144:147], v7, s[8:11], s37 offen offset:128 sc1
    buffer_load_dwordx4 v[148:151], v7, s[8:11], s37 offen offset:192 sc1
    buffer_load_dwordx4 v[152:155], v7, s[8:11], s36 offen offset:128 sc1
    buffer_load_dwordx4 v[156:159], v7, s[8:11], s36 offen offset:192 sc1
    buffer_load_dwordx4 v[160:163], v7, s[8:11], s37 offen offset:256 sc1
    buffer_load_dwordx4 v[164:167], v7, s[8:11], s37 offen offset:320 sc1
    buffer_load_dwordx4 v[168:171], v7, s[8:11], s36 offen offset:256 sc1
    buffer_load_dwordx4 v[172:175], v7, s[8:11], s36 offen offset:320 sc1
    buffer_load_dwordx4 v[176:179], v7, s[8:11], s37 offen offset:384 sc1
    buffer_load_dwordx4 v[180:183], v7, s[8:11], s37 offen offset:448 sc1
    buffer_load_dwordx4 v[184:187], v7, s[8:11], s36 offen offset:384 sc1
    buffer_load_dwordx4 v[188:191], v7, s[8:11], s36 offen offset:448 sc1
    buffer_load_dwordx4 v[192:195], v7, s[8:11], s37 offen offset:512 sc1
    buffer_load_dwordx4 v[196:199], v7, s[8:11], s37 offen offset:576 sc1
    buffer_load_dwordx4 v[200:203], v7, s[8:11], s36 offen offset:512 sc1
    buffer_load_dwordx4 v[204:207], v7, s[8:11], s36 offen offset:576 sc1
    buffer_load_dwordx4 v[208:211], v7, s[8:11], s37 offen offset:640 sc1
    buffer_load_dwordx4 v[212:215], v7, s[8:11], s37 offen offset:704 sc1
    buffer_load_dwordx4 v[216:219], v7, s[8:11], s36 offen offset:640 sc1
    buffer_load_dwordx4 v[220:223], v7, s[8:11], s36 offen offset:704 sc1
    buffer_load_dwordx4 v[224:227], v7, s[8:11], s37 offen offset:768 sc1
    buffer_load_dwordx4 v[228:231], v7, s[8:11], s37 offen offset:832 sc1
    buffer_load_dwordx4 v[232:235], v7, s[8:11], s36 offen offset:768 sc1
    buffer_load_dwordx4 v[236:239], v7, s[8:11], s36 offen offset:832 sc1
    buffer_load_dwordx4 v[240:243], v7, s[8:11], s37 offen offset:896 sc1
    buffer_load_dwordx4 v[244:247], v7, s[8:11], s37 offen offset:960 sc1
    buffer_load_dwordx4 v[248:251], v7, s[8:11], s36 offen offset:896 sc1
    buffer_load_dwordx4 v[252:255], v7, s[8:11], s36 offen offset:960 sc1
    s_lshr_b32 s30, s55, 2
    s_lshl_b32 s30, s30, 7
    s_add_u32 s30, s30, 123008
    s_cmp_ge_u32 s55, 56
    s_cselect_b32 s34, 64, 8

    s_cmp_lg_u32 s20, 0
    s_cbranch_scc1 mega_kernel_w_wx_ok
    v_mov_b32 v30, 0
mega_kernel_w_wx:
    buffer_load_dword v31, v30, s[8:11], s30 offen sc1
    s_waitcnt vmcnt(0)
    v_readfirstlane_b32 s31, v31
    s_cmp_ge_u32 s31, s34
    s_cbranch_scc1 mega_kernel_w_wx_ok
    s_sub_u32 s40, s40, 1
    s_cbranch_scc1 mega_kernel_w_exit
    s_sleep 12
    s_branch mega_kernel_w_wx
mega_kernel_w_wx_ok:
    s_barrier

    s_lshl_b32 s30, s55, 16
    s_lshl_b32 s31, s20, 13
    s_add_u32 s30, s30, s31
    s_add_u32 s30, s30, 82214912
    s_add_u32 s31, s30, 4096

    buffer_load_dwordx4 v[96:99], v4, s[8:11], s30 offen offset:0 sc1
    buffer_load_dwordx4 v[100:103], v4, s[8:11], s30 offen offset:1024 sc1
    buffer_load_dwordx4 v[104:107], v4, s[8:11], s30 offen offset:2048 sc1
    buffer_load_dwordx4 v[108:111], v4, s[8:11], s30 offen offset:3072 sc1
    buffer_load_dwordx4 v[112:115], v4, s[8:11], s31 offen offset:0 sc1
    buffer_load_dwordx4 v[116:119], v4, s[8:11], s31 offen offset:1024 sc1
    buffer_load_dwordx4 v[120:123], v4, s[8:11], s31 offen offset:2048 sc1
    buffer_load_dwordx4 v[124:127], v4, s[8:11], s31 offen offset:3072 sc1
    s_add_u32 s30, s30, 32768
    s_add_u32 s31, s31, 32768
    buffer_load_dwordx4 a[0:3], v4, s[8:11], s30 offen offset:0 sc1
    buffer_load_dwordx4 a[4:7], v4, s[8:11], s30 offen offset:1024 sc1
    buffer_load_dwordx4 a[8:11], v4, s[8:11], s30 offen offset:2048 sc1
    buffer_load_dwordx4 a[12:15], v4, s[8:11], s30 offen offset:3072 sc1
    buffer_load_dwordx4 a[16:19], v4, s[8:11], s31 offen offset:0 sc1
    buffer_load_dwordx4 a[20:23], v4, s[8:11], s31 offen offset:1024 sc1
    buffer_load_dwordx4 a[24:27], v4, s[8:11], s31 offen offset:2048 sc1
    buffer_load_dwordx4 a[28:31], v4, s[8:11], s31 offen offset:3072 sc1
    s_mov_b32 s60, 0
    s_waitcnt vmcnt(8)
    s_branch mega_kernel_w_ln_tl
mega_kernel_w_ln_t2:
    s_waitcnt vmcnt(0)
    v_accvgpr_read_b32 v96, a0
    v_accvgpr_read_b32 v97, a1
    v_accvgpr_read_b32 v98, a2
    v_accvgpr_read_b32 v99, a3
    v_accvgpr_read_b32 v100, a4
    v_accvgpr_read_b32 v101, a5
    v_accvgpr_read_b32 v102, a6
    v_accvgpr_read_b32 v103, a7
    v_accvgpr_read_b32 v104, a8
    v_accvgpr_read_b32 v105, a9
    v_accvgpr_read_b32 v106, a10
    v_accvgpr_read_b32 v107, a11
    v_accvgpr_read_b32 v108, a12
    v_accvgpr_read_b32 v109, a13
    v_accvgpr_read_b32 v110, a14
    v_accvgpr_read_b32 v111, a15
    v_accvgpr_read_b32 v112, a16
    v_accvgpr_read_b32 v113, a17
    v_accvgpr_read_b32 v114, a18
    v_accvgpr_read_b32 v115, a19
    v_accvgpr_read_b32 v116, a20
    v_accvgpr_read_b32 v117, a21
    v_accvgpr_read_b32 v118, a22
    v_accvgpr_read_b32 v119, a23
    v_accvgpr_read_b32 v120, a24
    v_accvgpr_read_b32 v121, a25
    v_accvgpr_read_b32 v122, a26
    v_accvgpr_read_b32 v123, a27
    v_accvgpr_read_b32 v124, a28
    v_accvgpr_read_b32 v125, a29
    v_accvgpr_read_b32 v126, a30
    v_accvgpr_read_b32 v127, a31
mega_kernel_w_ln_tl:
    v_lshlrev_b32 v32, 16, v96
    v_and_b32 v33, 0xffff0000, v96
    v_lshlrev_b32 v34, 16, v97
    v_and_b32 v35, 0xffff0000, v97
    v_lshlrev_b32 v36, 16, v98
    v_and_b32 v37, 0xffff0000, v98
    v_lshlrev_b32 v38, 16, v99
    v_and_b32 v39, 0xffff0000, v99
    v_lshlrev_b32 v40, 16, v100
    v_and_b32 v41, 0xffff0000, v100
    v_lshlrev_b32 v42, 16, v101
    v_and_b32 v43, 0xffff0000, v101
    v_lshlrev_b32 v44, 16, v102
    v_and_b32 v45, 0xffff0000, v102
    v_lshlrev_b32 v46, 16, v103
    v_and_b32 v47, 0xffff0000, v103
    v_lshlrev_b32 v48, 16, v104
    v_and_b32 v49, 0xffff0000, v104
    v_lshlrev_b32 v50, 16, v105
    v_and_b32 v51, 0xffff0000, v105
    v_lshlrev_b32 v52, 16, v106
    v_and_b32 v53, 0xffff0000, v106
    v_lshlrev_b32 v54, 16, v107
    v_and_b32 v55, 0xffff0000, v107
    v_lshlrev_b32 v56, 16, v108
    v_and_b32 v57, 0xffff0000, v108
    v_lshlrev_b32 v58, 16, v109
    v_and_b32 v59, 0xffff0000, v109
    v_lshlrev_b32 v60, 16, v110
    v_and_b32 v61, 0xffff0000, v110
    v_lshlrev_b32 v62, 16, v111
    v_and_b32 v63, 0xffff0000, v111
    v_lshlrev_b32 v64, 16, v112
    v_and_b32 v65, 0xffff0000, v112
    v_lshlrev_b32 v66, 16, v113
    v_and_b32 v67, 0xffff0000, v113
    v_lshlrev_b32 v68, 16, v114
    v_and_b32 v69, 0xffff0000, v114
    v_lshlrev_b32 v70, 16, v115
    v_and_b32 v71, 0xffff0000, v115
    v_lshlrev_b32 v72, 16, v116
    v_and_b32 v73, 0xffff0000, v116
    v_lshlrev_b32 v74, 16, v117
    v_and_b32 v75, 0xffff0000, v117
    v_lshlrev_b32 v76, 16, v118
    v_and_b32 v77, 0xffff0000, v118
    v_lshlrev_b32 v78, 16, v119
    v_and_b32 v79, 0xffff0000, v119
    v_lshlrev_b32 v80, 16, v120
    v_and_b32 v81, 0xffff0000, v120
    v_lshlrev_b32 v82, 16, v121
    v_and_b32 v83, 0xffff0000, v121
    v_lshlrev_b32 v84, 16, v122
    v_and_b32 v85, 0xffff0000, v122
    v_lshlrev_b32 v86, 16, v123
    v_and_b32 v87, 0xffff0000, v123
    v_lshlrev_b32 v88, 16, v124
    v_and_b32 v89, 0xffff0000, v124
    v_lshlrev_b32 v90, 16, v125
    v_and_b32 v91, 0xffff0000, v125
    v_lshlrev_b32 v92, 16, v126
    v_and_b32 v93, 0xffff0000, v126
    v_lshlrev_b32 v94, 16, v127
    v_and_b32 v95, 0xffff0000, v127
    v_add_f32 v8, v32, v33
    v_add_f32 v16, v34, v35
    v_add_f32 v17, v36, v37
    v_add_f32 v18, v38, v39
    v_add_f32 v8, v8, v40
    v_add_f32 v16, v16, v41
    v_add_f32 v17, v17, v42
    v_add_f32 v18, v18, v43
    v_add_f32 v8, v8, v44
    v_add_f32 v16, v16, v45
    v_add_f32 v17, v17, v46
    v_add_f32 v18, v18, v47
    v_add_f32 v8, v8, v48
    v_add_f32 v16, v16, v49
    v_add_f32 v17, v17, v50
    v_add_f32 v18, v18, v51
    v_add_f32 v8, v8, v52
    v_add_f32 v16, v16, v53
    v_add_f32 v17, v17, v54
    v_add_f32 v18, v18, v55
    v_add_f32 v8, v8, v56
    v_add_f32 v16, v16, v57
    v_add_f32 v17, v17, v58
    v_add_f32 v18, v18, v59
    v_add_f32 v8, v8, v60
    v_add_f32 v16, v16, v61
    v_add_f32 v17, v17, v62
    v_add_f32 v18, v18, v63
    v_add_f32 v8, v8, v64
    v_add_f32 v16, v16, v65
    v_add_f32 v17, v17, v66
    v_add_f32 v18, v18, v67
    v_add_f32 v8, v8, v68
    v_add_f32 v16, v16, v69
    v_add_f32 v17, v17, v70
    v_add_f32 v18, v18, v71
    v_add_f32 v8, v8, v72
    v_add_f32 v16, v16, v73
    v_add_f32 v17, v17, v74
    v_add_f32 v18, v18, v75
    v_add_f32 v8, v8, v76
    v_add_f32 v16, v16, v77
    v_add_f32 v17, v17, v78
    v_add_f32 v18, v18, v79
    v_add_f32 v8, v8, v80
    v_add_f32 v16, v16, v81
    v_add_f32 v17, v17, v82
    v_add_f32 v18, v18, v83
    v_add_f32 v8, v8, v84
    v_add_f32 v16, v16, v85
    v_add_f32 v17, v17, v86
    v_add_f32 v18, v18, v87
    v_add_f32 v8, v8, v88
    v_add_f32 v16, v16, v89
    v_add_f32 v17, v17, v90
    v_add_f32 v18, v18, v91
    v_add_f32 v8, v8, v92
    v_add_f32 v16, v16, v93
    v_add_f32 v17, v17, v94
    v_add_f32 v18, v18, v95
    v_add_f32 v8, v8, v16
    v_add_f32 v17, v17, v18
    v_add_f32 v8, v8, v17
    v_mov_b32 v9, v8
    s_nop 1
    v_permlane16_swap_b32 v8, v9
    s_nop 1
    v_add_f32 v8, v8, v9
    v_mov_b32 v9, v8
    s_nop 1
    v_permlane32_swap_b32 v8, v9
    s_nop 1
    v_add_f32 v8, v8, v9
    v_lshlrev_b32 v10, 2, v2
    v_add_u32 v10, 66816, v10
    s_lshl_b32 s30, s20, 6
    v_add_u32 v11, s30, v10
    ds_write_b32 v11, v8 offset:0
    s_waitcnt lgkmcnt(0)
    s_barrier
    ds_read_b32 v12, v10 offset:0
    ds_read_b32 v13, v10 offset:64
    ds_read_b32 v14, v10 offset:128
    ds_read_b32 v15, v10 offset:192
    s_waitcnt lgkmcnt(0)
    v_add_f32 v12, v12, v13
    v_add_f32 v14, v14, v15
    v_add_f32 v8, v12, v14

    v_mul_f32 v16, 0x3a800000, v8
    v_sub_f32 v32, v32, v16
    v_sub_f32 v33, v33, v16
    v_sub_f32 v34, v34, v16
    v_sub_f32 v35, v35, v16
    v_sub_f32 v36, v36, v16
    v_sub_f32 v37, v37, v16
    v_sub_f32 v38, v38, v16
    v_sub_f32 v39, v39, v16
    v_sub_f32 v40, v40, v16
    v_sub_f32 v41, v41, v16
    v_sub_f32 v42, v42, v16
    v_sub_f32 v43, v43, v16
    v_sub_f32 v44, v44, v16
    v_sub_f32 v45, v45, v16
    v_sub_f32 v46, v46, v16
    v_sub_f32 v47, v47, v16
    v_sub_f32 v48, v48, v16
    v_sub_f32 v49, v49, v16
    v_sub_f32 v50, v50, v16
    v_sub_f32 v51, v51, v16
    v_sub_f32 v52, v52, v16
    v_sub_f32 v53, v53, v16
    v_sub_f32 v54, v54, v16
    v_sub_f32 v55, v55, v16
    v_sub_f32 v56, v56, v16
    v_sub_f32 v57, v57, v16
    v_sub_f32 v58, v58, v16
    v_sub_f32 v59, v59, v16
    v_sub_f32 v60, v60, v16
    v_sub_f32 v61, v61, v16
    v_sub_f32 v62, v62, v16
    v_sub_f32 v63, v63, v16
    v_sub_f32 v64, v64, v16
    v_sub_f32 v65, v65, v16
    v_sub_f32 v66, v66, v16
    v_sub_f32 v67, v67, v16
    v_sub_f32 v68, v68, v16
    v_sub_f32 v69, v69, v16
    v_sub_f32 v70, v70, v16
    v_sub_f32 v71, v71, v16
    v_sub_f32 v72, v72, v16
    v_sub_f32 v73, v73, v16
    v_sub_f32 v74, v74, v16
    v_sub_f32 v75, v75, v16
    v_sub_f32 v76, v76, v16
    v_sub_f32 v77, v77, v16
    v_sub_f32 v78, v78, v16
    v_sub_f32 v79, v79, v16
    v_sub_f32 v80, v80, v16
    v_sub_f32 v81, v81, v16
    v_sub_f32 v82, v82, v16
    v_sub_f32 v83, v83, v16
    v_sub_f32 v84, v84, v16
    v_sub_f32 v85, v85, v16
    v_sub_f32 v86, v86, v16
    v_sub_f32 v87, v87, v16
    v_sub_f32 v88, v88, v16
    v_sub_f32 v89, v89, v16
    v_sub_f32 v90, v90, v16
    v_sub_f32 v91, v91, v16
    v_sub_f32 v92, v92, v16
    v_sub_f32 v93, v93, v16
    v_sub_f32 v94, v94, v16
    v_sub_f32 v95, v95, v16
    v_mul_f32 v8, v32, v32
    v_mul_f32 v17, v33, v33
    v_fmac_f32 v8, v34, v34
    v_fmac_f32 v17, v35, v35
    v_fmac_f32 v8, v36, v36
    v_fmac_f32 v17, v37, v37
    v_fmac_f32 v8, v38, v38
    v_fmac_f32 v17, v39, v39
    v_fmac_f32 v8, v40, v40
    v_fmac_f32 v17, v41, v41
    v_fmac_f32 v8, v42, v42
    v_fmac_f32 v17, v43, v43
    v_fmac_f32 v8, v44, v44
    v_fmac_f32 v17, v45, v45
    v_fmac_f32 v8, v46, v46
    v_fmac_f32 v17, v47, v47
    v_fmac_f32 v8, v48, v48
    v_fmac_f32 v17, v49, v49
    v_fmac_f32 v8, v50, v50
    v_fmac_f32 v17, v51, v51
    v_fmac_f32 v8, v52, v52
    v_fmac_f32 v17, v53, v53
    v_fmac_f32 v8, v54, v54
    v_fmac_f32 v17, v55, v55
    v_fmac_f32 v8, v56, v56
    v_fmac_f32 v17, v57, v57
    v_fmac_f32 v8, v58, v58
    v_fmac_f32 v17, v59, v59
    v_fmac_f32 v8, v60, v60
    v_fmac_f32 v17, v61, v61
    v_fmac_f32 v8, v62, v62
    v_fmac_f32 v17, v63, v63
    v_fmac_f32 v8, v64, v64
    v_fmac_f32 v17, v65, v65
    v_fmac_f32 v8, v66, v66
    v_fmac_f32 v17, v67, v67
    v_fmac_f32 v8, v68, v68
    v_fmac_f32 v17, v69, v69
    v_fmac_f32 v8, v70, v70
    v_fmac_f32 v17, v71, v71
    v_fmac_f32 v8, v72, v72
    v_fmac_f32 v17, v73, v73
    v_fmac_f32 v8, v74, v74
    v_fmac_f32 v17, v75, v75
    v_fmac_f32 v8, v76, v76
    v_fmac_f32 v17, v77, v77
    v_fmac_f32 v8, v78, v78
    v_fmac_f32 v17, v79, v79
    v_fmac_f32 v8, v80, v80
    v_fmac_f32 v17, v81, v81
    v_fmac_f32 v8, v82, v82
    v_fmac_f32 v17, v83, v83
    v_fmac_f32 v8, v84, v84
    v_fmac_f32 v17, v85, v85
    v_fmac_f32 v8, v86, v86
    v_fmac_f32 v17, v87, v87
    v_fmac_f32 v8, v88, v88
    v_fmac_f32 v17, v89, v89
    v_fmac_f32 v8, v90, v90
    v_fmac_f32 v17, v91, v91
    v_fmac_f32 v8, v92, v92
    v_fmac_f32 v17, v93, v93
    v_fmac_f32 v8, v94, v94
    v_fmac_f32 v17, v95, v95
    v_add_f32 v8, v8, v17
    v_mov_b32 v9, v8
    s_nop 1
    v_permlane16_swap_b32 v8, v9
    s_nop 1
    v_add_f32 v8, v8, v9
    v_mov_b32 v9, v8
    s_nop 1
    v_permlane32_swap_b32 v8, v9
    s_nop 1
    v_add_f32 v8, v8, v9
    v_lshlrev_b32 v10, 2, v2
    v_add_u32 v10, 66816, v10
    s_lshl_b32 s30, s20, 6
    v_add_u32 v11, s30, v10
    ds_write_b32 v11, v8 offset:512
    s_waitcnt lgkmcnt(0)
    s_barrier
    ds_read_b32 v12, v10 offset:512
    ds_read_b32 v13, v10 offset:576
    ds_read_b32 v14, v10 offset:640
    ds_read_b32 v15, v10 offset:704
    s_waitcnt lgkmcnt(0)
    v_add_f32 v12, v12, v13
    v_add_f32 v14, v14, v15
    v_add_f32 v8, v12, v14

    v_mov_b32 v17, 0x3727c5ac
    v_fmac_f32 v17, 0x3a800000, v8
    v_rsq_f32 v17, v17
    s_lshl_b32 s30, s60, 4
    v_add_u32 v18, s30, v2
    v_mul_u32_u24 v18, 2080, v18
    v_lshl_add_u32 v18, v3, 3, v18
    s_lshl_b32 s30, s20, 9
    v_add_u32 v18, s30, v18

    v_mul_f32 v32, v32, v17
    v_mul_f32 v33, v33, v17
    v_mul_f32 v34, v34, v17
    v_mul_f32 v35, v35, v17
    v_mul_f32 v36, v36, v17
    v_mul_f32 v37, v37, v17
    v_mul_f32 v38, v38, v17
    v_mul_f32 v39, v39, v17
    v_fma_f32 v32, v32, v128, v136
    v_fma_f32 v33, v33, v129, v137
    v_fma_f32 v34, v34, v130, v138
    v_fma_f32 v35, v35, v131, v139
    v_fma_f32 v36, v36, v132, v140
    v_fma_f32 v37, v37, v133, v141
    v_fma_f32 v38, v38, v134, v142
    v_fma_f32 v39, v39, v135, v143
    v_cvt_pk_bf16_f32 v20, v32, v33
    v_cvt_pk_bf16_f32 v21, v34, v35
    v_cvt_pk_bf16_f32 v22, v36, v37
    v_cvt_pk_bf16_f32 v23, v38, v39
    ds_write_b64 v18, v[20:21] offset:0
    ds_write_b64 v18, v[22:23] offset:32
    v_mul_f32 v40, v40, v17
    v_mul_f32 v41, v41, v17
    v_mul_f32 v42, v42, v17
    v_mul_f32 v43, v43, v17
    v_mul_f32 v44, v44, v17
    v_mul_f32 v45, v45, v17
    v_mul_f32 v46, v46, v17
    v_mul_f32 v47, v47, v17
    v_fma_f32 v40, v40, v144, v152
    v_fma_f32 v41, v41, v145, v153
    v_fma_f32 v42, v42, v146, v154
    v_fma_f32 v43, v43, v147, v155
    v_fma_f32 v44, v44, v148, v156
    v_fma_f32 v45, v45, v149, v157
    v_fma_f32 v46, v46, v150, v158
    v_fma_f32 v47, v47, v151, v159
    v_cvt_pk_bf16_f32 v24, v40, v41
    v_cvt_pk_bf16_f32 v25, v42, v43
    v_cvt_pk_bf16_f32 v26, v44, v45
    v_cvt_pk_bf16_f32 v27, v46, v47
    ds_write_b64 v18, v[24:25] offset:64
    ds_write_b64 v18, v[26:27] offset:96
    v_mul_f32 v48, v48, v17
    v_mul_f32 v49, v49, v17
    v_mul_f32 v50, v50, v17
    v_mul_f32 v51, v51, v17
    v_mul_f32 v52, v52, v17
    v_mul_f32 v53, v53, v17
    v_mul_f32 v54, v54, v17
    v_mul_f32 v55, v55, v17
    v_fma_f32 v48, v48, v160, v168
    v_fma_f32 v49, v49, v161, v169
    v_fma_f32 v50, v50, v162, v170
    v_fma_f32 v51, v51, v163, v171
    v_fma_f32 v52, v52, v164, v172
    v_fma_f32 v53, v53, v165, v173
    v_fma_f32 v54, v54, v166, v174
    v_fma_f32 v55, v55, v167, v175
    v_cvt_pk_bf16_f32 v20, v48, v49
    v_cvt_pk_bf16_f32 v21, v50, v51
    v_cvt_pk_bf16_f32 v22, v52, v53
    v_cvt_pk_bf16_f32 v23, v54, v55
    ds_write_b64 v18, v[20:21] offset:128
    ds_write_b64 v18, v[22:23] offset:160
    v_mul_f32 v56, v56, v17
    v_mul_f32 v57, v57, v17
    v_mul_f32 v58, v58, v17
    v_mul_f32 v59, v59, v17
    v_mul_f32 v60, v60, v17
    v_mul_f32 v61, v61, v17
    v_mul_f32 v62, v62, v17
    v_mul_f32 v63, v63, v17
    v_fma_f32 v56, v56, v176, v184
    v_fma_f32 v57, v57, v177, v185
    v_fma_f32 v58, v58, v178, v186
    v_fma_f32 v59, v59, v179, v187
    v_fma_f32 v60, v60, v180, v188
    v_fma_f32 v61, v61, v181, v189
    v_fma_f32 v62, v62, v182, v190
    v_fma_f32 v63, v63, v183, v191
    v_cvt_pk_bf16_f32 v24, v56, v57
    v_cvt_pk_bf16_f32 v25, v58, v59
    v_cvt_pk_bf16_f32 v26, v60, v61
    v_cvt_pk_bf16_f32 v27, v62, v63
    ds_write_b64 v18, v[24:25] offset:192
    ds_write_b64 v18, v[26:27] offset:224
    v_mul_f32 v64, v64, v17
    v_mul_f32 v65, v65, v17
    v_mul_f32 v66, v66, v17
    v_mul_f32 v67, v67, v17
    v_mul_f32 v68, v68, v17
    v_mul_f32 v69, v69, v17
    v_mul_f32 v70, v70, v17
    v_mul_f32 v71, v71, v17
    v_fma_f32 v64, v64, v192, v200
    v_fma_f32 v65, v65, v193, v201
    v_fma_f32 v66, v66, v194, v202
    v_fma_f32 v67, v67, v195, v203
    v_fma_f32 v68, v68, v196, v204
    v_fma_f32 v69, v69, v197, v205
    v_fma_f32 v70, v70, v198, v206
    v_fma_f32 v71, v71, v199, v207
    v_cvt_pk_bf16_f32 v20, v64, v65
    v_cvt_pk_bf16_f32 v21, v66, v67
    v_cvt_pk_bf16_f32 v22, v68, v69
    v_cvt_pk_bf16_f32 v23, v70, v71
    ds_write_b64 v18, v[20:21] offset:256
    ds_write_b64 v18, v[22:23] offset:288
    v_mul_f32 v72, v72, v17
    v_mul_f32 v73, v73, v17
    v_mul_f32 v74, v74, v17
    v_mul_f32 v75, v75, v17
    v_mul_f32 v76, v76, v17
    v_mul_f32 v77, v77, v17
    v_mul_f32 v78, v78, v17
    v_mul_f32 v79, v79, v17
    v_fma_f32 v72, v72, v208, v216
    v_fma_f32 v73, v73, v209, v217
    v_fma_f32 v74, v74, v210, v218
    v_fma_f32 v75, v75, v211, v219
    v_fma_f32 v76, v76, v212, v220
    v_fma_f32 v77, v77, v213, v221
    v_fma_f32 v78, v78, v214, v222
    v_fma_f32 v79, v79, v215, v223
    v_cvt_pk_bf16_f32 v24, v72, v73
    v_cvt_pk_bf16_f32 v25, v74, v75
    v_cvt_pk_bf16_f32 v26, v76, v77
    v_cvt_pk_bf16_f32 v27, v78, v79
    ds_write_b64 v18, v[24:25] offset:320
    ds_write_b64 v18, v[26:27] offset:352
    v_mul_f32 v80, v80, v17
    v_mul_f32 v81, v81, v17
    v_mul_f32 v82, v82, v17
    v_mul_f32 v83, v83, v17
    v_mul_f32 v84, v84, v17
    v_mul_f32 v85, v85, v17
    v_mul_f32 v86, v86, v17
    v_mul_f32 v87, v87, v17
    v_fma_f32 v80, v80, v224, v232
    v_fma_f32 v81, v81, v225, v233
    v_fma_f32 v82, v82, v226, v234
    v_fma_f32 v83, v83, v227, v235
    v_fma_f32 v84, v84, v228, v236
    v_fma_f32 v85, v85, v229, v237
    v_fma_f32 v86, v86, v230, v238
    v_fma_f32 v87, v87, v231, v239
    v_cvt_pk_bf16_f32 v20, v80, v81
    v_cvt_pk_bf16_f32 v21, v82, v83
    v_cvt_pk_bf16_f32 v22, v84, v85
    v_cvt_pk_bf16_f32 v23, v86, v87
    ds_write_b64 v18, v[20:21] offset:384
    ds_write_b64 v18, v[22:23] offset:416
    v_mul_f32 v88, v88, v17
    v_mul_f32 v89, v89, v17
    v_mul_f32 v90, v90, v17
    v_mul_f32 v91, v91, v17
    v_mul_f32 v92, v92, v17
    v_mul_f32 v93, v93, v17
    v_mul_f32 v94, v94, v17
    v_mul_f32 v95, v95, v17
    v_fma_f32 v88, v88, v240, v248
    v_fma_f32 v89, v89, v241, v249
    v_fma_f32 v90, v90, v242, v250
    v_fma_f32 v91, v91, v243, v251
    v_fma_f32 v92, v92, v244, v252
    v_fma_f32 v93, v93, v245, v253
    v_fma_f32 v94, v94, v246, v254
    v_fma_f32 v95, v95, v247, v255
    v_cvt_pk_bf16_f32 v24, v88, v89
    v_cvt_pk_bf16_f32 v25, v90, v91
    v_cvt_pk_bf16_f32 v26, v92, v93
    v_cvt_pk_bf16_f32 v27, v94, v95
    ds_write_b64 v18, v[24:25] offset:448
    ds_write_b64 v18, v[26:27] offset:480
    s_waitcnt lgkmcnt(0)
    s_barrier
    s_add_u32 s60, s60, 1
    s_cmp_lt_u32 s60, 2
    s_cbranch_scc1 mega_kernel_w_ln_t2
    v_lshrrev_b32 v19, 2, v2
    v_lshl_add_u32 v19, v3, 2, v19
    v_mul_u32_u24 v19, 2080, v19
    v_and_b32 v20, 3, v2
    v_lshl_add_u32 v19, v20, 3, v19
    s_lshl_b32 s30, s20, 9
    v_add_u32 v19, s30, v19
    s_lshl_b32 s36, s20, 20
    s_lshl_b32 s30, s55, 10
    s_add_u32 s36, s36, s30
    s_add_u32 s36, s36, 86409216

    ds_read_b64_tr_b16 v[32:33], v19 offset:0
    ds_read_b64_tr_b16 v[34:35], v19 offset:33280
    ds_read_b64_tr_b16 v[36:37], v19 offset:32
    ds_read_b64_tr_b16 v[38:39], v19 offset:33312
    ds_read_b64_tr_b16 v[40:41], v19 offset:64
    ds_read_b64_tr_b16 v[42:43], v19 offset:33344
    ds_read_b64_tr_b16 v[44:45], v19 offset:96
    ds_read_b64_tr_b16 v[46:47], v19 offset:33376
    s_waitcnt lgkmcnt(0)
    ds_read_b64_tr_b16 v[48:49], v19 offset:128
    ds_read_b64_tr_b16 v[50:51], v19 offset:33408
    ds_read_b64_tr_b16 v[52:53], v19 offset:160
    ds_read_b64_tr_b16 v[54:55], v19 offset:33440
    ds_read_b64_tr_b16 v[56:57], v19 offset:192
    ds_read_b64_tr_b16 v[58:59], v19 offset:33472
    ds_read_b64_tr_b16 v[60:61], v19 offset:224
    ds_read_b64_tr_b16 v[62:63], v19 offset:33504
    s_waitcnt lgkmcnt(0)
    ds_read_b64_tr_b16 v[64:65], v19 offset:256
    ds_read_b64_tr_b16 v[66:67], v19 offset:33536
    ds_read_b64_tr_b16 v[68:69], v19 offset:288
    ds_read_b64_tr_b16 v[70:71], v19 offset:33568
    ds_read_b64_tr_b16 v[72:73], v19 offset:320
    ds_read_b64_tr_b16 v[74:75], v19 offset:33600
    ds_read_b64_tr_b16 v[76:77], v19 offset:352
    ds_read_b64_tr_b16 v[78:79], v19 offset:33632
    s_waitcnt lgkmcnt(0)
    ds_read_b64_tr_b16 v[80:81], v19 offset:384
    ds_read_b64_tr_b16 v[82:83], v19 offset:33664
    ds_read_b64_tr_b16 v[84:85], v19 offset:416
    ds_read_b64_tr_b16 v[86:87], v19 offset:33696
    ds_read_b64_tr_b16 v[88:89], v19 offset:448
    ds_read_b64_tr_b16 v[90:91], v19 offset:33728
    ds_read_b64_tr_b16 v[92:93], v19 offset:480
    ds_read_b64_tr_b16 v[94:95], v19 offset:33760
    s_waitcnt lgkmcnt(0)
    buffer_store_dwordx4 v[32:35], v4, s[8:11], s36 offen sc1
    s_add_u32 s36, s36, 65536
    buffer_store_dwordx4 v[36:39], v4, s[8:11], s36 offen sc1
    s_add_u32 s36, s36, 65536
    buffer_store_dwordx4 v[40:43], v4, s[8:11], s36 offen sc1
    s_add_u32 s36, s36, 65536
    buffer_store_dwordx4 v[44:47], v4, s[8:11], s36 offen sc1
    s_add_u32 s36, s36, 65536
    buffer_store_dwordx4 v[48:51], v4, s[8:11], s36 offen sc1
    s_add_u32 s36, s36, 65536
    buffer_store_dwordx4 v[52:55], v4, s[8:11], s36 offen sc1
    s_add_u32 s36, s36, 65536
    buffer_store_dwordx4 v[56:59], v4, s[8:11], s36 offen sc1
    s_add_u32 s36, s36, 65536
    buffer_store_dwordx4 v[60:63], v4, s[8:11], s36 offen sc1
    s_add_u32 s36, s36, 65536
    buffer_store_dwordx4 v[64:67], v4, s[8:11], s36 offen sc1
    s_add_u32 s36, s36, 65536
    buffer_store_dwordx4 v[68:71], v4, s[8:11], s36 offen sc1
    s_add_u32 s36, s36, 65536
    buffer_store_dwordx4 v[72:75], v4, s[8:11], s36 offen sc1
    s_add_u32 s36, s36, 65536
    buffer_store_dwordx4 v[76:79], v4, s[8:11], s36 offen sc1
    s_add_u32 s36, s36, 65536
    buffer_store_dwordx4 v[80:83], v4, s[8:11], s36 offen sc1
    s_add_u32 s36, s36, 65536
    buffer_store_dwordx4 v[84:87], v4, s[8:11], s36 offen sc1
    s_add_u32 s36, s36, 65536
    buffer_store_dwordx4 v[88:91], v4, s[8:11], s36 offen sc1
    s_add_u32 s36, s36, 65536
    buffer_store_dwordx4 v[92:95], v4, s[8:11], s36 offen sc1
    s_add_u32 s36, s36, 65536
    s_cmp_lt_u32 s55, 48
    s_cselect_b32 s41, 0, 64
    s_cmp_lt_u32 s55, 56
    s_cselect_b32 s41, s41, 32
    s_add_u32 s41, s41, 122880
    s_branch mega_kernel_w_next

mega_kernel_w_g5a:
    s_branch mega_kernel_w_next
mega_kernel_w_g4s:
    s_and_b32 s60, s55, 7
    s_lshr_b32 s55, s55, 3
    s_add_u32 s55, s55, 13

    s_mov_b32 s12, s50
    s_mov_b32 s13, s51
    s_mov_b32 s14, 8388608
    s_mov_b32 s15, 0x20000
    s_mov_b32 s16, s52
    s_mov_b32 s17, s53
    s_mov_b32 s18, 4194304
    s_mov_b32 s19, 0x20000
    s_lshl_b32 s28, s20, 12
    v_lshrrev_b32 v5, 4, v1
    s_lshl_b32 s30, s20, 4
    v_add_u32 v5, s30, v5
    v_and_b32 v6, 15, v1
    s_mov_b32 s31, 2048
    v_add_u32 v7, 0, v5
    v_and_b32 v8, 7, v7
    v_lshlrev_b32 v8, 1, v8
    v_xor_b32 v8, v8, v6
    v_lshlrev_b32 v8, 4, v8
    v_mul_lo_u32 v7, v7, s31
    v_add_u32 v8, v8, v7
    v_add_u32 v7, 4, v5
    v_and_b32 v9, 7, v7
    v_lshlrev_b32 v9, 1, v9
    v_xor_b32 v9, v9, v6
    v_lshlrev_b32 v9, 4, v9
    v_mul_lo_u32 v7, v7, s31
    v_add_u32 v9, v9, v7
    v_subrev_u32 v9, 1024, v9
    v_add_u32 v7, 8, v5
    v_and_b32 v10, 7, v7
    v_lshlrev_b32 v10, 1, v10
    v_xor_b32 v10, v10, v6
    v_lshlrev_b32 v10, 4, v10
    v_mul_lo_u32 v7, v7, s31
    v_add_u32 v10, v10, v7
    v_subrev_u32 v10, 2048, v10
    v_add_u32 v7, 12, v5
    v_and_b32 v11, 7, v7
    v_lshlrev_b32 v11, 1, v11
    v_xor_b32 v11, v11, v6
    v_lshlrev_b32 v11, 4, v11
    v_mul_lo_u32 v7, v7, s31
    v_add_u32 v11, v11, v7
    v_subrev_u32 v11, 3072, v11
    v_lshrrev_b32 v5, 2, v2
    v_lshl_add_u32 v5, v3, 2, v5
    v_and_b32 v6, 7, v5
    v_lshlrev_b32 v6, 5, v6
    v_lshlrev_b32 v5, 8, v5
    v_and_b32 v7, 3, v2
    v_lshl_add_u32 v5, v7, 3, v5
    v_xor_b32 v14, 0, v6
    v_add_u32 v14, v14, v5
    v_add_u32 v22, 0x10000, v14
    v_xor_b32 v15, 32, v6
    v_add_u32 v15, v15, v5
    v_add_u32 v23, 0x10000, v15
    v_xor_b32 v16, 64, v6
    v_add_u32 v16, v16, v5
    v_add_u32 v24, 0x10000, v16
    v_xor_b32 v17, 96, v6
    v_add_u32 v17, v17, v5
    v_add_u32 v25, 0x10000, v17
    v_xor_b32 v18, 128, v6
    v_add_u32 v18, v18, v5
    v_add_u32 v26, 0x10000, v18
    v_xor_b32 v19, 160, v6
    v_add_u32 v19, v19, v5
    v_add_u32 v27, 0x10000, v19
    v_xor_b32 v20, 192, v6
    v_add_u32 v20, v20, v5
    v_add_u32 v28, 0x10000, v20
    v_xor_b32 v21, 224, v6
    v_add_u32 v21, v21, v5
    v_add_u32 v29, 0x10000, v21
    s_mul_i32 s30, s20, 262144
    v_add_u32 v12, s30, v4
    v_add_u32 v13, 131072, v12
    s_lshl_b32 s26, s38, 8
    s_lshl_b32 s25, s55, 20
    s_add_u32 s25, s25, 65437696
    s_lshl_b32 s30, s60, 20
    s_add_u32 s26, s26, s30
    s_lshl_b32 s30, s60, 14
    s_add_u32 s25, s25, s30
    s_add_u32 m0, s28, 0
    s_nop 0
    buffer_load_dwordx4 v8, s[12:15], s26 offen offset:0 lds
    buffer_load_dwordx4 v9, s[12:15], s26 offen offset:1024 lds
    buffer_load_dwordx4 v10, s[12:15], s26 offen offset:2048 lds
    buffer_load_dwordx4 v11, s[12:15], s26 offen offset:3072 lds
    s_add_u32 s26, s26, 131072
    s_add_u32 m0, s28, 16384
    s_nop 0
    buffer_load_dwordx4 v8, s[12:15], s26 offen offset:0 lds
    buffer_load_dwordx4 v9, s[12:15], s26 offen offset:1024 lds
    buffer_load_dwordx4 v10, s[12:15], s26 offen offset:2048 lds
    buffer_load_dwordx4 v11, s[12:15], s26 offen offset:3072 lds
    s_add_u32 s26, s26, 131072
    s_add_u32 m0, s28, 32768
    s_nop 0
    buffer_load_dwordx4 v8, s[12:15], s26 offen offset:0 lds
    buffer_load_dwordx4 v9, s[12:15], s26 offen offset:1024 lds
    buffer_load_dwordx4 v10, s[12:15], s26 offen offset:2048 lds
    buffer_load_dwordx4 v11, s[12:15], s26 offen offset:3072 lds
    s_add_u32 s26, s26, 131072
    s_add_u32 m0, s28, 49152
    s_nop 0
    buffer_load_dwordx4 v8, s[12:15], s26 offen offset:0 lds
    buffer_load_dwordx4 v9, s[12:15], s26 offen offset:1024 lds
    buffer_load_dwordx4 v10, s[12:15], s26 offen offset:2048 lds
    buffer_load_dwordx4 v11, s[12:15], s26 offen offset:3072 lds
    s_add_u32 s26, s26, 131072
    s_add_u32 m0, s28, 65536
    s_nop 0
    buffer_load_dwordx4 v8, s[12:15], s26 offen offset:0 lds
    buffer_load_dwordx4 v9, s[12:15], s26 offen offset:1024 lds
    buffer_load_dwordx4 v10, s[12:15], s26 offen offset:2048 lds
    buffer_load_dwordx4 v11, s[12:15], s26 offen offset:3072 lds
    s_add_u32 s26, s26, 131072
    s_add_u32 m0, s28, 81920
    s_nop 0
    buffer_load_dwordx4 v8, s[12:15], s26 offen offset:0 lds
    buffer_load_dwordx4 v9, s[12:15], s26 offen offset:1024 lds
    buffer_load_dwordx4 v10, s[12:15], s26 offen offset:2048 lds
    buffer_load_dwordx4 v11, s[12:15], s26 offen offset:3072 lds
    s_add_u32 s26, s26, 131072
    s_add_u32 m0, s28, 98304
    s_nop 0
    buffer_load_dwordx4 v8, s[12:15], s26 offen offset:0 lds
    buffer_load_dwordx4 v9, s[12:15], s26 offen offset:1024 lds
    buffer_load_dwordx4 v10, s[12:15], s26 offen offset:2048 lds
    buffer_load_dwordx4 v11, s[12:15], s26 offen offset:3072 lds
    s_add_u32 s26, s26, 131072
    s_add_u32 m0, s28, 114688
    s_nop 0
    buffer_load_dwordx4 v8, s[12:15], s26 offen offset:0 lds
    buffer_load_dwordx4 v9, s[12:15], s26 offen offset:1024 lds
    buffer_load_dwordx4 v10, s[12:15], s26 offen offset:2048 lds
    buffer_load_dwordx4 v11, s[12:15], s26 offen offset:3072 lds
    s_add_u32 s26, s26, 131072
    s_mov_b32 s34, 8
    s_mov_b32 s30, s55
    s_cmp_lg_u32 s55, 15
    s_cbranch_scc1 mega_kernel_w_hw0
    s_cmp_lt_u32 s20, 2
    s_cbranch_scc1 mega_kernel_w_hw0
    s_mov_b32 s34, 16
    s_mov_b32 s30, 16
mega_kernel_w_hw0:
    s_lshl_b32 s30, s30, 7
    s_add_u32 s30, s30, 98304
    v_mov_b32 v250, 0
mega_kernel_w_hw1:
    buffer_load_dword v251, v250, s[8:11], s30 offen sc1
    s_waitcnt vmcnt(0)
    v_readfirstlane_b32 s31, v251
    s_cmp_ge_u32 s31, s34
    s_cbranch_scc1 mega_kernel_w_hw2
    s_sub_u32 s40, s40, 1
    s_cbranch_scc1 mega_kernel_w_exit
    s_cmp_eq_u32 s55, 15
    s_cbranch_scc1 mega_kernel_w_hw3
    s_sleep 24
    s_branch mega_kernel_w_hw1
mega_kernel_w_hw3:
    s_sleep 2
    s_branch mega_kernel_w_hw1
mega_kernel_w_hw2:

    buffer_load_dwordx4 v[96:99], v12, s[8:11], s25 offen sc1
    buffer_load_dwordx4 v[100:103], v13, s[8:11], s25 offen sc1
    s_add_u32 s25, s25, 1024
    buffer_load_dwordx4 v[104:107], v12, s[8:11], s25 offen sc1
    buffer_load_dwordx4 v[108:111], v13, s[8:11], s25 offen sc1
    s_add_u32 s25, s25, 1024
    buffer_load_dwordx4 v[112:115], v12, s[8:11], s25 offen sc1
    buffer_load_dwordx4 v[116:119], v13, s[8:11], s25 offen sc1
    s_add_u32 s25, s25, 1024
    buffer_load_dwordx4 v[120:123], v12, s[8:11], s25 offen sc1
    buffer_load_dwordx4 v[124:127], v13, s[8:11], s25 offen sc1
    s_add_u32 s25, s25, 1024
    buffer_load_dwordx4 v[128:131], v12, s[8:11], s25 offen sc1
    buffer_load_dwordx4 v[132:135], v13, s[8:11], s25 offen sc1
    s_add_u32 s25, s25, 1024
    buffer_load_dwordx4 v[136:139], v12, s[8:11], s25 offen sc1
    buffer_load_dwordx4 v[140:143], v13, s[8:11], s25 offen sc1
    s_add_u32 s25, s25, 1024
    buffer_load_dwordx4 v[144:147], v12, s[8:11], s25 offen sc1
    buffer_load_dwordx4 v[148:151], v13, s[8:11], s25 offen sc1
    s_add_u32 s25, s25, 1024
    buffer_load_dwordx4 v[152:155], v12, s[8:11], s25 offen sc1
    buffer_load_dwordx4 v[156:159], v13, s[8:11], s25 offen sc1
    s_add_u32 s25, s25, 1024
    buffer_load_dwordx4 v[160:163], v12, s[8:11], s25 offen sc1
    buffer_load_dwordx4 v[164:167], v13, s[8:11], s25 offen sc1
    s_add_u32 s25, s25, 1024
    buffer_load_dwordx4 v[168:171], v12, s[8:11], s25 offen sc1
    buffer_load_dwordx4 v[172:175], v13, s[8:11], s25 offen sc1
    s_add_u32 s25, s25, 1024
    buffer_load_dwordx4 v[176:179], v12, s[8:11], s25 offen sc1
    buffer_load_dwordx4 v[180:183], v13, s[8:11], s25 offen sc1
    s_add_u32 s25, s25, 1024
    buffer_load_dwordx4 v[184:187], v12, s[8:11], s25 offen sc1
    buffer_load_dwordx4 v[188:191], v13, s[8:11], s25 offen sc1
    s_add_u32 s25, s25, 1024
    buffer_load_dwordx4 v[192:195], v12, s[8:11], s25 offen sc1
    buffer_load_dwordx4 v[196:199], v13, s[8:11], s25 offen sc1
    s_add_u32 s25, s25, 1024
    buffer_load_dwordx4 v[200:203], v12, s[8:11], s25 offen sc1
    buffer_load_dwordx4 v[204:207], v13, s[8:11], s25 offen sc1
    s_add_u32 s25, s25, 1024
    buffer_load_dwordx4 v[208:211], v12, s[8:11], s25 offen sc1
    buffer_load_dwordx4 v[212:215], v13, s[8:11], s25 offen sc1
    s_add_u32 s25, s25, 1024
    v_accvgpr_write_b32 a0, 0
    v_accvgpr_write_b32 a1, 0
    v_accvgpr_write_b32 a2, 0
    v_accvgpr_write_b32 a3, 0
    v_accvgpr_write_b32 a4, 0
    v_accvgpr_write_b32 a5, 0
    v_accvgpr_write_b32 a6, 0
    v_accvgpr_write_b32 a7, 0
    v_accvgpr_write_b32 a8, 0
    v_accvgpr_write_b32 a9, 0
    v_accvgpr_write_b32 a10, 0
    v_accvgpr_write_b32 a11, 0
    v_accvgpr_write_b32 a12, 0
    v_accvgpr_write_b32 a13, 0
    v_accvgpr_write_b32 a14, 0
    v_accvgpr_write_b32 a15, 0
    v_accvgpr_write_b32 a16, 0
    v_accvgpr_write_b32 a17, 0
    v_accvgpr_write_b32 a18, 0
    v_accvgpr_write_b32 a19, 0
    v_accvgpr_write_b32 a20, 0
    v_accvgpr_write_b32 a21, 0
    v_accvgpr_write_b32 a22, 0
    v_accvgpr_write_b32 a23, 0
    v_accvgpr_write_b32 a24, 0
    v_accvgpr_write_b32 a25, 0
    v_accvgpr_write_b32 a26, 0
    v_accvgpr_write_b32 a27, 0
    v_accvgpr_write_b32 a28, 0
    v_accvgpr_write_b32 a29, 0
    v_accvgpr_write_b32 a30, 0
    v_accvgpr_write_b32 a31, 0
    v_accvgpr_write_b32 a32, 0
    v_accvgpr_write_b32 a33, 0
    v_accvgpr_write_b32 a34, 0
    v_accvgpr_write_b32 a35, 0
    v_accvgpr_write_b32 a36, 0
    v_accvgpr_write_b32 a37, 0
    v_accvgpr_write_b32 a38, 0
    v_accvgpr_write_b32 a39, 0
    v_accvgpr_write_b32 a40, 0
    v_accvgpr_write_b32 a41, 0
    v_accvgpr_write_b32 a42, 0
    v_accvgpr_write_b32 a43, 0
    v_accvgpr_write_b32 a44, 0
    v_accvgpr_write_b32 a45, 0
    v_accvgpr_write_b32 a46, 0
    v_accvgpr_write_b32 a47, 0
    v_accvgpr_write_b32 a48, 0
    v_accvgpr_write_b32 a49, 0
    v_accvgpr_write_b32 a50, 0
    v_accvgpr_write_b32 a51, 0
    v_accvgpr_write_b32 a52, 0
    v_accvgpr_write_b32 a53, 0
    v_accvgpr_write_b32 a54, 0
    v_accvgpr_write_b32 a55, 0
    v_accvgpr_write_b32 a56, 0
    v_accvgpr_write_b32 a57, 0
    v_accvgpr_write_b32 a58, 0
    v_accvgpr_write_b32 a59, 0
    v_accvgpr_write_b32 a60, 0
    v_accvgpr_write_b32 a61, 0
    v_accvgpr_write_b32 a62, 0
    v_accvgpr_write_b32 a63, 0
    s_mov_b32 s27, 1
    s_waitcnt vmcnt(58)
    s_barrier
    ds_read_b64_tr_b16 v[32:33], v14 offset:0
    ds_read_b64_tr_b16 v[34:35], v14 offset:4096
    ds_read_b64_tr_b16 v[36:37], v15 offset:0
    ds_read_b64_tr_b16 v[38:39], v15 offset:4096
    ds_read_b64_tr_b16 v[40:41], v16 offset:0
    ds_read_b64_tr_b16 v[42:43], v16 offset:4096
    ds_read_b64_tr_b16 v[44:45], v17 offset:0
    ds_read_b64_tr_b16 v[46:47], v17 offset:4096
    ds_read_b64_tr_b16 v[48:49], v18 offset:0
    ds_read_b64_tr_b16 v[50:51], v18 offset:4096
    ds_read_b64_tr_b16 v[52:53], v19 offset:0
    ds_read_b64_tr_b16 v[54:55], v19 offset:4096
    ds_read_b64_tr_b16 v[56:57], v20 offset:0
    ds_read_b64_tr_b16 v[58:59], v20 offset:4096
    ds_read_b64_tr_b16 v[60:61], v21 offset:0
    ds_read_b64_tr_b16 v[62:63], v21 offset:4096
mega_kernel_w_g4s_loop:
    s_waitcnt vmcnt(28) lgkmcnt(0)
    v_mfma_f32_16x16x32_bf16 a[0:3], v[32:35], v[96:99], a[0:3]
    ds_read_b64_tr_b16 v[64:65], v14 offset:8192
    ds_read_b64_tr_b16 v[66:67], v14 offset:12288
    v_mfma_f32_16x16x32_bf16 a[4:7], v[32:35], v[100:103], a[4:7]
    ds_read_b64_tr_b16 v[68:69], v15 offset:8192
    ds_read_b64_tr_b16 v[70:71], v15 offset:12288
    v_mfma_f32_16x16x32_bf16 a[8:11], v[36:39], v[96:99], a[8:11]
    ds_read_b64_tr_b16 v[72:73], v16 offset:8192
    ds_read_b64_tr_b16 v[74:75], v16 offset:12288
    v_mfma_f32_16x16x32_bf16 a[12:15], v[36:39], v[100:103], a[12:15]
    ds_read_b64_tr_b16 v[76:77], v17 offset:8192
    ds_read_b64_tr_b16 v[78:79], v17 offset:12288
    v_mfma_f32_16x16x32_bf16 a[16:19], v[40:43], v[96:99], a[16:19]
    ds_read_b64_tr_b16 v[80:81], v18 offset:8192
    ds_read_b64_tr_b16 v[82:83], v18 offset:12288
    v_mfma_f32_16x16x32_bf16 a[20:23], v[40:43], v[100:103], a[20:23]
    ds_read_b64_tr_b16 v[84:85], v19 offset:8192
    ds_read_b64_tr_b16 v[86:87], v19 offset:12288
    v_mfma_f32_16x16x32_bf16 a[24:27], v[44:47], v[96:99], a[24:27]
    ds_read_b64_tr_b16 v[88:89], v20 offset:8192
    ds_read_b64_tr_b16 v[90:91], v20 offset:12288
    v_mfma_f32_16x16x32_bf16 a[28:31], v[44:47], v[100:103], a[28:31]
    ds_read_b64_tr_b16 v[92:93], v21 offset:8192
    ds_read_b64_tr_b16 v[94:95], v21 offset:12288
    v_mfma_f32_16x16x32_bf16 a[32:35], v[48:51], v[96:99], a[32:35]
    buffer_load_dwordx4 v[216:219], v12, s[8:11], s25 offen sc1
    buffer_load_dwordx4 v[220:223], v13, s[8:11], s25 offen sc1
    v_mfma_f32_16x16x32_bf16 a[36:39], v[48:51], v[100:103], a[36:39]
    s_add_u32 s25, s25, 1024
    v_mfma_f32_16x16x32_bf16 a[40:43], v[52:55], v[96:99], a[40:43]
    v_mfma_f32_16x16x32_bf16 a[44:47], v[52:55], v[100:103], a[44:47]
    v_mfma_f32_16x16x32_bf16 a[48:51], v[56:59], v[96:99], a[48:51]
    v_mfma_f32_16x16x32_bf16 a[52:55], v[56:59], v[100:103], a[52:55]
    v_mfma_f32_16x16x32_bf16 a[56:59], v[60:63], v[96:99], a[56:59]
    v_mfma_f32_16x16x32_bf16 a[60:63], v[60:63], v[100:103], a[60:63]
    s_waitcnt vmcnt(28) lgkmcnt(0)
    s_barrier
    v_mfma_f32_16x16x32_bf16 a[0:3], v[64:67], v[104:107], a[0:3]
    ds_read_b64_tr_b16 v[32:33], v14 offset:16384
    ds_read_b64_tr_b16 v[34:35], v14 offset:20480
    v_mfma_f32_16x16x32_bf16 a[4:7], v[64:67], v[108:111], a[4:7]
    ds_read_b64_tr_b16 v[36:37], v15 offset:16384
    ds_read_b64_tr_b16 v[38:39], v15 offset:20480
    v_mfma_f32_16x16x32_bf16 a[8:11], v[68:71], v[104:107], a[8:11]
    ds_read_b64_tr_b16 v[40:41], v16 offset:16384
    ds_read_b64_tr_b16 v[42:43], v16 offset:20480
    v_mfma_f32_16x16x32_bf16 a[12:15], v[68:71], v[108:111], a[12:15]
    ds_read_b64_tr_b16 v[44:45], v17 offset:16384
    ds_read_b64_tr_b16 v[46:47], v17 offset:20480
    v_mfma_f32_16x16x32_bf16 a[16:19], v[72:75], v[104:107], a[16:19]
    ds_read_b64_tr_b16 v[48:49], v18 offset:16384
    ds_read_b64_tr_b16 v[50:51], v18 offset:20480
    v_mfma_f32_16x16x32_bf16 a[20:23], v[72:75], v[108:111], a[20:23]
    ds_read_b64_tr_b16 v[52:53], v19 offset:16384
    ds_read_b64_tr_b16 v[54:55], v19 offset:20480
    v_mfma_f32_16x16x32_bf16 a[24:27], v[76:79], v[104:107], a[24:27]
    ds_read_b64_tr_b16 v[56:57], v20 offset:16384
    ds_read_b64_tr_b16 v[58:59], v20 offset:20480
    v_mfma_f32_16x16x32_bf16 a[28:31], v[76:79], v[108:111], a[28:31]
    ds_read_b64_tr_b16 v[60:61], v21 offset:16384
    ds_read_b64_tr_b16 v[62:63], v21 offset:20480
    v_mfma_f32_16x16x32_bf16 a[32:35], v[80:83], v[104:107], a[32:35]
    buffer_load_dwordx4 v[96:99], v12, s[8:11], s25 offen sc1
    buffer_load_dwordx4 v[100:103], v13, s[8:11], s25 offen sc1
    v_mfma_f32_16x16x32_bf16 a[36:39], v[80:83], v[108:111], a[36:39]
    s_add_u32 s25, s25, 1024
    s_add_u32 m0, s28, 0
    v_mfma_f32_16x16x32_bf16 a[40:43], v[84:87], v[104:107], a[40:43]
    s_nop 0
    buffer_load_dwordx4 v8, s[12:15], s26 offen offset:0 lds
    v_mfma_f32_16x16x32_bf16 a[44:47], v[84:87], v[108:111], a[44:47]
    buffer_load_dwordx4 v9, s[12:15], s26 offen offset:1024 lds
    buffer_load_dwordx4 v10, s[12:15], s26 offen offset:2048 lds
    v_mfma_f32_16x16x32_bf16 a[48:51], v[88:91], v[104:107], a[48:51]
    buffer_load_dwordx4 v11, s[12:15], s26 offen offset:3072 lds
    s_add_u32 s26, s26, 131072
    v_mfma_f32_16x16x32_bf16 a[52:55], v[88:91], v[108:111], a[52:55]
    v_mfma_f32_16x16x32_bf16 a[56:59], v[92:95], v[104:107], a[56:59]
    v_mfma_f32_16x16x32_bf16 a[60:63], v[92:95], v[108:111], a[60:63]
    s_waitcnt vmcnt(32) lgkmcnt(0)
    v_mfma_f32_16x16x32_bf16 a[0:3], v[32:35], v[112:115], a[0:3]
    ds_read_b64_tr_b16 v[64:65], v14 offset:24576
    ds_read_b64_tr_b16 v[66:67], v14 offset:28672
    v_mfma_f32_16x16x32_bf16 a[4:7], v[32:35], v[116:119], a[4:7]
    ds_read_b64_tr_b16 v[68:69], v15 offset:24576
    ds_read_b64_tr_b16 v[70:71], v15 offset:28672
    v_mfma_f32_16x16x32_bf16 a[8:11], v[36:39], v[112:115], a[8:11]
    ds_read_b64_tr_b16 v[72:73], v16 offset:24576
    ds_read_b64_tr_b16 v[74:75], v16 offset:28672
    v_mfma_f32_16x16x32_bf16 a[12:15], v[36:39], v[116:119], a[12:15]
    ds_read_b64_tr_b16 v[76:77], v17 offset:24576
    ds_read_b64_tr_b16 v[78:79], v17 offset:28672
    v_mfma_f32_16x16x32_bf16 a[16:19], v[40:43], v[112:115], a[16:19]
    ds_read_b64_tr_b16 v[80:81], v18 offset:24576
    ds_read_b64_tr_b16 v[82:83], v18 offset:28672
    v_mfma_f32_16x16x32_bf16 a[20:23], v[40:43], v[116:119], a[20:23]
    ds_read_b64_tr_b16 v[84:85], v19 offset:24576
    ds_read_b64_tr_b16 v[86:87], v19 offset:28672
    v_mfma_f32_16x16x32_bf16 a[24:27], v[44:47], v[112:115], a[24:27]
    ds_read_b64_tr_b16 v[88:89], v20 offset:24576
    ds_read_b64_tr_b16 v[90:91], v20 offset:28672
    v_mfma_f32_16x16x32_bf16 a[28:31], v[44:47], v[116:119], a[28:31]
    ds_read_b64_tr_b16 v[92:93], v21 offset:24576
    ds_read_b64_tr_b16 v[94:95], v21 offset:28672
    v_mfma_f32_16x16x32_bf16 a[32:35], v[48:51], v[112:115], a[32:35]
    buffer_load_dwordx4 v[104:107], v12, s[8:11], s25 offen sc1
    buffer_load_dwordx4 v[108:111], v13, s[8:11], s25 offen sc1
    v_mfma_f32_16x16x32_bf16 a[36:39], v[48:51], v[116:119], a[36:39]
    s_add_u32 s25, s25, 1024
    v_mfma_f32_16x16x32_bf16 a[40:43], v[52:55], v[112:115], a[40:43]
    v_mfma_f32_16x16x32_bf16 a[44:47], v[52:55], v[116:119], a[44:47]
    v_mfma_f32_16x16x32_bf16 a[48:51], v[56:59], v[112:115], a[48:51]
    v_mfma_f32_16x16x32_bf16 a[52:55], v[56:59], v[116:119], a[52:55]
    v_mfma_f32_16x16x32_bf16 a[56:59], v[60:63], v[112:115], a[56:59]
    v_mfma_f32_16x16x32_bf16 a[60:63], v[60:63], v[116:119], a[60:63]
    s_waitcnt vmcnt(32) lgkmcnt(0)
    s_barrier
    v_mfma_f32_16x16x32_bf16 a[0:3], v[64:67], v[120:123], a[0:3]
    ds_read_b64_tr_b16 v[32:33], v14 offset:32768
    ds_read_b64_tr_b16 v[34:35], v14 offset:36864
    v_mfma_f32_16x16x32_bf16 a[4:7], v[64:67], v[124:127], a[4:7]
    ds_read_b64_tr_b16 v[36:37], v15 offset:32768
    ds_read_b64_tr_b16 v[38:39], v15 offset:36864
    v_mfma_f32_16x16x32_bf16 a[8:11], v[68:71], v[120:123], a[8:11]
    ds_read_b64_tr_b16 v[40:41], v16 offset:32768
    ds_read_b64_tr_b16 v[42:43], v16 offset:36864
    v_mfma_f32_16x16x32_bf16 a[12:15], v[68:71], v[124:127], a[12:15]
    ds_read_b64_tr_b16 v[44:45], v17 offset:32768
    ds_read_b64_tr_b16 v[46:47], v17 offset:36864
    v_mfma_f32_16x16x32_bf16 a[16:19], v[72:75], v[120:123], a[16:19]
    ds_read_b64_tr_b16 v[48:49], v18 offset:32768
    ds_read_b64_tr_b16 v[50:51], v18 offset:36864
    v_mfma_f32_16x16x32_bf16 a[20:23], v[72:75], v[124:127], a[20:23]
    ds_read_b64_tr_b16 v[52:53], v19 offset:32768
    ds_read_b64_tr_b16 v[54:55], v19 offset:36864
    v_mfma_f32_16x16x32_bf16 a[24:27], v[76:79], v[120:123], a[24:27]
    ds_read_b64_tr_b16 v[56:57], v20 offset:32768
    ds_read_b64_tr_b16 v[58:59], v20 offset:36864
    v_mfma_f32_16x16x32_bf16 a[28:31], v[76:79], v[124:127], a[28:31]
    ds_read_b64_tr_b16 v[60:61], v21 offset:32768
    ds_read_b64_tr_b16 v[62:63], v21 offset:36864
    v_mfma_f32_16x16x32_bf16 a[32:35], v[80:83], v[120:123], a[32:35]
    buffer_load_dwordx4 v[112:115], v12, s[8:11], s25 offen sc1
    buffer_load_dwordx4 v[116:119], v13, s[8:11], s25 offen sc1
    v_mfma_f32_16x16x32_bf16 a[36:39], v[80:83], v[124:127], a[36:39]
    s_add_u32 s25, s25, 1024
    s_add_u32 m0, s28, 16384
    v_mfma_f32_16x16x32_bf16 a[40:43], v[84:87], v[120:123], a[40:43]
    s_nop 0
    buffer_load_dwordx4 v8, s[12:15], s26 offen offset:0 lds
    v_mfma_f32_16x16x32_bf16 a[44:47], v[84:87], v[124:127], a[44:47]
    buffer_load_dwordx4 v9, s[12:15], s26 offen offset:1024 lds
    buffer_load_dwordx4 v10, s[12:15], s26 offen offset:2048 lds
    v_mfma_f32_16x16x32_bf16 a[48:51], v[88:91], v[120:123], a[48:51]
    buffer_load_dwordx4 v11, s[12:15], s26 offen offset:3072 lds
    s_add_u32 s26, s26, 131072
    v_mfma_f32_16x16x32_bf16 a[52:55], v[88:91], v[124:127], a[52:55]
    v_mfma_f32_16x16x32_bf16 a[56:59], v[92:95], v[120:123], a[56:59]
    v_mfma_f32_16x16x32_bf16 a[60:63], v[92:95], v[124:127], a[60:63]
    s_waitcnt vmcnt(36) lgkmcnt(0)
    v_mfma_f32_16x16x32_bf16 a[0:3], v[32:35], v[128:131], a[0:3]
    ds_read_b64_tr_b16 v[64:65], v14 offset:40960
    ds_read_b64_tr_b16 v[66:67], v14 offset:45056
    v_mfma_f32_16x16x32_bf16 a[4:7], v[32:35], v[132:135], a[4:7]
    ds_read_b64_tr_b16 v[68:69], v15 offset:40960
    ds_read_b64_tr_b16 v[70:71], v15 offset:45056
    v_mfma_f32_16x16x32_bf16 a[8:11], v[36:39], v[128:131], a[8:11]
    ds_read_b64_tr_b16 v[72:73], v16 offset:40960
    ds_read_b64_tr_b16 v[74:75], v16 offset:45056
    v_mfma_f32_16x16x32_bf16 a[12:15], v[36:39], v[132:135], a[12:15]
    ds_read_b64_tr_b16 v[76:77], v17 offset:40960
    ds_read_b64_tr_b16 v[78:79], v17 offset:45056
    v_mfma_f32_16x16x32_bf16 a[16:19], v[40:43], v[128:131], a[16:19]
    ds_read_b64_tr_b16 v[80:81], v18 offset:40960
    ds_read_b64_tr_b16 v[82:83], v18 offset:45056
    v_mfma_f32_16x16x32_bf16 a[20:23], v[40:43], v[132:135], a[20:23]
    ds_read_b64_tr_b16 v[84:85], v19 offset:40960
    ds_read_b64_tr_b16 v[86:87], v19 offset:45056
    v_mfma_f32_16x16x32_bf16 a[24:27], v[44:47], v[128:131], a[24:27]
    ds_read_b64_tr_b16 v[88:89], v20 offset:40960
    ds_read_b64_tr_b16 v[90:91], v20 offset:45056
    v_mfma_f32_16x16x32_bf16 a[28:31], v[44:47], v[132:135], a[28:31]
    ds_read_b64_tr_b16 v[92:93], v21 offset:40960
    ds_read_b64_tr_b16 v[94:95], v21 offset:45056
    v_mfma_f32_16x16x32_bf16 a[32:35], v[48:51], v[128:131], a[32:35]
    buffer_load_dwordx4 v[120:123], v12, s[8:11], s25 offen sc1
    buffer_load_dwordx4 v[124:127], v13, s[8:11], s25 offen sc1
    v_mfma_f32_16x16x32_bf16 a[36:39], v[48:51], v[132:135], a[36:39]
    s_add_u32 s25, s25, 1024
    v_mfma_f32_16x16x32_bf16 a[40:43], v[52:55], v[128:131], a[40:43]
    v_mfma_f32_16x16x32_bf16 a[44:47], v[52:55], v[132:135], a[44:47]
    v_mfma_f32_16x16x32_bf16 a[48:51], v[56:59], v[128:131], a[48:51]
    v_mfma_f32_16x16x32_bf16 a[52:55], v[56:59], v[132:135], a[52:55]
    v_mfma_f32_16x16x32_bf16 a[56:59], v[60:63], v[128:131], a[56:59]
    v_mfma_f32_16x16x32_bf16 a[60:63], v[60:63], v[132:135], a[60:63]
    s_waitcnt vmcnt(36) lgkmcnt(0)
    s_barrier
    v_mfma_f32_16x16x32_bf16 a[0:3], v[64:67], v[136:139], a[0:3]
    ds_read_b64_tr_b16 v[32:33], v14 offset:49152
    ds_read_b64_tr_b16 v[34:35], v14 offset:53248
    v_mfma_f32_16x16x32_bf16 a[4:7], v[64:67], v[140:143], a[4:7]
    ds_read_b64_tr_b16 v[36:37], v15 offset:49152
    ds_read_b64_tr_b16 v[38:39], v15 offset:53248
    v_mfma_f32_16x16x32_bf16 a[8:11], v[68:71], v[136:139], a[8:11]
    ds_read_b64_tr_b16 v[40:41], v16 offset:49152
    ds_read_b64_tr_b16 v[42:43], v16 offset:53248
    v_mfma_f32_16x16x32_bf16 a[12:15], v[68:71], v[140:143], a[12:15]
    ds_read_b64_tr_b16 v[44:45], v17 offset:49152
    ds_read_b64_tr_b16 v[46:47], v17 offset:53248
    v_mfma_f32_16x16x32_bf16 a[16:19], v[72:75], v[136:139], a[16:19]
    ds_read_b64_tr_b16 v[48:49], v18 offset:49152
    ds_read_b64_tr_b16 v[50:51], v18 offset:53248
    v_mfma_f32_16x16x32_bf16 a[20:23], v[72:75], v[140:143], a[20:23]
    ds_read_b64_tr_b16 v[52:53], v19 offset:49152
    ds_read_b64_tr_b16 v[54:55], v19 offset:53248
    v_mfma_f32_16x16x32_bf16 a[24:27], v[76:79], v[136:139], a[24:27]
    ds_read_b64_tr_b16 v[56:57], v20 offset:49152
    ds_read_b64_tr_b16 v[58:59], v20 offset:53248
    v_mfma_f32_16x16x32_bf16 a[28:31], v[76:79], v[140:143], a[28:31]
    ds_read_b64_tr_b16 v[60:61], v21 offset:49152
    ds_read_b64_tr_b16 v[62:63], v21 offset:53248
    v_mfma_f32_16x16x32_bf16 a[32:35], v[80:83], v[136:139], a[32:35]
    buffer_load_dwordx4 v[128:131], v12, s[8:11], s25 offen sc1
    buffer_load_dwordx4 v[132:135], v13, s[8:11], s25 offen sc1
    v_mfma_f32_16x16x32_bf16 a[36:39], v[80:83], v[140:143], a[36:39]
    s_add_u32 s25, s25, 1024
    s_add_u32 m0, s28, 32768
    v_mfma_f32_16x16x32_bf16 a[40:43], v[84:87], v[136:139], a[40:43]
    s_nop 0
    buffer_load_dwordx4 v8, s[12:15], s26 offen offset:0 lds
    v_mfma_f32_16x16x32_bf16 a[44:47], v[84:87], v[140:143], a[44:47]
    buffer_load_dwordx4 v9, s[12:15], s26 offen offset:1024 lds
    buffer_load_dwordx4 v10, s[12:15], s26 offen offset:2048 lds
    v_mfma_f32_16x16x32_bf16 a[48:51], v[88:91], v[136:139], a[48:51]
    buffer_load_dwordx4 v11, s[12:15], s26 offen offset:3072 lds
    s_add_u32 s26, s26, 131072
    v_mfma_f32_16x16x32_bf16 a[52:55], v[88:91], v[140:143], a[52:55]
    v_mfma_f32_16x16x32_bf16 a[56:59], v[92:95], v[136:139], a[56:59]
    v_mfma_f32_16x16x32_bf16 a[60:63], v[92:95], v[140:143], a[60:63]
    s_waitcnt vmcnt(40) lgkmcnt(0)
    v_mfma_f32_16x16x32_bf16 a[0:3], v[32:35], v[144:147], a[0:3]
    ds_read_b64_tr_b16 v[64:65], v14 offset:57344
    ds_read_b64_tr_b16 v[66:67], v14 offset:61440
    v_mfma_f32_16x16x32_bf16 a[4:7], v[32:35], v[148:151], a[4:7]
    ds_read_b64_tr_b16 v[68:69], v15 offset:57344
    ds_read_b64_tr_b16 v[70:71], v15 offset:61440
    v_mfma_f32_16x16x32_bf16 a[8:11], v[36:39], v[144:147], a[8:11]
    ds_read_b64_tr_b16 v[72:73], v16 offset:57344
    ds_read_b64_tr_b16 v[74:75], v16 offset:61440
    v_mfma_f32_16x16x32_bf16 a[12:15], v[36:39], v[148:151], a[12:15]
    ds_read_b64_tr_b16 v[76:77], v17 offset:57344
    ds_read_b64_tr_b16 v[78:79], v17 offset:61440
    v_mfma_f32_16x16x32_bf16 a[16:19], v[40:43], v[144:147], a[16:19]
    ds_read_b64_tr_b16 v[80:81], v18 offset:57344
    ds_read_b64_tr_b16 v[82:83], v18 offset:61440
    v_mfma_f32_16x16x32_bf16 a[20:23], v[40:43], v[148:151], a[20:23]
    ds_read_b64_tr_b16 v[84:85], v19 offset:57344
    ds_read_b64_tr_b16 v[86:87], v19 offset:61440
    v_mfma_f32_16x16x32_bf16 a[24:27], v[44:47], v[144:147], a[24:27]
    ds_read_b64_tr_b16 v[88:89], v20 offset:57344
    ds_read_b64_tr_b16 v[90:91], v20 offset:61440
    v_mfma_f32_16x16x32_bf16 a[28:31], v[44:47], v[148:151], a[28:31]
    ds_read_b64_tr_b16 v[92:93], v21 offset:57344
    ds_read_b64_tr_b16 v[94:95], v21 offset:61440
    v_mfma_f32_16x16x32_bf16 a[32:35], v[48:51], v[144:147], a[32:35]
    buffer_load_dwordx4 v[136:139], v12, s[8:11], s25 offen sc1
    buffer_load_dwordx4 v[140:143], v13, s[8:11], s25 offen sc1
    v_mfma_f32_16x16x32_bf16 a[36:39], v[48:51], v[148:151], a[36:39]
    s_add_u32 s25, s25, 1024
    v_mfma_f32_16x16x32_bf16 a[40:43], v[52:55], v[144:147], a[40:43]
    v_mfma_f32_16x16x32_bf16 a[44:47], v[52:55], v[148:151], a[44:47]
    v_mfma_f32_16x16x32_bf16 a[48:51], v[56:59], v[144:147], a[48:51]
    v_mfma_f32_16x16x32_bf16 a[52:55], v[56:59], v[148:151], a[52:55]
    v_mfma_f32_16x16x32_bf16 a[56:59], v[60:63], v[144:147], a[56:59]
    v_mfma_f32_16x16x32_bf16 a[60:63], v[60:63], v[148:151], a[60:63]
    s_waitcnt vmcnt(40) lgkmcnt(0)
    s_barrier
    v_mfma_f32_16x16x32_bf16 a[0:3], v[64:67], v[152:155], a[0:3]
    ds_read_b64_tr_b16 v[32:33], v22 offset:0
    ds_read_b64_tr_b16 v[34:35], v22 offset:4096
    v_mfma_f32_16x16x32_bf16 a[4:7], v[64:67], v[156:159], a[4:7]
    ds_read_b64_tr_b16 v[36:37], v23 offset:0
    ds_read_b64_tr_b16 v[38:39], v23 offset:4096
    v_mfma_f32_16x16x32_bf16 a[8:11], v[68:71], v[152:155], a[8:11]
    ds_read_b64_tr_b16 v[40:41], v24 offset:0
    ds_read_b64_tr_b16 v[42:43], v24 offset:4096
    v_mfma_f32_16x16x32_bf16 a[12:15], v[68:71], v[156:159], a[12:15]
    ds_read_b64_tr_b16 v[44:45], v25 offset:0
    ds_read_b64_tr_b16 v[46:47], v25 offset:4096
    v_mfma_f32_16x16x32_bf16 a[16:19], v[72:75], v[152:155], a[16:19]
    ds_read_b64_tr_b16 v[48:49], v26 offset:0
    ds_read_b64_tr_b16 v[50:51], v26 offset:4096
    v_mfma_f32_16x16x32_bf16 a[20:23], v[72:75], v[156:159], a[20:23]
    ds_read_b64_tr_b16 v[52:53], v27 offset:0
    ds_read_b64_tr_b16 v[54:55], v27 offset:4096
    v_mfma_f32_16x16x32_bf16 a[24:27], v[76:79], v[152:155], a[24:27]
    ds_read_b64_tr_b16 v[56:57], v28 offset:0
    ds_read_b64_tr_b16 v[58:59], v28 offset:4096
    v_mfma_f32_16x16x32_bf16 a[28:31], v[76:79], v[156:159], a[28:31]
    ds_read_b64_tr_b16 v[60:61], v29 offset:0
    ds_read_b64_tr_b16 v[62:63], v29 offset:4096
    v_mfma_f32_16x16x32_bf16 a[32:35], v[80:83], v[152:155], a[32:35]
    buffer_load_dwordx4 v[144:147], v12, s[8:11], s25 offen sc1
    buffer_load_dwordx4 v[148:151], v13, s[8:11], s25 offen sc1
    v_mfma_f32_16x16x32_bf16 a[36:39], v[80:83], v[156:159], a[36:39]
    s_add_u32 s25, s25, 1024
    s_add_u32 m0, s28, 49152
    v_mfma_f32_16x16x32_bf16 a[40:43], v[84:87], v[152:155], a[40:43]
    s_nop 0
    buffer_load_dwordx4 v8, s[12:15], s26 offen offset:0 lds
    v_mfma_f32_16x16x32_bf16 a[44:47], v[84:87], v[156:159], a[44:47]
    buffer_load_dwordx4 v9, s[12:15], s26 offen offset:1024 lds
    buffer_load_dwordx4 v10, s[12:15], s26 offen offset:2048 lds
    v_mfma_f32_16x16x32_bf16 a[48:51], v[88:91], v[152:155], a[48:51]
    buffer_load_dwordx4 v11, s[12:15], s26 offen offset:3072 lds
    s_add_u32 s26, s26, 131072
    v_mfma_f32_16x16x32_bf16 a[52:55], v[88:91], v[156:159], a[52:55]
    v_mfma_f32_16x16x32_bf16 a[56:59], v[92:95], v[152:155], a[56:59]
    v_mfma_f32_16x16x32_bf16 a[60:63], v[92:95], v[156:159], a[60:63]
    s_waitcnt vmcnt(44) lgkmcnt(0)
    v_mfma_f32_16x16x32_bf16 a[0:3], v[32:35], v[160:163], a[0:3]
    ds_read_b64_tr_b16 v[64:65], v22 offset:8192
    ds_read_b64_tr_b16 v[66:67], v22 offset:12288
    v_mfma_f32_16x16x32_bf16 a[4:7], v[32:35], v[164:167], a[4:7]
    ds_read_b64_tr_b16 v[68:69], v23 offset:8192
    ds_read_b64_tr_b16 v[70:71], v23 offset:12288
    v_mfma_f32_16x16x32_bf16 a[8:11], v[36:39], v[160:163], a[8:11]
    ds_read_b64_tr_b16 v[72:73], v24 offset:8192
    ds_read_b64_tr_b16 v[74:75], v24 offset:12288
    v_mfma_f32_16x16x32_bf16 a[12:15], v[36:39], v[164:167], a[12:15]
    ds_read_b64_tr_b16 v[76:77], v25 offset:8192
    ds_read_b64_tr_b16 v[78:79], v25 offset:12288
    v_mfma_f32_16x16x32_bf16 a[16:19], v[40:43], v[160:163], a[16:19]
    ds_read_b64_tr_b16 v[80:81], v26 offset:8192
    ds_read_b64_tr_b16 v[82:83], v26 offset:12288
    v_mfma_f32_16x16x32_bf16 a[20:23], v[40:43], v[164:167], a[20:23]
    ds_read_b64_tr_b16 v[84:85], v27 offset:8192
    ds_read_b64_tr_b16 v[86:87], v27 offset:12288
    v_mfma_f32_16x16x32_bf16 a[24:27], v[44:47], v[160:163], a[24:27]
    ds_read_b64_tr_b16 v[88:89], v28 offset:8192
    ds_read_b64_tr_b16 v[90:91], v28 offset:12288
    v_mfma_f32_16x16x32_bf16 a[28:31], v[44:47], v[164:167], a[28:31]
    ds_read_b64_tr_b16 v[92:93], v29 offset:8192
    ds_read_b64_tr_b16 v[94:95], v29 offset:12288
    v_mfma_f32_16x16x32_bf16 a[32:35], v[48:51], v[160:163], a[32:35]
    buffer_load_dwordx4 v[152:155], v12, s[8:11], s25 offen sc1
    buffer_load_dwordx4 v[156:159], v13, s[8:11], s25 offen sc1
    v_mfma_f32_16x16x32_bf16 a[36:39], v[48:51], v[164:167], a[36:39]
    s_add_u32 s25, s25, 1024
    v_mfma_f32_16x16x32_bf16 a[40:43], v[52:55], v[160:163], a[40:43]
    v_mfma_f32_16x16x32_bf16 a[44:47], v[52:55], v[164:167], a[44:47]
    v_mfma_f32_16x16x32_bf16 a[48:51], v[56:59], v[160:163], a[48:51]
    v_mfma_f32_16x16x32_bf16 a[52:55], v[56:59], v[164:167], a[52:55]
    v_mfma_f32_16x16x32_bf16 a[56:59], v[60:63], v[160:163], a[56:59]
    v_mfma_f32_16x16x32_bf16 a[60:63], v[60:63], v[164:167], a[60:63]
    s_waitcnt vmcnt(44) lgkmcnt(0)
    s_barrier
    v_mfma_f32_16x16x32_bf16 a[0:3], v[64:67], v[168:171], a[0:3]
    ds_read_b64_tr_b16 v[32:33], v22 offset:16384
    ds_read_b64_tr_b16 v[34:35], v22 offset:20480
    v_mfma_f32_16x16x32_bf16 a[4:7], v[64:67], v[172:175], a[4:7]
    ds_read_b64_tr_b16 v[36:37], v23 offset:16384
    ds_read_b64_tr_b16 v[38:39], v23 offset:20480
    v_mfma_f32_16x16x32_bf16 a[8:11], v[68:71], v[168:171], a[8:11]
    ds_read_b64_tr_b16 v[40:41], v24 offset:16384
    ds_read_b64_tr_b16 v[42:43], v24 offset:20480
    v_mfma_f32_16x16x32_bf16 a[12:15], v[68:71], v[172:175], a[12:15]
    ds_read_b64_tr_b16 v[44:45], v25 offset:16384
    ds_read_b64_tr_b16 v[46:47], v25 offset:20480
    v_mfma_f32_16x16x32_bf16 a[16:19], v[72:75], v[168:171], a[16:19]
    ds_read_b64_tr_b16 v[48:49], v26 offset:16384
    ds_read_b64_tr_b16 v[50:51], v26 offset:20480
    v_mfma_f32_16x16x32_bf16 a[20:23], v[72:75], v[172:175], a[20:23]
    ds_read_b64_tr_b16 v[52:53], v27 offset:16384
    ds_read_b64_tr_b16 v[54:55], v27 offset:20480
    v_mfma_f32_16x16x32_bf16 a[24:27], v[76:79], v[168:171], a[24:27]
    ds_read_b64_tr_b16 v[56:57], v28 offset:16384
    ds_read_b64_tr_b16 v[58:59], v28 offset:20480
    v_mfma_f32_16x16x32_bf16 a[28:31], v[76:79], v[172:175], a[28:31]
    ds_read_b64_tr_b16 v[60:61], v29 offset:16384
    ds_read_b64_tr_b16 v[62:63], v29 offset:20480
    v_mfma_f32_16x16x32_bf16 a[32:35], v[80:83], v[168:171], a[32:35]
    buffer_load_dwordx4 v[160:163], v12, s[8:11], s25 offen sc1
    buffer_load_dwordx4 v[164:167], v13, s[8:11], s25 offen sc1
    v_mfma_f32_16x16x32_bf16 a[36:39], v[80:83], v[172:175], a[36:39]
    s_add_u32 s25, s25, 1024
    s_add_u32 m0, s28, 65536
    v_mfma_f32_16x16x32_bf16 a[40:43], v[84:87], v[168:171], a[40:43]
    s_nop 0
    buffer_load_dwordx4 v8, s[12:15], s26 offen offset:0 lds
    v_mfma_f32_16x16x32_bf16 a[44:47], v[84:87], v[172:175], a[44:47]
    buffer_load_dwordx4 v9, s[12:15], s26 offen offset:1024 lds
    buffer_load_dwordx4 v10, s[12:15], s26 offen offset:2048 lds
    v_mfma_f32_16x16x32_bf16 a[48:51], v[88:91], v[168:171], a[48:51]
    buffer_load_dwordx4 v11, s[12:15], s26 offen offset:3072 lds
    s_add_u32 s26, s26, 131072
    v_mfma_f32_16x16x32_bf16 a[52:55], v[88:91], v[172:175], a[52:55]
    v_mfma_f32_16x16x32_bf16 a[56:59], v[92:95], v[168:171], a[56:59]
    v_mfma_f32_16x16x32_bf16 a[60:63], v[92:95], v[172:175], a[60:63]
    s_waitcnt vmcnt(48) lgkmcnt(0)
    v_mfma_f32_16x16x32_bf16 a[0:3], v[32:35], v[176:179], a[0:3]
    ds_read_b64_tr_b16 v[64:65], v22 offset:24576
    ds_read_b64_tr_b16 v[66:67], v22 offset:28672
    v_mfma_f32_16x16x32_bf16 a[4:7], v[32:35], v[180:183], a[4:7]
    ds_read_b64_tr_b16 v[68:69], v23 offset:24576
    ds_read_b64_tr_b16 v[70:71], v23 offset:28672
    v_mfma_f32_16x16x32_bf16 a[8:11], v[36:39], v[176:179], a[8:11]
    ds_read_b64_tr_b16 v[72:73], v24 offset:24576
    ds_read_b64_tr_b16 v[74:75], v24 offset:28672
    v_mfma_f32_16x16x32_bf16 a[12:15], v[36:39], v[180:183], a[12:15]
    ds_read_b64_tr_b16 v[76:77], v25 offset:24576
    ds_read_b64_tr_b16 v[78:79], v25 offset:28672
    v_mfma_f32_16x16x32_bf16 a[16:19], v[40:43], v[176:179], a[16:19]
    ds_read_b64_tr_b16 v[80:81], v26 offset:24576
    ds_read_b64_tr_b16 v[82:83], v26 offset:28672
    v_mfma_f32_16x16x32_bf16 a[20:23], v[40:43], v[180:183], a[20:23]
    ds_read_b64_tr_b16 v[84:85], v27 offset:24576
    ds_read_b64_tr_b16 v[86:87], v27 offset:28672
    v_mfma_f32_16x16x32_bf16 a[24:27], v[44:47], v[176:179], a[24:27]
    ds_read_b64_tr_b16 v[88:89], v28 offset:24576
    ds_read_b64_tr_b16 v[90:91], v28 offset:28672
    v_mfma_f32_16x16x32_bf16 a[28:31], v[44:47], v[180:183], a[28:31]
    ds_read_b64_tr_b16 v[92:93], v29 offset:24576
    ds_read_b64_tr_b16 v[94:95], v29 offset:28672
    v_mfma_f32_16x16x32_bf16 a[32:35], v[48:51], v[176:179], a[32:35]
    buffer_load_dwordx4 v[168:171], v12, s[8:11], s25 offen sc1
    buffer_load_dwordx4 v[172:175], v13, s[8:11], s25 offen sc1
    v_mfma_f32_16x16x32_bf16 a[36:39], v[48:51], v[180:183], a[36:39]
    s_add_u32 s25, s25, 1024
    v_mfma_f32_16x16x32_bf16 a[40:43], v[52:55], v[176:179], a[40:43]
    v_mfma_f32_16x16x32_bf16 a[44:47], v[52:55], v[180:183], a[44:47]
    v_mfma_f32_16x16x32_bf16 a[48:51], v[56:59], v[176:179], a[48:51]
    v_mfma_f32_16x16x32_bf16 a[52:55], v[56:59], v[180:183], a[52:55]
    v_mfma_f32_16x16x32_bf16 a[56:59], v[60:63], v[176:179], a[56:59]
    v_mfma_f32_16x16x32_bf16 a[60:63], v[60:63], v[180:183], a[60:63]
    s_waitcnt vmcnt(48) lgkmcnt(0)
    s_barrier
    v_mfma_f32_16x16x32_bf16 a[0:3], v[64:67], v[184:187], a[0:3]
    ds_read_b64_tr_b16 v[32:33], v22 offset:32768
    ds_read_b64_tr_b16 v[34:35], v22 offset:36864
    v_mfma_f32_16x16x32_bf16 a[4:7], v[64:67], v[188:191], a[4:7]
    ds_read_b64_tr_b16 v[36:37], v23 offset:32768
    ds_read_b64_tr_b16 v[38:39], v23 offset:36864
    v_mfma_f32_16x16x32_bf16 a[8:11], v[68:71], v[184:187], a[8:11]
    ds_read_b64_tr_b16 v[40:41], v24 offset:32768
    ds_read_b64_tr_b16 v[42:43], v24 offset:36864
    v_mfma_f32_16x16x32_bf16 a[12:15], v[68:71], v[188:191], a[12:15]
    ds_read_b64_tr_b16 v[44:45], v25 offset:32768
    ds_read_b64_tr_b16 v[46:47], v25 offset:36864
    v_mfma_f32_16x16x32_bf16 a[16:19], v[72:75], v[184:187], a[16:19]
    ds_read_b64_tr_b16 v[48:49], v26 offset:32768
    ds_read_b64_tr_b16 v[50:51], v26 offset:36864
    v_mfma_f32_16x16x32_bf16 a[20:23], v[72:75], v[188:191], a[20:23]
    ds_read_b64_tr_b16 v[52:53], v27 offset:32768
    ds_read_b64_tr_b16 v[54:55], v27 offset:36864
    v_mfma_f32_16x16x32_bf16 a[24:27], v[76:79], v[184:187], a[24:27]
    ds_read_b64_tr_b16 v[56:57], v28 offset:32768
    ds_read_b64_tr_b16 v[58:59], v28 offset:36864
    v_mfma_f32_16x16x32_bf16 a[28:31], v[76:79], v[188:191], a[28:31]
    ds_read_b64_tr_b16 v[60:61], v29 offset:32768
    ds_read_b64_tr_b16 v[62:63], v29 offset:36864
    v_mfma_f32_16x16x32_bf16 a[32:35], v[80:83], v[184:187], a[32:35]
    buffer_load_dwordx4 v[176:179], v12, s[8:11], s25 offen sc1
    buffer_load_dwordx4 v[180:183], v13, s[8:11], s25 offen sc1
    v_mfma_f32_16x16x32_bf16 a[36:39], v[80:83], v[188:191], a[36:39]
    s_add_u32 s25, s25, 1024
    s_add_u32 m0, s28, 81920
    v_mfma_f32_16x16x32_bf16 a[40:43], v[84:87], v[184:187], a[40:43]
    s_nop 0
    buffer_load_dwordx4 v8, s[12:15], s26 offen offset:0 lds
    v_mfma_f32_16x16x32_bf16 a[44:47], v[84:87], v[188:191], a[44:47]
    buffer_load_dwordx4 v9, s[12:15], s26 offen offset:1024 lds
    buffer_load_dwordx4 v10, s[12:15], s26 offen offset:2048 lds
    v_mfma_f32_16x16x32_bf16 a[48:51], v[88:91], v[184:187], a[48:51]
    buffer_load_dwordx4 v11, s[12:15], s26 offen offset:3072 lds
    s_add_u32 s26, s26, 131072
    v_mfma_f32_16x16x32_bf16 a[52:55], v[88:91], v[188:191], a[52:55]
    v_mfma_f32_16x16x32_bf16 a[56:59], v[92:95], v[184:187], a[56:59]
    v_mfma_f32_16x16x32_bf16 a[60:63], v[92:95], v[188:191], a[60:63]
    s_waitcnt vmcnt(52) lgkmcnt(0)
    v_mfma_f32_16x16x32_bf16 a[0:3], v[32:35], v[192:195], a[0:3]
    ds_read_b64_tr_b16 v[64:65], v22 offset:40960
    ds_read_b64_tr_b16 v[66:67], v22 offset:45056
    v_mfma_f32_16x16x32_bf16 a[4:7], v[32:35], v[196:199], a[4:7]
    ds_read_b64_tr_b16 v[68:69], v23 offset:40960
    ds_read_b64_tr_b16 v[70:71], v23 offset:45056
    v_mfma_f32_16x16x32_bf16 a[8:11], v[36:39], v[192:195], a[8:11]
    ds_read_b64_tr_b16 v[72:73], v24 offset:40960
    ds_read_b64_tr_b16 v[74:75], v24 offset:45056
    v_mfma_f32_16x16x32_bf16 a[12:15], v[36:39], v[196:199], a[12:15]
    ds_read_b64_tr_b16 v[76:77], v25 offset:40960
    ds_read_b64_tr_b16 v[78:79], v25 offset:45056
    v_mfma_f32_16x16x32_bf16 a[16:19], v[40:43], v[192:195], a[16:19]
    ds_read_b64_tr_b16 v[80:81], v26 offset:40960
    ds_read_b64_tr_b16 v[82:83], v26 offset:45056
    v_mfma_f32_16x16x32_bf16 a[20:23], v[40:43], v[196:199], a[20:23]
    ds_read_b64_tr_b16 v[84:85], v27 offset:40960
    ds_read_b64_tr_b16 v[86:87], v27 offset:45056
    v_mfma_f32_16x16x32_bf16 a[24:27], v[44:47], v[192:195], a[24:27]
    ds_read_b64_tr_b16 v[88:89], v28 offset:40960
    ds_read_b64_tr_b16 v[90:91], v28 offset:45056
    v_mfma_f32_16x16x32_bf16 a[28:31], v[44:47], v[196:199], a[28:31]
    ds_read_b64_tr_b16 v[92:93], v29 offset:40960
    ds_read_b64_tr_b16 v[94:95], v29 offset:45056
    v_mfma_f32_16x16x32_bf16 a[32:35], v[48:51], v[192:195], a[32:35]
    buffer_load_dwordx4 v[184:187], v12, s[8:11], s25 offen sc1
    buffer_load_dwordx4 v[188:191], v13, s[8:11], s25 offen sc1
    v_mfma_f32_16x16x32_bf16 a[36:39], v[48:51], v[196:199], a[36:39]
    s_add_u32 s25, s25, 1024
    v_mfma_f32_16x16x32_bf16 a[40:43], v[52:55], v[192:195], a[40:43]
    v_mfma_f32_16x16x32_bf16 a[44:47], v[52:55], v[196:199], a[44:47]
    v_mfma_f32_16x16x32_bf16 a[48:51], v[56:59], v[192:195], a[48:51]
    v_mfma_f32_16x16x32_bf16 a[52:55], v[56:59], v[196:199], a[52:55]
    v_mfma_f32_16x16x32_bf16 a[56:59], v[60:63], v[192:195], a[56:59]
    v_mfma_f32_16x16x32_bf16 a[60:63], v[60:63], v[196:199], a[60:63]
    s_waitcnt vmcnt(50) lgkmcnt(0)
    s_barrier
    v_mfma_f32_16x16x32_bf16 a[0:3], v[64:67], v[200:203], a[0:3]
    ds_read_b64_tr_b16 v[32:33], v22 offset:49152
    ds_read_b64_tr_b16 v[34:35], v22 offset:53248
    v_mfma_f32_16x16x32_bf16 a[4:7], v[64:67], v[204:207], a[4:7]
    ds_read_b64_tr_b16 v[36:37], v23 offset:49152
    ds_read_b64_tr_b16 v[38:39], v23 offset:53248
    v_mfma_f32_16x16x32_bf16 a[8:11], v[68:71], v[200:203], a[8:11]
    ds_read_b64_tr_b16 v[40:41], v24 offset:49152
    ds_read_b64_tr_b16 v[42:43], v24 offset:53248
    v_mfma_f32_16x16x32_bf16 a[12:15], v[68:71], v[204:207], a[12:15]
    ds_read_b64_tr_b16 v[44:45], v25 offset:49152
    ds_read_b64_tr_b16 v[46:47], v25 offset:53248
    v_mfma_f32_16x16x32_bf16 a[16:19], v[72:75], v[200:203], a[16:19]
    ds_read_b64_tr_b16 v[48:49], v26 offset:49152
    ds_read_b64_tr_b16 v[50:51], v26 offset:53248
    v_mfma_f32_16x16x32_bf16 a[20:23], v[72:75], v[204:207], a[20:23]
    ds_read_b64_tr_b16 v[52:53], v27 offset:49152
    ds_read_b64_tr_b16 v[54:55], v27 offset:53248
    v_mfma_f32_16x16x32_bf16 a[24:27], v[76:79], v[200:203], a[24:27]
    ds_read_b64_tr_b16 v[56:57], v28 offset:49152
    ds_read_b64_tr_b16 v[58:59], v28 offset:53248
    v_mfma_f32_16x16x32_bf16 a[28:31], v[76:79], v[204:207], a[28:31]
    ds_read_b64_tr_b16 v[60:61], v29 offset:49152
    ds_read_b64_tr_b16 v[62:63], v29 offset:53248
    v_mfma_f32_16x16x32_bf16 a[32:35], v[80:83], v[200:203], a[32:35]
    buffer_load_dwordx4 v[192:195], v12, s[8:11], s25 offen sc1
    buffer_load_dwordx4 v[196:199], v13, s[8:11], s25 offen sc1
    v_mfma_f32_16x16x32_bf16 a[36:39], v[80:83], v[204:207], a[36:39]
    s_add_u32 s25, s25, 1024
    s_add_u32 m0, s28, 98304
    v_mfma_f32_16x16x32_bf16 a[40:43], v[84:87], v[200:203], a[40:43]
    s_nop 0
    buffer_load_dwordx4 v8, s[12:15], s26 offen offset:0 lds
    v_mfma_f32_16x16x32_bf16 a[44:47], v[84:87], v[204:207], a[44:47]
    buffer_load_dwordx4 v9, s[12:15], s26 offen offset:1024 lds
    buffer_load_dwordx4 v10, s[12:15], s26 offen offset:2048 lds
    v_mfma_f32_16x16x32_bf16 a[48:51], v[88:91], v[200:203], a[48:51]
    buffer_load_dwordx4 v11, s[12:15], s26 offen offset:3072 lds
    s_add_u32 s26, s26, 131072
    v_mfma_f32_16x16x32_bf16 a[52:55], v[88:91], v[204:207], a[52:55]
    v_mfma_f32_16x16x32_bf16 a[56:59], v[92:95], v[200:203], a[56:59]
    v_mfma_f32_16x16x32_bf16 a[60:63], v[92:95], v[204:207], a[60:63]
    s_waitcnt vmcnt(56) lgkmcnt(0)
    v_mfma_f32_16x16x32_bf16 a[0:3], v[32:35], v[208:211], a[0:3]
    ds_read_b64_tr_b16 v[64:65], v22 offset:57344
    ds_read_b64_tr_b16 v[66:67], v22 offset:61440
    v_mfma_f32_16x16x32_bf16 a[4:7], v[32:35], v[212:215], a[4:7]
    ds_read_b64_tr_b16 v[68:69], v23 offset:57344
    ds_read_b64_tr_b16 v[70:71], v23 offset:61440
    v_mfma_f32_16x16x32_bf16 a[8:11], v[36:39], v[208:211], a[8:11]
    ds_read_b64_tr_b16 v[72:73], v24 offset:57344
    ds_read_b64_tr_b16 v[74:75], v24 offset:61440
    v_mfma_f32_16x16x32_bf16 a[12:15], v[36:39], v[212:215], a[12:15]
    ds_read_b64_tr_b16 v[76:77], v25 offset:57344
    ds_read_b64_tr_b16 v[78:79], v25 offset:61440
    v_mfma_f32_16x16x32_bf16 a[16:19], v[40:43], v[208:211], a[16:19]
    ds_read_b64_tr_b16 v[80:81], v26 offset:57344
    ds_read_b64_tr_b16 v[82:83], v26 offset:61440
    v_mfma_f32_16x16x32_bf16 a[20:23], v[40:43], v[212:215], a[20:23]
    ds_read_b64_tr_b16 v[84:85], v27 offset:57344
    ds_read_b64_tr_b16 v[86:87], v27 offset:61440
    v_mfma_f32_16x16x32_bf16 a[24:27], v[44:47], v[208:211], a[24:27]
    ds_read_b64_tr_b16 v[88:89], v28 offset:57344
    ds_read_b64_tr_b16 v[90:91], v28 offset:61440
    v_mfma_f32_16x16x32_bf16 a[28:31], v[44:47], v[212:215], a[28:31]
    ds_read_b64_tr_b16 v[92:93], v29 offset:57344
    ds_read_b64_tr_b16 v[94:95], v29 offset:61440
    v_mfma_f32_16x16x32_bf16 a[32:35], v[48:51], v[208:211], a[32:35]
    buffer_load_dwordx4 v[200:203], v12, s[8:11], s25 offen sc1
    buffer_load_dwordx4 v[204:207], v13, s[8:11], s25 offen sc1
    v_mfma_f32_16x16x32_bf16 a[36:39], v[48:51], v[212:215], a[36:39]
    s_add_u32 s25, s25, 1024
    v_mfma_f32_16x16x32_bf16 a[40:43], v[52:55], v[208:211], a[40:43]
    v_mfma_f32_16x16x32_bf16 a[44:47], v[52:55], v[212:215], a[44:47]
    v_mfma_f32_16x16x32_bf16 a[48:51], v[56:59], v[208:211], a[48:51]
    v_mfma_f32_16x16x32_bf16 a[52:55], v[56:59], v[212:215], a[52:55]
    v_mfma_f32_16x16x32_bf16 a[56:59], v[60:63], v[208:211], a[56:59]
    v_mfma_f32_16x16x32_bf16 a[60:63], v[60:63], v[212:215], a[60:63]
    s_waitcnt vmcnt(50) lgkmcnt(0)
    s_barrier
    v_mfma_f32_16x16x32_bf16 a[0:3], v[64:67], v[216:219], a[0:3]
    ds_read_b64_tr_b16 v[32:33], v14 offset:0
    ds_read_b64_tr_b16 v[34:35], v14 offset:4096
    v_mfma_f32_16x16x32_bf16 a[4:7], v[64:67], v[220:223], a[4:7]
    ds_read_b64_tr_b16 v[36:37], v15 offset:0
    ds_read_b64_tr_b16 v[38:39], v15 offset:4096
    v_mfma_f32_16x16x32_bf16 a[8:11], v[68:71], v[216:219], a[8:11]
    ds_read_b64_tr_b16 v[40:41], v16 offset:0
    ds_read_b64_tr_b16 v[42:43], v16 offset:4096
    v_mfma_f32_16x16x32_bf16 a[12:15], v[68:71], v[220:223], a[12:15]
    ds_read_b64_tr_b16 v[44:45], v17 offset:0
    ds_read_b64_tr_b16 v[46:47], v17 offset:4096
    v_mfma_f32_16x16x32_bf16 a[16:19], v[72:75], v[216:219], a[16:19]
    ds_read_b64_tr_b16 v[48:49], v18 offset:0
    ds_read_b64_tr_b16 v[50:51], v18 offset:4096
    v_mfma_f32_16x16x32_bf16 a[20:23], v[72:75], v[220:223], a[20:23]
    ds_read_b64_tr_b16 v[52:53], v19 offset:0
    ds_read_b64_tr_b16 v[54:55], v19 offset:4096
    v_mfma_f32_16x16x32_bf16 a[24:27], v[76:79], v[216:219], a[24:27]
    ds_read_b64_tr_b16 v[56:57], v20 offset:0
    ds_read_b64_tr_b16 v[58:59], v20 offset:4096
    v_mfma_f32_16x16x32_bf16 a[28:31], v[76:79], v[220:223], a[28:31]
    ds_read_b64_tr_b16 v[60:61], v21 offset:0
    ds_read_b64_tr_b16 v[62:63], v21 offset:4096
    v_mfma_f32_16x16x32_bf16 a[32:35], v[80:83], v[216:219], a[32:35]
    buffer_load_dwordx4 v[208:211], v12, s[8:11], s25 offen sc1
    buffer_load_dwordx4 v[212:215], v13, s[8:11], s25 offen sc1
    v_mfma_f32_16x16x32_bf16 a[36:39], v[80:83], v[220:223], a[36:39]
    s_add_u32 s25, s25, 1024
    s_add_u32 m0, s28, 114688
    v_mfma_f32_16x16x32_bf16 a[40:43], v[84:87], v[216:219], a[40:43]
    s_nop 0
    buffer_load_dwordx4 v8, s[12:15], s26 offen offset:0 lds
    v_mfma_f32_16x16x32_bf16 a[44:47], v[84:87], v[220:223], a[44:47]
    buffer_load_dwordx4 v9, s[12:15], s26 offen offset:1024 lds
    buffer_load_dwordx4 v10, s[12:15], s26 offen offset:2048 lds
    v_mfma_f32_16x16x32_bf16 a[48:51], v[88:91], v[216:219], a[48:51]
    buffer_load_dwordx4 v11, s[12:15], s26 offen offset:3072 lds
    s_add_u32 s26, s26, 131072
    v_mfma_f32_16x16x32_bf16 a[52:55], v[88:91], v[220:223], a[52:55]
    v_mfma_f32_16x16x32_bf16 a[56:59], v[92:95], v[216:219], a[56:59]
    v_mfma_f32_16x16x32_bf16 a[60:63], v[92:95], v[220:223], a[60:63]
    s_sub_u32 s27, s27, 1
    s_cmp_lg_u32 s27, 0
    s_cbranch_scc1 mega_kernel_w_g4s_loop
mega_kernel_w_g4s_done:
    s_nop 7
    s_sub_u32 s30, s55, 13
    s_lshl_b32 s30, s30, 3
    s_add_u32 s30, s30, s60
    s_lshl_b32 s30, s30, 19
    s_lshl_b32 s31, s20, 17
    s_add_u32 s30, s30, s31
    s_lshl_b32 s31, s38, 13
    s_add_u32 s30, s30, s31
    s_add_u32 s30, s30, 115769344
    v_lshlrev_b32 v5, 5, v1

    s_add_u32 s31, s30, 0
    buffer_store_dwordx4 a[0:3], v4, s[8:11], s31 offen offset:0 sc1
    buffer_store_dwordx4 a[8:11], v4, s[8:11], s31 offen offset:1024 sc1
    buffer_store_dwordx4 a[16:19], v4, s[8:11], s31 offen offset:2048 sc1
    buffer_store_dwordx4 a[24:27], v4, s[8:11], s31 offen offset:3072 sc1
    s_add_u32 s31, s30, 4096
    buffer_store_dwordx4 a[32:35], v4, s[8:11], s31 offen offset:0 sc1
    buffer_store_dwordx4 a[40:43], v4, s[8:11], s31 offen offset:1024 sc1
    buffer_store_dwordx4 a[48:51], v4, s[8:11], s31 offen offset:2048 sc1
    buffer_store_dwordx4 a[56:59], v4, s[8:11], s31 offen offset:3072 sc1
    s_add_u32 s31, s30, 65536
    buffer_store_dwordx4 a[4:7], v4, s[8:11], s31 offen offset:0 sc1
    buffer_store_dwordx4 a[12:15], v4, s[8:11], s31 offen offset:1024 sc1
    buffer_store_dwordx4 a[20:23], v4, s[8:11], s31 offen offset:2048 sc1
    buffer_store_dwordx4 a[28:31], v4, s[8:11], s31 offen offset:3072 sc1
    s_add_u32 s31, s30, 69632
    buffer_store_dwordx4 a[36:39], v4, s[8:11], s31 offen offset:0 sc1
    buffer_store_dwordx4 a[44:47], v4, s[8:11], s31 offen offset:1024 sc1
    buffer_store_dwordx4 a[52:55], v4, s[8:11], s31 offen offset:2048 sc1
    buffer_store_dwordx4 a[60:63], v4, s[8:11], s31 offen offset:3072 sc1
    s_sub_u32 s36, s55, 13
    s_lshl_b32 s36, s36, 3
    s_add_u32 s36, s36, s38
    s_lshl_b32 s36, s36, 7
    s_add_u32 s36, s36, 102400
    s_waitcnt vmcnt(0)
    s_barrier
    s_cmp_lg_u32 s20, 0
    s_cbranch_scc1 mega_kernel_w_g4s_ns
    s_mov_b64 s[42:43], exec
    s_mov_b64 exec, 1
    v_mov_b32 v6, 0
    v_mov_b32 v7, 1
    buffer_atomic_add v7, v6, s[8:11], s36 offen
    s_mov_b64 exec, s[42:43]
mega_kernel_w_g4s_ns:

    s_mov_b32 s30, s36
    s_cmp_lg_u32 s20, 0
    s_cbranch_scc1 mega_kernel_w_g4s_wp_ok
    v_mov_b32 v5, 0
mega_kernel_w_g4s_wp:
    buffer_load_dword v6, v5, s[8:11], s30 offen sc1
    s_waitcnt vmcnt(0)
    v_readfirstlane_b32 s31, v6
    s_cmp_ge_u32 s31, 8
    s_cbranch_scc1 mega_kernel_w_g4s_wp_ok
    s_sub_u32 s40, s40, 1
    s_cbranch_scc1 mega_kernel_w_exit
    s_sleep 1
    s_branch mega_kernel_w_g4s_wp
mega_kernel_w_g4s_wp_ok:
    s_barrier

    s_sub_u32 s30, s55, 13
    s_lshl_b32 s30, s30, 22
    s_lshl_b32 s31, s60, 16
    s_add_u32 s30, s30, s31
    s_lshl_b32 s31, s38, 2
    s_add_u32 s31, s31, s20
    s_lshl_b32 s36, s31, 11
    s_add_u32 s30, s30, s36
    s_add_u32 s30, s30, 115769344
    v_lshlrev_b32 v5, 5, v1

    buffer_load_dwordx4 v[16:19], v4, s[8:11], s30 offen sc1
    buffer_load_dwordx4 v[20:23], v4, s[8:11], s30 offen offset:1024 sc1
    s_add_u32 s30, s30, 524288
    buffer_load_dwordx4 v[24:27], v4, s[8:11], s30 offen sc1
    buffer_load_dwordx4 v[28:31], v4, s[8:11], s30 offen offset:1024 sc1
    s_add_u32 s30, s30, 524288
    buffer_load_dwordx4 v[32:35], v4, s[8:11], s30 offen sc1
    buffer_load_dwordx4 v[36:39], v4, s[8:11], s30 offen offset:1024 sc1
    s_add_u32 s30, s30, 524288
    buffer_load_dwordx4 v[40:43], v4, s[8:11], s30 offen sc1
    buffer_load_dwordx4 v[44:47], v4, s[8:11], s30 offen offset:1024 sc1
    s_add_u32 s30, s30, 524288
    buffer_load_dwordx4 v[48:51], v4, s[8:11], s30 offen sc1
    buffer_load_dwordx4 v[52:55], v4, s[8:11], s30 offen offset:1024 sc1
    s_add_u32 s30, s30, 524288
    buffer_load_dwordx4 v[56:59], v4, s[8:11], s30 offen sc1
    buffer_load_dwordx4 v[60:63], v4, s[8:11], s30 offen offset:1024 sc1
    s_add_u32 s30, s30, 524288
    buffer_load_dwordx4 v[64:67], v4, s[8:11], s30 offen sc1
    buffer_load_dwordx4 v[68:71], v4, s[8:11], s30 offen offset:1024 sc1
    s_add_u32 s30, s30, 524288
    buffer_load_dwordx4 v[72:75], v4, s[8:11], s30 offen sc1
    buffer_load_dwordx4 v[76:79], v4, s[8:11], s30 offen offset:1024 sc1
    v_lshlrev_b32 v6, 11, v2
    v_lshl_add_u32 v6, v3, 3, v6
    s_lshl_b32 s36, s55, 3
    s_add_u32 s36, s36, s60
    s_lshl_b32 s37, s36, 15
    s_lshl_b32 s30, s31, 6
    s_add_u32 s37, s37, s30
    buffer_load_dwordx2 v[88:89], v6, s[16:19], s37 offen
    buffer_load_dwordx2 v[90:91], v6, s[16:19], s37 offen offset:32
    v_lshlrev_b32 v7, 4, v3
    s_lshl_b32 s30, s31, 7
    s_add_u32 s30, s30, 8192
    buffer_load_dwordx4 v[92:95], v7, s[8:11], s30 offen sc1
    buffer_load_dwordx4 v[96:99], v7, s[8:11], s30 offen offset:64 sc1
    s_lshl_b32 s36, s36, 15
    s_lshl_b32 s30, s31, 10
    s_add_u32 s36, s36, s30
    s_add_u32 s36, s36, 82214912
    s_waitcnt vmcnt(0)

    v_add_f32 v16, v16, v24
    v_add_f32 v17, v17, v25
    v_add_f32 v18, v18, v26
    v_add_f32 v19, v19, v27
    v_add_f32 v20, v20, v28
    v_add_f32 v21, v21, v29
    v_add_f32 v22, v22, v30
    v_add_f32 v23, v23, v31
    v_add_f32 v16, v16, v32
    v_add_f32 v17, v17, v33
    v_add_f32 v18, v18, v34
    v_add_f32 v19, v19, v35
    v_add_f32 v20, v20, v36
    v_add_f32 v21, v21, v37
    v_add_f32 v22, v22, v38
    v_add_f32 v23, v23, v39
    v_add_f32 v16, v16, v40
    v_add_f32 v17, v17, v41
    v_add_f32 v18, v18, v42
    v_add_f32 v19, v19, v43
    v_add_f32 v20, v20, v44
    v_add_f32 v21, v21, v45
    v_add_f32 v22, v22, v46
    v_add_f32 v23, v23, v47
    v_add_f32 v16, v16, v48
    v_add_f32 v17, v17, v49
    v_add_f32 v18, v18, v50
    v_add_f32 v19, v19, v51
    v_add_f32 v20, v20, v52
    v_add_f32 v21, v21, v53
    v_add_f32 v22, v22, v54
    v_add_f32 v23, v23, v55
    v_add_f32 v16, v16, v56
    v_add_f32 v17, v17, v57
    v_add_f32 v18, v18, v58
    v_add_f32 v19, v19, v59
    v_add_f32 v20, v20, v60
    v_add_f32 v21, v21, v61
    v_add_f32 v22, v22, v62
    v_add_f32 v23, v23, v63
    v_add_f32 v16, v16, v64
    v_add_f32 v17, v17, v65
    v_add_f32 v18, v18, v66
    v_add_f32 v19, v19, v67
    v_add_f32 v20, v20, v68
    v_add_f32 v21, v21, v69
    v_add_f32 v22, v22, v70
    v_add_f32 v23, v23, v71
    v_add_f32 v16, v16, v72
    v_add_f32 v17, v17, v73
    v_add_f32 v18, v18, v74
    v_add_f32 v19, v19, v75
    v_add_f32 v20, v20, v76
    v_add_f32 v21, v21, v77
    v_add_f32 v22, v22, v78
    v_add_f32 v23, v23, v79
    v_lshlrev_b32 v100, 16, v88
    v_fma_f32 v16, v16, v92, v100
    v_and_b32 v100, 0xffff0000, v88
    v_fma_f32 v17, v17, v93, v100
    v_lshlrev_b32 v100, 16, v89
    v_fma_f32 v18, v18, v94, v100
    v_and_b32 v100, 0xffff0000, v89
    v_fma_f32 v19, v19, v95, v100
    v_lshlrev_b32 v100, 16, v90
    v_fma_f32 v20, v20, v96, v100
    v_and_b32 v100, 0xffff0000, v90
    v_fma_f32 v21, v21, v97, v100
    v_lshlrev_b32 v100, 16, v91
    v_fma_f32 v22, v22, v98, v100
    v_and_b32 v100, 0xffff0000, v91
    v_fma_f32 v23, v23, v99, v100
    v_cvt_pk_bf16_f32 v16, v16, v17
    v_cvt_pk_bf16_f32 v17, v18, v19
    v_cvt_pk_bf16_f32 v18, v20, v21
    v_cvt_pk_bf16_f32 v19, v22, v23
    buffer_store_dwordx4 v[16:19], v4, s[8:11], s36 offen sc1
    s_lshl_b32 s41, s55, 7
    s_add_u32 s41, s41, 123008
    s_branch mega_kernel_w_next
mega_kernel_w_pf:
    s_load_dwordx2 s[44:45], s[0:1], 64
    s_load_dwordx2 s[46:47], s[0:1], 80
    s_lshl_b32 s30, s38, 2
    s_add_u32 s30, s30, s55
    s_waitcnt lgkmcnt(0)
    s_cmp_lt_u32 s30, 16
    s_cselect_b32 s12, s44, s46
    s_cselect_b32 s13, s45, s47
    s_mov_b32 s14, 14680064
    s_mov_b32 s15, 0x20000
    s_and_b32 s30, s30, 15
    s_mul_i32 s30, s30, 917504
    v_lshlrev_b32 v5, 4, v0
    s_mov_b32 s60, 28
mega_kernel_w_pfl:

    buffer_load_dwordx4 v[16:19], v5, s[12:15], s30 offen
    s_add_u32 s30, s30, 4096
    buffer_load_dwordx4 v[20:23], v5, s[12:15], s30 offen
    s_add_u32 s30, s30, 4096
    buffer_load_dwordx4 v[24:27], v5, s[12:15], s30 offen
    s_add_u32 s30, s30, 4096
    buffer_load_dwordx4 v[28:31], v5, s[12:15], s30 offen
    s_add_u32 s30, s30, 4096
    buffer_load_dwordx4 v[32:35], v5, s[12:15], s30 offen
    s_add_u32 s30, s30, 4096
    buffer_load_dwordx4 v[36:39], v5, s[12:15], s30 offen
    s_add_u32 s30, s30, 4096
    buffer_load_dwordx4 v[40:43], v5, s[12:15], s30 offen
    s_add_u32 s30, s30, 4096
    buffer_load_dwordx4 v[44:47], v5, s[12:15], s30 offen
    s_add_u32 s30, s30, 4096
    s_waitcnt vmcnt(0)
    s_sub_u32 s60, s60, 1
    s_cmp_lg_u32 s60, 0
    s_cbranch_scc1 mega_kernel_w_pfl
    s_branch mega_kernel_w_next

mega_kernel_w_tail0:
    s_load_dwordx2 s[44:45], s[0:1], 16
    s_load_dwordx2 s[46:47], s[0:1], 24
    s_load_dwordx2 s[48:49], s[0:1], 32
    s_load_dwordx2 s[50:51], s[0:1], 40
    s_load_dwordx2 s[52:53], s[0:1], 0
    s_mov_b32 s54, 0x3e0293ee
    s_mov_b32 s41, 0
    s_mov_b32 s62, -1
    s_waitcnt lgkmcnt(0)
    s_lshr_b32 s21, s20, 1
    s_and_b32 s22, s20, 1
    s_mov_b32 s40, 2000000

mega_kernel_w_tail:
    s_waitcnt vmcnt(0) lgkmcnt(0)
    s_barrier
    s_cmp_ge_u32 s61, 28
    s_cbranch_scc1 mega_kernel_w_t_xln
    s_load_dwordx2 s[44:45], s[0:1], 64
    s_load_dwordx2 s[46:47], s[0:1], 72
    s_and_b32 s34, s38, 1
    s_lshl_b32 s34, s34, 2
    s_and_b32 s30, s61, 3
    s_add_u32 s34, s34, s30
    s_lshr_b32 s33, s38, 1
    s_mul_i32 s33, s33, 7
    s_lshr_b32 s30, s61, 2
    s_add_u32 s33, s33, s30
    s_waitcnt lgkmcnt(0)

    s_mov_b32 s12, s44
    s_mov_b32 s13, s45
    s_mov_b32 s14, 14680064
    s_mov_b32 s15, 0x20000
    s_mov_b32 s16, s46
    s_mov_b32 s17, s47
    s_mov_b32 s18, 7168
    s_mov_b32 s19, 0x20000
    s_lshl_b32 s28, s20, 12
    v_lshrrev_b32 v5, 4, v1
    s_lshl_b32 s30, s20, 4
    v_add_u32 v5, s30, v5
    v_and_b32 v6, 15, v1
    s_mov_b32 s31, 7168
    v_add_u32 v7, 0, v5
    v_and_b32 v8, 7, v7
    v_lshlrev_b32 v8, 1, v8
    v_xor_b32 v8, v8, v6
    v_lshlrev_b32 v8, 4, v8
    v_mul_lo_u32 v7, v7, s31
    v_add_u32 v8, v8, v7
    v_add_u32 v7, 4, v5
    v_and_b32 v9, 7, v7
    v_lshlrev_b32 v9, 1, v9
    v_xor_b32 v9, v9, v6
    v_lshlrev_b32 v9, 4, v9
    v_mul_lo_u32 v7, v7, s31
    v_add_u32 v9, v9, v7
    v_subrev_u32 v9, 1024, v9
    v_add_u32 v7, 8, v5
    v_and_b32 v10, 7, v7
    v_lshlrev_b32 v10, 1, v10
    v_xor_b32 v10, v10, v6
    v_lshlrev_b32 v10, 4, v10
    v_mul_lo_u32 v7, v7, s31
    v_add_u32 v10, v10, v7
    v_subrev_u32 v10, 2048, v10
    v_add_u32 v7, 12, v5
    v_and_b32 v11, 7, v7
    v_lshlrev_b32 v11, 1, v11
    v_xor_b32 v11, v11, v6
    v_lshlrev_b32 v11, 4, v11
    v_mul_lo_u32 v7, v7, s31
    v_add_u32 v11, v11, v7
    v_subrev_u32 v11, 3072, v11
    v_lshrrev_b32 v5, 2, v2
    v_lshl_add_u32 v5, v3, 2, v5
    v_and_b32 v6, 7, v5
    v_lshlrev_b32 v6, 5, v6
    v_lshlrev_b32 v5, 8, v5
    v_and_b32 v7, 3, v2
    v_lshl_add_u32 v5, v7, 3, v5
    v_xor_b32 v14, 0, v6
    v_add_u32 v14, v14, v5
    v_add_u32 v22, 0x10000, v14
    v_xor_b32 v15, 32, v6
    v_add_u32 v15, v15, v5
    v_add_u32 v23, 0x10000, v15
    v_xor_b32 v16, 64, v6
    v_add_u32 v16, v16, v5
    v_add_u32 v24, 0x10000, v16
    v_xor_b32 v17, 96, v6
    v_add_u32 v17, v17, v5
    v_add_u32 v25, 0x10000, v17
    v_xor_b32 v18, 128, v6
    v_add_u32 v18, v18, v5
    v_add_u32 v26, 0x10000, v18
    v_xor_b32 v19, 160, v6
    v_add_u32 v19, v19, v5
    v_add_u32 v27, 0x10000, v19
    v_xor_b32 v20, 192, v6
    v_add_u32 v20, v20, v5
    v_add_u32 v28, 0x10000, v20
    v_xor_b32 v21, 224, v6
    v_add_u32 v21, v21, v5
    v_add_u32 v29, 0x10000, v21
    s_mul_i32 s30, s20, 131072
    v_add_u32 v12, s30, v4
    v_add_u32 v13, 65536, v12
    s_lshl_b32 s26, s33, 8
    s_lshl_b32 s25, s34, 19
    s_add_u32 s25, s25, 86409216

    s_add_u32 m0, s28, 0
    s_nop 0
    buffer_load_dwordx4 v8, s[12:15], s26 offen offset:0 lds
    buffer_load_dwordx4 v9, s[12:15], s26 offen offset:1024 lds
    buffer_load_dwordx4 v10, s[12:15], s26 offen offset:2048 lds
    buffer_load_dwordx4 v11, s[12:15], s26 offen offset:3072 lds
    s_add_u32 s26, s26, 458752
    s_add_u32 m0, s28, 16384
    s_nop 0
    buffer_load_dwordx4 v8, s[12:15], s26 offen offset:0 lds
    buffer_load_dwordx4 v9, s[12:15], s26 offen offset:1024 lds
    buffer_load_dwordx4 v10, s[12:15], s26 offen offset:2048 lds
    buffer_load_dwordx4 v11, s[12:15], s26 offen offset:3072 lds
    s_add_u32 s26, s26, 458752
    s_add_u32 m0, s28, 32768
    s_nop 0
    buffer_load_dwordx4 v8, s[12:15], s26 offen offset:0 lds
    buffer_load_dwordx4 v9, s[12:15], s26 offen offset:1024 lds
    buffer_load_dwordx4 v10, s[12:15], s26 offen offset:2048 lds
    buffer_load_dwordx4 v11, s[12:15], s26 offen offset:3072 lds
    s_add_u32 s26, s26, 458752
    s_add_u32 m0, s28, 49152
    s_nop 0
    buffer_load_dwordx4 v8, s[12:15], s26 offen offset:0 lds
    buffer_load_dwordx4 v9, s[12:15], s26 offen offset:1024 lds
    buffer_load_dwordx4 v10, s[12:15], s26 offen offset:2048 lds
    buffer_load_dwordx4 v11, s[12:15], s26 offen offset:3072 lds
    s_add_u32 s26, s26, 458752
    s_add_u32 m0, s28, 65536
    s_nop 0
    buffer_load_dwordx4 v8, s[12:15], s26 offen offset:0 lds
    buffer_load_dwordx4 v9, s[12:15], s26 offen offset:1024 lds
    buffer_load_dwordx4 v10, s[12:15], s26 offen offset:2048 lds
    buffer_load_dwordx4 v11, s[12:15], s26 offen offset:3072 lds
    s_add_u32 s26, s26, 458752
    s_add_u32 m0, s28, 81920
    s_nop 0
    buffer_load_dwordx4 v8, s[12:15], s26 offen offset:0 lds
    buffer_load_dwordx4 v9, s[12:15], s26 offen offset:1024 lds
    buffer_load_dwordx4 v10, s[12:15], s26 offen offset:2048 lds
    buffer_load_dwordx4 v11, s[12:15], s26 offen offset:3072 lds
    s_add_u32 s26, s26, 458752
    s_add_u32 m0, s28, 98304
    s_nop 0
    buffer_load_dwordx4 v8, s[12:15], s26 offen offset:0 lds
    buffer_load_dwordx4 v9, s[12:15], s26 offen offset:1024 lds
    buffer_load_dwordx4 v10, s[12:15], s26 offen offset:2048 lds
    buffer_load_dwordx4 v11, s[12:15], s26 offen offset:3072 lds
    s_add_u32 s26, s26, 458752
    s_add_u32 m0, s28, 114688
    s_nop 0
    buffer_load_dwordx4 v8, s[12:15], s26 offen offset:0 lds
    buffer_load_dwordx4 v9, s[12:15], s26 offen offset:1024 lds
    buffer_load_dwordx4 v10, s[12:15], s26 offen offset:2048 lds
    buffer_load_dwordx4 v11, s[12:15], s26 offen offset:3072 lds
    s_add_u32 s26, s26, 458752
    s_mov_b32 s30, 122880
    s_cmp_lg_u32 s20, 0
    s_cbranch_scc1 mega_kernel_w_t_w5_ok
    v_mov_b32 v250, 0
mega_kernel_w_t_w5:
    buffer_load_dword v251, v250, s[8:11], s30 offen sc1
    s_waitcnt vmcnt(0)
    v_readfirstlane_b32 s31, v251
    s_cmp_ge_u32 s31, 48
    s_cbranch_scc1 mega_kernel_w_t_w5_ok
    s_sub_u32 s40, s40, 1
    s_cbranch_scc1 mega_kernel_w_exit
    s_sleep 10
    s_branch mega_kernel_w_t_w5
mega_kernel_w_t_w5_ok:
    s_barrier

    buffer_load_dwordx4 v[96:99], v12, s[8:11], s25 offen sc1
    buffer_load_dwordx4 v[100:103], v13, s[8:11], s25 offen sc1
    s_add_u32 s25, s25, 1024
    buffer_load_dwordx4 v[104:107], v12, s[8:11], s25 offen sc1
    buffer_load_dwordx4 v[108:111], v13, s[8:11], s25 offen sc1
    s_add_u32 s25, s25, 1024
    buffer_load_dwordx4 v[112:115], v12, s[8:11], s25 offen sc1
    buffer_load_dwordx4 v[116:119], v13, s[8:11], s25 offen sc1
    s_add_u32 s25, s25, 1024
    buffer_load_dwordx4 v[120:123], v12, s[8:11], s25 offen sc1
    buffer_load_dwordx4 v[124:127], v13, s[8:11], s25 offen sc1
    s_add_u32 s25, s25, 1024
    buffer_load_dwordx4 v[128:131], v12, s[8:11], s25 offen sc1
    buffer_load_dwordx4 v[132:135], v13, s[8:11], s25 offen sc1
    s_add_u32 s25, s25, 1024
    buffer_load_dwordx4 v[136:139], v12, s[8:11], s25 offen sc1
    buffer_load_dwordx4 v[140:143], v13, s[8:11], s25 offen sc1
    s_add_u32 s25, s25, 1024
    buffer_load_dwordx4 v[144:147], v12, s[8:11], s25 offen sc1
    buffer_load_dwordx4 v[148:151], v13, s[8:11], s25 offen sc1
    s_add_u32 s25, s25, 1024
    buffer_load_dwordx4 v[152:155], v12, s[8:11], s25 offen sc1
    buffer_load_dwordx4 v[156:159], v13, s[8:11], s25 offen sc1
    s_add_u32 s25, s25, 1024
    buffer_load_dwordx4 v[160:163], v12, s[8:11], s25 offen sc1
    buffer_load_dwordx4 v[164:167], v13, s[8:11], s25 offen sc1
    s_add_u32 s25, s25, 1024
    buffer_load_dwordx4 v[168:171], v12, s[8:11], s25 offen sc1
    buffer_load_dwordx4 v[172:175], v13, s[8:11], s25 offen sc1
    s_add_u32 s25, s25, 1024
    buffer_load_dwordx4 v[176:179], v12, s[8:11], s25 offen sc1
    buffer_load_dwordx4 v[180:183], v13, s[8:11], s25 offen sc1
    s_add_u32 s25, s25, 1024
    buffer_load_dwordx4 v[184:187], v12, s[8:11], s25 offen sc1
    buffer_load_dwordx4 v[188:191], v13, s[8:11], s25 offen sc1
    s_add_u32 s25, s25, 1024
    buffer_load_dwordx4 v[192:195], v12, s[8:11], s25 offen sc1
    buffer_load_dwordx4 v[196:199], v13, s[8:11], s25 offen sc1
    s_add_u32 s25, s25, 1024
    buffer_load_dwordx4 v[200:203], v12, s[8:11], s25 offen sc1
    buffer_load_dwordx4 v[204:207], v13, s[8:11], s25 offen sc1
    s_add_u32 s25, s25, 1024
    buffer_load_dwordx4 v[208:211], v12, s[8:11], s25 offen sc1
    buffer_load_dwordx4 v[212:215], v13, s[8:11], s25 offen sc1
    s_add_u32 s25, s25, 1024
    v_accvgpr_write_b32 a0, 0
    v_accvgpr_write_b32 a1, 0
    v_accvgpr_write_b32 a2, 0
    v_accvgpr_write_b32 a3, 0
    v_accvgpr_write_b32 a4, 0
    v_accvgpr_write_b32 a5, 0
    v_accvgpr_write_b32 a6, 0
    v_accvgpr_write_b32 a7, 0
    v_accvgpr_write_b32 a8, 0
    v_accvgpr_write_b32 a9, 0
    v_accvgpr_write_b32 a10, 0
    v_accvgpr_write_b32 a11, 0
    v_accvgpr_write_b32 a12, 0
    v_accvgpr_write_b32 a13, 0
    v_accvgpr_write_b32 a14, 0
    v_accvgpr_write_b32 a15, 0
    v_accvgpr_write_b32 a16, 0
    v_accvgpr_write_b32 a17, 0
    v_accvgpr_write_b32 a18, 0
    v_accvgpr_write_b32 a19, 0
    v_accvgpr_write_b32 a20, 0
    v_accvgpr_write_b32 a21, 0
    v_accvgpr_write_b32 a22, 0
    v_accvgpr_write_b32 a23, 0
    v_accvgpr_write_b32 a24, 0
    v_accvgpr_write_b32 a25, 0
    v_accvgpr_write_b32 a26, 0
    v_accvgpr_write_b32 a27, 0
    v_accvgpr_write_b32 a28, 0
    v_accvgpr_write_b32 a29, 0
    v_accvgpr_write_b32 a30, 0
    v_accvgpr_write_b32 a31, 0
    v_accvgpr_write_b32 a32, 0
    v_accvgpr_write_b32 a33, 0
    v_accvgpr_write_b32 a34, 0
    v_accvgpr_write_b32 a35, 0
    v_accvgpr_write_b32 a36, 0
    v_accvgpr_write_b32 a37, 0
    v_accvgpr_write_b32 a38, 0
    v_accvgpr_write_b32 a39, 0
    v_accvgpr_write_b32 a40, 0
    v_accvgpr_write_b32 a41, 0
    v_accvgpr_write_b32 a42, 0
    v_accvgpr_write_b32 a43, 0
    v_accvgpr_write_b32 a44, 0
    v_accvgpr_write_b32 a45, 0
    v_accvgpr_write_b32 a46, 0
    v_accvgpr_write_b32 a47, 0
    v_accvgpr_write_b32 a48, 0
    v_accvgpr_write_b32 a49, 0
    v_accvgpr_write_b32 a50, 0
    v_accvgpr_write_b32 a51, 0
    v_accvgpr_write_b32 a52, 0
    v_accvgpr_write_b32 a53, 0
    v_accvgpr_write_b32 a54, 0
    v_accvgpr_write_b32 a55, 0
    v_accvgpr_write_b32 a56, 0
    v_accvgpr_write_b32 a57, 0
    v_accvgpr_write_b32 a58, 0
    v_accvgpr_write_b32 a59, 0
    v_accvgpr_write_b32 a60, 0
    v_accvgpr_write_b32 a61, 0
    v_accvgpr_write_b32 a62, 0
    v_accvgpr_write_b32 a63, 0
    s_mov_b32 s27, 4
    s_waitcnt vmcnt(58)
    s_barrier
    ds_read_b64_tr_b16 v[32:33], v14 offset:0
    ds_read_b64_tr_b16 v[34:35], v14 offset:4096
    ds_read_b64_tr_b16 v[36:37], v15 offset:0
    ds_read_b64_tr_b16 v[38:39], v15 offset:4096
    ds_read_b64_tr_b16 v[40:41], v16 offset:0
    ds_read_b64_tr_b16 v[42:43], v16 offset:4096
    ds_read_b64_tr_b16 v[44:45], v17 offset:0
    ds_read_b64_tr_b16 v[46:47], v17 offset:4096
    ds_read_b64_tr_b16 v[48:49], v18 offset:0
    ds_read_b64_tr_b16 v[50:51], v18 offset:4096
    ds_read_b64_tr_b16 v[52:53], v19 offset:0
    ds_read_b64_tr_b16 v[54:55], v19 offset:4096
    ds_read_b64_tr_b16 v[56:57], v20 offset:0
    ds_read_b64_tr_b16 v[58:59], v20 offset:4096
    ds_read_b64_tr_b16 v[60:61], v21 offset:0
    ds_read_b64_tr_b16 v[62:63], v21 offset:4096
mega_kernel_w_t_5_loop:
    s_cmp_lg_u32 s27, 2
    s_cbranch_scc1 mega_kernel_w_t_5_nomid
    s_mov_b32 s30, 122944
    s_cmp_lg_u32 s20, 0
    s_cbranch_scc1 mega_kernel_w_t_w5b_ok
    v_mov_b32 v250, 0
mega_kernel_w_t_w5b:
    buffer_load_dword v251, v250, s[8:11], s30 offen sc1
    s_waitcnt vmcnt(0)
    v_readfirstlane_b32 s31, v251
    s_cmp_ge_u32 s31, 8
    s_cbranch_scc1 mega_kernel_w_t_w5b_ok
    s_sub_u32 s40, s40, 1
    s_cbranch_scc1 mega_kernel_w_exit
    s_sleep 2
    s_branch mega_kernel_w_t_w5b
mega_kernel_w_t_w5b_ok:
    s_barrier

mega_kernel_w_t_5_nomid:
    s_waitcnt vmcnt(28) lgkmcnt(0)
    v_mfma_f32_16x16x32_bf16 a[0:3], v[32:35], v[96:99], a[0:3]
    ds_read_b64_tr_b16 v[64:65], v14 offset:8192
    ds_read_b64_tr_b16 v[66:67], v14 offset:12288
    v_mfma_f32_16x16x32_bf16 a[4:7], v[32:35], v[100:103], a[4:7]
    ds_read_b64_tr_b16 v[68:69], v15 offset:8192
    ds_read_b64_tr_b16 v[70:71], v15 offset:12288
    v_mfma_f32_16x16x32_bf16 a[8:11], v[36:39], v[96:99], a[8:11]
    ds_read_b64_tr_b16 v[72:73], v16 offset:8192
    ds_read_b64_tr_b16 v[74:75], v16 offset:12288
    v_mfma_f32_16x16x32_bf16 a[12:15], v[36:39], v[100:103], a[12:15]
    ds_read_b64_tr_b16 v[76:77], v17 offset:8192
    ds_read_b64_tr_b16 v[78:79], v17 offset:12288
    v_mfma_f32_16x16x32_bf16 a[16:19], v[40:43], v[96:99], a[16:19]
    ds_read_b64_tr_b16 v[80:81], v18 offset:8192
    ds_read_b64_tr_b16 v[82:83], v18 offset:12288
    v_mfma_f32_16x16x32_bf16 a[20:23], v[40:43], v[100:103], a[20:23]
    ds_read_b64_tr_b16 v[84:85], v19 offset:8192
    ds_read_b64_tr_b16 v[86:87], v19 offset:12288
    v_mfma_f32_16x16x32_bf16 a[24:27], v[44:47], v[96:99], a[24:27]
    ds_read_b64_tr_b16 v[88:89], v20 offset:8192
    ds_read_b64_tr_b16 v[90:91], v20 offset:12288
    v_mfma_f32_16x16x32_bf16 a[28:31], v[44:47], v[100:103], a[28:31]
    ds_read_b64_tr_b16 v[92:93], v21 offset:8192
    ds_read_b64_tr_b16 v[94:95], v21 offset:12288
    v_mfma_f32_16x16x32_bf16 a[32:35], v[48:51], v[96:99], a[32:35]
    buffer_load_dwordx4 v[216:219], v12, s[8:11], s25 offen sc1
    buffer_load_dwordx4 v[220:223], v13, s[8:11], s25 offen sc1
    v_mfma_f32_16x16x32_bf16 a[36:39], v[48:51], v[100:103], a[36:39]
    s_add_u32 s25, s25, 1024
    v_mfma_f32_16x16x32_bf16 a[40:43], v[52:55], v[96:99], a[40:43]
    v_mfma_f32_16x16x32_bf16 a[44:47], v[52:55], v[100:103], a[44:47]
    v_mfma_f32_16x16x32_bf16 a[48:51], v[56:59], v[96:99], a[48:51]
    v_mfma_f32_16x16x32_bf16 a[52:55], v[56:59], v[100:103], a[52:55]
    v_mfma_f32_16x16x32_bf16 a[56:59], v[60:63], v[96:99], a[56:59]
    v_mfma_f32_16x16x32_bf16 a[60:63], v[60:63], v[100:103], a[60:63]
    s_waitcnt vmcnt(28) lgkmcnt(0)
    s_barrier
    v_mfma_f32_16x16x32_bf16 a[0:3], v[64:67], v[104:107], a[0:3]
    ds_read_b64_tr_b16 v[32:33], v14 offset:16384
    ds_read_b64_tr_b16 v[34:35], v14 offset:20480
    v_mfma_f32_16x16x32_bf16 a[4:7], v[64:67], v[108:111], a[4:7]
    ds_read_b64_tr_b16 v[36:37], v15 offset:16384
    ds_read_b64_tr_b16 v[38:39], v15 offset:20480
    v_mfma_f32_16x16x32_bf16 a[8:11], v[68:71], v[104:107], a[8:11]
    ds_read_b64_tr_b16 v[40:41], v16 offset:16384
    ds_read_b64_tr_b16 v[42:43], v16 offset:20480
    v_mfma_f32_16x16x32_bf16 a[12:15], v[68:71], v[108:111], a[12:15]
    ds_read_b64_tr_b16 v[44:45], v17 offset:16384
    ds_read_b64_tr_b16 v[46:47], v17 offset:20480
    v_mfma_f32_16x16x32_bf16 a[16:19], v[72:75], v[104:107], a[16:19]
    ds_read_b64_tr_b16 v[48:49], v18 offset:16384
    ds_read_b64_tr_b16 v[50:51], v18 offset:20480
    v_mfma_f32_16x16x32_bf16 a[20:23], v[72:75], v[108:111], a[20:23]
    ds_read_b64_tr_b16 v[52:53], v19 offset:16384
    ds_read_b64_tr_b16 v[54:55], v19 offset:20480
    v_mfma_f32_16x16x32_bf16 a[24:27], v[76:79], v[104:107], a[24:27]
    ds_read_b64_tr_b16 v[56:57], v20 offset:16384
    ds_read_b64_tr_b16 v[58:59], v20 offset:20480
    v_mfma_f32_16x16x32_bf16 a[28:31], v[76:79], v[108:111], a[28:31]
    ds_read_b64_tr_b16 v[60:61], v21 offset:16384
    ds_read_b64_tr_b16 v[62:63], v21 offset:20480
    v_mfma_f32_16x16x32_bf16 a[32:35], v[80:83], v[104:107], a[32:35]
    buffer_load_dwordx4 v[96:99], v12, s[8:11], s25 offen sc1
    buffer_load_dwordx4 v[100:103], v13, s[8:11], s25 offen sc1
    v_mfma_f32_16x16x32_bf16 a[36:39], v[80:83], v[108:111], a[36:39]
    s_add_u32 s25, s25, 1024
    s_add_u32 m0, s28, 0
    v_mfma_f32_16x16x32_bf16 a[40:43], v[84:87], v[104:107], a[40:43]
    s_nop 0
    buffer_load_dwordx4 v8, s[12:15], s26 offen offset:0 lds
    v_mfma_f32_16x16x32_bf16 a[44:47], v[84:87], v[108:111], a[44:47]
    buffer_load_dwordx4 v9, s[12:15], s26 offen offset:1024 lds
    buffer_load_dwordx4 v10, s[12:15], s26 offen offset:2048 lds
    v_mfma_f32_16x16x32_bf16 a[48:51], v[88:91], v[104:107], a[48:51]
    buffer_load_dwordx4 v11, s[12:15], s26 offen offset:3072 lds
    s_add_u32 s26, s26, 458752
    v_mfma_f32_16x16x32_bf16 a[52:55], v[88:91], v[108:111], a[52:55]
    v_mfma_f32_16x16x32_bf16 a[56:59], v[92:95], v[104:107], a[56:59]
    v_mfma_f32_16x16x32_bf16 a[60:63], v[92:95], v[108:111], a[60:63]
    s_waitcnt vmcnt(32) lgkmcnt(0)
    v_mfma_f32_16x16x32_bf16 a[0:3], v[32:35], v[112:115], a[0:3]
    ds_read_b64_tr_b16 v[64:65], v14 offset:24576
    ds_read_b64_tr_b16 v[66:67], v14 offset:28672
    v_mfma_f32_16x16x32_bf16 a[4:7], v[32:35], v[116:119], a[4:7]
    ds_read_b64_tr_b16 v[68:69], v15 offset:24576
    ds_read_b64_tr_b16 v[70:71], v15 offset:28672
    v_mfma_f32_16x16x32_bf16 a[8:11], v[36:39], v[112:115], a[8:11]
    ds_read_b64_tr_b16 v[72:73], v16 offset:24576
    ds_read_b64_tr_b16 v[74:75], v16 offset:28672
    v_mfma_f32_16x16x32_bf16 a[12:15], v[36:39], v[116:119], a[12:15]
    ds_read_b64_tr_b16 v[76:77], v17 offset:24576
    ds_read_b64_tr_b16 v[78:79], v17 offset:28672
    v_mfma_f32_16x16x32_bf16 a[16:19], v[40:43], v[112:115], a[16:19]
    ds_read_b64_tr_b16 v[80:81], v18 offset:24576
    ds_read_b64_tr_b16 v[82:83], v18 offset:28672
    v_mfma_f32_16x16x32_bf16 a[20:23], v[40:43], v[116:119], a[20:23]
    ds_read_b64_tr_b16 v[84:85], v19 offset:24576
    ds_read_b64_tr_b16 v[86:87], v19 offset:28672
    v_mfma_f32_16x16x32_bf16 a[24:27], v[44:47], v[112:115], a[24:27]
    ds_read_b64_tr_b16 v[88:89], v20 offset:24576
    ds_read_b64_tr_b16 v[90:91], v20 offset:28672
    v_mfma_f32_16x16x32_bf16 a[28:31], v[44:47], v[116:119], a[28:31]
    ds_read_b64_tr_b16 v[92:93], v21 offset:24576
    ds_read_b64_tr_b16 v[94:95], v21 offset:28672
    v_mfma_f32_16x16x32_bf16 a[32:35], v[48:51], v[112:115], a[32:35]
    buffer_load_dwordx4 v[104:107], v12, s[8:11], s25 offen sc1
    buffer_load_dwordx4 v[108:111], v13, s[8:11], s25 offen sc1
    v_mfma_f32_16x16x32_bf16 a[36:39], v[48:51], v[116:119], a[36:39]
    s_add_u32 s25, s25, 1024
    v_mfma_f32_16x16x32_bf16 a[40:43], v[52:55], v[112:115], a[40:43]
    v_mfma_f32_16x16x32_bf16 a[44:47], v[52:55], v[116:119], a[44:47]
    v_mfma_f32_16x16x32_bf16 a[48:51], v[56:59], v[112:115], a[48:51]
    v_mfma_f32_16x16x32_bf16 a[52:55], v[56:59], v[116:119], a[52:55]
    v_mfma_f32_16x16x32_bf16 a[56:59], v[60:63], v[112:115], a[56:59]
    v_mfma_f32_16x16x32_bf16 a[60:63], v[60:63], v[116:119], a[60:63]
    s_waitcnt vmcnt(32) lgkmcnt(0)
    s_barrier
    v_mfma_f32_16x16x32_bf16 a[0:3], v[64:67], v[120:123], a[0:3]
    ds_read_b64_tr_b16 v[32:33], v14 offset:32768
    ds_read_b64_tr_b16 v[34:35], v14 offset:36864
    v_mfma_f32_16x16x32_bf16 a[4:7], v[64:67], v[124:127], a[4:7]
    ds_read_b64_tr_b16 v[36:37], v15 offset:32768
    ds_read_b64_tr_b16 v[38:39], v15 offset:36864
    v_mfma_f32_16x16x32_bf16 a[8:11], v[68:71], v[120:123], a[8:11]
    ds_read_b64_tr_b16 v[40:41], v16 offset:32768
    ds_read_b64_tr_b16 v[42:43], v16 offset:36864
    v_mfma_f32_16x16x32_bf16 a[12:15], v[68:71], v[124:127], a[12:15]
    ds_read_b64_tr_b16 v[44:45], v17 offset:32768
    ds_read_b64_tr_b16 v[46:47], v17 offset:36864
    v_mfma_f32_16x16x32_bf16 a[16:19], v[72:75], v[120:123], a[16:19]
    ds_read_b64_tr_b16 v[48:49], v18 offset:32768
    ds_read_b64_tr_b16 v[50:51], v18 offset:36864
    v_mfma_f32_16x16x32_bf16 a[20:23], v[72:75], v[124:127], a[20:23]
    ds_read_b64_tr_b16 v[52:53], v19 offset:32768
    ds_read_b64_tr_b16 v[54:55], v19 offset:36864
    v_mfma_f32_16x16x32_bf16 a[24:27], v[76:79], v[120:123], a[24:27]
    ds_read_b64_tr_b16 v[56:57], v20 offset:32768
    ds_read_b64_tr_b16 v[58:59], v20 offset:36864
    v_mfma_f32_16x16x32_bf16 a[28:31], v[76:79], v[124:127], a[28:31]
    ds_read_b64_tr_b16 v[60:61], v21 offset:32768
    ds_read_b64_tr_b16 v[62:63], v21 offset:36864
    v_mfma_f32_16x16x32_bf16 a[32:35], v[80:83], v[120:123], a[32:35]
    buffer_load_dwordx4 v[112:115], v12, s[8:11], s25 offen sc1
    buffer_load_dwordx4 v[116:119], v13, s[8:11], s25 offen sc1
    v_mfma_f32_16x16x32_bf16 a[36:39], v[80:83], v[124:127], a[36:39]
    s_add_u32 s25, s25, 1024
    s_add_u32 m0, s28, 16384
    v_mfma_f32_16x16x32_bf16 a[40:43], v[84:87], v[120:123], a[40:43]
    s_nop 0
    buffer_load_dwordx4 v8, s[12:15], s26 offen offset:0 lds
    v_mfma_f32_16x16x32_bf16 a[44:47], v[84:87], v[124:127], a[44:47]
    buffer_load_dwordx4 v9, s[12:15], s26 offen offset:1024 lds
    buffer_load_dwordx4 v10, s[12:15], s26 offen offset:2048 lds
    v_mfma_f32_16x16x32_bf16 a[48:51], v[88:91], v[120:123], a[48:51]
    buffer_load_dwordx4 v11, s[12:15], s26 offen offset:3072 lds
    s_add_u32 s26, s26, 458752
    v_mfma_f32_16x16x32_bf16 a[52:55], v[88:91], v[124:127], a[52:55]
    v_mfma_f32_16x16x32_bf16 a[56:59], v[92:95], v[120:123], a[56:59]
    v_mfma_f32_16x16x32_bf16 a[60:63], v[92:95], v[124:127], a[60:63]
    s_waitcnt vmcnt(36) lgkmcnt(0)
    v_mfma_f32_16x16x32_bf16 a[0:3], v[32:35], v[128:131], a[0:3]
    ds_read_b64_tr_b16 v[64:65], v14 offset:40960
    ds_read_b64_tr_b16 v[66:67], v14 offset:45056
    v_mfma_f32_16x16x32_bf16 a[4:7], v[32:35], v[132:135], a[4:7]
    ds_read_b64_tr_b16 v[68:69], v15 offset:40960
    ds_read_b64_tr_b16 v[70:71], v15 offset:45056
    v_mfma_f32_16x16x32_bf16 a[8:11], v[36:39], v[128:131], a[8:11]
    ds_read_b64_tr_b16 v[72:73], v16 offset:40960
    ds_read_b64_tr_b16 v[74:75], v16 offset:45056
    v_mfma_f32_16x16x32_bf16 a[12:15], v[36:39], v[132:135], a[12:15]
    ds_read_b64_tr_b16 v[76:77], v17 offset:40960
    ds_read_b64_tr_b16 v[78:79], v17 offset:45056
    v_mfma_f32_16x16x32_bf16 a[16:19], v[40:43], v[128:131], a[16:19]
    ds_read_b64_tr_b16 v[80:81], v18 offset:40960
    ds_read_b64_tr_b16 v[82:83], v18 offset:45056
    v_mfma_f32_16x16x32_bf16 a[20:23], v[40:43], v[132:135], a[20:23]
    ds_read_b64_tr_b16 v[84:85], v19 offset:40960
    ds_read_b64_tr_b16 v[86:87], v19 offset:45056
    v_mfma_f32_16x16x32_bf16 a[24:27], v[44:47], v[128:131], a[24:27]
    ds_read_b64_tr_b16 v[88:89], v20 offset:40960
    ds_read_b64_tr_b16 v[90:91], v20 offset:45056
    v_mfma_f32_16x16x32_bf16 a[28:31], v[44:47], v[132:135], a[28:31]
    ds_read_b64_tr_b16 v[92:93], v21 offset:40960
    ds_read_b64_tr_b16 v[94:95], v21 offset:45056
    v_mfma_f32_16x16x32_bf16 a[32:35], v[48:51], v[128:131], a[32:35]
    buffer_load_dwordx4 v[120:123], v12, s[8:11], s25 offen sc1
    buffer_load_dwordx4 v[124:127], v13, s[8:11], s25 offen sc1
    v_mfma_f32_16x16x32_bf16 a[36:39], v[48:51], v[132:135], a[36:39]
    s_add_u32 s25, s25, 1024
    v_mfma_f32_16x16x32_bf16 a[40:43], v[52:55], v[128:131], a[40:43]
    v_mfma_f32_16x16x32_bf16 a[44:47], v[52:55], v[132:135], a[44:47]
    v_mfma_f32_16x16x32_bf16 a[48:51], v[56:59], v[128:131], a[48:51]
    v_mfma_f32_16x16x32_bf16 a[52:55], v[56:59], v[132:135], a[52:55]
    v_mfma_f32_16x16x32_bf16 a[56:59], v[60:63], v[128:131], a[56:59]
    v_mfma_f32_16x16x32_bf16 a[60:63], v[60:63], v[132:135], a[60:63]
    s_waitcnt vmcnt(36) lgkmcnt(0)
    s_barrier
    v_mfma_f32_16x16x32_bf16 a[0:3], v[64:67], v[136:139], a[0:3]
    ds_read_b64_tr_b16 v[32:33], v14 offset:49152
    ds_read_b64_tr_b16 v[34:35], v14 offset:53248
    v_mfma_f32_16x16x32_bf16 a[4:7], v[64:67], v[140:143], a[4:7]
    ds_read_b64_tr_b16 v[36:37], v15 offset:49152
    ds_read_b64_tr_b16 v[38:39], v15 offset:53248
    v_mfma_f32_16x16x32_bf16 a[8:11], v[68:71], v[136:139], a[8:11]
    ds_read_b64_tr_b16 v[40:41], v16 offset:49152
    ds_read_b64_tr_b16 v[42:43], v16 offset:53248
    v_mfma_f32_16x16x32_bf16 a[12:15], v[68:71], v[140:143], a[12:15]
    ds_read_b64_tr_b16 v[44:45], v17 offset:49152
    ds_read_b64_tr_b16 v[46:47], v17 offset:53248
    v_mfma_f32_16x16x32_bf16 a[16:19], v[72:75], v[136:139], a[16:19]
    ds_read_b64_tr_b16 v[48:49], v18 offset:49152
    ds_read_b64_tr_b16 v[50:51], v18 offset:53248
    v_mfma_f32_16x16x32_bf16 a[20:23], v[72:75], v[140:143], a[20:23]
    ds_read_b64_tr_b16 v[52:53], v19 offset:49152
    ds_read_b64_tr_b16 v[54:55], v19 offset:53248
    v_mfma_f32_16x16x32_bf16 a[24:27], v[76:79], v[136:139], a[24:27]
    ds_read_b64_tr_b16 v[56:57], v20 offset:49152
    ds_read_b64_tr_b16 v[58:59], v20 offset:53248
    v_mfma_f32_16x16x32_bf16 a[28:31], v[76:79], v[140:143], a[28:31]
    ds_read_b64_tr_b16 v[60:61], v21 offset:49152
    ds_read_b64_tr_b16 v[62:63], v21 offset:53248
    v_mfma_f32_16x16x32_bf16 a[32:35], v[80:83], v[136:139], a[32:35]
    buffer_load_dwordx4 v[128:131], v12, s[8:11], s25 offen sc1
    buffer_load_dwordx4 v[132:135], v13, s[8:11], s25 offen sc1
    v_mfma_f32_16x16x32_bf16 a[36:39], v[80:83], v[140:143], a[36:39]
    s_add_u32 s25, s25, 1024
    s_add_u32 m0, s28, 32768
    v_mfma_f32_16x16x32_bf16 a[40:43], v[84:87], v[136:139], a[40:43]
    s_nop 0
    buffer_load_dwordx4 v8, s[12:15], s26 offen offset:0 lds
    v_mfma_f32_16x16x32_bf16 a[44:47], v[84:87], v[140:143], a[44:47]
    buffer_load_dwordx4 v9, s[12:15], s26 offen offset:1024 lds
    buffer_load_dwordx4 v10, s[12:15], s26 offen offset:2048 lds
    v_mfma_f32_16x16x32_bf16 a[48:51], v[88:91], v[136:139], a[48:51]
    buffer_load_dwordx4 v11, s[12:15], s26 offen offset:3072 lds
    s_add_u32 s26, s26, 458752
    v_mfma_f32_16x16x32_bf16 a[52:55], v[88:91], v[140:143], a[52:55]
    v_mfma_f32_16x16x32_bf16 a[56:59], v[92:95], v[136:139], a[56:59]
    v_mfma_f32_16x16x32_bf16 a[60:63], v[92:95], v[140:143], a[60:63]
    s_waitcnt vmcnt(40) lgkmcnt(0)
    v_mfma_f32_16x16x32_bf16 a[0:3], v[32:35], v[144:147], a[0:3]
    ds_read_b64_tr_b16 v[64:65], v14 offset:57344
    ds_read_b64_tr_b16 v[66:67], v14 offset:61440
    v_mfma_f32_16x16x32_bf16 a[4:7], v[32:35], v[148:151], a[4:7]
    ds_read_b64_tr_b16 v[68:69], v15 offset:57344
    ds_read_b64_tr_b16 v[70:71], v15 offset:61440
    v_mfma_f32_16x16x32_bf16 a[8:11], v[36:39], v[144:147], a[8:11]
    ds_read_b64_tr_b16 v[72:73], v16 offset:57344
    ds_read_b64_tr_b16 v[74:75], v16 offset:61440
    v_mfma_f32_16x16x32_bf16 a[12:15], v[36:39], v[148:151], a[12:15]
    ds_read_b64_tr_b16 v[76:77], v17 offset:57344
    ds_read_b64_tr_b16 v[78:79], v17 offset:61440
    v_mfma_f32_16x16x32_bf16 a[16:19], v[40:43], v[144:147], a[16:19]
    ds_read_b64_tr_b16 v[80:81], v18 offset:57344
    ds_read_b64_tr_b16 v[82:83], v18 offset:61440
    v_mfma_f32_16x16x32_bf16 a[20:23], v[40:43], v[148:151], a[20:23]
    ds_read_b64_tr_b16 v[84:85], v19 offset:57344
    ds_read_b64_tr_b16 v[86:87], v19 offset:61440
    v_mfma_f32_16x16x32_bf16 a[24:27], v[44:47], v[144:147], a[24:27]
    ds_read_b64_tr_b16 v[88:89], v20 offset:57344
    ds_read_b64_tr_b16 v[90:91], v20 offset:61440
    v_mfma_f32_16x16x32_bf16 a[28:31], v[44:47], v[148:151], a[28:31]
    ds_read_b64_tr_b16 v[92:93], v21 offset:57344
    ds_read_b64_tr_b16 v[94:95], v21 offset:61440
    v_mfma_f32_16x16x32_bf16 a[32:35], v[48:51], v[144:147], a[32:35]
    buffer_load_dwordx4 v[136:139], v12, s[8:11], s25 offen sc1
    buffer_load_dwordx4 v[140:143], v13, s[8:11], s25 offen sc1
    v_mfma_f32_16x16x32_bf16 a[36:39], v[48:51], v[148:151], a[36:39]
    s_add_u32 s25, s25, 1024
    v_mfma_f32_16x16x32_bf16 a[40:43], v[52:55], v[144:147], a[40:43]
    v_mfma_f32_16x16x32_bf16 a[44:47], v[52:55], v[148:151], a[44:47]
    v_mfma_f32_16x16x32_bf16 a[48:51], v[56:59], v[144:147], a[48:51]
    v_mfma_f32_16x16x32_bf16 a[52:55], v[56:59], v[148:151], a[52:55]
    v_mfma_f32_16x16x32_bf16 a[56:59], v[60:63], v[144:147], a[56:59]
    v_mfma_f32_16x16x32_bf16 a[60:63], v[60:63], v[148:151], a[60:63]
    s_waitcnt vmcnt(40) lgkmcnt(0)
    s_barrier
    v_mfma_f32_16x16x32_bf16 a[0:3], v[64:67], v[152:155], a[0:3]
    ds_read_b64_tr_b16 v[32:33], v22 offset:0
    ds_read_b64_tr_b16 v[34:35], v22 offset:4096
    v_mfma_f32_16x16x32_bf16 a[4:7], v[64:67], v[156:159], a[4:7]
    ds_read_b64_tr_b16 v[36:37], v23 offset:0
    ds_read_b64_tr_b16 v[38:39], v23 offset:4096
    v_mfma_f32_16x16x32_bf16 a[8:11], v[68:71], v[152:155], a[8:11]
    ds_read_b64_tr_b16 v[40:41], v24 offset:0
    ds_read_b64_tr_b16 v[42:43], v24 offset:4096
    v_mfma_f32_16x16x32_bf16 a[12:15], v[68:71], v[156:159], a[12:15]
    ds_read_b64_tr_b16 v[44:45], v25 offset:0
    ds_read_b64_tr_b16 v[46:47], v25 offset:4096
    v_mfma_f32_16x16x32_bf16 a[16:19], v[72:75], v[152:155], a[16:19]
    ds_read_b64_tr_b16 v[48:49], v26 offset:0
    ds_read_b64_tr_b16 v[50:51], v26 offset:4096
    v_mfma_f32_16x16x32_bf16 a[20:23], v[72:75], v[156:159], a[20:23]
    ds_read_b64_tr_b16 v[52:53], v27 offset:0
    ds_read_b64_tr_b16 v[54:55], v27 offset:4096
    v_mfma_f32_16x16x32_bf16 a[24:27], v[76:79], v[152:155], a[24:27]
    ds_read_b64_tr_b16 v[56:57], v28 offset:0
    ds_read_b64_tr_b16 v[58:59], v28 offset:4096
    v_mfma_f32_16x16x32_bf16 a[28:31], v[76:79], v[156:159], a[28:31]
    ds_read_b64_tr_b16 v[60:61], v29 offset:0
    ds_read_b64_tr_b16 v[62:63], v29 offset:4096
    v_mfma_f32_16x16x32_bf16 a[32:35], v[80:83], v[152:155], a[32:35]
    buffer_load_dwordx4 v[144:147], v12, s[8:11], s25 offen sc1
    buffer_load_dwordx4 v[148:151], v13, s[8:11], s25 offen sc1
    v_mfma_f32_16x16x32_bf16 a[36:39], v[80:83], v[156:159], a[36:39]
    s_add_u32 s25, s25, 1024
    s_add_u32 m0, s28, 49152
    v_mfma_f32_16x16x32_bf16 a[40:43], v[84:87], v[152:155], a[40:43]
    s_nop 0
    buffer_load_dwordx4 v8, s[12:15], s26 offen offset:0 lds
    v_mfma_f32_16x16x32_bf16 a[44:47], v[84:87], v[156:159], a[44:47]
    buffer_load_dwordx4 v9, s[12:15], s26 offen offset:1024 lds
    buffer_load_dwordx4 v10, s[12:15], s26 offen offset:2048 lds
    v_mfma_f32_16x16x32_bf16 a[48:51], v[88:91], v[152:155], a[48:51]
    buffer_load_dwordx4 v11, s[12:15], s26 offen offset:3072 lds
    s_add_u32 s26, s26, 458752
    v_mfma_f32_16x16x32_bf16 a[52:55], v[88:91], v[156:159], a[52:55]
    v_mfma_f32_16x16x32_bf16 a[56:59], v[92:95], v[152:155], a[56:59]
    v_mfma_f32_16x16x32_bf16 a[60:63], v[92:95], v[156:159], a[60:63]
    s_cmp_lg_u32 s27, 2
    s_cbranch_scc1 mega_kernel_w_t_5_nomid2
    s_mov_b32 s30, 122912
    s_cmp_lg_u32 s20, 0
    s_cbranch_scc1 mega_kernel_w_t_w5c_ok
    v_mov_b32 v250, 0
mega_kernel_w_t_w5c:
    buffer_load_dword v251, v250, s[8:11], s30 offen sc1
    s_waitcnt vmcnt(0)
    v_readfirstlane_b32 s31, v251
    s_cmp_ge_u32 s31, 8
    s_cbranch_scc1 mega_kernel_w_t_w5c_ok
    s_sub_u32 s40, s40, 1
    s_cbranch_scc1 mega_kernel_w_exit
    s_sleep 2
    s_branch mega_kernel_w_t_w5c
mega_kernel_w_t_w5c_ok:
    s_barrier

mega_kernel_w_t_5_nomid2:
    s_waitcnt vmcnt(44) lgkmcnt(0)
    v_mfma_f32_16x16x32_bf16 a[0:3], v[32:35], v[160:163], a[0:3]
    ds_read_b64_tr_b16 v[64:65], v22 offset:8192
    ds_read_b64_tr_b16 v[66:67], v22 offset:12288
    v_mfma_f32_16x16x32_bf16 a[4:7], v[32:35], v[164:167], a[4:7]
    ds_read_b64_tr_b16 v[68:69], v23 offset:8192
    ds_read_b64_tr_b16 v[70:71], v23 offset:12288
    v_mfma_f32_16x16x32_bf16 a[8:11], v[36:39], v[160:163], a[8:11]
    ds_read_b64_tr_b16 v[72:73], v24 offset:8192
    ds_read_b64_tr_b16 v[74:75], v24 offset:12288
    v_mfma_f32_16x16x32_bf16 a[12:15], v[36:39], v[164:167], a[12:15]
    ds_read_b64_tr_b16 v[76:77], v25 offset:8192
    ds_read_b64_tr_b16 v[78:79], v25 offset:12288
    v_mfma_f32_16x16x32_bf16 a[16:19], v[40:43], v[160:163], a[16:19]
    ds_read_b64_tr_b16 v[80:81], v26 offset:8192
    ds_read_b64_tr_b16 v[82:83], v26 offset:12288
    v_mfma_f32_16x16x32_bf16 a[20:23], v[40:43], v[164:167], a[20:23]
    ds_read_b64_tr_b16 v[84:85], v27 offset:8192
    ds_read_b64_tr_b16 v[86:87], v27 offset:12288
    v_mfma_f32_16x16x32_bf16 a[24:27], v[44:47], v[160:163], a[24:27]
    ds_read_b64_tr_b16 v[88:89], v28 offset:8192
    ds_read_b64_tr_b16 v[90:91], v28 offset:12288
    v_mfma_f32_16x16x32_bf16 a[28:31], v[44:47], v[164:167], a[28:31]
    ds_read_b64_tr_b16 v[92:93], v29 offset:8192
    ds_read_b64_tr_b16 v[94:95], v29 offset:12288
    v_mfma_f32_16x16x32_bf16 a[32:35], v[48:51], v[160:163], a[32:35]
    buffer_load_dwordx4 v[152:155], v12, s[8:11], s25 offen sc1
    buffer_load_dwordx4 v[156:159], v13, s[8:11], s25 offen sc1
    v_mfma_f32_16x16x32_bf16 a[36:39], v[48:51], v[164:167], a[36:39]
    s_add_u32 s25, s25, 1024
    v_mfma_f32_16x16x32_bf16 a[40:43], v[52:55], v[160:163], a[40:43]
    v_mfma_f32_16x16x32_bf16 a[44:47], v[52:55], v[164:167], a[44:47]
    v_mfma_f32_16x16x32_bf16 a[48:51], v[56:59], v[160:163], a[48:51]
    v_mfma_f32_16x16x32_bf16 a[52:55], v[56:59], v[164:167], a[52:55]
    v_mfma_f32_16x16x32_bf16 a[56:59], v[60:63], v[160:163], a[56:59]
    v_mfma_f32_16x16x32_bf16 a[60:63], v[60:63], v[164:167], a[60:63]
    s_waitcnt vmcnt(44) lgkmcnt(0)
    s_barrier
    v_mfma_f32_16x16x32_bf16 a[0:3], v[64:67], v[168:171], a[0:3]
    ds_read_b64_tr_b16 v[32:33], v22 offset:16384
    ds_read_b64_tr_b16 v[34:35], v22 offset:20480
    v_mfma_f32_16x16x32_bf16 a[4:7], v[64:67], v[172:175], a[4:7]
    ds_read_b64_tr_b16 v[36:37], v23 offset:16384
    ds_read_b64_tr_b16 v[38:39], v23 offset:20480
    v_mfma_f32_16x16x32_bf16 a[8:11], v[68:71], v[168:171], a[8:11]
    ds_read_b64_tr_b16 v[40:41], v24 offset:16384
    ds_read_b64_tr_b16 v[42:43], v24 offset:20480
    v_mfma_f32_16x16x32_bf16 a[12:15], v[68:71], v[172:175], a[12:15]
    ds_read_b64_tr_b16 v[44:45], v25 offset:16384
    ds_read_b64_tr_b16 v[46:47], v25 offset:20480
    v_mfma_f32_16x16x32_bf16 a[16:19], v[72:75], v[168:171], a[16:19]
    ds_read_b64_tr_b16 v[48:49], v26 offset:16384
    ds_read_b64_tr_b16 v[50:51], v26 offset:20480
    v_mfma_f32_16x16x32_bf16 a[20:23], v[72:75], v[172:175], a[20:23]
    ds_read_b64_tr_b16 v[52:53], v27 offset:16384
    ds_read_b64_tr_b16 v[54:55], v27 offset:20480
    v_mfma_f32_16x16x32_bf16 a[24:27], v[76:79], v[168:171], a[24:27]
    ds_read_b64_tr_b16 v[56:57], v28 offset:16384
    ds_read_b64_tr_b16 v[58:59], v28 offset:20480
    v_mfma_f32_16x16x32_bf16 a[28:31], v[76:79], v[172:175], a[28:31]
    ds_read_b64_tr_b16 v[60:61], v29 offset:16384
    ds_read_b64_tr_b16 v[62:63], v29 offset:20480
    v_mfma_f32_16x16x32_bf16 a[32:35], v[80:83], v[168:171], a[32:35]
    buffer_load_dwordx4 v[160:163], v12, s[8:11], s25 offen sc1
    buffer_load_dwordx4 v[164:167], v13, s[8:11], s25 offen sc1
    v_mfma_f32_16x16x32_bf16 a[36:39], v[80:83], v[172:175], a[36:39]
    s_add_u32 s25, s25, 1024
    s_add_u32 m0, s28, 65536
    v_mfma_f32_16x16x32_bf16 a[40:43], v[84:87], v[168:171], a[40:43]
    s_nop 0
    buffer_load_dwordx4 v8, s[12:15], s26 offen offset:0 lds
    v_mfma_f32_16x16x32_bf16 a[44:47], v[84:87], v[172:175], a[44:47]
    buffer_load_dwordx4 v9, s[12:15], s26 offen offset:1024 lds
    buffer_load_dwordx4 v10, s[12:15], s26 offen offset:2048 lds
    v_mfma_f32_16x16x32_bf16 a[48:51], v[88:91], v[168:171], a[48:51]
    buffer_load_dwordx4 v11, s[12:15], s26 offen offset:3072 lds
    s_add_u32 s26, s26, 458752
    v_mfma_f32_16x16x32_bf16 a[52:55], v[88:91], v[172:175], a[52:55]
    v_mfma_f32_16x16x32_bf16 a[56:59], v[92:95], v[168:171], a[56:59]
    v_mfma_f32_16x16x32_bf16 a[60:63], v[92:95], v[172:175], a[60:63]
    s_waitcnt vmcnt(48) lgkmcnt(0)
    v_mfma_f32_16x16x32_bf16 a[0:3], v[32:35], v[176:179], a[0:3]
    ds_read_b64_tr_b16 v[64:65], v22 offset:24576
    ds_read_b64_tr_b16 v[66:67], v22 offset:28672
    v_mfma_f32_16x16x32_bf16 a[4:7], v[32:35], v[180:183], a[4:7]
    ds_read_b64_tr_b16 v[68:69], v23 offset:24576
    ds_read_b64_tr_b16 v[70:71], v23 offset:28672
    v_mfma_f32_16x16x32_bf16 a[8:11], v[36:39], v[176:179], a[8:11]
    ds_read_b64_tr_b16 v[72:73], v24 offset:24576
    ds_read_b64_tr_b16 v[74:75], v24 offset:28672
    v_mfma_f32_16x16x32_bf16 a[12:15], v[36:39], v[180:183], a[12:15]
    ds_read_b64_tr_b16 v[76:77], v25 offset:24576
    ds_read_b64_tr_b16 v[78:79], v25 offset:28672
    v_mfma_f32_16x16x32_bf16 a[16:19], v[40:43], v[176:179], a[16:19]
    ds_read_b64_tr_b16 v[80:81], v26 offset:24576
    ds_read_b64_tr_b16 v[82:83], v26 offset:28672
    v_mfma_f32_16x16x32_bf16 a[20:23], v[40:43], v[180:183], a[20:23]
    ds_read_b64_tr_b16 v[84:85], v27 offset:24576
    ds_read_b64_tr_b16 v[86:87], v27 offset:28672
    v_mfma_f32_16x16x32_bf16 a[24:27], v[44:47], v[176:179], a[24:27]
    ds_read_b64_tr_b16 v[88:89], v28 offset:24576
    ds_read_b64_tr_b16 v[90:91], v28 offset:28672
    v_mfma_f32_16x16x32_bf16 a[28:31], v[44:47], v[180:183], a[28:31]
    ds_read_b64_tr_b16 v[92:93], v29 offset:24576
    ds_read_b64_tr_b16 v[94:95], v29 offset:28672
    v_mfma_f32_16x16x32_bf16 a[32:35], v[48:51], v[176:179], a[32:35]
    buffer_load_dwordx4 v[168:171], v12, s[8:11], s25 offen sc1
    buffer_load_dwordx4 v[172:175], v13, s[8:11], s25 offen sc1
    v_mfma_f32_16x16x32_bf16 a[36:39], v[48:51], v[180:183], a[36:39]
    s_add_u32 s25, s25, 1024
    v_mfma_f32_16x16x32_bf16 a[40:43], v[52:55], v[176:179], a[40:43]
    v_mfma_f32_16x16x32_bf16 a[44:47], v[52:55], v[180:183], a[44:47]
    v_mfma_f32_16x16x32_bf16 a[48:51], v[56:59], v[176:179], a[48:51]
    v_mfma_f32_16x16x32_bf16 a[52:55], v[56:59], v[180:183], a[52:55]
    v_mfma_f32_16x16x32_bf16 a[56:59], v[60:63], v[176:179], a[56:59]
    v_mfma_f32_16x16x32_bf16 a[60:63], v[60:63], v[180:183], a[60:63]
    s_waitcnt vmcnt(48) lgkmcnt(0)
    s_barrier
    v_mfma_f32_16x16x32_bf16 a[0:3], v[64:67], v[184:187], a[0:3]
    ds_read_b64_tr_b16 v[32:33], v22 offset:32768
    ds_read_b64_tr_b16 v[34:35], v22 offset:36864
    v_mfma_f32_16x16x32_bf16 a[4:7], v[64:67], v[188:191], a[4:7]
    ds_read_b64_tr_b16 v[36:37], v23 offset:32768
    ds_read_b64_tr_b16 v[38:39], v23 offset:36864
    v_mfma_f32_16x16x32_bf16 a[8:11], v[68:71], v[184:187], a[8:11]
    ds_read_b64_tr_b16 v[40:41], v24 offset:32768
    ds_read_b64_tr_b16 v[42:43], v24 offset:36864
    v_mfma_f32_16x16x32_bf16 a[12:15], v[68:71], v[188:191], a[12:15]
    ds_read_b64_tr_b16 v[44:45], v25 offset:32768
    ds_read_b64_tr_b16 v[46:47], v25 offset:36864
    v_mfma_f32_16x16x32_bf16 a[16:19], v[72:75], v[184:187], a[16:19]
    ds_read_b64_tr_b16 v[48:49], v26 offset:32768
    ds_read_b64_tr_b16 v[50:51], v26 offset:36864
    v_mfma_f32_16x16x32_bf16 a[20:23], v[72:75], v[188:191], a[20:23]
    ds_read_b64_tr_b16 v[52:53], v27 offset:32768
    ds_read_b64_tr_b16 v[54:55], v27 offset:36864
    v_mfma_f32_16x16x32_bf16 a[24:27], v[76:79], v[184:187], a[24:27]
    ds_read_b64_tr_b16 v[56:57], v28 offset:32768
    ds_read_b64_tr_b16 v[58:59], v28 offset:36864
    v_mfma_f32_16x16x32_bf16 a[28:31], v[76:79], v[188:191], a[28:31]
    ds_read_b64_tr_b16 v[60:61], v29 offset:32768
    ds_read_b64_tr_b16 v[62:63], v29 offset:36864
    v_mfma_f32_16x16x32_bf16 a[32:35], v[80:83], v[184:187], a[32:35]
    buffer_load_dwordx4 v[176:179], v12, s[8:11], s25 offen sc1
    buffer_load_dwordx4 v[180:183], v13, s[8:11], s25 offen sc1
    v_mfma_f32_16x16x32_bf16 a[36:39], v[80:83], v[188:191], a[36:39]
    s_add_u32 s25, s25, 1024
    s_add_u32 m0, s28, 81920
    v_mfma_f32_16x16x32_bf16 a[40:43], v[84:87], v[184:187], a[40:43]
    s_nop 0
    buffer_load_dwordx4 v8, s[12:15], s26 offen offset:0 lds
    v_mfma_f32_16x16x32_bf16 a[44:47], v[84:87], v[188:191], a[44:47]
    buffer_load_dwordx4 v9, s[12:15], s26 offen offset:1024 lds
    buffer_load_dwordx4 v10, s[12:15], s26 offen offset:2048 lds
    v_mfma_f32_16x16x32_bf16 a[48:51], v[88:91], v[184:187], a[48:51]
    buffer_load_dwordx4 v11, s[12:15], s26 offen offset:3072 lds
    s_add_u32 s26, s26, 458752
    v_mfma_f32_16x16x32_bf16 a[52:55], v[88:91], v[188:191], a[52:55]
    v_mfma_f32_16x16x32_bf16 a[56:59], v[92:95], v[184:187], a[56:59]
    v_mfma_f32_16x16x32_bf16 a[60:63], v[92:95], v[188:191], a[60:63]
    s_waitcnt vmcnt(52) lgkmcnt(0)
    v_mfma_f32_16x16x32_bf16 a[0:3], v[32:35], v[192:195], a[0:3]
    ds_read_b64_tr_b16 v[64:65], v22 offset:40960
    ds_read_b64_tr_b16 v[66:67], v22 offset:45056
    v_mfma_f32_16x16x32_bf16 a[4:7], v[32:35], v[196:199], a[4:7]
    ds_read_b64_tr_b16 v[68:69], v23 offset:40960
    ds_read_b64_tr_b16 v[70:71], v23 offset:45056
    v_mfma_f32_16x16x32_bf16 a[8:11], v[36:39], v[192:195], a[8:11]
    ds_read_b64_tr_b16 v[72:73], v24 offset:40960
    ds_read_b64_tr_b16 v[74:75], v24 offset:45056
    v_mfma_f32_16x16x32_bf16 a[12:15], v[36:39], v[196:199], a[12:15]
    ds_read_b64_tr_b16 v[76:77], v25 offset:40960
    ds_read_b64_tr_b16 v[78:79], v25 offset:45056
    v_mfma_f32_16x16x32_bf16 a[16:19], v[40:43], v[192:195], a[16:19]
    ds_read_b64_tr_b16 v[80:81], v26 offset:40960
    ds_read_b64_tr_b16 v[82:83], v26 offset:45056
    v_mfma_f32_16x16x32_bf16 a[20:23], v[40:43], v[196:199], a[20:23]
    ds_read_b64_tr_b16 v[84:85], v27 offset:40960
    ds_read_b64_tr_b16 v[86:87], v27 offset:45056
    v_mfma_f32_16x16x32_bf16 a[24:27], v[44:47], v[192:195], a[24:27]
    ds_read_b64_tr_b16 v[88:89], v28 offset:40960
    ds_read_b64_tr_b16 v[90:91], v28 offset:45056
    v_mfma_f32_16x16x32_bf16 a[28:31], v[44:47], v[196:199], a[28:31]
    ds_read_b64_tr_b16 v[92:93], v29 offset:40960
    ds_read_b64_tr_b16 v[94:95], v29 offset:45056
    v_mfma_f32_16x16x32_bf16 a[32:35], v[48:51], v[192:195], a[32:35]
    buffer_load_dwordx4 v[184:187], v12, s[8:11], s25 offen sc1
    buffer_load_dwordx4 v[188:191], v13, s[8:11], s25 offen sc1
    v_mfma_f32_16x16x32_bf16 a[36:39], v[48:51], v[196:199], a[36:39]
    s_add_u32 s25, s25, 1024
    v_mfma_f32_16x16x32_bf16 a[40:43], v[52:55], v[192:195], a[40:43]
    v_mfma_f32_16x16x32_bf16 a[44:47], v[52:55], v[196:199], a[44:47]
    v_mfma_f32_16x16x32_bf16 a[48:51], v[56:59], v[192:195], a[48:51]
    v_mfma_f32_16x16x32_bf16 a[52:55], v[56:59], v[196:199], a[52:55]
    v_mfma_f32_16x16x32_bf16 a[56:59], v[60:63], v[192:195], a[56:59]
    v_mfma_f32_16x16x32_bf16 a[60:63], v[60:63], v[196:199], a[60:63]
    s_waitcnt vmcnt(50) lgkmcnt(0)
    s_barrier
    v_mfma_f32_16x16x32_bf16 a[0:3], v[64:67], v[200:203], a[0:3]
    ds_read_b64_tr_b16 v[32:33], v22 offset:49152
    ds_read_b64_tr_b16 v[34:35], v22 offset:53248
    v_mfma_f32_16x16x32_bf16 a[4:7], v[64:67], v[204:207], a[4:7]
    ds_read_b64_tr_b16 v[36:37], v23 offset:49152
    ds_read_b64_tr_b16 v[38:39], v23 offset:53248
    v_mfma_f32_16x16x32_bf16 a[8:11], v[68:71], v[200:203], a[8:11]
    ds_read_b64_tr_b16 v[40:41], v24 offset:49152
    ds_read_b64_tr_b16 v[42:43], v24 offset:53248
    v_mfma_f32_16x16x32_bf16 a[12:15], v[68:71], v[204:207], a[12:15]
    ds_read_b64_tr_b16 v[44:45], v25 offset:49152
    ds_read_b64_tr_b16 v[46:47], v25 offset:53248
    v_mfma_f32_16x16x32_bf16 a[16:19], v[72:75], v[200:203], a[16:19]
    ds_read_b64_tr_b16 v[48:49], v26 offset:49152
    ds_read_b64_tr_b16 v[50:51], v26 offset:53248
    v_mfma_f32_16x16x32_bf16 a[20:23], v[72:75], v[204:207], a[20:23]
    ds_read_b64_tr_b16 v[52:53], v27 offset:49152
    ds_read_b64_tr_b16 v[54:55], v27 offset:53248
    v_mfma_f32_16x16x32_bf16 a[24:27], v[76:79], v[200:203], a[24:27]
    ds_read_b64_tr_b16 v[56:57], v28 offset:49152
    ds_read_b64_tr_b16 v[58:59], v28 offset:53248
    v_mfma_f32_16x16x32_bf16 a[28:31], v[76:79], v[204:207], a[28:31]
    ds_read_b64_tr_b16 v[60:61], v29 offset:49152
    ds_read_b64_tr_b16 v[62:63], v29 offset:53248
    v_mfma_f32_16x16x32_bf16 a[32:35], v[80:83], v[200:203], a[32:35]
    buffer_load_dwordx4 v[192:195], v12, s[8:11], s25 offen sc1
    buffer_load_dwordx4 v[196:199], v13, s[8:11], s25 offen sc1
    v_mfma_f32_16x16x32_bf16 a[36:39], v[80:83], v[204:207], a[36:39]
    s_add_u32 s25, s25, 1024
    s_add_u32 m0, s28, 98304
    v_mfma_f32_16x16x32_bf16 a[40:43], v[84:87], v[200:203], a[40:43]
    s_nop 0
    buffer_load_dwordx4 v8, s[12:15], s26 offen offset:0 lds
    v_mfma_f32_16x16x32_bf16 a[44:47], v[84:87], v[204:207], a[44:47]
    buffer_load_dwordx4 v9, s[12:15], s26 offen offset:1024 lds
    buffer_load_dwordx4 v10, s[12:15], s26 offen offset:2048 lds
    v_mfma_f32_16x16x32_bf16 a[48:51], v[88:91], v[200:203], a[48:51]
    buffer_load_dwordx4 v11, s[12:15], s26 offen offset:3072 lds
    s_add_u32 s26, s26, 458752
    v_mfma_f32_16x16x32_bf16 a[52:55], v[88:91], v[204:207], a[52:55]
    v_mfma_f32_16x16x32_bf16 a[56:59], v[92:95], v[200:203], a[56:59]
    v_mfma_f32_16x16x32_bf16 a[60:63], v[92:95], v[204:207], a[60:63]
    s_waitcnt vmcnt(56) lgkmcnt(0)
    v_mfma_f32_16x16x32_bf16 a[0:3], v[32:35], v[208:211], a[0:3]
    ds_read_b64_tr_b16 v[64:65], v22 offset:57344
    ds_read_b64_tr_b16 v[66:67], v22 offset:61440
    v_mfma_f32_16x16x32_bf16 a[4:7], v[32:35], v[212:215], a[4:7]
    ds_read_b64_tr_b16 v[68:69], v23 offset:57344
    ds_read_b64_tr_b16 v[70:71], v23 offset:61440
    v_mfma_f32_16x16x32_bf16 a[8:11], v[36:39], v[208:211], a[8:11]
    ds_read_b64_tr_b16 v[72:73], v24 offset:57344
    ds_read_b64_tr_b16 v[74:75], v24 offset:61440
    v_mfma_f32_16x16x32_bf16 a[12:15], v[36:39], v[212:215], a[12:15]
    ds_read_b64_tr_b16 v[76:77], v25 offset:57344
    ds_read_b64_tr_b16 v[78:79], v25 offset:61440
    v_mfma_f32_16x16x32_bf16 a[16:19], v[40:43], v[208:211], a[16:19]
    ds_read_b64_tr_b16 v[80:81], v26 offset:57344
    ds_read_b64_tr_b16 v[82:83], v26 offset:61440
    v_mfma_f32_16x16x32_bf16 a[20:23], v[40:43], v[212:215], a[20:23]
    ds_read_b64_tr_b16 v[84:85], v27 offset:57344
    ds_read_b64_tr_b16 v[86:87], v27 offset:61440
    v_mfma_f32_16x16x32_bf16 a[24:27], v[44:47], v[208:211], a[24:27]
    ds_read_b64_tr_b16 v[88:89], v28 offset:57344
    ds_read_b64_tr_b16 v[90:91], v28 offset:61440
    v_mfma_f32_16x16x32_bf16 a[28:31], v[44:47], v[212:215], a[28:31]
    ds_read_b64_tr_b16 v[92:93], v29 offset:57344
    ds_read_b64_tr_b16 v[94:95], v29 offset:61440
    v_mfma_f32_16x16x32_bf16 a[32:35], v[48:51], v[208:211], a[32:35]
    buffer_load_dwordx4 v[200:203], v12, s[8:11], s25 offen sc1
    buffer_load_dwordx4 v[204:207], v13, s[8:11], s25 offen sc1
    v_mfma_f32_16x16x32_bf16 a[36:39], v[48:51], v[212:215], a[36:39]
    s_add_u32 s25, s25, 1024
    v_mfma_f32_16x16x32_bf16 a[40:43], v[52:55], v[208:211], a[40:43]
    v_mfma_f32_16x16x32_bf16 a[44:47], v[52:55], v[212:215], a[44:47]
    v_mfma_f32_16x16x32_bf16 a[48:51], v[56:59], v[208:211], a[48:51]
    v_mfma_f32_16x16x32_bf16 a[52:55], v[56:59], v[212:215], a[52:55]
    v_mfma_f32_16x16x32_bf16 a[56:59], v[60:63], v[208:211], a[56:59]
    v_mfma_f32_16x16x32_bf16 a[60:63], v[60:63], v[212:215], a[60:63]
    s_waitcnt vmcnt(50) lgkmcnt(0)
    s_barrier
    v_mfma_f32_16x16x32_bf16 a[0:3], v[64:67], v[216:219], a[0:3]
    ds_read_b64_tr_b16 v[32:33], v14 offset:0
    ds_read_b64_tr_b16 v[34:35], v14 offset:4096
    v_mfma_f32_16x16x32_bf16 a[4:7], v[64:67], v[220:223], a[4:7]
    ds_read_b64_tr_b16 v[36:37], v15 offset:0
    ds_read_b64_tr_b16 v[38:39], v15 offset:4096
    v_mfma_f32_16x16x32_bf16 a[8:11], v[68:71], v[216:219], a[8:11]
    ds_read_b64_tr_b16 v[40:41], v16 offset:0
    ds_read_b64_tr_b16 v[42:43], v16 offset:4096
    v_mfma_f32_16x16x32_bf16 a[12:15], v[68:71], v[220:223], a[12:15]
    ds_read_b64_tr_b16 v[44:45], v17 offset:0
    ds_read_b64_tr_b16 v[46:47], v17 offset:4096
    v_mfma_f32_16x16x32_bf16 a[16:19], v[72:75], v[216:219], a[16:19]
    ds_read_b64_tr_b16 v[48:49], v18 offset:0
    ds_read_b64_tr_b16 v[50:51], v18 offset:4096
    v_mfma_f32_16x16x32_bf16 a[20:23], v[72:75], v[220:223], a[20:23]
    ds_read_b64_tr_b16 v[52:53], v19 offset:0
    ds_read_b64_tr_b16 v[54:55], v19 offset:4096
    v_mfma_f32_16x16x32_bf16 a[24:27], v[76:79], v[216:219], a[24:27]
    ds_read_b64_tr_b16 v[56:57], v20 offset:0
    ds_read_b64_tr_b16 v[58:59], v20 offset:4096
    v_mfma_f32_16x16x32_bf16 a[28:31], v[76:79], v[220:223], a[28:31]
    ds_read_b64_tr_b16 v[60:61], v21 offset:0
    ds_read_b64_tr_b16 v[62:63], v21 offset:4096
    v_mfma_f32_16x16x32_bf16 a[32:35], v[80:83], v[216:219], a[32:35]
    buffer_load_dwordx4 v[208:211], v12, s[8:11], s25 offen sc1
    buffer_load_dwordx4 v[212:215], v13, s[8:11], s25 offen sc1
    v_mfma_f32_16x16x32_bf16 a[36:39], v[80:83], v[220:223], a[36:39]
    s_add_u32 s25, s25, 1024
    s_add_u32 m0, s28, 114688
    v_mfma_f32_16x16x32_bf16 a[40:43], v[84:87], v[216:219], a[40:43]
    s_nop 0
    buffer_load_dwordx4 v8, s[12:15], s26 offen offset:0 lds
    v_mfma_f32_16x16x32_bf16 a[44:47], v[84:87], v[220:223], a[44:47]
    buffer_load_dwordx4 v9, s[12:15], s26 offen offset:1024 lds
    buffer_load_dwordx4 v10, s[12:15], s26 offen offset:2048 lds
    v_mfma_f32_16x16x32_bf16 a[48:51], v[88:91], v[216:219], a[48:51]
    buffer_load_dwordx4 v11, s[12:15], s26 offen offset:3072 lds
    s_add_u32 s26, s26, 458752
    v_mfma_f32_16x16x32_bf16 a[52:55], v[88:91], v[220:223], a[52:55]
    v_mfma_f32_16x16x32_bf16 a[56:59], v[92:95], v[216:219], a[56:59]
    v_mfma_f32_16x16x32_bf16 a[60:63], v[92:95], v[220:223], a[60:63]
    s_sub_u32 s27, s27, 1
    s_cmp_lg_u32 s27, 0
    s_cbranch_scc1 mega_kernel_w_t_5_loop
mega_kernel_w_t_5_done:
    s_nop 7
    v_lshlrev_b32 v5, 3, v3
    s_lshl_b32 s30, s33, 8

    buffer_load_dwordx2 v[160:161], v5, s[16:19], s30 offen offset:0
    buffer_load_dwordx2 v[162:163], v5, s[16:19], s30 offen offset:32
    buffer_load_dwordx2 v[164:165], v5, s[16:19], s30 offen offset:64
    buffer_load_dwordx2 v[166:167], v5, s[16:19], s30 offen offset:96
    buffer_load_dwordx2 v[168:169], v5, s[16:19], s30 offen offset:128
    buffer_load_dwordx2 v[170:171], v5, s[16:19], s30 offen offset:160
    buffer_load_dwordx2 v[172:173], v5, s[16:19], s30 offen offset:192
    buffer_load_dwordx2 v[174:175], v5, s[16:19], s30 offen offset:224
    s_lshl_b32 s31, s34, 3
    s_lshl_b32 s36, s20, 1
    s_add_u32 s31, s31, s36
    s_mul_i32 s31, s31, 114688
    s_lshl_b32 s36, s33, 12
    s_add_u32 s31, s31, s36
    s_add_u32 s31, s31, 90603520
    s_mov_b32 s56, 0x3d372713
    s_mov_b32 s57, 0xc0135761
    s_waitcnt vmcnt(0)

    v_lshlrev_b32 v96, 16, v160
    v_and_b32 v97, 0xffff0000, v160
    v_lshlrev_b32 v98, 16, v161
    v_and_b32 v99, 0xffff0000, v161
    v_lshlrev_b32 v100, 16, v162
    v_and_b32 v101, 0xffff0000, v162
    v_lshlrev_b32 v102, 16, v163
    v_and_b32 v103, 0xffff0000, v163
    v_lshlrev_b32 v104, 16, v164
    v_and_b32 v105, 0xffff0000, v164
    v_lshlrev_b32 v106, 16, v165
    v_and_b32 v107, 0xffff0000, v165
    v_lshlrev_b32 v108, 16, v166
    v_and_b32 v109, 0xffff0000, v166
    v_lshlrev_b32 v110, 16, v167
    v_and_b32 v111, 0xffff0000, v167
    v_lshlrev_b32 v112, 16, v168
    v_and_b32 v113, 0xffff0000, v168
    v_lshlrev_b32 v114, 16, v169
    v_and_b32 v115, 0xffff0000, v169
    v_lshlrev_b32 v116, 16, v170
    v_and_b32 v117, 0xffff0000, v170
    v_lshlrev_b32 v118, 16, v171
    v_and_b32 v119, 0xffff0000, v171
    v_lshlrev_b32 v120, 16, v172
    v_and_b32 v121, 0xffff0000, v172
    v_lshlrev_b32 v122, 16, v173
    v_and_b32 v123, 0xffff0000, v173
    v_lshlrev_b32 v124, 16, v174
    v_and_b32 v125, 0xffff0000, v174
    v_lshlrev_b32 v126, 16, v175
    v_and_b32 v127, 0xffff0000, v175
    s_add_u32 s36, s31, 0
    v_accvgpr_read_b32 v32, a0
    v_accvgpr_read_b32 v33, a1
    v_accvgpr_read_b32 v34, a2
    v_accvgpr_read_b32 v35, a3
    v_accvgpr_read_b32 v36, a8
    v_accvgpr_read_b32 v37, a9
    v_accvgpr_read_b32 v38, a10
    v_accvgpr_read_b32 v39, a11
    v_add_f32 v32, v32, v96
    v_add_f32 v33, v33, v97
    v_add_f32 v34, v34, v98
    v_add_f32 v35, v35, v99
    v_add_f32 v36, v36, v100
    v_add_f32 v37, v37, v101
    v_add_f32 v38, v38, v102
    v_add_f32 v39, v39, v103
    v_mul_f32 v40, v32, v32
    v_mul_f32 v41, v33, v33
    v_mul_f32 v42, v34, v34
    v_mul_f32 v43, v35, v35
    v_mul_f32 v44, v36, v36
    v_mul_f32 v45, v37, v37
    v_mul_f32 v46, v38, v38
    v_mul_f32 v47, v39, v39
    v_fma_f32 v40, v40, s56, 1.0
    v_fma_f32 v41, v41, s56, 1.0
    v_fma_f32 v42, v42, s56, 1.0
    v_fma_f32 v43, v43, s56, 1.0
    v_fma_f32 v44, v44, s56, 1.0
    v_fma_f32 v45, v45, s56, 1.0
    v_fma_f32 v46, v46, s56, 1.0
    v_fma_f32 v47, v47, s56, 1.0
    v_mul_f32 v40, v40, v32
    v_mul_f32 v41, v41, v33
    v_mul_f32 v42, v42, v34
    v_mul_f32 v43, v43, v35
    v_mul_f32 v44, v44, v36
    v_mul_f32 v45, v45, v37
    v_mul_f32 v46, v46, v38
    v_mul_f32 v47, v47, v39
    v_mul_f32 v40, s57, v40
    v_mul_f32 v41, s57, v41
    v_mul_f32 v42, s57, v42
    v_mul_f32 v43, s57, v43
    v_mul_f32 v44, s57, v44
    v_mul_f32 v45, s57, v45
    v_mul_f32 v46, s57, v46
    v_mul_f32 v47, s57, v47
    v_exp_f32 v40, v40
    v_exp_f32 v41, v41
    v_exp_f32 v42, v42
    v_exp_f32 v43, v43
    v_exp_f32 v44, v44
    v_exp_f32 v45, v45
    v_exp_f32 v46, v46
    v_exp_f32 v47, v47
    s_nop 0
    v_add_f32 v40, 1.0, v40
    v_add_f32 v41, 1.0, v41
    v_add_f32 v42, 1.0, v42
    v_add_f32 v43, 1.0, v43
    v_add_f32 v44, 1.0, v44
    v_add_f32 v45, 1.0, v45
    v_add_f32 v46, 1.0, v46
    v_add_f32 v47, 1.0, v47
    v_rcp_f32 v40, v40
    v_rcp_f32 v41, v41
    v_rcp_f32 v42, v42
    v_rcp_f32 v43, v43
    v_rcp_f32 v44, v44
    v_rcp_f32 v45, v45
    v_rcp_f32 v46, v46
    v_rcp_f32 v47, v47
    s_nop 0
    v_mul_f32 v32, v32, v40
    v_mul_f32 v33, v33, v41
    v_mul_f32 v34, v34, v42
    v_mul_f32 v35, v35, v43
    v_mul_f32 v36, v36, v44
    v_mul_f32 v37, v37, v45
    v_mul_f32 v38, v38, v46
    v_mul_f32 v39, v39, v47
    v_cvt_pk_bf16_f32 v32, v32, v33
    v_cvt_pk_bf16_f32 v33, v34, v35
    v_cvt_pk_bf16_f32 v34, v36, v37
    v_cvt_pk_bf16_f32 v35, v38, v39
    buffer_store_dwordx4 v[32:35], v4, s[8:11], s36 offen offset:0 sc1
    v_accvgpr_read_b32 v48, a16
    v_accvgpr_read_b32 v49, a17
    v_accvgpr_read_b32 v50, a18
    v_accvgpr_read_b32 v51, a19
    v_accvgpr_read_b32 v52, a24
    v_accvgpr_read_b32 v53, a25
    v_accvgpr_read_b32 v54, a26
    v_accvgpr_read_b32 v55, a27
    v_add_f32 v48, v48, v104
    v_add_f32 v49, v49, v105
    v_add_f32 v50, v50, v106
    v_add_f32 v51, v51, v107
    v_add_f32 v52, v52, v108
    v_add_f32 v53, v53, v109
    v_add_f32 v54, v54, v110
    v_add_f32 v55, v55, v111
    v_mul_f32 v56, v48, v48
    v_mul_f32 v57, v49, v49
    v_mul_f32 v58, v50, v50
    v_mul_f32 v59, v51, v51
    v_mul_f32 v60, v52, v52
    v_mul_f32 v61, v53, v53
    v_mul_f32 v62, v54, v54
    v_mul_f32 v63, v55, v55
    v_fma_f32 v56, v56, s56, 1.0
    v_fma_f32 v57, v57, s56, 1.0
    v_fma_f32 v58, v58, s56, 1.0
    v_fma_f32 v59, v59, s56, 1.0
    v_fma_f32 v60, v60, s56, 1.0
    v_fma_f32 v61, v61, s56, 1.0
    v_fma_f32 v62, v62, s56, 1.0
    v_fma_f32 v63, v63, s56, 1.0
    v_mul_f32 v56, v56, v48
    v_mul_f32 v57, v57, v49
    v_mul_f32 v58, v58, v50
    v_mul_f32 v59, v59, v51
    v_mul_f32 v60, v60, v52
    v_mul_f32 v61, v61, v53
    v_mul_f32 v62, v62, v54
    v_mul_f32 v63, v63, v55
    v_mul_f32 v56, s57, v56
    v_mul_f32 v57, s57, v57
    v_mul_f32 v58, s57, v58
    v_mul_f32 v59, s57, v59
    v_mul_f32 v60, s57, v60
    v_mul_f32 v61, s57, v61
    v_mul_f32 v62, s57, v62
    v_mul_f32 v63, s57, v63
    v_exp_f32 v56, v56
    v_exp_f32 v57, v57
    v_exp_f32 v58, v58
    v_exp_f32 v59, v59
    v_exp_f32 v60, v60
    v_exp_f32 v61, v61
    v_exp_f32 v62, v62
    v_exp_f32 v63, v63
    s_nop 0
    v_add_f32 v56, 1.0, v56
    v_add_f32 v57, 1.0, v57
    v_add_f32 v58, 1.0, v58
    v_add_f32 v59, 1.0, v59
    v_add_f32 v60, 1.0, v60
    v_add_f32 v61, 1.0, v61
    v_add_f32 v62, 1.0, v62
    v_add_f32 v63, 1.0, v63
    v_rcp_f32 v56, v56
    v_rcp_f32 v57, v57
    v_rcp_f32 v58, v58
    v_rcp_f32 v59, v59
    v_rcp_f32 v60, v60
    v_rcp_f32 v61, v61
    v_rcp_f32 v62, v62
    v_rcp_f32 v63, v63
    s_nop 0
    v_mul_f32 v48, v48, v56
    v_mul_f32 v49, v49, v57
    v_mul_f32 v50, v50, v58
    v_mul_f32 v51, v51, v59
    v_mul_f32 v52, v52, v60
    v_mul_f32 v53, v53, v61
    v_mul_f32 v54, v54, v62
    v_mul_f32 v55, v55, v63
    v_cvt_pk_bf16_f32 v48, v48, v49
    v_cvt_pk_bf16_f32 v49, v50, v51
    v_cvt_pk_bf16_f32 v50, v52, v53
    v_cvt_pk_bf16_f32 v51, v54, v55
    buffer_store_dwordx4 v[48:51], v4, s[8:11], s36 offen offset:1024 sc1
    v_accvgpr_read_b32 v32, a32
    v_accvgpr_read_b32 v33, a33
    v_accvgpr_read_b32 v34, a34
    v_accvgpr_read_b32 v35, a35
    v_accvgpr_read_b32 v36, a40
    v_accvgpr_read_b32 v37, a41
    v_accvgpr_read_b32 v38, a42
    v_accvgpr_read_b32 v39, a43
    v_add_f32 v32, v32, v112
    v_add_f32 v33, v33, v113
    v_add_f32 v34, v34, v114
    v_add_f32 v35, v35, v115
    v_add_f32 v36, v36, v116
    v_add_f32 v37, v37, v117
    v_add_f32 v38, v38, v118
    v_add_f32 v39, v39, v119
    v_mul_f32 v40, v32, v32
    v_mul_f32 v41, v33, v33
    v_mul_f32 v42, v34, v34
    v_mul_f32 v43, v35, v35
    v_mul_f32 v44, v36, v36
    v_mul_f32 v45, v37, v37
    v_mul_f32 v46, v38, v38
    v_mul_f32 v47, v39, v39
    v_fma_f32 v40, v40, s56, 1.0
    v_fma_f32 v41, v41, s56, 1.0
    v_fma_f32 v42, v42, s56, 1.0
    v_fma_f32 v43, v43, s56, 1.0
    v_fma_f32 v44, v44, s56, 1.0
    v_fma_f32 v45, v45, s56, 1.0
    v_fma_f32 v46, v46, s56, 1.0
    v_fma_f32 v47, v47, s56, 1.0
    v_mul_f32 v40, v40, v32
    v_mul_f32 v41, v41, v33
    v_mul_f32 v42, v42, v34
    v_mul_f32 v43, v43, v35
    v_mul_f32 v44, v44, v36
    v_mul_f32 v45, v45, v37
    v_mul_f32 v46, v46, v38
    v_mul_f32 v47, v47, v39
    v_mul_f32 v40, s57, v40
    v_mul_f32 v41, s57, v41
    v_mul_f32 v42, s57, v42
    v_mul_f32 v43, s57, v43
    v_mul_f32 v44, s57, v44
    v_mul_f32 v45, s57, v45
    v_mul_f32 v46, s57, v46
    v_mul_f32 v47, s57, v47
    v_exp_f32 v40, v40
    v_exp_f32 v41, v41
    v_exp_f32 v42, v42
    v_exp_f32 v43, v43
    v_exp_f32 v44, v44
    v_exp_f32 v45, v45
    v_exp_f32 v46, v46
    v_exp_f32 v47, v47
    s_nop 0
    v_add_f32 v40, 1.0, v40
    v_add_f32 v41, 1.0, v41
    v_add_f32 v42, 1.0, v42
    v_add_f32 v43, 1.0, v43
    v_add_f32 v44, 1.0, v44
    v_add_f32 v45, 1.0, v45
    v_add_f32 v46, 1.0, v46
    v_add_f32 v47, 1.0, v47
    v_rcp_f32 v40, v40
    v_rcp_f32 v41, v41
    v_rcp_f32 v42, v42
    v_rcp_f32 v43, v43
    v_rcp_f32 v44, v44
    v_rcp_f32 v45, v45
    v_rcp_f32 v46, v46
    v_rcp_f32 v47, v47
    s_nop 0
    v_mul_f32 v32, v32, v40
    v_mul_f32 v33, v33, v41
    v_mul_f32 v34, v34, v42
    v_mul_f32 v35, v35, v43
    v_mul_f32 v36, v36, v44
    v_mul_f32 v37, v37, v45
    v_mul_f32 v38, v38, v46
    v_mul_f32 v39, v39, v47
    v_cvt_pk_bf16_f32 v32, v32, v33
    v_cvt_pk_bf16_f32 v33, v34, v35
    v_cvt_pk_bf16_f32 v34, v36, v37
    v_cvt_pk_bf16_f32 v35, v38, v39
    buffer_store_dwordx4 v[32:35], v4, s[8:11], s36 offen offset:2048 sc1
    v_accvgpr_read_b32 v48, a48
    v_accvgpr_read_b32 v49, a49
    v_accvgpr_read_b32 v50, a50
    v_accvgpr_read_b32 v51, a51
    v_accvgpr_read_b32 v52, a56
    v_accvgpr_read_b32 v53, a57
    v_accvgpr_read_b32 v54, a58
    v_accvgpr_read_b32 v55, a59
    v_add_f32 v48, v48, v120
    v_add_f32 v49, v49, v121
    v_add_f32 v50, v50, v122
    v_add_f32 v51, v51, v123
    v_add_f32 v52, v52, v124
    v_add_f32 v53, v53, v125
    v_add_f32 v54, v54, v126
    v_add_f32 v55, v55, v127
    v_mul_f32 v56, v48, v48
    v_mul_f32 v57, v49, v49
    v_mul_f32 v58, v50, v50
    v_mul_f32 v59, v51, v51
    v_mul_f32 v60, v52, v52
    v_mul_f32 v61, v53, v53
    v_mul_f32 v62, v54, v54
    v_mul_f32 v63, v55, v55
    v_fma_f32 v56, v56, s56, 1.0
    v_fma_f32 v57, v57, s56, 1.0
    v_fma_f32 v58, v58, s56, 1.0
    v_fma_f32 v59, v59, s56, 1.0
    v_fma_f32 v60, v60, s56, 1.0
    v_fma_f32 v61, v61, s56, 1.0
    v_fma_f32 v62, v62, s56, 1.0
    v_fma_f32 v63, v63, s56, 1.0
    v_mul_f32 v56, v56, v48
    v_mul_f32 v57, v57, v49
    v_mul_f32 v58, v58, v50
    v_mul_f32 v59, v59, v51
    v_mul_f32 v60, v60, v52
    v_mul_f32 v61, v61, v53
    v_mul_f32 v62, v62, v54
    v_mul_f32 v63, v63, v55
    v_mul_f32 v56, s57, v56
    v_mul_f32 v57, s57, v57
    v_mul_f32 v58, s57, v58
    v_mul_f32 v59, s57, v59
    v_mul_f32 v60, s57, v60
    v_mul_f32 v61, s57, v61
    v_mul_f32 v62, s57, v62
    v_mul_f32 v63, s57, v63
    v_exp_f32 v56, v56
    v_exp_f32 v57, v57
    v_exp_f32 v58, v58
    v_exp_f32 v59, v59
    v_exp_f32 v60, v60
    v_exp_f32 v61, v61
    v_exp_f32 v62, v62
    v_exp_f32 v63, v63
    s_nop 0
    v_add_f32 v56, 1.0, v56
    v_add_f32 v57, 1.0, v57
    v_add_f32 v58, 1.0, v58
    v_add_f32 v59, 1.0, v59
    v_add_f32 v60, 1.0, v60
    v_add_f32 v61, 1.0, v61
    v_add_f32 v62, 1.0, v62
    v_add_f32 v63, 1.0, v63
    v_rcp_f32 v56, v56
    v_rcp_f32 v57, v57
    v_rcp_f32 v58, v58
    v_rcp_f32 v59, v59
    v_rcp_f32 v60, v60
    v_rcp_f32 v61, v61
    v_rcp_f32 v62, v62
    v_rcp_f32 v63, v63
    s_nop 0
    v_mul_f32 v48, v48, v56
    v_mul_f32 v49, v49, v57
    v_mul_f32 v50, v50, v58
    v_mul_f32 v51, v51, v59
    v_mul_f32 v52, v52, v60
    v_mul_f32 v53, v53, v61
    v_mul_f32 v54, v54, v62
    v_mul_f32 v55, v55, v63
    v_cvt_pk_bf16_f32 v48, v48, v49
    v_cvt_pk_bf16_f32 v49, v50, v51
    v_cvt_pk_bf16_f32 v50, v52, v53
    v_cvt_pk_bf16_f32 v51, v54, v55
    buffer_store_dwordx4 v[48:51], v4, s[8:11], s36 offen offset:3072 sc1
    s_add_u32 s36, s31, 114688
    v_accvgpr_read_b32 v32, a4
    v_accvgpr_read_b32 v33, a5
    v_accvgpr_read_b32 v34, a6
    v_accvgpr_read_b32 v35, a7
    v_accvgpr_read_b32 v36, a12
    v_accvgpr_read_b32 v37, a13
    v_accvgpr_read_b32 v38, a14
    v_accvgpr_read_b32 v39, a15
    v_add_f32 v32, v32, v96
    v_add_f32 v33, v33, v97
    v_add_f32 v34, v34, v98
    v_add_f32 v35, v35, v99
    v_add_f32 v36, v36, v100
    v_add_f32 v37, v37, v101
    v_add_f32 v38, v38, v102
    v_add_f32 v39, v39, v103
    v_mul_f32 v40, v32, v32
    v_mul_f32 v41, v33, v33
    v_mul_f32 v42, v34, v34
    v_mul_f32 v43, v35, v35
    v_mul_f32 v44, v36, v36
    v_mul_f32 v45, v37, v37
    v_mul_f32 v46, v38, v38
    v_mul_f32 v47, v39, v39
    v_fma_f32 v40, v40, s56, 1.0
    v_fma_f32 v41, v41, s56, 1.0
    v_fma_f32 v42, v42, s56, 1.0
    v_fma_f32 v43, v43, s56, 1.0
    v_fma_f32 v44, v44, s56, 1.0
    v_fma_f32 v45, v45, s56, 1.0
    v_fma_f32 v46, v46, s56, 1.0
    v_fma_f32 v47, v47, s56, 1.0
    v_mul_f32 v40, v40, v32
    v_mul_f32 v41, v41, v33
    v_mul_f32 v42, v42, v34
    v_mul_f32 v43, v43, v35
    v_mul_f32 v44, v44, v36
    v_mul_f32 v45, v45, v37
    v_mul_f32 v46, v46, v38
    v_mul_f32 v47, v47, v39
    v_mul_f32 v40, s57, v40
    v_mul_f32 v41, s57, v41
    v_mul_f32 v42, s57, v42
    v_mul_f32 v43, s57, v43
    v_mul_f32 v44, s57, v44
    v_mul_f32 v45, s57, v45
    v_mul_f32 v46, s57, v46
    v_mul_f32 v47, s57, v47
    v_exp_f32 v40, v40
    v_exp_f32 v41, v41
    v_exp_f32 v42, v42
    v_exp_f32 v43, v43
    v_exp_f32 v44, v44
    v_exp_f32 v45, v45
    v_exp_f32 v46, v46
    v_exp_f32 v47, v47
    s_nop 0
    v_add_f32 v40, 1.0, v40
    v_add_f32 v41, 1.0, v41
    v_add_f32 v42, 1.0, v42
    v_add_f32 v43, 1.0, v43
    v_add_f32 v44, 1.0, v44
    v_add_f32 v45, 1.0, v45
    v_add_f32 v46, 1.0, v46
    v_add_f32 v47, 1.0, v47
    v_rcp_f32 v40, v40
    v_rcp_f32 v41, v41
    v_rcp_f32 v42, v42
    v_rcp_f32 v43, v43
    v_rcp_f32 v44, v44
    v_rcp_f32 v45, v45
    v_rcp_f32 v46, v46
    v_rcp_f32 v47, v47
    s_nop 0
    v_mul_f32 v32, v32, v40
    v_mul_f32 v33, v33, v41
    v_mul_f32 v34, v34, v42
    v_mul_f32 v35, v35, v43
    v_mul_f32 v36, v36, v44
    v_mul_f32 v37, v37, v45
    v_mul_f32 v38, v38, v46
    v_mul_f32 v39, v39, v47
    v_cvt_pk_bf16_f32 v32, v32, v33
    v_cvt_pk_bf16_f32 v33, v34, v35
    v_cvt_pk_bf16_f32 v34, v36, v37
    v_cvt_pk_bf16_f32 v35, v38, v39
    buffer_store_dwordx4 v[32:35], v4, s[8:11], s36 offen offset:0 sc1
    v_accvgpr_read_b32 v48, a20
    v_accvgpr_read_b32 v49, a21
    v_accvgpr_read_b32 v50, a22
    v_accvgpr_read_b32 v51, a23
    v_accvgpr_read_b32 v52, a28
    v_accvgpr_read_b32 v53, a29
    v_accvgpr_read_b32 v54, a30
    v_accvgpr_read_b32 v55, a31
    v_add_f32 v48, v48, v104
    v_add_f32 v49, v49, v105
    v_add_f32 v50, v50, v106
    v_add_f32 v51, v51, v107
    v_add_f32 v52, v52, v108
    v_add_f32 v53, v53, v109
    v_add_f32 v54, v54, v110
    v_add_f32 v55, v55, v111
    v_mul_f32 v56, v48, v48
    v_mul_f32 v57, v49, v49
    v_mul_f32 v58, v50, v50
    v_mul_f32 v59, v51, v51
    v_mul_f32 v60, v52, v52
    v_mul_f32 v61, v53, v53
    v_mul_f32 v62, v54, v54
    v_mul_f32 v63, v55, v55
    v_fma_f32 v56, v56, s56, 1.0
    v_fma_f32 v57, v57, s56, 1.0
    v_fma_f32 v58, v58, s56, 1.0
    v_fma_f32 v59, v59, s56, 1.0
    v_fma_f32 v60, v60, s56, 1.0
    v_fma_f32 v61, v61, s56, 1.0
    v_fma_f32 v62, v62, s56, 1.0
    v_fma_f32 v63, v63, s56, 1.0
    v_mul_f32 v56, v56, v48
    v_mul_f32 v57, v57, v49
    v_mul_f32 v58, v58, v50
    v_mul_f32 v59, v59, v51
    v_mul_f32 v60, v60, v52
    v_mul_f32 v61, v61, v53
    v_mul_f32 v62, v62, v54
    v_mul_f32 v63, v63, v55
    v_mul_f32 v56, s57, v56
    v_mul_f32 v57, s57, v57
    v_mul_f32 v58, s57, v58
    v_mul_f32 v59, s57, v59
    v_mul_f32 v60, s57, v60
    v_mul_f32 v61, s57, v61
    v_mul_f32 v62, s57, v62
    v_mul_f32 v63, s57, v63
    v_exp_f32 v56, v56
    v_exp_f32 v57, v57
    v_exp_f32 v58, v58
    v_exp_f32 v59, v59
    v_exp_f32 v60, v60
    v_exp_f32 v61, v61
    v_exp_f32 v62, v62
    v_exp_f32 v63, v63
    s_nop 0
    v_add_f32 v56, 1.0, v56
    v_add_f32 v57, 1.0, v57
    v_add_f32 v58, 1.0, v58
    v_add_f32 v59, 1.0, v59
    v_add_f32 v60, 1.0, v60
    v_add_f32 v61, 1.0, v61
    v_add_f32 v62, 1.0, v62
    v_add_f32 v63, 1.0, v63
    v_rcp_f32 v56, v56
    v_rcp_f32 v57, v57
    v_rcp_f32 v58, v58
    v_rcp_f32 v59, v59
    v_rcp_f32 v60, v60
    v_rcp_f32 v61, v61
    v_rcp_f32 v62, v62
    v_rcp_f32 v63, v63
    s_nop 0
    v_mul_f32 v48, v48, v56
    v_mul_f32 v49, v49, v57
    v_mul_f32 v50, v50, v58
    v_mul_f32 v51, v51, v59
    v_mul_f32 v52, v52, v60
    v_mul_f32 v53, v53, v61
    v_mul_f32 v54, v54, v62
    v_mul_f32 v55, v55, v63
    v_cvt_pk_bf16_f32 v48, v48, v49
    v_cvt_pk_bf16_f32 v49, v50, v51
    v_cvt_pk_bf16_f32 v50, v52, v53
    v_cvt_pk_bf16_f32 v51, v54, v55
    buffer_store_dwordx4 v[48:51], v4, s[8:11], s36 offen offset:1024 sc1
    v_accvgpr_read_b32 v32, a36
    v_accvgpr_read_b32 v33, a37
    v_accvgpr_read_b32 v34, a38
    v_accvgpr_read_b32 v35, a39
    v_accvgpr_read_b32 v36, a44
    v_accvgpr_read_b32 v37, a45
    v_accvgpr_read_b32 v38, a46
    v_accvgpr_read_b32 v39, a47
    v_add_f32 v32, v32, v112
    v_add_f32 v33, v33, v113
    v_add_f32 v34, v34, v114
    v_add_f32 v35, v35, v115
    v_add_f32 v36, v36, v116
    v_add_f32 v37, v37, v117
    v_add_f32 v38, v38, v118
    v_add_f32 v39, v39, v119
    v_mul_f32 v40, v32, v32
    v_mul_f32 v41, v33, v33
    v_mul_f32 v42, v34, v34
    v_mul_f32 v43, v35, v35
    v_mul_f32 v44, v36, v36
    v_mul_f32 v45, v37, v37
    v_mul_f32 v46, v38, v38
    v_mul_f32 v47, v39, v39
    v_fma_f32 v40, v40, s56, 1.0
    v_fma_f32 v41, v41, s56, 1.0
    v_fma_f32 v42, v42, s56, 1.0
    v_fma_f32 v43, v43, s56, 1.0
    v_fma_f32 v44, v44, s56, 1.0
    v_fma_f32 v45, v45, s56, 1.0
    v_fma_f32 v46, v46, s56, 1.0
    v_fma_f32 v47, v47, s56, 1.0
    v_mul_f32 v40, v40, v32
    v_mul_f32 v41, v41, v33
    v_mul_f32 v42, v42, v34
    v_mul_f32 v43, v43, v35
    v_mul_f32 v44, v44, v36
    v_mul_f32 v45, v45, v37
    v_mul_f32 v46, v46, v38
    v_mul_f32 v47, v47, v39
    v_mul_f32 v40, s57, v40
    v_mul_f32 v41, s57, v41
    v_mul_f32 v42, s57, v42
    v_mul_f32 v43, s57, v43
    v_mul_f32 v44, s57, v44
    v_mul_f32 v45, s57, v45
    v_mul_f32 v46, s57, v46
    v_mul_f32 v47, s57, v47
    v_exp_f32 v40, v40
    v_exp_f32 v41, v41
    v_exp_f32 v42, v42
    v_exp_f32 v43, v43
    v_exp_f32 v44, v44
    v_exp_f32 v45, v45
    v_exp_f32 v46, v46
    v_exp_f32 v47, v47
    s_nop 0
    v_add_f32 v40, 1.0, v40
    v_add_f32 v41, 1.0, v41
    v_add_f32 v42, 1.0, v42
    v_add_f32 v43, 1.0, v43
    v_add_f32 v44, 1.0, v44
    v_add_f32 v45, 1.0, v45
    v_add_f32 v46, 1.0, v46
    v_add_f32 v47, 1.0, v47
    v_rcp_f32 v40, v40
    v_rcp_f32 v41, v41
    v_rcp_f32 v42, v42
    v_rcp_f32 v43, v43
    v_rcp_f32 v44, v44
    v_rcp_f32 v45, v45
    v_rcp_f32 v46, v46
    v_rcp_f32 v47, v47
    s_nop 0
    v_mul_f32 v32, v32, v40
    v_mul_f32 v33, v33, v41
    v_mul_f32 v34, v34, v42
    v_mul_f32 v35, v35, v43
    v_mul_f32 v36, v36, v44
    v_mul_f32 v37, v37, v45
    v_mul_f32 v38, v38, v46
    v_mul_f32 v39, v39, v47
    v_cvt_pk_bf16_f32 v32, v32, v33
    v_cvt_pk_bf16_f32 v33, v34, v35
    v_cvt_pk_bf16_f32 v34, v36, v37
    v_cvt_pk_bf16_f32 v35, v38, v39
    buffer_store_dwordx4 v[32:35], v4, s[8:11], s36 offen offset:2048 sc1
    v_accvgpr_read_b32 v48, a52
    v_accvgpr_read_b32 v49, a53
    v_accvgpr_read_b32 v50, a54
    v_accvgpr_read_b32 v51, a55
    v_accvgpr_read_b32 v52, a60
    v_accvgpr_read_b32 v53, a61
    v_accvgpr_read_b32 v54, a62
    v_accvgpr_read_b32 v55, a63
    v_add_f32 v48, v48, v120
    v_add_f32 v49, v49, v121
    v_add_f32 v50, v50, v122
    v_add_f32 v51, v51, v123
    v_add_f32 v52, v52, v124
    v_add_f32 v53, v53, v125
    v_add_f32 v54, v54, v126
    v_add_f32 v55, v55, v127
    v_mul_f32 v56, v48, v48
    v_mul_f32 v57, v49, v49
    v_mul_f32 v58, v50, v50
    v_mul_f32 v59, v51, v51
    v_mul_f32 v60, v52, v52
    v_mul_f32 v61, v53, v53
    v_mul_f32 v62, v54, v54
    v_mul_f32 v63, v55, v55
    v_fma_f32 v56, v56, s56, 1.0
    v_fma_f32 v57, v57, s56, 1.0
    v_fma_f32 v58, v58, s56, 1.0
    v_fma_f32 v59, v59, s56, 1.0
    v_fma_f32 v60, v60, s56, 1.0
    v_fma_f32 v61, v61, s56, 1.0
    v_fma_f32 v62, v62, s56, 1.0
    v_fma_f32 v63, v63, s56, 1.0
    v_mul_f32 v56, v56, v48
    v_mul_f32 v57, v57, v49
    v_mul_f32 v58, v58, v50
    v_mul_f32 v59, v59, v51
    v_mul_f32 v60, v60, v52
    v_mul_f32 v61, v61, v53
    v_mul_f32 v62, v62, v54
    v_mul_f32 v63, v63, v55
    v_mul_f32 v56, s57, v56
    v_mul_f32 v57, s57, v57
    v_mul_f32 v58, s57, v58
    v_mul_f32 v59, s57, v59
    v_mul_f32 v60, s57, v60
    v_mul_f32 v61, s57, v61
    v_mul_f32 v62, s57, v62
    v_mul_f32 v63, s57, v63
    v_exp_f32 v56, v56
    v_exp_f32 v57, v57
    v_exp_f32 v58, v58
    v_exp_f32 v59, v59
    v_exp_f32 v60, v60
    v_exp_f32 v61, v61
    v_exp_f32 v62, v62
    v_exp_f32 v63, v63
    s_nop 0
    v_add_f32 v56, 1.0, v56
    v_add_f32 v57, 1.0, v57
    v_add_f32 v58, 1.0, v58
    v_add_f32 v59, 1.0, v59
    v_add_f32 v60, 1.0, v60
    v_add_f32 v61, 1.0, v61
    v_add_f32 v62, 1.0, v62
    v_add_f32 v63, 1.0, v63
    v_rcp_f32 v56, v56
    v_rcp_f32 v57, v57
    v_rcp_f32 v58, v58
    v_rcp_f32 v59, v59
    v_rcp_f32 v60, v60
    v_rcp_f32 v61, v61
    v_rcp_f32 v62, v62
    v_rcp_f32 v63, v63
    s_nop 0
    v_mul_f32 v48, v48, v56
    v_mul_f32 v49, v49, v57
    v_mul_f32 v50, v50, v58
    v_mul_f32 v51, v51, v59
    v_mul_f32 v52, v52, v60
    v_mul_f32 v53, v53, v61
    v_mul_f32 v54, v54, v62
    v_mul_f32 v55, v55, v63
    v_cvt_pk_bf16_f32 v48, v48, v49
    v_cvt_pk_bf16_f32 v49, v50, v51
    v_cvt_pk_bf16_f32 v50, v52, v53
    v_cvt_pk_bf16_f32 v51, v54, v55
    buffer_store_dwordx4 v[48:51], v4, s[8:11], s36 offen offset:3072 sc1
    s_lshl_b32 s36, s34, 7
    s_add_u32 s36, s36, 126976
    s_waitcnt vmcnt(0)
    s_barrier
    s_cmp_lg_u32 s20, 0
    s_cbranch_scc1 mega_kernel_w_t_s5
    s_mov_b64 s[42:43], exec
    s_mov_b64 exec, 1
    v_mov_b32 v250, 0
    v_mov_b32 v251, 1
    buffer_atomic_add v251, v250, s[8:11], s36 offen
    s_mov_b64 exec, s[42:43]
mega_kernel_w_t_s5:

    s_branch mega_kernel_w_t_g6
mega_kernel_w_t_xln:
    s_cmp_ge_u32 s61, 30
    s_cbranch_scc1 mega_kernel_w_t_xw
    s_sub_u32 s55, 35, s61
    s_mov_b32 s39, -20
    s_branch mega_kernel_w_ln

mega_kernel_w_t_xw:
    s_mov_b32 s30, 122912
    s_cmp_lg_u32 s20, 0
    s_cbranch_scc1 mega_kernel_w_t_wxw_ok
    v_mov_b32 v250, 0
mega_kernel_w_t_wxw:
    buffer_load_dword v251, v250, s[8:11], s30 offen sc1
    s_waitcnt vmcnt(0)
    v_readfirstlane_b32 s31, v251
    s_cmp_ge_u32 s31, 8
    s_cbranch_scc1 mega_kernel_w_t_wxw_ok
    s_sub_u32 s40, s40, 1
    s_cbranch_scc1 mega_kernel_w_exit
    s_sleep 24
    s_branch mega_kernel_w_t_wxw
mega_kernel_w_t_wxw_ok:
    s_barrier

mega_kernel_w_t_g6:
    s_load_dwordx2 s[44:45], s[0:1], 80
    s_load_dwordx2 s[46:47], s[0:1], 88
    s_load_dwordx2 s[48:49], s[0:1], 112
    s_and_b32 s32, s61, 1
    s_lshr_b32 s31, s61, 1
    s_and_b32 s34, s38, 1
    s_lshl_b32 s34, s34, 2
    s_and_b32 s36, s31, 3
    s_add_u32 s34, s34, s36
    s_lshr_b32 s24, s38, 1
    s_lshl_b32 s24, s24, 2
    s_lshr_b32 s36, s31, 2
    s_add_u32 s24, s24, s36
    s_waitcnt lgkmcnt(0)
    s_mov_b32 s50, 4194304
    s_mov_b32 s51, 0x20000

    s_mov_b32 s12, s44
    s_mov_b32 s13, s45
    s_mov_b32 s14, 14680064
    s_mov_b32 s15, 0x20000
    s_mov_b32 s16, s46
    s_mov_b32 s17, s47
    s_mov_b32 s18, 4096
    s_mov_b32 s19, 0x20000
    s_lshl_b32 s28, s20, 12
    v_lshrrev_b32 v5, 4, v1
    s_lshl_b32 s30, s20, 4
    v_add_u32 v5, s30, v5
    v_and_b32 v6, 15, v1
    s_mov_b32 s31, 4096
    v_add_u32 v7, 0, v5
    v_and_b32 v8, 7, v7
    v_lshlrev_b32 v8, 1, v8
    v_xor_b32 v8, v8, v6
    v_lshlrev_b32 v8, 4, v8
    v_mul_lo_u32 v7, v7, s31
    v_add_u32 v8, v8, v7
    v_add_u32 v7, 4, v5
    v_and_b32 v9, 7, v7
    v_lshlrev_b32 v9, 1, v9
    v_xor_b32 v9, v9, v6
    v_lshlrev_b32 v9, 4, v9
    v_mul_lo_u32 v7, v7, s31
    v_add_u32 v9, v9, v7
    v_subrev_u32 v9, 1024, v9
    v_add_u32 v7, 8, v5
    v_and_b32 v10, 7, v7
    v_lshlrev_b32 v10, 1, v10
    v_xor_b32 v10, v10, v6
    v_lshlrev_b32 v10, 4, v10
    v_mul_lo_u32 v7, v7, s31
    v_add_u32 v10, v10, v7
    v_subrev_u32 v10, 2048, v10
    v_add_u32 v7, 12, v5
    v_and_b32 v11, 7, v7
    v_lshlrev_b32 v11, 1, v11
    v_xor_b32 v11, v11, v6
    v_lshlrev_b32 v11, 4, v11
    v_mul_lo_u32 v7, v7, s31
    v_add_u32 v11, v11, v7
    v_subrev_u32 v11, 3072, v11
    v_lshrrev_b32 v5, 2, v2
    v_lshl_add_u32 v5, v3, 2, v5
    v_and_b32 v6, 7, v5
    v_lshlrev_b32 v6, 5, v6
    v_lshlrev_b32 v5, 8, v5
    v_and_b32 v7, 3, v2
    v_lshl_add_u32 v5, v7, 3, v5
    v_xor_b32 v14, 0, v6
    v_add_u32 v14, v14, v5
    v_add_u32 v22, 0x10000, v14
    v_xor_b32 v15, 32, v6
    v_add_u32 v15, v15, v5
    v_add_u32 v23, 0x10000, v15
    v_xor_b32 v16, 64, v6
    v_add_u32 v16, v16, v5
    v_add_u32 v24, 0x10000, v16
    v_xor_b32 v17, 96, v6
    v_add_u32 v17, v17, v5
    v_add_u32 v25, 0x10000, v17
    v_xor_b32 v18, 128, v6
    v_add_u32 v18, v18, v5
    v_add_u32 v26, 0x10000, v18
    v_xor_b32 v19, 160, v6
    v_add_u32 v19, v19, v5
    v_add_u32 v27, 0x10000, v19
    v_xor_b32 v20, 192, v6
    v_add_u32 v20, v20, v5
    v_add_u32 v28, 0x10000, v20
    v_xor_b32 v21, 224, v6
    v_add_u32 v21, v21, v5
    v_add_u32 v29, 0x10000, v21
    s_mul_i32 s30, s20, 229376
    v_add_u32 v12, s30, v4
    v_add_u32 v13, 114688, v12
    s_lshl_b32 s26, s24, 8
    s_mul_i32 s30, s32, 7340032
    s_add_u32 s26, s26, s30
    s_mul_i32 s25, s34, 917504
    s_mul_i32 s30, s32, 57344
    s_add_u32 s25, s25, s30
    s_add_u32 s25, s25, 90603520

    s_add_u32 m0, s28, 0
    s_nop 0
    buffer_load_dwordx4 v8, s[12:15], s26 offen offset:0 lds
    buffer_load_dwordx4 v9, s[12:15], s26 offen offset:1024 lds
    buffer_load_dwordx4 v10, s[12:15], s26 offen offset:2048 lds
    buffer_load_dwordx4 v11, s[12:15], s26 offen offset:3072 lds
    s_add_u32 s26, s26, 262144
    s_add_u32 m0, s28, 16384
    s_nop 0
    buffer_load_dwordx4 v8, s[12:15], s26 offen offset:0 lds
    buffer_load_dwordx4 v9, s[12:15], s26 offen offset:1024 lds
    buffer_load_dwordx4 v10, s[12:15], s26 offen offset:2048 lds
    buffer_load_dwordx4 v11, s[12:15], s26 offen offset:3072 lds
    s_add_u32 s26, s26, 262144
    s_add_u32 m0, s28, 32768
    s_nop 0
    buffer_load_dwordx4 v8, s[12:15], s26 offen offset:0 lds
    buffer_load_dwordx4 v9, s[12:15], s26 offen offset:1024 lds
    buffer_load_dwordx4 v10, s[12:15], s26 offen offset:2048 lds
    buffer_load_dwordx4 v11, s[12:15], s26 offen offset:3072 lds
    s_add_u32 s26, s26, 262144
    s_add_u32 m0, s28, 49152
    s_nop 0
    buffer_load_dwordx4 v8, s[12:15], s26 offen offset:0 lds
    buffer_load_dwordx4 v9, s[12:15], s26 offen offset:1024 lds
    buffer_load_dwordx4 v10, s[12:15], s26 offen offset:2048 lds
    buffer_load_dwordx4 v11, s[12:15], s26 offen offset:3072 lds
    s_add_u32 s26, s26, 262144
    s_add_u32 m0, s28, 65536
    s_nop 0
    buffer_load_dwordx4 v8, s[12:15], s26 offen offset:0 lds
    buffer_load_dwordx4 v9, s[12:15], s26 offen offset:1024 lds
    buffer_load_dwordx4 v10, s[12:15], s26 offen offset:2048 lds
    buffer_load_dwordx4 v11, s[12:15], s26 offen offset:3072 lds
    s_add_u32 s26, s26, 262144
    s_add_u32 m0, s28, 81920
    s_nop 0
    buffer_load_dwordx4 v8, s[12:15], s26 offen offset:0 lds
    buffer_load_dwordx4 v9, s[12:15], s26 offen offset:1024 lds
    buffer_load_dwordx4 v10, s[12:15], s26 offen offset:2048 lds
    buffer_load_dwordx4 v11, s[12:15], s26 offen offset:3072 lds
    s_add_u32 s26, s26, 262144
    s_add_u32 m0, s28, 98304
    s_nop 0
    buffer_load_dwordx4 v8, s[12:15], s26 offen offset:0 lds
    buffer_load_dwordx4 v9, s[12:15], s26 offen offset:1024 lds
    buffer_load_dwordx4 v10, s[12:15], s26 offen offset:2048 lds
    buffer_load_dwordx4 v11, s[12:15], s26 offen offset:3072 lds
    s_add_u32 s26, s26, 262144
    s_add_u32 m0, s28, 114688
    s_nop 0
    buffer_load_dwordx4 v8, s[12:15], s26 offen offset:0 lds
    buffer_load_dwordx4 v9, s[12:15], s26 offen offset:1024 lds
    buffer_load_dwordx4 v10, s[12:15], s26 offen offset:2048 lds
    buffer_load_dwordx4 v11, s[12:15], s26 offen offset:3072 lds
    s_add_u32 s26, s26, 262144
    s_lshl_b32 s30, s34, 7
    s_add_u32 s30, s30, 126976

    s_cmp_lg_u32 s20, 0
    s_cbranch_scc1 mega_kernel_w_t_w6_ok
    v_mov_b32 v250, 0
mega_kernel_w_t_w6:
    buffer_load_dword v251, v250, s[8:11], s30 offen sc1
    s_waitcnt vmcnt(0)
    v_readfirstlane_b32 s31, v251
    s_cmp_ge_u32 s31, 28
    s_cbranch_scc1 mega_kernel_w_t_w6_ok
    s_sub_u32 s40, s40, 1
    s_cbranch_scc1 mega_kernel_w_exit
    s_sleep 2
    s_branch mega_kernel_w_t_w6
mega_kernel_w_t_w6_ok:
    s_barrier

    buffer_load_dwordx4 v[96:99], v12, s[8:11], s25 offen sc1
    buffer_load_dwordx4 v[100:103], v13, s[8:11], s25 offen sc1
    s_add_u32 s25, s25, 1024
    buffer_load_dwordx4 v[104:107], v12, s[8:11], s25 offen sc1
    buffer_load_dwordx4 v[108:111], v13, s[8:11], s25 offen sc1
    s_add_u32 s25, s25, 1024
    buffer_load_dwordx4 v[112:115], v12, s[8:11], s25 offen sc1
    buffer_load_dwordx4 v[116:119], v13, s[8:11], s25 offen sc1
    s_add_u32 s25, s25, 1024
    buffer_load_dwordx4 v[120:123], v12, s[8:11], s25 offen sc1
    buffer_load_dwordx4 v[124:127], v13, s[8:11], s25 offen sc1
    s_add_u32 s25, s25, 1024
    buffer_load_dwordx4 v[128:131], v12, s[8:11], s25 offen sc1
    buffer_load_dwordx4 v[132:135], v13, s[8:11], s25 offen sc1
    s_add_u32 s25, s25, 1024
    buffer_load_dwordx4 v[136:139], v12, s[8:11], s25 offen sc1
    buffer_load_dwordx4 v[140:143], v13, s[8:11], s25 offen sc1
    s_add_u32 s25, s25, 1024
    buffer_load_dwordx4 v[144:147], v12, s[8:11], s25 offen sc1
    buffer_load_dwordx4 v[148:151], v13, s[8:11], s25 offen sc1
    s_add_u32 s25, s25, 1024
    buffer_load_dwordx4 v[152:155], v12, s[8:11], s25 offen sc1
    buffer_load_dwordx4 v[156:159], v13, s[8:11], s25 offen sc1
    s_add_u32 s25, s25, 1024
    buffer_load_dwordx4 v[160:163], v12, s[8:11], s25 offen sc1
    buffer_load_dwordx4 v[164:167], v13, s[8:11], s25 offen sc1
    s_add_u32 s25, s25, 1024
    buffer_load_dwordx4 v[168:171], v12, s[8:11], s25 offen sc1
    buffer_load_dwordx4 v[172:175], v13, s[8:11], s25 offen sc1
    s_add_u32 s25, s25, 1024
    buffer_load_dwordx4 v[176:179], v12, s[8:11], s25 offen sc1
    buffer_load_dwordx4 v[180:183], v13, s[8:11], s25 offen sc1
    s_add_u32 s25, s25, 1024
    buffer_load_dwordx4 v[184:187], v12, s[8:11], s25 offen sc1
    buffer_load_dwordx4 v[188:191], v13, s[8:11], s25 offen sc1
    s_add_u32 s25, s25, 1024
    buffer_load_dwordx4 v[192:195], v12, s[8:11], s25 offen sc1
    buffer_load_dwordx4 v[196:199], v13, s[8:11], s25 offen sc1
    s_add_u32 s25, s25, 1024
    buffer_load_dwordx4 v[200:203], v12, s[8:11], s25 offen sc1
    buffer_load_dwordx4 v[204:207], v13, s[8:11], s25 offen sc1
    s_add_u32 s25, s25, 1024
    buffer_load_dwordx4 v[208:211], v12, s[8:11], s25 offen sc1
    buffer_load_dwordx4 v[212:215], v13, s[8:11], s25 offen sc1
    s_add_u32 s25, s25, 1024
    v_accvgpr_write_b32 a0, 0
    v_accvgpr_write_b32 a1, 0
    v_accvgpr_write_b32 a2, 0
    v_accvgpr_write_b32 a3, 0
    v_accvgpr_write_b32 a4, 0
    v_accvgpr_write_b32 a5, 0
    v_accvgpr_write_b32 a6, 0
    v_accvgpr_write_b32 a7, 0
    v_accvgpr_write_b32 a8, 0
    v_accvgpr_write_b32 a9, 0
    v_accvgpr_write_b32 a10, 0
    v_accvgpr_write_b32 a11, 0
    v_accvgpr_write_b32 a12, 0
    v_accvgpr_write_b32 a13, 0
    v_accvgpr_write_b32 a14, 0
    v_accvgpr_write_b32 a15, 0
    v_accvgpr_write_b32 a16, 0
    v_accvgpr_write_b32 a17, 0
    v_accvgpr_write_b32 a18, 0
    v_accvgpr_write_b32 a19, 0
    v_accvgpr_write_b32 a20, 0
    v_accvgpr_write_b32 a21, 0
    v_accvgpr_write_b32 a22, 0
    v_accvgpr_write_b32 a23, 0
    v_accvgpr_write_b32 a24, 0
    v_accvgpr_write_b32 a25, 0
    v_accvgpr_write_b32 a26, 0
    v_accvgpr_write_b32 a27, 0
    v_accvgpr_write_b32 a28, 0
    v_accvgpr_write_b32 a29, 0
    v_accvgpr_write_b32 a30, 0
    v_accvgpr_write_b32 a31, 0
    v_accvgpr_write_b32 a32, 0
    v_accvgpr_write_b32 a33, 0
    v_accvgpr_write_b32 a34, 0
    v_accvgpr_write_b32 a35, 0
    v_accvgpr_write_b32 a36, 0
    v_accvgpr_write_b32 a37, 0
    v_accvgpr_write_b32 a38, 0
    v_accvgpr_write_b32 a39, 0
    v_accvgpr_write_b32 a40, 0
    v_accvgpr_write_b32 a41, 0
    v_accvgpr_write_b32 a42, 0
    v_accvgpr_write_b32 a43, 0
    v_accvgpr_write_b32 a44, 0
    v_accvgpr_write_b32 a45, 0
    v_accvgpr_write_b32 a46, 0
    v_accvgpr_write_b32 a47, 0
    v_accvgpr_write_b32 a48, 0
    v_accvgpr_write_b32 a49, 0
    v_accvgpr_write_b32 a50, 0
    v_accvgpr_write_b32 a51, 0
    v_accvgpr_write_b32 a52, 0
    v_accvgpr_write_b32 a53, 0
    v_accvgpr_write_b32 a54, 0
    v_accvgpr_write_b32 a55, 0
    v_accvgpr_write_b32 a56, 0
    v_accvgpr_write_b32 a57, 0
    v_accvgpr_write_b32 a58, 0
    v_accvgpr_write_b32 a59, 0
    v_accvgpr_write_b32 a60, 0
    v_accvgpr_write_b32 a61, 0
    v_accvgpr_write_b32 a62, 0
    v_accvgpr_write_b32 a63, 0
    s_mov_b32 s27, 4
    s_waitcnt vmcnt(58)
    s_barrier
    ds_read_b64_tr_b16 v[32:33], v14 offset:0
    ds_read_b64_tr_b16 v[34:35], v14 offset:4096
    ds_read_b64_tr_b16 v[36:37], v15 offset:0
    ds_read_b64_tr_b16 v[38:39], v15 offset:4096
    ds_read_b64_tr_b16 v[40:41], v16 offset:0
    ds_read_b64_tr_b16 v[42:43], v16 offset:4096
    ds_read_b64_tr_b16 v[44:45], v17 offset:0
    ds_read_b64_tr_b16 v[46:47], v17 offset:4096
    ds_read_b64_tr_b16 v[48:49], v18 offset:0
    ds_read_b64_tr_b16 v[50:51], v18 offset:4096
    ds_read_b64_tr_b16 v[52:53], v19 offset:0
    ds_read_b64_tr_b16 v[54:55], v19 offset:4096
    ds_read_b64_tr_b16 v[56:57], v20 offset:0
    ds_read_b64_tr_b16 v[58:59], v20 offset:4096
    ds_read_b64_tr_b16 v[60:61], v21 offset:0
    ds_read_b64_tr_b16 v[62:63], v21 offset:4096
mega_kernel_w_t_6_loop:
    s_waitcnt vmcnt(28) lgkmcnt(0)
    v_mfma_f32_16x16x32_bf16 a[0:3], v[96:99], v[32:35], a[0:3]
    ds_read_b64_tr_b16 v[64:65], v14 offset:8192
    ds_read_b64_tr_b16 v[66:67], v14 offset:12288
    v_mfma_f32_16x16x32_bf16 a[32:35], v[100:103], v[32:35], a[32:35]
    ds_read_b64_tr_b16 v[68:69], v15 offset:8192
    ds_read_b64_tr_b16 v[70:71], v15 offset:12288
    v_mfma_f32_16x16x32_bf16 a[4:7], v[96:99], v[36:39], a[4:7]
    ds_read_b64_tr_b16 v[72:73], v16 offset:8192
    ds_read_b64_tr_b16 v[74:75], v16 offset:12288
    v_mfma_f32_16x16x32_bf16 a[36:39], v[100:103], v[36:39], a[36:39]
    ds_read_b64_tr_b16 v[76:77], v17 offset:8192
    ds_read_b64_tr_b16 v[78:79], v17 offset:12288
    v_mfma_f32_16x16x32_bf16 a[8:11], v[96:99], v[40:43], a[8:11]
    ds_read_b64_tr_b16 v[80:81], v18 offset:8192
    ds_read_b64_tr_b16 v[82:83], v18 offset:12288
    v_mfma_f32_16x16x32_bf16 a[40:43], v[100:103], v[40:43], a[40:43]
    ds_read_b64_tr_b16 v[84:85], v19 offset:8192
    ds_read_b64_tr_b16 v[86:87], v19 offset:12288
    v_mfma_f32_16x16x32_bf16 a[12:15], v[96:99], v[44:47], a[12:15]
    ds_read_b64_tr_b16 v[88:89], v20 offset:8192
    ds_read_b64_tr_b16 v[90:91], v20 offset:12288
    v_mfma_f32_16x16x32_bf16 a[44:47], v[100:103], v[44:47], a[44:47]
    ds_read_b64_tr_b16 v[92:93], v21 offset:8192
    ds_read_b64_tr_b16 v[94:95], v21 offset:12288
    v_mfma_f32_16x16x32_bf16 a[16:19], v[96:99], v[48:51], a[16:19]
    buffer_load_dwordx4 v[216:219], v12, s[8:11], s25 offen sc1
    buffer_load_dwordx4 v[220:223], v13, s[8:11], s25 offen sc1
    v_mfma_f32_16x16x32_bf16 a[48:51], v[100:103], v[48:51], a[48:51]
    s_add_u32 s25, s25, 1024
    v_mfma_f32_16x16x32_bf16 a[20:23], v[96:99], v[52:55], a[20:23]
    v_mfma_f32_16x16x32_bf16 a[52:55], v[100:103], v[52:55], a[52:55]
    v_mfma_f32_16x16x32_bf16 a[24:27], v[96:99], v[56:59], a[24:27]
    v_mfma_f32_16x16x32_bf16 a[56:59], v[100:103], v[56:59], a[56:59]
    v_mfma_f32_16x16x32_bf16 a[28:31], v[96:99], v[60:63], a[28:31]
    v_mfma_f32_16x16x32_bf16 a[60:63], v[100:103], v[60:63], a[60:63]
    s_waitcnt vmcnt(28) lgkmcnt(0)
    s_barrier
    v_mfma_f32_16x16x32_bf16 a[0:3], v[104:107], v[64:67], a[0:3]
    ds_read_b64_tr_b16 v[32:33], v14 offset:16384
    ds_read_b64_tr_b16 v[34:35], v14 offset:20480
    v_mfma_f32_16x16x32_bf16 a[32:35], v[108:111], v[64:67], a[32:35]
    ds_read_b64_tr_b16 v[36:37], v15 offset:16384
    ds_read_b64_tr_b16 v[38:39], v15 offset:20480
    v_mfma_f32_16x16x32_bf16 a[4:7], v[104:107], v[68:71], a[4:7]
    ds_read_b64_tr_b16 v[40:41], v16 offset:16384
    ds_read_b64_tr_b16 v[42:43], v16 offset:20480
    v_mfma_f32_16x16x32_bf16 a[36:39], v[108:111], v[68:71], a[36:39]
    ds_read_b64_tr_b16 v[44:45], v17 offset:16384
    ds_read_b64_tr_b16 v[46:47], v17 offset:20480
    v_mfma_f32_16x16x32_bf16 a[8:11], v[104:107], v[72:75], a[8:11]
    ds_read_b64_tr_b16 v[48:49], v18 offset:16384
    ds_read_b64_tr_b16 v[50:51], v18 offset:20480
    v_mfma_f32_16x16x32_bf16 a[40:43], v[108:111], v[72:75], a[40:43]
    ds_read_b64_tr_b16 v[52:53], v19 offset:16384
    ds_read_b64_tr_b16 v[54:55], v19 offset:20480
    v_mfma_f32_16x16x32_bf16 a[12:15], v[104:107], v[76:79], a[12:15]
    ds_read_b64_tr_b16 v[56:57], v20 offset:16384
    ds_read_b64_tr_b16 v[58:59], v20 offset:20480
    v_mfma_f32_16x16x32_bf16 a[44:47], v[108:111], v[76:79], a[44:47]
    ds_read_b64_tr_b16 v[60:61], v21 offset:16384
    ds_read_b64_tr_b16 v[62:63], v21 offset:20480
    v_mfma_f32_16x16x32_bf16 a[16:19], v[104:107], v[80:83], a[16:19]
    buffer_load_dwordx4 v[96:99], v12, s[8:11], s25 offen sc1
    buffer_load_dwordx4 v[100:103], v13, s[8:11], s25 offen sc1
    v_mfma_f32_16x16x32_bf16 a[48:51], v[108:111], v[80:83], a[48:51]
    s_add_u32 s25, s25, 1024
    s_add_u32 m0, s28, 0
    v_mfma_f32_16x16x32_bf16 a[20:23], v[104:107], v[84:87], a[20:23]
    s_nop 0
    buffer_load_dwordx4 v8, s[12:15], s26 offen offset:0 lds
    v_mfma_f32_16x16x32_bf16 a[52:55], v[108:111], v[84:87], a[52:55]
    buffer_load_dwordx4 v9, s[12:15], s26 offen offset:1024 lds
    buffer_load_dwordx4 v10, s[12:15], s26 offen offset:2048 lds
    v_mfma_f32_16x16x32_bf16 a[24:27], v[104:107], v[88:91], a[24:27]
    buffer_load_dwordx4 v11, s[12:15], s26 offen offset:3072 lds
    s_add_u32 s26, s26, 262144
    v_mfma_f32_16x16x32_bf16 a[56:59], v[108:111], v[88:91], a[56:59]
    v_mfma_f32_16x16x32_bf16 a[28:31], v[104:107], v[92:95], a[28:31]
    v_mfma_f32_16x16x32_bf16 a[60:63], v[108:111], v[92:95], a[60:63]
    s_waitcnt vmcnt(32) lgkmcnt(0)
    v_mfma_f32_16x16x32_bf16 a[0:3], v[112:115], v[32:35], a[0:3]
    ds_read_b64_tr_b16 v[64:65], v14 offset:24576
    ds_read_b64_tr_b16 v[66:67], v14 offset:28672
    v_mfma_f32_16x16x32_bf16 a[32:35], v[116:119], v[32:35], a[32:35]
    ds_read_b64_tr_b16 v[68:69], v15 offset:24576
    ds_read_b64_tr_b16 v[70:71], v15 offset:28672
    v_mfma_f32_16x16x32_bf16 a[4:7], v[112:115], v[36:39], a[4:7]
    ds_read_b64_tr_b16 v[72:73], v16 offset:24576
    ds_read_b64_tr_b16 v[74:75], v16 offset:28672
    v_mfma_f32_16x16x32_bf16 a[36:39], v[116:119], v[36:39], a[36:39]
    ds_read_b64_tr_b16 v[76:77], v17 offset:24576
    ds_read_b64_tr_b16 v[78:79], v17 offset:28672
    v_mfma_f32_16x16x32_bf16 a[8:11], v[112:115], v[40:43], a[8:11]
    ds_read_b64_tr_b16 v[80:81], v18 offset:24576
    ds_read_b64_tr_b16 v[82:83], v18 offset:28672
    v_mfma_f32_16x16x32_bf16 a[40:43], v[116:119], v[40:43], a[40:43]
    ds_read_b64_tr_b16 v[84:85], v19 offset:24576
    ds_read_b64_tr_b16 v[86:87], v19 offset:28672
    v_mfma_f32_16x16x32_bf16 a[12:15], v[112:115], v[44:47], a[12:15]
    ds_read_b64_tr_b16 v[88:89], v20 offset:24576
    ds_read_b64_tr_b16 v[90:91], v20 offset:28672
    v_mfma_f32_16x16x32_bf16 a[44:47], v[116:119], v[44:47], a[44:47]
    ds_read_b64_tr_b16 v[92:93], v21 offset:24576
    ds_read_b64_tr_b16 v[94:95], v21 offset:28672
    v_mfma_f32_16x16x32_bf16 a[16:19], v[112:115], v[48:51], a[16:19]
    buffer_load_dwordx4 v[104:107], v12, s[8:11], s25 offen sc1
    buffer_load_dwordx4 v[108:111], v13, s[8:11], s25 offen sc1
    v_mfma_f32_16x16x32_bf16 a[48:51], v[116:119], v[48:51], a[48:51]
    s_add_u32 s25, s25, 1024
    v_mfma_f32_16x16x32_bf16 a[20:23], v[112:115], v[52:55], a[20:23]
    v_mfma_f32_16x16x32_bf16 a[52:55], v[116:119], v[52:55], a[52:55]
    v_mfma_f32_16x16x32_bf16 a[24:27], v[112:115], v[56:59], a[24:27]
    v_mfma_f32_16x16x32_bf16 a[56:59], v[116:119], v[56:59], a[56:59]
    v_mfma_f32_16x16x32_bf16 a[28:31], v[112:115], v[60:63], a[28:31]
    v_mfma_f32_16x16x32_bf16 a[60:63], v[116:119], v[60:63], a[60:63]
    s_waitcnt vmcnt(32) lgkmcnt(0)
    s_barrier
    v_mfma_f32_16x16x32_bf16 a[0:3], v[120:123], v[64:67], a[0:3]
    ds_read_b64_tr_b16 v[32:33], v14 offset:32768
    ds_read_b64_tr_b16 v[34:35], v14 offset:36864
    v_mfma_f32_16x16x32_bf16 a[32:35], v[124:127], v[64:67], a[32:35]
    ds_read_b64_tr_b16 v[36:37], v15 offset:32768
    ds_read_b64_tr_b16 v[38:39], v15 offset:36864
    v_mfma_f32_16x16x32_bf16 a[4:7], v[120:123], v[68:71], a[4:7]
    ds_read_b64_tr_b16 v[40:41], v16 offset:32768
    ds_read_b64_tr_b16 v[42:43], v16 offset:36864
    v_mfma_f32_16x16x32_bf16 a[36:39], v[124:127], v[68:71], a[36:39]
    ds_read_b64_tr_b16 v[44:45], v17 offset:32768
    ds_read_b64_tr_b16 v[46:47], v17 offset:36864
    v_mfma_f32_16x16x32_bf16 a[8:11], v[120:123], v[72:75], a[8:11]
    ds_read_b64_tr_b16 v[48:49], v18 offset:32768
    ds_read_b64_tr_b16 v[50:51], v18 offset:36864
    v_mfma_f32_16x16x32_bf16 a[40:43], v[124:127], v[72:75], a[40:43]
    ds_read_b64_tr_b16 v[52:53], v19 offset:32768
    ds_read_b64_tr_b16 v[54:55], v19 offset:36864
    v_mfma_f32_16x16x32_bf16 a[12:15], v[120:123], v[76:79], a[12:15]
    ds_read_b64_tr_b16 v[56:57], v20 offset:32768
    ds_read_b64_tr_b16 v[58:59], v20 offset:36864
    v_mfma_f32_16x16x32_bf16 a[44:47], v[124:127], v[76:79], a[44:47]
    ds_read_b64_tr_b16 v[60:61], v21 offset:32768
    ds_read_b64_tr_b16 v[62:63], v21 offset:36864
    v_mfma_f32_16x16x32_bf16 a[16:19], v[120:123], v[80:83], a[16:19]
    buffer_load_dwordx4 v[112:115], v12, s[8:11], s25 offen sc1
    buffer_load_dwordx4 v[116:119], v13, s[8:11], s25 offen sc1
    v_mfma_f32_16x16x32_bf16 a[48:51], v[124:127], v[80:83], a[48:51]
    s_add_u32 s25, s25, 1024
    s_add_u32 m0, s28, 16384
    v_mfma_f32_16x16x32_bf16 a[20:23], v[120:123], v[84:87], a[20:23]
    s_nop 0
    buffer_load_dwordx4 v8, s[12:15], s26 offen offset:0 lds
    v_mfma_f32_16x16x32_bf16 a[52:55], v[124:127], v[84:87], a[52:55]
    buffer_load_dwordx4 v9, s[12:15], s26 offen offset:1024 lds
    buffer_load_dwordx4 v10, s[12:15], s26 offen offset:2048 lds
    v_mfma_f32_16x16x32_bf16 a[24:27], v[120:123], v[88:91], a[24:27]
    buffer_load_dwordx4 v11, s[12:15], s26 offen offset:3072 lds
    s_add_u32 s26, s26, 262144
    v_mfma_f32_16x16x32_bf16 a[56:59], v[124:127], v[88:91], a[56:59]
    v_mfma_f32_16x16x32_bf16 a[28:31], v[120:123], v[92:95], a[28:31]
    v_mfma_f32_16x16x32_bf16 a[60:63], v[124:127], v[92:95], a[60:63]
    s_waitcnt vmcnt(36) lgkmcnt(0)
    v_mfma_f32_16x16x32_bf16 a[0:3], v[128:131], v[32:35], a[0:3]
    ds_read_b64_tr_b16 v[64:65], v14 offset:40960
    ds_read_b64_tr_b16 v[66:67], v14 offset:45056
    v_mfma_f32_16x16x32_bf16 a[32:35], v[132:135], v[32:35], a[32:35]
    ds_read_b64_tr_b16 v[68:69], v15 offset:40960
    ds_read_b64_tr_b16 v[70:71], v15 offset:45056
    v_mfma_f32_16x16x32_bf16 a[4:7], v[128:131], v[36:39], a[4:7]
    ds_read_b64_tr_b16 v[72:73], v16 offset:40960
    ds_read_b64_tr_b16 v[74:75], v16 offset:45056
    v_mfma_f32_16x16x32_bf16 a[36:39], v[132:135], v[36:39], a[36:39]
    ds_read_b64_tr_b16 v[76:77], v17 offset:40960
    ds_read_b64_tr_b16 v[78:79], v17 offset:45056
    v_mfma_f32_16x16x32_bf16 a[8:11], v[128:131], v[40:43], a[8:11]
    ds_read_b64_tr_b16 v[80:81], v18 offset:40960
    ds_read_b64_tr_b16 v[82:83], v18 offset:45056
    v_mfma_f32_16x16x32_bf16 a[40:43], v[132:135], v[40:43], a[40:43]
    ds_read_b64_tr_b16 v[84:85], v19 offset:40960
    ds_read_b64_tr_b16 v[86:87], v19 offset:45056
    v_mfma_f32_16x16x32_bf16 a[12:15], v[128:131], v[44:47], a[12:15]
    ds_read_b64_tr_b16 v[88:89], v20 offset:40960
    ds_read_b64_tr_b16 v[90:91], v20 offset:45056
    v_mfma_f32_16x16x32_bf16 a[44:47], v[132:135], v[44:47], a[44:47]
    ds_read_b64_tr_b16 v[92:93], v21 offset:40960
    ds_read_b64_tr_b16 v[94:95], v21 offset:45056
    v_mfma_f32_16x16x32_bf16 a[16:19], v[128:131], v[48:51], a[16:19]
    buffer_load_dwordx4 v[120:123], v12, s[8:11], s25 offen sc1
    buffer_load_dwordx4 v[124:127], v13, s[8:11], s25 offen sc1
    v_mfma_f32_16x16x32_bf16 a[48:51], v[132:135], v[48:51], a[48:51]
    s_add_u32 s25, s25, 1024
    v_mfma_f32_16x16x32_bf16 a[20:23], v[128:131], v[52:55], a[20:23]
    v_mfma_f32_16x16x32_bf16 a[52:55], v[132:135], v[52:55], a[52:55]
    v_mfma_f32_16x16x32_bf16 a[24:27], v[128:131], v[56:59], a[24:27]
    v_mfma_f32_16x16x32_bf16 a[56:59], v[132:135], v[56:59], a[56:59]
    v_mfma_f32_16x16x32_bf16 a[28:31], v[128:131], v[60:63], a[28:31]
    v_mfma_f32_16x16x32_bf16 a[60:63], v[132:135], v[60:63], a[60:63]
    s_waitcnt vmcnt(36) lgkmcnt(0)
    s_barrier
    v_mfma_f32_16x16x32_bf16 a[0:3], v[136:139], v[64:67], a[0:3]
    ds_read_b64_tr_b16 v[32:33], v14 offset:49152
    ds_read_b64_tr_b16 v[34:35], v14 offset:53248
    v_mfma_f32_16x16x32_bf16 a[32:35], v[140:143], v[64:67], a[32:35]
    ds_read_b64_tr_b16 v[36:37], v15 offset:49152
    ds_read_b64_tr_b16 v[38:39], v15 offset:53248
    v_mfma_f32_16x16x32_bf16 a[4:7], v[136:139], v[68:71], a[4:7]
    ds_read_b64_tr_b16 v[40:41], v16 offset:49152
    ds_read_b64_tr_b16 v[42:43], v16 offset:53248
    v_mfma_f32_16x16x32_bf16 a[36:39], v[140:143], v[68:71], a[36:39]
    ds_read_b64_tr_b16 v[44:45], v17 offset:49152
    ds_read_b64_tr_b16 v[46:47], v17 offset:53248
    v_mfma_f32_16x16x32_bf16 a[8:11], v[136:139], v[72:75], a[8:11]
    ds_read_b64_tr_b16 v[48:49], v18 offset:49152
    ds_read_b64_tr_b16 v[50:51], v18 offset:53248
    v_mfma_f32_16x16x32_bf16 a[40:43], v[140:143], v[72:75], a[40:43]
    ds_read_b64_tr_b16 v[52:53], v19 offset:49152
    ds_read_b64_tr_b16 v[54:55], v19 offset:53248
    v_mfma_f32_16x16x32_bf16 a[12:15], v[136:139], v[76:79], a[12:15]
    ds_read_b64_tr_b16 v[56:57], v20 offset:49152
    ds_read_b64_tr_b16 v[58:59], v20 offset:53248
    v_mfma_f32_16x16x32_bf16 a[44:47], v[140:143], v[76:79], a[44:47]
    ds_read_b64_tr_b16 v[60:61], v21 offset:49152
    ds_read_b64_tr_b16 v[62:63], v21 offset:53248
    v_mfma_f32_16x16x32_bf16 a[16:19], v[136:139], v[80:83], a[16:19]
    buffer_load_dwordx4 v[128:131], v12, s[8:11], s25 offen sc1
    buffer_load_dwordx4 v[132:135], v13, s[8:11], s25 offen sc1
    v_mfma_f32_16x16x32_bf16 a[48:51], v[140:143], v[80:83], a[48:51]
    s_add_u32 s25, s25, 1024
    s_add_u32 m0, s28, 32768
    v_mfma_f32_16x16x32_bf16 a[20:23], v[136:139], v[84:87], a[20:23]
    s_nop 0
    buffer_load_dwordx4 v8, s[12:15], s26 offen offset:0 lds
    v_mfma_f32_16x16x32_bf16 a[52:55], v[140:143], v[84:87], a[52:55]
    buffer_load_dwordx4 v9, s[12:15], s26 offen offset:1024 lds
    buffer_load_dwordx4 v10, s[12:15], s26 offen offset:2048 lds
    v_mfma_f32_16x16x32_bf16 a[24:27], v[136:139], v[88:91], a[24:27]
    buffer_load_dwordx4 v11, s[12:15], s26 offen offset:3072 lds
    s_add_u32 s26, s26, 262144
    v_mfma_f32_16x16x32_bf16 a[56:59], v[140:143], v[88:91], a[56:59]
    v_mfma_f32_16x16x32_bf16 a[28:31], v[136:139], v[92:95], a[28:31]
    v_mfma_f32_16x16x32_bf16 a[60:63], v[140:143], v[92:95], a[60:63]
    s_waitcnt vmcnt(40) lgkmcnt(0)
    v_mfma_f32_16x16x32_bf16 a[0:3], v[144:147], v[32:35], a[0:3]
    ds_read_b64_tr_b16 v[64:65], v14 offset:57344
    ds_read_b64_tr_b16 v[66:67], v14 offset:61440
    v_mfma_f32_16x16x32_bf16 a[32:35], v[148:151], v[32:35], a[32:35]
    ds_read_b64_tr_b16 v[68:69], v15 offset:57344
    ds_read_b64_tr_b16 v[70:71], v15 offset:61440
    v_mfma_f32_16x16x32_bf16 a[4:7], v[144:147], v[36:39], a[4:7]
    ds_read_b64_tr_b16 v[72:73], v16 offset:57344
    ds_read_b64_tr_b16 v[74:75], v16 offset:61440
    v_mfma_f32_16x16x32_bf16 a[36:39], v[148:151], v[36:39], a[36:39]
    ds_read_b64_tr_b16 v[76:77], v17 offset:57344
    ds_read_b64_tr_b16 v[78:79], v17 offset:61440
    v_mfma_f32_16x16x32_bf16 a[8:11], v[144:147], v[40:43], a[8:11]
    ds_read_b64_tr_b16 v[80:81], v18 offset:57344
    ds_read_b64_tr_b16 v[82:83], v18 offset:61440
    v_mfma_f32_16x16x32_bf16 a[40:43], v[148:151], v[40:43], a[40:43]
    ds_read_b64_tr_b16 v[84:85], v19 offset:57344
    ds_read_b64_tr_b16 v[86:87], v19 offset:61440
    v_mfma_f32_16x16x32_bf16 a[12:15], v[144:147], v[44:47], a[12:15]
    ds_read_b64_tr_b16 v[88:89], v20 offset:57344
    ds_read_b64_tr_b16 v[90:91], v20 offset:61440
    v_mfma_f32_16x16x32_bf16 a[44:47], v[148:151], v[44:47], a[44:47]
    ds_read_b64_tr_b16 v[92:93], v21 offset:57344
    ds_read_b64_tr_b16 v[94:95], v21 offset:61440
    v_mfma_f32_16x16x32_bf16 a[16:19], v[144:147], v[48:51], a[16:19]
    buffer_load_dwordx4 v[136:139], v12, s[8:11], s25 offen sc1
    buffer_load_dwordx4 v[140:143], v13, s[8:11], s25 offen sc1
    v_mfma_f32_16x16x32_bf16 a[48:51], v[148:151], v[48:51], a[48:51]
    s_add_u32 s25, s25, 1024
    v_mfma_f32_16x16x32_bf16 a[20:23], v[144:147], v[52:55], a[20:23]
    v_mfma_f32_16x16x32_bf16 a[52:55], v[148:151], v[52:55], a[52:55]
    v_mfma_f32_16x16x32_bf16 a[24:27], v[144:147], v[56:59], a[24:27]
    v_mfma_f32_16x16x32_bf16 a[56:59], v[148:151], v[56:59], a[56:59]
    v_mfma_f32_16x16x32_bf16 a[28:31], v[144:147], v[60:63], a[28:31]
    v_mfma_f32_16x16x32_bf16 a[60:63], v[148:151], v[60:63], a[60:63]
    s_waitcnt vmcnt(40) lgkmcnt(0)
    s_barrier
    v_mfma_f32_16x16x32_bf16 a[0:3], v[152:155], v[64:67], a[0:3]
    ds_read_b64_tr_b16 v[32:33], v22 offset:0
    ds_read_b64_tr_b16 v[34:35], v22 offset:4096
    v_mfma_f32_16x16x32_bf16 a[32:35], v[156:159], v[64:67], a[32:35]
    ds_read_b64_tr_b16 v[36:37], v23 offset:0
    ds_read_b64_tr_b16 v[38:39], v23 offset:4096
    v_mfma_f32_16x16x32_bf16 a[4:7], v[152:155], v[68:71], a[4:7]
    ds_read_b64_tr_b16 v[40:41], v24 offset:0
    ds_read_b64_tr_b16 v[42:43], v24 offset:4096
    v_mfma_f32_16x16x32_bf16 a[36:39], v[156:159], v[68:71], a[36:39]
    ds_read_b64_tr_b16 v[44:45], v25 offset:0
    ds_read_b64_tr_b16 v[46:47], v25 offset:4096
    v_mfma_f32_16x16x32_bf16 a[8:11], v[152:155], v[72:75], a[8:11]
    ds_read_b64_tr_b16 v[48:49], v26 offset:0
    ds_read_b64_tr_b16 v[50:51], v26 offset:4096
    v_mfma_f32_16x16x32_bf16 a[40:43], v[156:159], v[72:75], a[40:43]
    ds_read_b64_tr_b16 v[52:53], v27 offset:0
    ds_read_b64_tr_b16 v[54:55], v27 offset:4096
    v_mfma_f32_16x16x32_bf16 a[12:15], v[152:155], v[76:79], a[12:15]
    ds_read_b64_tr_b16 v[56:57], v28 offset:0
    ds_read_b64_tr_b16 v[58:59], v28 offset:4096
    v_mfma_f32_16x16x32_bf16 a[44:47], v[156:159], v[76:79], a[44:47]
    ds_read_b64_tr_b16 v[60:61], v29 offset:0
    ds_read_b64_tr_b16 v[62:63], v29 offset:4096
    v_mfma_f32_16x16x32_bf16 a[16:19], v[152:155], v[80:83], a[16:19]
    buffer_load_dwordx4 v[144:147], v12, s[8:11], s25 offen sc1
    buffer_load_dwordx4 v[148:151], v13, s[8:11], s25 offen sc1
    v_mfma_f32_16x16x32_bf16 a[48:51], v[156:159], v[80:83], a[48:51]
    s_add_u32 s25, s25, 1024
    s_add_u32 m0, s28, 49152
    v_mfma_f32_16x16x32_bf16 a[20:23], v[152:155], v[84:87], a[20:23]
    s_nop 0
    buffer_load_dwordx4 v8, s[12:15], s26 offen offset:0 lds
    v_mfma_f32_16x16x32_bf16 a[52:55], v[156:159], v[84:87], a[52:55]
    buffer_load_dwordx4 v9, s[12:15], s26 offen offset:1024 lds
    buffer_load_dwordx4 v10, s[12:15], s26 offen offset:2048 lds
    v_mfma_f32_16x16x32_bf16 a[24:27], v[152:155], v[88:91], a[24:27]
    buffer_load_dwordx4 v11, s[12:15], s26 offen offset:3072 lds
    s_add_u32 s26, s26, 262144
    v_mfma_f32_16x16x32_bf16 a[56:59], v[156:159], v[88:91], a[56:59]
    v_mfma_f32_16x16x32_bf16 a[28:31], v[152:155], v[92:95], a[28:31]
    v_mfma_f32_16x16x32_bf16 a[60:63], v[156:159], v[92:95], a[60:63]
    s_cmp_eq_u32 s27, 1
    s_cbranch_scc1 mega_kernel_w_t_6_done
    s_waitcnt vmcnt(44) lgkmcnt(0)
    v_mfma_f32_16x16x32_bf16 a[0:3], v[160:163], v[32:35], a[0:3]
    ds_read_b64_tr_b16 v[64:65], v22 offset:8192
    ds_read_b64_tr_b16 v[66:67], v22 offset:12288
    v_mfma_f32_16x16x32_bf16 a[32:35], v[164:167], v[32:35], a[32:35]
    ds_read_b64_tr_b16 v[68:69], v23 offset:8192
    ds_read_b64_tr_b16 v[70:71], v23 offset:12288
    v_mfma_f32_16x16x32_bf16 a[4:7], v[160:163], v[36:39], a[4:7]
    ds_read_b64_tr_b16 v[72:73], v24 offset:8192
    ds_read_b64_tr_b16 v[74:75], v24 offset:12288
    v_mfma_f32_16x16x32_bf16 a[36:39], v[164:167], v[36:39], a[36:39]
    ds_read_b64_tr_b16 v[76:77], v25 offset:8192
    ds_read_b64_tr_b16 v[78:79], v25 offset:12288
    v_mfma_f32_16x16x32_bf16 a[8:11], v[160:163], v[40:43], a[8:11]
    ds_read_b64_tr_b16 v[80:81], v26 offset:8192
    ds_read_b64_tr_b16 v[82:83], v26 offset:12288
    v_mfma_f32_16x16x32_bf16 a[40:43], v[164:167], v[40:43], a[40:43]
    ds_read_b64_tr_b16 v[84:85], v27 offset:8192
    ds_read_b64_tr_b16 v[86:87], v27 offset:12288
    v_mfma_f32_16x16x32_bf16 a[12:15], v[160:163], v[44:47], a[12:15]
    ds_read_b64_tr_b16 v[88:89], v28 offset:8192
    ds_read_b64_tr_b16 v[90:91], v28 offset:12288
    v_mfma_f32_16x16x32_bf16 a[44:47], v[164:167], v[44:47], a[44:47]
    ds_read_b64_tr_b16 v[92:93], v29 offset:8192
    ds_read_b64_tr_b16 v[94:95], v29 offset:12288
    v_mfma_f32_16x16x32_bf16 a[16:19], v[160:163], v[48:51], a[16:19]
    buffer_load_dwordx4 v[152:155], v12, s[8:11], s25 offen sc1
    buffer_load_dwordx4 v[156:159], v13, s[8:11], s25 offen sc1
    v_mfma_f32_16x16x32_bf16 a[48:51], v[164:167], v[48:51], a[48:51]
    s_add_u32 s25, s25, 1024
    v_mfma_f32_16x16x32_bf16 a[20:23], v[160:163], v[52:55], a[20:23]
    v_mfma_f32_16x16x32_bf16 a[52:55], v[164:167], v[52:55], a[52:55]
    v_mfma_f32_16x16x32_bf16 a[24:27], v[160:163], v[56:59], a[24:27]
    v_mfma_f32_16x16x32_bf16 a[56:59], v[164:167], v[56:59], a[56:59]
    v_mfma_f32_16x16x32_bf16 a[28:31], v[160:163], v[60:63], a[28:31]
    v_mfma_f32_16x16x32_bf16 a[60:63], v[164:167], v[60:63], a[60:63]
    s_waitcnt vmcnt(44) lgkmcnt(0)
    s_barrier
    v_mfma_f32_16x16x32_bf16 a[0:3], v[168:171], v[64:67], a[0:3]
    ds_read_b64_tr_b16 v[32:33], v22 offset:16384
    ds_read_b64_tr_b16 v[34:35], v22 offset:20480
    v_mfma_f32_16x16x32_bf16 a[32:35], v[172:175], v[64:67], a[32:35]
    ds_read_b64_tr_b16 v[36:37], v23 offset:16384
    ds_read_b64_tr_b16 v[38:39], v23 offset:20480
    v_mfma_f32_16x16x32_bf16 a[4:7], v[168:171], v[68:71], a[4:7]
    ds_read_b64_tr_b16 v[40:41], v24 offset:16384
    ds_read_b64_tr_b16 v[42:43], v24 offset:20480
    v_mfma_f32_16x16x32_bf16 a[36:39], v[172:175], v[68:71], a[36:39]
    ds_read_b64_tr_b16 v[44:45], v25 offset:16384
    ds_read_b64_tr_b16 v[46:47], v25 offset:20480
    v_mfma_f32_16x16x32_bf16 a[8:11], v[168:171], v[72:75], a[8:11]
    ds_read_b64_tr_b16 v[48:49], v26 offset:16384
    ds_read_b64_tr_b16 v[50:51], v26 offset:20480
    v_mfma_f32_16x16x32_bf16 a[40:43], v[172:175], v[72:75], a[40:43]
    ds_read_b64_tr_b16 v[52:53], v27 offset:16384
    ds_read_b64_tr_b16 v[54:55], v27 offset:20480
    v_mfma_f32_16x16x32_bf16 a[12:15], v[168:171], v[76:79], a[12:15]
    ds_read_b64_tr_b16 v[56:57], v28 offset:16384
    ds_read_b64_tr_b16 v[58:59], v28 offset:20480
    v_mfma_f32_16x16x32_bf16 a[44:47], v[172:175], v[76:79], a[44:47]
    ds_read_b64_tr_b16 v[60:61], v29 offset:16384
    ds_read_b64_tr_b16 v[62:63], v29 offset:20480
    v_mfma_f32_16x16x32_bf16 a[16:19], v[168:171], v[80:83], a[16:19]
    buffer_load_dwordx4 v[160:163], v12, s[8:11], s25 offen sc1
    buffer_load_dwordx4 v[164:167], v13, s[8:11], s25 offen sc1
    v_mfma_f32_16x16x32_bf16 a[48:51], v[172:175], v[80:83], a[48:51]
    s_add_u32 s25, s25, 1024
    s_add_u32 m0, s28, 65536
    v_mfma_f32_16x16x32_bf16 a[20:23], v[168:171], v[84:87], a[20:23]
    s_nop 0
    buffer_load_dwordx4 v8, s[12:15], s26 offen offset:0 lds
    v_mfma_f32_16x16x32_bf16 a[52:55], v[172:175], v[84:87], a[52:55]
    buffer_load_dwordx4 v9, s[12:15], s26 offen offset:1024 lds
    buffer_load_dwordx4 v10, s[12:15], s26 offen offset:2048 lds
    v_mfma_f32_16x16x32_bf16 a[24:27], v[168:171], v[88:91], a[24:27]
    buffer_load_dwordx4 v11, s[12:15], s26 offen offset:3072 lds
    s_add_u32 s26, s26, 262144
    v_mfma_f32_16x16x32_bf16 a[56:59], v[172:175], v[88:91], a[56:59]
    v_mfma_f32_16x16x32_bf16 a[28:31], v[168:171], v[92:95], a[28:31]
    v_mfma_f32_16x16x32_bf16 a[60:63], v[172:175], v[92:95], a[60:63]
    s_waitcnt vmcnt(48) lgkmcnt(0)
    v_mfma_f32_16x16x32_bf16 a[0:3], v[176:179], v[32:35], a[0:3]
    ds_read_b64_tr_b16 v[64:65], v22 offset:24576
    ds_read_b64_tr_b16 v[66:67], v22 offset:28672
    v_mfma_f32_16x16x32_bf16 a[32:35], v[180:183], v[32:35], a[32:35]
    ds_read_b64_tr_b16 v[68:69], v23 offset:24576
    ds_read_b64_tr_b16 v[70:71], v23 offset:28672
    v_mfma_f32_16x16x32_bf16 a[4:7], v[176:179], v[36:39], a[4:7]
    ds_read_b64_tr_b16 v[72:73], v24 offset:24576
    ds_read_b64_tr_b16 v[74:75], v24 offset:28672
    v_mfma_f32_16x16x32_bf16 a[36:39], v[180:183], v[36:39], a[36:39]
    ds_read_b64_tr_b16 v[76:77], v25 offset:24576
    ds_read_b64_tr_b16 v[78:79], v25 offset:28672
    v_mfma_f32_16x16x32_bf16 a[8:11], v[176:179], v[40:43], a[8:11]
    ds_read_b64_tr_b16 v[80:81], v26 offset:24576
    ds_read_b64_tr_b16 v[82:83], v26 offset:28672
    v_mfma_f32_16x16x32_bf16 a[40:43], v[180:183], v[40:43], a[40:43]
    ds_read_b64_tr_b16 v[84:85], v27 offset:24576
    ds_read_b64_tr_b16 v[86:87], v27 offset:28672
    v_mfma_f32_16x16x32_bf16 a[12:15], v[176:179], v[44:47], a[12:15]
    ds_read_b64_tr_b16 v[88:89], v28 offset:24576
    ds_read_b64_tr_b16 v[90:91], v28 offset:28672
    v_mfma_f32_16x16x32_bf16 a[44:47], v[180:183], v[44:47], a[44:47]
    ds_read_b64_tr_b16 v[92:93], v29 offset:24576
    ds_read_b64_tr_b16 v[94:95], v29 offset:28672
    v_mfma_f32_16x16x32_bf16 a[16:19], v[176:179], v[48:51], a[16:19]
    buffer_load_dwordx4 v[168:171], v12, s[8:11], s25 offen sc1
    buffer_load_dwordx4 v[172:175], v13, s[8:11], s25 offen sc1
    v_mfma_f32_16x16x32_bf16 a[48:51], v[180:183], v[48:51], a[48:51]
    s_add_u32 s25, s25, 1024
    v_mfma_f32_16x16x32_bf16 a[20:23], v[176:179], v[52:55], a[20:23]
    v_mfma_f32_16x16x32_bf16 a[52:55], v[180:183], v[52:55], a[52:55]
    v_mfma_f32_16x16x32_bf16 a[24:27], v[176:179], v[56:59], a[24:27]
    v_mfma_f32_16x16x32_bf16 a[56:59], v[180:183], v[56:59], a[56:59]
    v_mfma_f32_16x16x32_bf16 a[28:31], v[176:179], v[60:63], a[28:31]
    v_mfma_f32_16x16x32_bf16 a[60:63], v[180:183], v[60:63], a[60:63]
    s_waitcnt vmcnt(48) lgkmcnt(0)
    s_barrier
    v_mfma_f32_16x16x32_bf16 a[0:3], v[184:187], v[64:67], a[0:3]
    ds_read_b64_tr_b16 v[32:33], v22 offset:32768
    ds_read_b64_tr_b16 v[34:35], v22 offset:36864
    v_mfma_f32_16x16x32_bf16 a[32:35], v[188:191], v[64:67], a[32:35]
    ds_read_b64_tr_b16 v[36:37], v23 offset:32768
    ds_read_b64_tr_b16 v[38:39], v23 offset:36864
    v_mfma_f32_16x16x32_bf16 a[4:7], v[184:187], v[68:71], a[4:7]
    ds_read_b64_tr_b16 v[40:41], v24 offset:32768
    ds_read_b64_tr_b16 v[42:43], v24 offset:36864
    v_mfma_f32_16x16x32_bf16 a[36:39], v[188:191], v[68:71], a[36:39]
    ds_read_b64_tr_b16 v[44:45], v25 offset:32768
    ds_read_b64_tr_b16 v[46:47], v25 offset:36864
    v_mfma_f32_16x16x32_bf16 a[8:11], v[184:187], v[72:75], a[8:11]
    ds_read_b64_tr_b16 v[48:49], v26 offset:32768
    ds_read_b64_tr_b16 v[50:51], v26 offset:36864
    v_mfma_f32_16x16x32_bf16 a[40:43], v[188:191], v[72:75], a[40:43]
    ds_read_b64_tr_b16 v[52:53], v27 offset:32768
    ds_read_b64_tr_b16 v[54:55], v27 offset:36864
    v_mfma_f32_16x16x32_bf16 a[12:15], v[184:187], v[76:79], a[12:15]
    ds_read_b64_tr_b16 v[56:57], v28 offset:32768
    ds_read_b64_tr_b16 v[58:59], v28 offset:36864
    v_mfma_f32_16x16x32_bf16 a[44:47], v[188:191], v[76:79], a[44:47]
    ds_read_b64_tr_b16 v[60:61], v29 offset:32768
    ds_read_b64_tr_b16 v[62:63], v29 offset:36864
    v_mfma_f32_16x16x32_bf16 a[16:19], v[184:187], v[80:83], a[16:19]
    buffer_load_dwordx4 v[176:179], v12, s[8:11], s25 offen sc1
    buffer_load_dwordx4 v[180:183], v13, s[8:11], s25 offen sc1
    v_mfma_f32_16x16x32_bf16 a[48:51], v[188:191], v[80:83], a[48:51]
    s_add_u32 s25, s25, 1024
    s_add_u32 m0, s28, 81920
    v_mfma_f32_16x16x32_bf16 a[20:23], v[184:187], v[84:87], a[20:23]
    s_nop 0
    buffer_load_dwordx4 v8, s[12:15], s26 offen offset:0 lds
    v_mfma_f32_16x16x32_bf16 a[52:55], v[188:191], v[84:87], a[52:55]
    buffer_load_dwordx4 v9, s[12:15], s26 offen offset:1024 lds
    buffer_load_dwordx4 v10, s[12:15], s26 offen offset:2048 lds
    v_mfma_f32_16x16x32_bf16 a[24:27], v[184:187], v[88:91], a[24:27]
    buffer_load_dwordx4 v11, s[12:15], s26 offen offset:3072 lds
    s_add_u32 s26, s26, 262144
    v_mfma_f32_16x16x32_bf16 a[56:59], v[188:191], v[88:91], a[56:59]
    v_mfma_f32_16x16x32_bf16 a[28:31], v[184:187], v[92:95], a[28:31]
    v_mfma_f32_16x16x32_bf16 a[60:63], v[188:191], v[92:95], a[60:63]
    s_waitcnt vmcnt(52) lgkmcnt(0)
    v_mfma_f32_16x16x32_bf16 a[0:3], v[192:195], v[32:35], a[0:3]
    ds_read_b64_tr_b16 v[64:65], v22 offset:40960
    ds_read_b64_tr_b16 v[66:67], v22 offset:45056
    v_mfma_f32_16x16x32_bf16 a[32:35], v[196:199], v[32:35], a[32:35]
    ds_read_b64_tr_b16 v[68:69], v23 offset:40960
    ds_read_b64_tr_b16 v[70:71], v23 offset:45056
    v_mfma_f32_16x16x32_bf16 a[4:7], v[192:195], v[36:39], a[4:7]
    ds_read_b64_tr_b16 v[72:73], v24 offset:40960
    ds_read_b64_tr_b16 v[74:75], v24 offset:45056
    v_mfma_f32_16x16x32_bf16 a[36:39], v[196:199], v[36:39], a[36:39]
    ds_read_b64_tr_b16 v[76:77], v25 offset:40960
    ds_read_b64_tr_b16 v[78:79], v25 offset:45056
    v_mfma_f32_16x16x32_bf16 a[8:11], v[192:195], v[40:43], a[8:11]
    ds_read_b64_tr_b16 v[80:81], v26 offset:40960
    ds_read_b64_tr_b16 v[82:83], v26 offset:45056
    v_mfma_f32_16x16x32_bf16 a[40:43], v[196:199], v[40:43], a[40:43]
    ds_read_b64_tr_b16 v[84:85], v27 offset:40960
    ds_read_b64_tr_b16 v[86:87], v27 offset:45056
    v_mfma_f32_16x16x32_bf16 a[12:15], v[192:195], v[44:47], a[12:15]
    ds_read_b64_tr_b16 v[88:89], v28 offset:40960
    ds_read_b64_tr_b16 v[90:91], v28 offset:45056
    v_mfma_f32_16x16x32_bf16 a[44:47], v[196:199], v[44:47], a[44:47]
    ds_read_b64_tr_b16 v[92:93], v29 offset:40960
    ds_read_b64_tr_b16 v[94:95], v29 offset:45056
    v_mfma_f32_16x16x32_bf16 a[16:19], v[192:195], v[48:51], a[16:19]
    buffer_load_dwordx4 v[184:187], v12, s[8:11], s25 offen sc1
    buffer_load_dwordx4 v[188:191], v13, s[8:11], s25 offen sc1
    v_mfma_f32_16x16x32_bf16 a[48:51], v[196:199], v[48:51], a[48:51]
    s_add_u32 s25, s25, 1024
    v_mfma_f32_16x16x32_bf16 a[20:23], v[192:195], v[52:55], a[20:23]
    v_mfma_f32_16x16x32_bf16 a[52:55], v[196:199], v[52:55], a[52:55]
    v_mfma_f32_16x16x32_bf16 a[24:27], v[192:195], v[56:59], a[24:27]
    v_mfma_f32_16x16x32_bf16 a[56:59], v[196:199], v[56:59], a[56:59]
    v_mfma_f32_16x16x32_bf16 a[28:31], v[192:195], v[60:63], a[28:31]
    v_mfma_f32_16x16x32_bf16 a[60:63], v[196:199], v[60:63], a[60:63]
    s_waitcnt vmcnt(50) lgkmcnt(0)
    s_barrier
    v_mfma_f32_16x16x32_bf16 a[0:3], v[200:203], v[64:67], a[0:3]
    ds_read_b64_tr_b16 v[32:33], v22 offset:49152
    ds_read_b64_tr_b16 v[34:35], v22 offset:53248
    v_mfma_f32_16x16x32_bf16 a[32:35], v[204:207], v[64:67], a[32:35]
    ds_read_b64_tr_b16 v[36:37], v23 offset:49152
    ds_read_b64_tr_b16 v[38:39], v23 offset:53248
    v_mfma_f32_16x16x32_bf16 a[4:7], v[200:203], v[68:71], a[4:7]
    ds_read_b64_tr_b16 v[40:41], v24 offset:49152
    ds_read_b64_tr_b16 v[42:43], v24 offset:53248
    v_mfma_f32_16x16x32_bf16 a[36:39], v[204:207], v[68:71], a[36:39]
    ds_read_b64_tr_b16 v[44:45], v25 offset:49152
    ds_read_b64_tr_b16 v[46:47], v25 offset:53248
    v_mfma_f32_16x16x32_bf16 a[8:11], v[200:203], v[72:75], a[8:11]
    ds_read_b64_tr_b16 v[48:49], v26 offset:49152
    ds_read_b64_tr_b16 v[50:51], v26 offset:53248
    v_mfma_f32_16x16x32_bf16 a[40:43], v[204:207], v[72:75], a[40:43]
    ds_read_b64_tr_b16 v[52:53], v27 offset:49152
    ds_read_b64_tr_b16 v[54:55], v27 offset:53248
    v_mfma_f32_16x16x32_bf16 a[12:15], v[200:203], v[76:79], a[12:15]
    ds_read_b64_tr_b16 v[56:57], v28 offset:49152
    ds_read_b64_tr_b16 v[58:59], v28 offset:53248
    v_mfma_f32_16x16x32_bf16 a[44:47], v[204:207], v[76:79], a[44:47]
    ds_read_b64_tr_b16 v[60:61], v29 offset:49152
    ds_read_b64_tr_b16 v[62:63], v29 offset:53248
    v_mfma_f32_16x16x32_bf16 a[16:19], v[200:203], v[80:83], a[16:19]
    buffer_load_dwordx4 v[192:195], v12, s[8:11], s25 offen sc1
    buffer_load_dwordx4 v[196:199], v13, s[8:11], s25 offen sc1
    v_mfma_f32_16x16x32_bf16 a[48:51], v[204:207], v[80:83], a[48:51]
    s_add_u32 s25, s25, 1024
    s_add_u32 m0, s28, 98304
    v_mfma_f32_16x16x32_bf16 a[20:23], v[200:203], v[84:87], a[20:23]
    s_nop 0
    buffer_load_dwordx4 v8, s[12:15], s26 offen offset:0 lds
    v_mfma_f32_16x16x32_bf16 a[52:55], v[204:207], v[84:87], a[52:55]
    buffer_load_dwordx4 v9, s[12:15], s26 offen offset:1024 lds
    buffer_load_dwordx4 v10, s[12:15], s26 offen offset:2048 lds
    v_mfma_f32_16x16x32_bf16 a[24:27], v[200:203], v[88:91], a[24:27]
    buffer_load_dwordx4 v11, s[12:15], s26 offen offset:3072 lds
    s_add_u32 s26, s26, 262144
    v_mfma_f32_16x16x32_bf16 a[56:59], v[204:207], v[88:91], a[56:59]
    v_mfma_f32_16x16x32_bf16 a[28:31], v[200:203], v[92:95], a[28:31]
    v_mfma_f32_16x16x32_bf16 a[60:63], v[204:207], v[92:95], a[60:63]
    s_waitcnt vmcnt(56) lgkmcnt(0)
    v_mfma_f32_16x16x32_bf16 a[0:3], v[208:211], v[32:35], a[0:3]
    ds_read_b64_tr_b16 v[64:65], v22 offset:57344
    ds_read_b64_tr_b16 v[66:67], v22 offset:61440
    v_mfma_f32_16x16x32_bf16 a[32:35], v[212:215], v[32:35], a[32:35]
    ds_read_b64_tr_b16 v[68:69], v23 offset:57344
    ds_read_b64_tr_b16 v[70:71], v23 offset:61440
    v_mfma_f32_16x16x32_bf16 a[4:7], v[208:211], v[36:39], a[4:7]
    ds_read_b64_tr_b16 v[72:73], v24 offset:57344
    ds_read_b64_tr_b16 v[74:75], v24 offset:61440
    v_mfma_f32_16x16x32_bf16 a[36:39], v[212:215], v[36:39], a[36:39]
    ds_read_b64_tr_b16 v[76:77], v25 offset:57344
    ds_read_b64_tr_b16 v[78:79], v25 offset:61440
    v_mfma_f32_16x16x32_bf16 a[8:11], v[208:211], v[40:43], a[8:11]
    ds_read_b64_tr_b16 v[80:81], v26 offset:57344
    ds_read_b64_tr_b16 v[82:83], v26 offset:61440
    v_mfma_f32_16x16x32_bf16 a[40:43], v[212:215], v[40:43], a[40:43]
    ds_read_b64_tr_b16 v[84:85], v27 offset:57344
    ds_read_b64_tr_b16 v[86:87], v27 offset:61440
    v_mfma_f32_16x16x32_bf16 a[12:15], v[208:211], v[44:47], a[12:15]
    ds_read_b64_tr_b16 v[88:89], v28 offset:57344
    ds_read_b64_tr_b16 v[90:91], v28 offset:61440
    v_mfma_f32_16x16x32_bf16 a[44:47], v[212:215], v[44:47], a[44:47]
    ds_read_b64_tr_b16 v[92:93], v29 offset:57344
    ds_read_b64_tr_b16 v[94:95], v29 offset:61440
    v_mfma_f32_16x16x32_bf16 a[16:19], v[208:211], v[48:51], a[16:19]
    buffer_load_dwordx4 v[200:203], v12, s[8:11], s25 offen sc1
    buffer_load_dwordx4 v[204:207], v13, s[8:11], s25 offen sc1
    v_mfma_f32_16x16x32_bf16 a[48:51], v[212:215], v[48:51], a[48:51]
    s_add_u32 s25, s25, 1024
    v_mfma_f32_16x16x32_bf16 a[20:23], v[208:211], v[52:55], a[20:23]
    v_mfma_f32_16x16x32_bf16 a[52:55], v[212:215], v[52:55], a[52:55]
    v_mfma_f32_16x16x32_bf16 a[24:27], v[208:211], v[56:59], a[24:27]
    v_mfma_f32_16x16x32_bf16 a[56:59], v[212:215], v[56:59], a[56:59]
    v_mfma_f32_16x16x32_bf16 a[28:31], v[208:211], v[60:63], a[28:31]
    v_mfma_f32_16x16x32_bf16 a[60:63], v[212:215], v[60:63], a[60:63]
    s_waitcnt vmcnt(50) lgkmcnt(0)
    s_barrier
    v_mfma_f32_16x16x32_bf16 a[0:3], v[216:219], v[64:67], a[0:3]
    ds_read_b64_tr_b16 v[32:33], v14 offset:0
    ds_read_b64_tr_b16 v[34:35], v14 offset:4096
    v_mfma_f32_16x16x32_bf16 a[32:35], v[220:223], v[64:67], a[32:35]
    ds_read_b64_tr_b16 v[36:37], v15 offset:0
    ds_read_b64_tr_b16 v[38:39], v15 offset:4096
    v_mfma_f32_16x16x32_bf16 a[4:7], v[216:219], v[68:71], a[4:7]
    ds_read_b64_tr_b16 v[40:41], v16 offset:0
    ds_read_b64_tr_b16 v[42:43], v16 offset:4096
    v_mfma_f32_16x16x32_bf16 a[36:39], v[220:223], v[68:71], a[36:39]
    ds_read_b64_tr_b16 v[44:45], v17 offset:0
    ds_read_b64_tr_b16 v[46:47], v17 offset:4096
    v_mfma_f32_16x16x32_bf16 a[8:11], v[216:219], v[72:75], a[8:11]
    ds_read_b64_tr_b16 v[48:49], v18 offset:0
    ds_read_b64_tr_b16 v[50:51], v18 offset:4096
    v_mfma_f32_16x16x32_bf16 a[40:43], v[220:223], v[72:75], a[40:43]
    ds_read_b64_tr_b16 v[52:53], v19 offset:0
    ds_read_b64_tr_b16 v[54:55], v19 offset:4096
    v_mfma_f32_16x16x32_bf16 a[12:15], v[216:219], v[76:79], a[12:15]
    ds_read_b64_tr_b16 v[56:57], v20 offset:0
    ds_read_b64_tr_b16 v[58:59], v20 offset:4096
    v_mfma_f32_16x16x32_bf16 a[44:47], v[220:223], v[76:79], a[44:47]
    ds_read_b64_tr_b16 v[60:61], v21 offset:0
    ds_read_b64_tr_b16 v[62:63], v21 offset:4096
    v_mfma_f32_16x16x32_bf16 a[16:19], v[216:219], v[80:83], a[16:19]
    buffer_load_dwordx4 v[208:211], v12, s[8:11], s25 offen sc1
    buffer_load_dwordx4 v[212:215], v13, s[8:11], s25 offen sc1
    v_mfma_f32_16x16x32_bf16 a[48:51], v[220:223], v[80:83], a[48:51]
    s_add_u32 s25, s25, 1024
    s_add_u32 m0, s28, 114688
    v_mfma_f32_16x16x32_bf16 a[20:23], v[216:219], v[84:87], a[20:23]
    s_nop 0
    buffer_load_dwordx4 v8, s[12:15], s26 offen offset:0 lds
    v_mfma_f32_16x16x32_bf16 a[52:55], v[220:223], v[84:87], a[52:55]
    buffer_load_dwordx4 v9, s[12:15], s26 offen offset:1024 lds
    buffer_load_dwordx4 v10, s[12:15], s26 offen offset:2048 lds
    v_mfma_f32_16x16x32_bf16 a[24:27], v[216:219], v[88:91], a[24:27]
    buffer_load_dwordx4 v11, s[12:15], s26 offen offset:3072 lds
    s_add_u32 s26, s26, 262144
    v_mfma_f32_16x16x32_bf16 a[56:59], v[220:223], v[88:91], a[56:59]
    v_mfma_f32_16x16x32_bf16 a[28:31], v[216:219], v[92:95], a[28:31]
    v_mfma_f32_16x16x32_bf16 a[60:63], v[220:223], v[92:95], a[60:63]
    s_sub_u32 s27, s27, 1
    s_cmp_lg_u32 s27, 0
    s_cbranch_scc1 mega_kernel_w_t_6_loop
mega_kernel_w_t_6_done:
    s_nop 7
    s_lshl_b32 s56, s34, 4
    s_add_u32 s56, s56, s24
    s_lshl_b32 s56, s56, 1
    s_add_u32 s57, s56, s32
    s_xor_b32 s58, s57, 1
    s_lshl_b32 s57, s57, 2
    s_add_u32 s57, s57, s20
    s_lshl_b32 s58, s58, 2
    s_add_u32 s58, s58, s20
    s_lshl_b32 s56, s57, 13
    s_add_u32 s56, s56, 98992128
    s_add_u32 s59, s56, 4096
    s_cmp_eq_u32 s32, 0
    s_cbranch_scc0 mega_kernel_w_t_k1s

    buffer_store_dwordx4 a[16:19], v4, s[8:11], s56 offen offset:0 sc1
    buffer_store_dwordx4 a[48:51], v4, s[8:11], s56 offen offset:1024 sc1
    buffer_store_dwordx4 a[20:23], v4, s[8:11], s56 offen offset:2048 sc1
    buffer_store_dwordx4 a[52:55], v4, s[8:11], s56 offen offset:3072 sc1
    buffer_store_dwordx4 a[24:27], v4, s[8:11], s59 offen offset:0 sc1
    buffer_store_dwordx4 a[56:59], v4, s[8:11], s59 offen offset:1024 sc1
    buffer_store_dwordx4 a[28:31], v4, s[8:11], s59 offen offset:2048 sc1
    buffer_store_dwordx4 a[60:63], v4, s[8:11], s59 offen offset:3072 sc1
    s_branch mega_kernel_w_t_sent
mega_kernel_w_t_k1s:
    buffer_store_dwordx4 a[0:3], v4, s[8:11], s56 offen offset:0 sc1
    buffer_store_dwordx4 a[32:35], v4, s[8:11], s56 offen offset:1024 sc1
    buffer_store_dwordx4 a[4:7], v4, s[8:11], s56 offen offset:2048 sc1
    buffer_store_dwordx4 a[36:39], v4, s[8:11], s56 offen offset:3072 sc1
    buffer_store_dwordx4 a[8:11], v4, s[8:11], s59 offen offset:0 sc1
    buffer_store_dwordx4 a[40:43], v4, s[8:11], s59 offen offset:1024 sc1
    buffer_store_dwordx4 a[12:15], v4, s[8:11], s59 offen offset:2048 sc1
    buffer_store_dwordx4 a[44:47], v4, s[8:11], s59 offen offset:3072 sc1
mega_kernel_w_t_sent:
    v_lshlrev_b32 v6, 4, v3
    s_lshl_b32 s30, s34, 2
    s_add_u32 s30, s30, s20
    s_lshl_b32 s36, s30, 7
    s_add_u32 s36, s36, 20480
    buffer_load_dwordx4 v[128:131], v6, s[8:11], s36 offen sc1
    buffer_load_dwordx4 v[132:135], v6, s[8:11], s36 offen offset:64 sc1
    s_lshl_b32 s31, s24, 3
    s_lshl_b32 s37, s32, 2
    s_add_u32 s31, s31, s37
    v_lshlrev_b32 v5, 1, v2
    s_lshl_b32 s36, s31, 5

    buffer_load_ushort v136, v5, s[16:19], s36 offen offset:0
    buffer_load_ushort v137, v5, s[16:19], s36 offen offset:32
    buffer_load_ushort v138, v5, s[16:19], s36 offen offset:64
    buffer_load_ushort v139, v5, s[16:19], s36 offen offset:96
    s_lshl_b32 s37, s31, 15
    s_lshl_b32 s36, s30, 10
    s_add_u32 s37, s37, s36
    s_add_u32 s37, s37, 82214912

    s_add_u32 s36, s37, 0
    buffer_load_dwordx4 v[96:99], v4, s[8:11], s36 offen sc1
    s_add_u32 s36, s37, 32768
    buffer_load_dwordx4 v[100:103], v4, s[8:11], s36 offen sc1
    s_add_u32 s36, s37, 65536
    buffer_load_dwordx4 v[104:107], v4, s[8:11], s36 offen sc1
    s_add_u32 s36, s37, 98304
    buffer_load_dwordx4 v[108:111], v4, s[8:11], s36 offen sc1
    v_lshlrev_b32 v5, 11, v2
    v_and_b32 v7, 1, v3
    v_lshl_add_u32 v5, v7, 5, v5
    v_lshrrev_b32 v7, 1, v3
    v_lshl_add_u32 v5, v7, 4, v5
    s_lshl_b32 s31, s31, 15
    s_lshl_b32 s36, s30, 6
    s_add_u32 s31, s31, s36
    s_waitcnt vmcnt(0)
    s_lshl_b32 s57, s57, 4
    s_add_u32 s57, s57, 106496
    v_mov_b32 v160, 1
    v_mov_b32 v161, 0
    s_mov_b64 s[42:43], exec
    s_mov_b64 exec, 1
    buffer_store_dword v160, v161, s[8:11], s57 offen sc1
    s_mov_b64 exec, s[42:43]
    s_lshl_b32 s56, s58, 13
    s_add_u32 s56, s56, 98992128
    s_add_u32 s59, s56, 4096
    s_lshl_b32 s58, s58, 4
    s_add_u32 s58, s58, 106496
mega_kernel_w_t_wp:
    buffer_load_dword v160, v161, s[8:11], s58 offen sc1
    s_waitcnt vmcnt(0)
    v_readfirstlane_b32 s57, v160
    s_cmp_eq_u32 s57, 1
    s_cbranch_scc1 mega_kernel_w_t_wpok
    s_sub_u32 s40, s40, 1
    s_cbranch_scc1 mega_kernel_w_exit
    s_sleep 1
    s_branch mega_kernel_w_t_wp
mega_kernel_w_t_wpok:

    buffer_load_dwordx4 v[160:163], v4, s[8:11], s56 offen offset:0 sc1
    buffer_load_dwordx4 v[164:167], v4, s[8:11], s56 offen offset:1024 sc1
    buffer_load_dwordx4 v[168:171], v4, s[8:11], s56 offen offset:2048 sc1
    buffer_load_dwordx4 v[172:175], v4, s[8:11], s56 offen offset:3072 sc1
    buffer_load_dwordx4 v[176:179], v4, s[8:11], s59 offen offset:0 sc1
    buffer_load_dwordx4 v[180:183], v4, s[8:11], s59 offen offset:1024 sc1
    buffer_load_dwordx4 v[184:187], v4, s[8:11], s59 offen offset:2048 sc1
    buffer_load_dwordx4 v[188:191], v4, s[8:11], s59 offen offset:3072 sc1
    v_lshlrev_b32 v136, 16, v136
    v_lshlrev_b32 v137, 16, v137
    v_lshlrev_b32 v138, 16, v138
    v_lshlrev_b32 v139, 16, v139
    s_waitcnt vmcnt(0)
    s_cmp_eq_u32 s32, 0
    s_cbranch_scc0 mega_kernel_w_t_k1f
    s_add_u32 s36, s31, 0
    v_accvgpr_read_b32 v32, a0
    v_accvgpr_read_b32 v33, a1
    v_accvgpr_read_b32 v34, a2
    v_accvgpr_read_b32 v35, a3
    v_accvgpr_read_b32 v36, a32
    v_accvgpr_read_b32 v37, a33
    v_accvgpr_read_b32 v38, a34
    v_accvgpr_read_b32 v39, a35
    v_add_f32 v32, v32, v160
    v_add_f32 v33, v33, v161
    v_add_f32 v34, v34, v162
    v_add_f32 v35, v35, v163
    v_add_f32 v36, v36, v164
    v_add_f32 v37, v37, v165
    v_add_f32 v38, v38, v166
    v_add_f32 v39, v39, v167
    v_add_f32 v32, v32, v136
    v_add_f32 v33, v33, v136
    v_add_f32 v34, v34, v136
    v_add_f32 v35, v35, v136
    v_add_f32 v36, v36, v136
    v_add_f32 v37, v37, v136
    v_add_f32 v38, v38, v136
    v_add_f32 v39, v39, v136
    v_lshlrev_b32 v7, 16, v96
    v_fma_f32 v32, v32, v128, v7
    v_and_b32 v7, 0xffff0000, v96
    v_fma_f32 v33, v33, v129, v7
    v_lshlrev_b32 v7, 16, v97
    v_fma_f32 v34, v34, v130, v7
    v_and_b32 v7, 0xffff0000, v97
    v_fma_f32 v35, v35, v131, v7
    v_lshlrev_b32 v7, 16, v98
    v_fma_f32 v36, v36, v132, v7
    v_and_b32 v7, 0xffff0000, v98
    v_fma_f32 v37, v37, v133, v7
    v_lshlrev_b32 v7, 16, v99
    v_fma_f32 v38, v38, v134, v7
    v_and_b32 v7, 0xffff0000, v99
    v_fma_f32 v39, v39, v135, v7
    v_cvt_pk_bf16_f32 v32, v32, v33
    v_cvt_pk_bf16_f32 v33, v34, v35
    v_cvt_pk_bf16_f32 v34, v36, v37
    v_cvt_pk_bf16_f32 v35, v38, v39
    s_nop 1
    v_permlane16_swap_b32 v32, v34
    v_permlane16_swap_b32 v33, v35
    s_nop 1
    buffer_store_dwordx4 v[32:35], v5, s[48:51], s36 offen

    s_add_u32 s36, s31, 32768
    v_accvgpr_read_b32 v40, a4
    v_accvgpr_read_b32 v41, a5
    v_accvgpr_read_b32 v42, a6
    v_accvgpr_read_b32 v43, a7
    v_accvgpr_read_b32 v44, a36
    v_accvgpr_read_b32 v45, a37
    v_accvgpr_read_b32 v46, a38
    v_accvgpr_read_b32 v47, a39
    v_add_f32 v40, v40, v168
    v_add_f32 v41, v41, v169
    v_add_f32 v42, v42, v170
    v_add_f32 v43, v43, v171
    v_add_f32 v44, v44, v172
    v_add_f32 v45, v45, v173
    v_add_f32 v46, v46, v174
    v_add_f32 v47, v47, v175
    v_add_f32 v40, v40, v137
    v_add_f32 v41, v41, v137
    v_add_f32 v42, v42, v137
    v_add_f32 v43, v43, v137
    v_add_f32 v44, v44, v137
    v_add_f32 v45, v45, v137
    v_add_f32 v46, v46, v137
    v_add_f32 v47, v47, v137
    v_lshlrev_b32 v7, 16, v100
    v_fma_f32 v40, v40, v128, v7
    v_and_b32 v7, 0xffff0000, v100
    v_fma_f32 v41, v41, v129, v7
    v_lshlrev_b32 v7, 16, v101
    v_fma_f32 v42, v42, v130, v7
    v_and_b32 v7, 0xffff0000, v101
    v_fma_f32 v43, v43, v131, v7
    v_lshlrev_b32 v7, 16, v102
    v_fma_f32 v44, v44, v132, v7
    v_and_b32 v7, 0xffff0000, v102
    v_fma_f32 v45, v45, v133, v7
    v_lshlrev_b32 v7, 16, v103
    v_fma_f32 v46, v46, v134, v7
    v_and_b32 v7, 0xffff0000, v103
    v_fma_f32 v47, v47, v135, v7
    v_cvt_pk_bf16_f32 v40, v40, v41
    v_cvt_pk_bf16_f32 v41, v42, v43
    v_cvt_pk_bf16_f32 v42, v44, v45
    v_cvt_pk_bf16_f32 v43, v46, v47
    s_nop 1
    v_permlane16_swap_b32 v40, v42
    v_permlane16_swap_b32 v41, v43
    s_nop 1
    buffer_store_dwordx4 v[40:43], v5, s[48:51], s36 offen

    s_add_u32 s36, s31, 65536
    v_accvgpr_read_b32 v48, a8
    v_accvgpr_read_b32 v49, a9
    v_accvgpr_read_b32 v50, a10
    v_accvgpr_read_b32 v51, a11
    v_accvgpr_read_b32 v52, a40
    v_accvgpr_read_b32 v53, a41
    v_accvgpr_read_b32 v54, a42
    v_accvgpr_read_b32 v55, a43
    v_add_f32 v48, v48, v176
    v_add_f32 v49, v49, v177
    v_add_f32 v50, v50, v178
    v_add_f32 v51, v51, v179
    v_add_f32 v52, v52, v180
    v_add_f32 v53, v53, v181
    v_add_f32 v54, v54, v182
    v_add_f32 v55, v55, v183
    v_add_f32 v48, v48, v138
    v_add_f32 v49, v49, v138
    v_add_f32 v50, v50, v138
    v_add_f32 v51, v51, v138
    v_add_f32 v52, v52, v138
    v_add_f32 v53, v53, v138
    v_add_f32 v54, v54, v138
    v_add_f32 v55, v55, v138
    v_lshlrev_b32 v7, 16, v104
    v_fma_f32 v48, v48, v128, v7
    v_and_b32 v7, 0xffff0000, v104
    v_fma_f32 v49, v49, v129, v7
    v_lshlrev_b32 v7, 16, v105
    v_fma_f32 v50, v50, v130, v7
    v_and_b32 v7, 0xffff0000, v105
    v_fma_f32 v51, v51, v131, v7
    v_lshlrev_b32 v7, 16, v106
    v_fma_f32 v52, v52, v132, v7
    v_and_b32 v7, 0xffff0000, v106
    v_fma_f32 v53, v53, v133, v7
    v_lshlrev_b32 v7, 16, v107
    v_fma_f32 v54, v54, v134, v7
    v_and_b32 v7, 0xffff0000, v107
    v_fma_f32 v55, v55, v135, v7
    v_cvt_pk_bf16_f32 v48, v48, v49
    v_cvt_pk_bf16_f32 v49, v50, v51
    v_cvt_pk_bf16_f32 v50, v52, v53
    v_cvt_pk_bf16_f32 v51, v54, v55
    s_nop 1
    v_permlane16_swap_b32 v48, v50
    v_permlane16_swap_b32 v49, v51
    s_nop 1
    buffer_store_dwordx4 v[48:51], v5, s[48:51], s36 offen

    s_add_u32 s36, s31, 98304
    v_accvgpr_read_b32 v56, a12
    v_accvgpr_read_b32 v57, a13
    v_accvgpr_read_b32 v58, a14
    v_accvgpr_read_b32 v59, a15
    v_accvgpr_read_b32 v60, a44
    v_accvgpr_read_b32 v61, a45
    v_accvgpr_read_b32 v62, a46
    v_accvgpr_read_b32 v63, a47
    v_add_f32 v56, v56, v184
    v_add_f32 v57, v57, v185
    v_add_f32 v58, v58, v186
    v_add_f32 v59, v59, v187
    v_add_f32 v60, v60, v188
    v_add_f32 v61, v61, v189
    v_add_f32 v62, v62, v190
    v_add_f32 v63, v63, v191
    v_add_f32 v56, v56, v139
    v_add_f32 v57, v57, v139
    v_add_f32 v58, v58, v139
    v_add_f32 v59, v59, v139
    v_add_f32 v60, v60, v139
    v_add_f32 v61, v61, v139
    v_add_f32 v62, v62, v139
    v_add_f32 v63, v63, v139
    v_lshlrev_b32 v7, 16, v108
    v_fma_f32 v56, v56, v128, v7
    v_and_b32 v7, 0xffff0000, v108
    v_fma_f32 v57, v57, v129, v7
    v_lshlrev_b32 v7, 16, v109
    v_fma_f32 v58, v58, v130, v7
    v_and_b32 v7, 0xffff0000, v109
    v_fma_f32 v59, v59, v131, v7
    v_lshlrev_b32 v7, 16, v110
    v_fma_f32 v60, v60, v132, v7
    v_and_b32 v7, 0xffff0000, v110
    v_fma_f32 v61, v61, v133, v7
    v_lshlrev_b32 v7, 16, v111
    v_fma_f32 v62, v62, v134, v7
    v_and_b32 v7, 0xffff0000, v111
    v_fma_f32 v63, v63, v135, v7
    v_cvt_pk_bf16_f32 v56, v56, v57
    v_cvt_pk_bf16_f32 v57, v58, v59
    v_cvt_pk_bf16_f32 v58, v60, v61
    v_cvt_pk_bf16_f32 v59, v62, v63
    s_nop 1
    v_permlane16_swap_b32 v56, v58
    v_permlane16_swap_b32 v57, v59
    s_nop 1
    buffer_store_dwordx4 v[56:59], v5, s[48:51], s36 offen

    s_branch mega_kernel_w_exit
mega_kernel_w_t_k1f:
    s_add_u32 s36, s31, 0
    v_accvgpr_read_b32 v32, a16
    v_accvgpr_read_b32 v33, a17
    v_accvgpr_read_b32 v34, a18
    v_accvgpr_read_b32 v35, a19
    v_accvgpr_read_b32 v36, a48
    v_accvgpr_read_b32 v37, a49
    v_accvgpr_read_b32 v38, a50
    v_accvgpr_read_b32 v39, a51
    v_add_f32 v32, v32, v160
    v_add_f32 v33, v33, v161
    v_add_f32 v34, v34, v162
    v_add_f32 v35, v35, v163
    v_add_f32 v36, v36, v164
    v_add_f32 v37, v37, v165
    v_add_f32 v38, v38, v166
    v_add_f32 v39, v39, v167
    v_add_f32 v32, v32, v136
    v_add_f32 v33, v33, v136
    v_add_f32 v34, v34, v136
    v_add_f32 v35, v35, v136
    v_add_f32 v36, v36, v136
    v_add_f32 v37, v37, v136
    v_add_f32 v38, v38, v136
    v_add_f32 v39, v39, v136
    v_lshlrev_b32 v7, 16, v96
    v_fma_f32 v32, v32, v128, v7
    v_and_b32 v7, 0xffff0000, v96
    v_fma_f32 v33, v33, v129, v7
    v_lshlrev_b32 v7, 16, v97
    v_fma_f32 v34, v34, v130, v7
    v_and_b32 v7, 0xffff0000, v97
    v_fma_f32 v35, v35, v131, v7
    v_lshlrev_b32 v7, 16, v98
    v_fma_f32 v36, v36, v132, v7
    v_and_b32 v7, 0xffff0000, v98
    v_fma_f32 v37, v37, v133, v7
    v_lshlrev_b32 v7, 16, v99
    v_fma_f32 v38, v38, v134, v7
    v_and_b32 v7, 0xffff0000, v99
    v_fma_f32 v39, v39, v135, v7
    v_cvt_pk_bf16_f32 v32, v32, v33
    v_cvt_pk_bf16_f32 v33, v34, v35
    v_cvt_pk_bf16_f32 v34, v36, v37
    v_cvt_pk_bf16_f32 v35, v38, v39
    s_nop 1
    v_permlane16_swap_b32 v32, v34
    v_permlane16_swap_b32 v33, v35
    s_nop 1
    buffer_store_dwordx4 v[32:35], v5, s[48:51], s36 offen

    s_add_u32 s36, s31, 32768
    v_accvgpr_read_b32 v40, a20
    v_accvgpr_read_b32 v41, a21
    v_accvgpr_read_b32 v42, a22
    v_accvgpr_read_b32 v43, a23
    v_accvgpr_read_b32 v44, a52
    v_accvgpr_read_b32 v45, a53
    v_accvgpr_read_b32 v46, a54
    v_accvgpr_read_b32 v47, a55
    v_add_f32 v40, v40, v168
    v_add_f32 v41, v41, v169
    v_add_f32 v42, v42, v170
    v_add_f32 v43, v43, v171
    v_add_f32 v44, v44, v172
    v_add_f32 v45, v45, v173
    v_add_f32 v46, v46, v174
    v_add_f32 v47, v47, v175
    v_add_f32 v40, v40, v137
    v_add_f32 v41, v41, v137
    v_add_f32 v42, v42, v137
    v_add_f32 v43, v43, v137
    v_add_f32 v44, v44, v137
    v_add_f32 v45, v45, v137
    v_add_f32 v46, v46, v137
    v_add_f32 v47, v47, v137
    v_lshlrev_b32 v7, 16, v100
    v_fma_f32 v40, v40, v128, v7
    v_and_b32 v7, 0xffff0000, v100
    v_fma_f32 v41, v41, v129, v7
    v_lshlrev_b32 v7, 16, v101
    v_fma_f32 v42, v42, v130, v7
    v_and_b32 v7, 0xffff0000, v101
    v_fma_f32 v43, v43, v131, v7
    v_lshlrev_b32 v7, 16, v102
    v_fma_f32 v44, v44, v132, v7
    v_and_b32 v7, 0xffff0000, v102
    v_fma_f32 v45, v45, v133, v7
    v_lshlrev_b32 v7, 16, v103
    v_fma_f32 v46, v46, v134, v7
    v_and_b32 v7, 0xffff0000, v103
    v_fma_f32 v47, v47, v135, v7
    v_cvt_pk_bf16_f32 v40, v40, v41
    v_cvt_pk_bf16_f32 v41, v42, v43
    v_cvt_pk_bf16_f32 v42, v44, v45
    v_cvt_pk_bf16_f32 v43, v46, v47
    s_nop 1
    v_permlane16_swap_b32 v40, v42
    v_permlane16_swap_b32 v41, v43
    s_nop 1
    buffer_store_dwordx4 v[40:43], v5, s[48:51], s36 offen

    s_add_u32 s36, s31, 65536
    v_accvgpr_read_b32 v48, a24
    v_accvgpr_read_b32 v49, a25
    v_accvgpr_read_b32 v50, a26
    v_accvgpr_read_b32 v51, a27
    v_accvgpr_read_b32 v52, a56
    v_accvgpr_read_b32 v53, a57
    v_accvgpr_read_b32 v54, a58
    v_accvgpr_read_b32 v55, a59
    v_add_f32 v48, v48, v176
    v_add_f32 v49, v49, v177
    v_add_f32 v50, v50, v178
    v_add_f32 v51, v51, v179
    v_add_f32 v52, v52, v180
    v_add_f32 v53, v53, v181
    v_add_f32 v54, v54, v182
    v_add_f32 v55, v55, v183
    v_add_f32 v48, v48, v138
    v_add_f32 v49, v49, v138
    v_add_f32 v50, v50, v138
    v_add_f32 v51, v51, v138
    v_add_f32 v52, v52, v138
    v_add_f32 v53, v53, v138
    v_add_f32 v54, v54, v138
    v_add_f32 v55, v55, v138
    v_lshlrev_b32 v7, 16, v104
    v_fma_f32 v48, v48, v128, v7
    v_and_b32 v7, 0xffff0000, v104
    v_fma_f32 v49, v49, v129, v7
    v_lshlrev_b32 v7, 16, v105
    v_fma_f32 v50, v50, v130, v7
    v_and_b32 v7, 0xffff0000, v105
    v_fma_f32 v51, v51, v131, v7
    v_lshlrev_b32 v7, 16, v106
    v_fma_f32 v52, v52, v132, v7
    v_and_b32 v7, 0xffff0000, v106
    v_fma_f32 v53, v53, v133, v7
    v_lshlrev_b32 v7, 16, v107
    v_fma_f32 v54, v54, v134, v7
    v_and_b32 v7, 0xffff0000, v107
    v_fma_f32 v55, v55, v135, v7
    v_cvt_pk_bf16_f32 v48, v48, v49
    v_cvt_pk_bf16_f32 v49, v50, v51
    v_cvt_pk_bf16_f32 v50, v52, v53
    v_cvt_pk_bf16_f32 v51, v54, v55
    s_nop 1
    v_permlane16_swap_b32 v48, v50
    v_permlane16_swap_b32 v49, v51
    s_nop 1
    buffer_store_dwordx4 v[48:51], v5, s[48:51], s36 offen

    s_add_u32 s36, s31, 98304
    v_accvgpr_read_b32 v56, a28
    v_accvgpr_read_b32 v57, a29
    v_accvgpr_read_b32 v58, a30
    v_accvgpr_read_b32 v59, a31
    v_accvgpr_read_b32 v60, a60
    v_accvgpr_read_b32 v61, a61
    v_accvgpr_read_b32 v62, a62
    v_accvgpr_read_b32 v63, a63
    v_add_f32 v56, v56, v184
    v_add_f32 v57, v57, v185
    v_add_f32 v58, v58, v186
    v_add_f32 v59, v59, v187
    v_add_f32 v60, v60, v188
    v_add_f32 v61, v61, v189
    v_add_f32 v62, v62, v190
    v_add_f32 v63, v63, v191
    v_add_f32 v56, v56, v139
    v_add_f32 v57, v57, v139
    v_add_f32 v58, v58, v139
    v_add_f32 v59, v59, v139
    v_add_f32 v60, v60, v139
    v_add_f32 v61, v61, v139
    v_add_f32 v62, v62, v139
    v_add_f32 v63, v63, v139
    v_lshlrev_b32 v7, 16, v108
    v_fma_f32 v56, v56, v128, v7
    v_and_b32 v7, 0xffff0000, v108
    v_fma_f32 v57, v57, v129, v7
    v_lshlrev_b32 v7, 16, v109
    v_fma_f32 v58, v58, v130, v7
    v_and_b32 v7, 0xffff0000, v109
    v_fma_f32 v59, v59, v131, v7
    v_lshlrev_b32 v7, 16, v110
    v_fma_f32 v60, v60, v132, v7
    v_and_b32 v7, 0xffff0000, v110
    v_fma_f32 v61, v61, v133, v7
    v_lshlrev_b32 v7, 16, v111
    v_fma_f32 v62, v62, v134, v7
    v_and_b32 v7, 0xffff0000, v111
    v_fma_f32 v63, v63, v135, v7
    v_cvt_pk_bf16_f32 v56, v56, v57
    v_cvt_pk_bf16_f32 v57, v58, v59
    v_cvt_pk_bf16_f32 v58, v60, v61
    v_cvt_pk_bf16_f32 v59, v62, v63
    s_nop 1
    v_permlane16_swap_b32 v56, v58
    v_permlane16_swap_b32 v57, v59
    s_nop 1
    buffer_store_dwordx4 v[56:59], v5, s[48:51], s36 offen

    s_branch mega_kernel_w_exit
mega_kernel_w_exit:
    s_endpgm
mega_kernel_chain:
    s_mov_b32 s21, s30
    s_mov_b32 s22, s20
    s_mov_b32 s20, s38

    s_load_dwordx2 s[48:49], s[0:1], 8
    s_load_dwordx2 s[40:41], s[0:1], 16
    s_load_dwordx2 s[42:43], s[0:1], 24
    s_load_dwordx2 s[44:45], s[0:1], 32
    s_load_dwordx2 s[46:47], s[0:1], 40
    v_and_b32 v1, 63, v0
    v_and_b32 v2, 15, v1
    v_lshrrev_b32 v3, 4, v1
    v_lshlrev_b32 v13, 4, v1
    s_lshr_b32 s52, s21, 2
    s_and_b32 s53, s21, 3
    s_waitcnt lgkmcnt(0)

    s_lshl_b32 s39, s20, 2
    s_add_u32 s39, s39, s52
    s_lshl_b32 s32, s39, 8
    s_lshl_b32 s33, s53, 6
    s_add_u32 s32, s32, s33
    s_lshl_b32 s33, s22, 21
    s_add_u32 s32, s32, s33
    v_lshrrev_b32 v4, 2, v1
    v_lshlrev_b32 v4, 13, v4
    v_and_b32 v5, 3, v1
    v_lshlrev_b32 v5, 4, v5
    v_add3_u32 v4, v4, v5, s32
    s_mov_b32 s14, 8388608
    s_mov_b32 s15, 0x20000
    v_lshrrev_b32 v5, 2, v2
    v_lshl_add_u32 v5, v3, 3, v5
    v_lshlrev_b32 v5, 6, v5
    v_and_b32 v6, 3, v2
    v_lshl_add_u32 v5, v6, 3, v5
    s_lshl_b32 s33, s22, 15
    v_add_u32 v5, s33, v5

    s_mov_b32 s12, s40
    s_mov_b32 s13, s41
    s_lshl_b32 s33, s22, 15
    s_add_u32 m0, s33, 0
    s_mov_b32 s32, 0
    buffer_load_dwordx4 v4, s[12:15], s32 offen lds

    s_lshl_b32 s33, s22, 15
    s_add_u32 m0, s33, 1024
    s_mov_b32 s32, 131072
    buffer_load_dwordx4 v4, s[12:15], s32 offen lds

    s_lshl_b32 s33, s22, 15
    s_add_u32 m0, s33, 2048
    s_mov_b32 s32, 262144
    buffer_load_dwordx4 v4, s[12:15], s32 offen lds

    s_lshl_b32 s33, s22, 15
    s_add_u32 m0, s33, 3072
    s_mov_b32 s32, 393216
    buffer_load_dwordx4 v4, s[12:15], s32 offen lds

    s_lshl_b32 s33, s22, 15
    s_add_u32 m0, s33, 4096
    s_mov_b32 s32, 524288
    buffer_load_dwordx4 v4, s[12:15], s32 offen lds

    s_lshl_b32 s33, s22, 15
    s_add_u32 m0, s33, 5120
    s_mov_b32 s32, 655360
    buffer_load_dwordx4 v4, s[12:15], s32 offen lds

    s_lshl_b32 s33, s22, 15
    s_add_u32 m0, s33, 6144
    s_mov_b32 s32, 786432
    buffer_load_dwordx4 v4, s[12:15], s32 offen lds

    s_lshl_b32 s33, s22, 15
    s_add_u32 m0, s33, 7168
    s_mov_b32 s32, 917504
    buffer_load_dwordx4 v4, s[12:15], s32 offen lds

    s_lshl_b32 s33, s22, 15
    s_add_u32 m0, s33, 8192
    s_mov_b32 s32, 1048576
    buffer_load_dwordx4 v4, s[12:15], s32 offen lds

    s_lshl_b32 s33, s22, 15
    s_add_u32 m0, s33, 9216
    s_mov_b32 s32, 1179648
    buffer_load_dwordx4 v4, s[12:15], s32 offen lds

    s_lshl_b32 s33, s22, 15
    s_add_u32 m0, s33, 10240
    s_mov_b32 s32, 1310720
    buffer_load_dwordx4 v4, s[12:15], s32 offen lds

    s_lshl_b32 s33, s22, 15
    s_add_u32 m0, s33, 11264
    s_mov_b32 s32, 1441792
    buffer_load_dwordx4 v4, s[12:15], s32 offen lds

    s_lshl_b32 s33, s22, 15
    s_add_u32 m0, s33, 12288
    s_mov_b32 s32, 1572864
    buffer_load_dwordx4 v4, s[12:15], s32 offen lds

    s_lshl_b32 s33, s22, 15
    s_add_u32 m0, s33, 13312
    s_mov_b32 s32, 1703936
    buffer_load_dwordx4 v4, s[12:15], s32 offen lds

    s_lshl_b32 s33, s22, 15
    s_add_u32 m0, s33, 14336
    s_mov_b32 s32, 1835008
    buffer_load_dwordx4 v4, s[12:15], s32 offen lds

    s_lshl_b32 s33, s22, 15
    s_add_u32 m0, s33, 15360
    s_mov_b32 s32, 1966080
    buffer_load_dwordx4 v4, s[12:15], s32 offen lds

    s_mov_b32 s12, s42
    s_mov_b32 s13, s43
    s_lshl_b32 s33, s22, 15
    s_add_u32 m0, s33, 16384
    s_mov_b32 s32, 0
    buffer_load_dwordx4 v4, s[12:15], s32 offen lds

    s_lshl_b32 s33, s22, 15
    s_add_u32 m0, s33, 17408
    s_mov_b32 s32, 131072
    buffer_load_dwordx4 v4, s[12:15], s32 offen lds

    s_lshl_b32 s33, s22, 15
    s_add_u32 m0, s33, 18432
    s_mov_b32 s32, 262144
    buffer_load_dwordx4 v4, s[12:15], s32 offen lds

    s_lshl_b32 s33, s22, 15
    s_add_u32 m0, s33, 19456
    s_mov_b32 s32, 393216
    buffer_load_dwordx4 v4, s[12:15], s32 offen lds

    s_lshl_b32 s33, s22, 15
    s_add_u32 m0, s33, 20480
    s_mov_b32 s32, 524288
    buffer_load_dwordx4 v4, s[12:15], s32 offen lds

    s_lshl_b32 s33, s22, 15
    s_add_u32 m0, s33, 21504
    s_mov_b32 s32, 655360
    buffer_load_dwordx4 v4, s[12:15], s32 offen lds

    s_lshl_b32 s33, s22, 15
    s_add_u32 m0, s33, 22528
    s_mov_b32 s32, 786432
    buffer_load_dwordx4 v4, s[12:15], s32 offen lds

    s_lshl_b32 s33, s22, 15
    s_add_u32 m0, s33, 23552
    s_mov_b32 s32, 917504
    buffer_load_dwordx4 v4, s[12:15], s32 offen lds

    s_lshl_b32 s33, s22, 15
    s_add_u32 m0, s33, 24576
    s_mov_b32 s32, 1048576
    buffer_load_dwordx4 v4, s[12:15], s32 offen lds

    s_lshl_b32 s33, s22, 15
    s_add_u32 m0, s33, 25600
    s_mov_b32 s32, 1179648
    buffer_load_dwordx4 v4, s[12:15], s32 offen lds

    s_lshl_b32 s33, s22, 15
    s_add_u32 m0, s33, 26624
    s_mov_b32 s32, 1310720
    buffer_load_dwordx4 v4, s[12:15], s32 offen lds

    s_lshl_b32 s33, s22, 15
    s_add_u32 m0, s33, 27648
    s_mov_b32 s32, 1441792
    buffer_load_dwordx4 v4, s[12:15], s32 offen lds

    s_lshl_b32 s33, s22, 15
    s_add_u32 m0, s33, 28672
    s_mov_b32 s32, 1572864
    buffer_load_dwordx4 v4, s[12:15], s32 offen lds

    s_lshl_b32 s33, s22, 15
    s_add_u32 m0, s33, 29696
    s_mov_b32 s32, 1703936
    buffer_load_dwordx4 v4, s[12:15], s32 offen lds

    s_lshl_b32 s33, s22, 15
    s_add_u32 m0, s33, 30720
    s_mov_b32 s32, 1835008
    buffer_load_dwordx4 v4, s[12:15], s32 offen lds

    s_lshl_b32 s33, s22, 15
    s_add_u32 m0, s33, 31744
    s_mov_b32 s32, 1966080
    buffer_load_dwordx4 v4, s[12:15], s32 offen lds

    s_waitcnt vmcnt(0)
    ds_read_b64_tr_b16 a[0:1], v5 offset:0
    ds_read_b64_tr_b16 a[2:3], v5 offset:256
    ds_read_b64_tr_b16 a[4:5], v5 offset:2048
    ds_read_b64_tr_b16 a[6:7], v5 offset:2304
    ds_read_b64_tr_b16 a[8:9], v5 offset:4096
    ds_read_b64_tr_b16 a[10:11], v5 offset:4352
    ds_read_b64_tr_b16 a[12:13], v5 offset:6144
    ds_read_b64_tr_b16 a[14:15], v5 offset:6400
    ds_read_b64_tr_b16 a[16:17], v5 offset:8192
    ds_read_b64_tr_b16 a[18:19], v5 offset:8448
    ds_read_b64_tr_b16 a[20:21], v5 offset:10240
    ds_read_b64_tr_b16 a[22:23], v5 offset:10496
    ds_read_b64_tr_b16 a[24:25], v5 offset:12288
    ds_read_b64_tr_b16 a[26:27], v5 offset:12544
    ds_read_b64_tr_b16 a[28:29], v5 offset:14336
    ds_read_b64_tr_b16 a[30:31], v5 offset:14592
    s_waitcnt lgkmcnt(0)
    ds_read_b64_tr_b16 a[32:33], v5 offset:32
    ds_read_b64_tr_b16 a[34:35], v5 offset:288
    ds_read_b64_tr_b16 a[36:37], v5 offset:2080
    ds_read_b64_tr_b16 a[38:39], v5 offset:2336
    ds_read_b64_tr_b16 a[40:41], v5 offset:4128
    ds_read_b64_tr_b16 a[42:43], v5 offset:4384
    ds_read_b64_tr_b16 a[44:45], v5 offset:6176
    ds_read_b64_tr_b16 a[46:47], v5 offset:6432
    ds_read_b64_tr_b16 a[48:49], v5 offset:8224
    ds_read_b64_tr_b16 a[50:51], v5 offset:8480
    ds_read_b64_tr_b16 a[52:53], v5 offset:10272
    ds_read_b64_tr_b16 a[54:55], v5 offset:10528
    ds_read_b64_tr_b16 a[56:57], v5 offset:12320
    ds_read_b64_tr_b16 a[58:59], v5 offset:12576
    ds_read_b64_tr_b16 a[60:61], v5 offset:14368
    ds_read_b64_tr_b16 a[62:63], v5 offset:14624
    s_waitcnt lgkmcnt(0)
    ds_read_b64_tr_b16 a[64:65], v5 offset:16384
    ds_read_b64_tr_b16 a[66:67], v5 offset:16640
    ds_read_b64_tr_b16 a[68:69], v5 offset:18432
    ds_read_b64_tr_b16 a[70:71], v5 offset:18688
    ds_read_b64_tr_b16 a[72:73], v5 offset:20480
    ds_read_b64_tr_b16 a[74:75], v5 offset:20736
    ds_read_b64_tr_b16 a[76:77], v5 offset:22528
    ds_read_b64_tr_b16 a[78:79], v5 offset:22784
    ds_read_b64_tr_b16 a[80:81], v5 offset:24576
    ds_read_b64_tr_b16 a[82:83], v5 offset:24832
    ds_read_b64_tr_b16 a[84:85], v5 offset:26624
    ds_read_b64_tr_b16 a[86:87], v5 offset:26880
    ds_read_b64_tr_b16 a[88:89], v5 offset:28672
    ds_read_b64_tr_b16 a[90:91], v5 offset:28928
    ds_read_b64_tr_b16 a[92:93], v5 offset:30720
    ds_read_b64_tr_b16 a[94:95], v5 offset:30976
    s_waitcnt lgkmcnt(0)
    ds_read_b64_tr_b16 a[96:97], v5 offset:16416
    ds_read_b64_tr_b16 a[98:99], v5 offset:16672
    ds_read_b64_tr_b16 a[100:101], v5 offset:18464
    ds_read_b64_tr_b16 a[102:103], v5 offset:18720
    ds_read_b64_tr_b16 a[104:105], v5 offset:20512
    ds_read_b64_tr_b16 a[106:107], v5 offset:20768
    ds_read_b64_tr_b16 a[108:109], v5 offset:22560
    ds_read_b64_tr_b16 a[110:111], v5 offset:22816
    ds_read_b64_tr_b16 a[112:113], v5 offset:24608
    ds_read_b64_tr_b16 a[114:115], v5 offset:24864
    ds_read_b64_tr_b16 a[116:117], v5 offset:26656
    ds_read_b64_tr_b16 a[118:119], v5 offset:26912
    ds_read_b64_tr_b16 a[120:121], v5 offset:28704
    ds_read_b64_tr_b16 a[122:123], v5 offset:28960
    ds_read_b64_tr_b16 a[124:125], v5 offset:30752
    ds_read_b64_tr_b16 a[126:127], v5 offset:31008
    s_waitcnt lgkmcnt(0)
    s_mov_b32 s12, s44
    s_mov_b32 s13, s45
    s_lshl_b32 s33, s22, 15
    s_add_u32 m0, s33, 0
    s_mov_b32 s32, 0
    buffer_load_dwordx4 v4, s[12:15], s32 offen lds

    s_lshl_b32 s33, s22, 15
    s_add_u32 m0, s33, 1024
    s_mov_b32 s32, 131072
    buffer_load_dwordx4 v4, s[12:15], s32 offen lds

    s_lshl_b32 s33, s22, 15
    s_add_u32 m0, s33, 2048
    s_mov_b32 s32, 262144
    buffer_load_dwordx4 v4, s[12:15], s32 offen lds

    s_lshl_b32 s33, s22, 15
    s_add_u32 m0, s33, 3072
    s_mov_b32 s32, 393216
    buffer_load_dwordx4 v4, s[12:15], s32 offen lds

    s_lshl_b32 s33, s22, 15
    s_add_u32 m0, s33, 4096
    s_mov_b32 s32, 524288
    buffer_load_dwordx4 v4, s[12:15], s32 offen lds

    s_lshl_b32 s33, s22, 15
    s_add_u32 m0, s33, 5120
    s_mov_b32 s32, 655360
    buffer_load_dwordx4 v4, s[12:15], s32 offen lds

    s_lshl_b32 s33, s22, 15
    s_add_u32 m0, s33, 6144
    s_mov_b32 s32, 786432
    buffer_load_dwordx4 v4, s[12:15], s32 offen lds

    s_lshl_b32 s33, s22, 15
    s_add_u32 m0, s33, 7168
    s_mov_b32 s32, 917504
    buffer_load_dwordx4 v4, s[12:15], s32 offen lds

    s_lshl_b32 s33, s22, 15
    s_add_u32 m0, s33, 8192
    s_mov_b32 s32, 1048576
    buffer_load_dwordx4 v4, s[12:15], s32 offen lds

    s_lshl_b32 s33, s22, 15
    s_add_u32 m0, s33, 9216
    s_mov_b32 s32, 1179648
    buffer_load_dwordx4 v4, s[12:15], s32 offen lds

    s_lshl_b32 s33, s22, 15
    s_add_u32 m0, s33, 10240
    s_mov_b32 s32, 1310720
    buffer_load_dwordx4 v4, s[12:15], s32 offen lds

    s_lshl_b32 s33, s22, 15
    s_add_u32 m0, s33, 11264
    s_mov_b32 s32, 1441792
    buffer_load_dwordx4 v4, s[12:15], s32 offen lds

    s_lshl_b32 s33, s22, 15
    s_add_u32 m0, s33, 12288
    s_mov_b32 s32, 1572864
    buffer_load_dwordx4 v4, s[12:15], s32 offen lds

    s_lshl_b32 s33, s22, 15
    s_add_u32 m0, s33, 13312
    s_mov_b32 s32, 1703936
    buffer_load_dwordx4 v4, s[12:15], s32 offen lds

    s_lshl_b32 s33, s22, 15
    s_add_u32 m0, s33, 14336
    s_mov_b32 s32, 1835008
    buffer_load_dwordx4 v4, s[12:15], s32 offen lds

    s_lshl_b32 s33, s22, 15
    s_add_u32 m0, s33, 15360
    s_mov_b32 s32, 1966080
    buffer_load_dwordx4 v4, s[12:15], s32 offen lds

    s_lshl_b32 s32, s20, 2
    s_add_u32 s32, s32, s22
    s_lshl_b32 s32, s32, 18
    s_lshl_b32 s33, s21, 7
    s_add_u32 s32, s32, s33
    v_lshrrev_b32 v6, 3, v1
    v_lshlrev_b32 v6, 11, v6
    v_and_b32 v7, 7, v1
    v_lshlrev_b32 v7, 4, v7
    v_add3_u32 v6, v6, v7, s32
    s_mov_b32 s12, s46
    s_mov_b32 s13, s47
    s_mov_b32 s14, 8388608

    s_lshl_b32 s33, s22, 15
    s_add_u32 m0, s33, 16384
    s_mov_b32 s32, 0
    buffer_load_dwordx4 v6, s[12:15], s32 offen lds

    s_lshl_b32 s33, s22, 15
    s_add_u32 m0, s33, 17408
    s_mov_b32 s32, 16384
    buffer_load_dwordx4 v6, s[12:15], s32 offen lds

    s_lshl_b32 s33, s22, 15
    s_add_u32 m0, s33, 18432
    s_mov_b32 s32, 32768
    buffer_load_dwordx4 v6, s[12:15], s32 offen lds

    s_lshl_b32 s33, s22, 15
    s_add_u32 m0, s33, 19456
    s_mov_b32 s32, 49152
    buffer_load_dwordx4 v6, s[12:15], s32 offen lds

    s_lshl_b32 s33, s22, 15
    s_add_u32 m0, s33, 20480
    s_mov_b32 s32, 65536
    buffer_load_dwordx4 v6, s[12:15], s32 offen lds

    s_lshl_b32 s33, s22, 15
    s_add_u32 m0, s33, 21504
    s_mov_b32 s32, 81920
    buffer_load_dwordx4 v6, s[12:15], s32 offen lds

    s_lshl_b32 s33, s22, 15
    s_add_u32 m0, s33, 22528
    s_mov_b32 s32, 98304
    buffer_load_dwordx4 v6, s[12:15], s32 offen lds

    s_lshl_b32 s33, s22, 15
    s_add_u32 m0, s33, 23552
    s_mov_b32 s32, 114688
    buffer_load_dwordx4 v6, s[12:15], s32 offen lds

    s_lshl_b32 s33, s22, 15
    s_add_u32 m0, s33, 24576
    s_mov_b32 s32, 131072
    buffer_load_dwordx4 v6, s[12:15], s32 offen lds

    s_lshl_b32 s33, s22, 15
    s_add_u32 m0, s33, 25600
    s_mov_b32 s32, 147456
    buffer_load_dwordx4 v6, s[12:15], s32 offen lds

    s_lshl_b32 s33, s22, 15
    s_add_u32 m0, s33, 26624
    s_mov_b32 s32, 163840
    buffer_load_dwordx4 v6, s[12:15], s32 offen lds

    s_lshl_b32 s33, s22, 15
    s_add_u32 m0, s33, 27648
    s_mov_b32 s32, 180224
    buffer_load_dwordx4 v6, s[12:15], s32 offen lds

    s_lshl_b32 s33, s22, 15
    s_add_u32 m0, s33, 28672
    s_mov_b32 s32, 196608
    buffer_load_dwordx4 v6, s[12:15], s32 offen lds

    s_lshl_b32 s33, s22, 15
    s_add_u32 m0, s33, 29696
    s_mov_b32 s32, 212992
    buffer_load_dwordx4 v6, s[12:15], s32 offen lds

    s_lshl_b32 s33, s22, 15
    s_add_u32 m0, s33, 30720
    s_mov_b32 s32, 229376
    buffer_load_dwordx4 v6, s[12:15], s32 offen lds

    s_lshl_b32 s33, s22, 15
    s_add_u32 m0, s33, 31744
    s_mov_b32 s32, 245760
    buffer_load_dwordx4 v6, s[12:15], s32 offen lds

    s_waitcnt vmcnt(0)
    ds_read_b64_tr_b16 a[128:129], v5 offset:0
    ds_read_b64_tr_b16 a[130:131], v5 offset:256
    ds_read_b64_tr_b16 a[132:133], v5 offset:2048
    ds_read_b64_tr_b16 a[134:135], v5 offset:2304
    ds_read_b64_tr_b16 a[136:137], v5 offset:4096
    ds_read_b64_tr_b16 a[138:139], v5 offset:4352
    ds_read_b64_tr_b16 a[140:141], v5 offset:6144
    ds_read_b64_tr_b16 a[142:143], v5 offset:6400
    ds_read_b64_tr_b16 a[144:145], v5 offset:8192
    ds_read_b64_tr_b16 a[146:147], v5 offset:8448
    ds_read_b64_tr_b16 a[148:149], v5 offset:10240
    ds_read_b64_tr_b16 a[150:151], v5 offset:10496
    ds_read_b64_tr_b16 a[152:153], v5 offset:12288
    ds_read_b64_tr_b16 a[154:155], v5 offset:12544
    ds_read_b64_tr_b16 a[156:157], v5 offset:14336
    ds_read_b64_tr_b16 a[158:159], v5 offset:14592
    s_waitcnt lgkmcnt(0)
    ds_read_b64_tr_b16 a[160:161], v5 offset:32
    ds_read_b64_tr_b16 a[162:163], v5 offset:288
    ds_read_b64_tr_b16 a[164:165], v5 offset:2080
    ds_read_b64_tr_b16 a[166:167], v5 offset:2336
    ds_read_b64_tr_b16 a[168:169], v5 offset:4128
    ds_read_b64_tr_b16 a[170:171], v5 offset:4384
    ds_read_b64_tr_b16 a[172:173], v5 offset:6176
    ds_read_b64_tr_b16 a[174:175], v5 offset:6432
    ds_read_b64_tr_b16 a[176:177], v5 offset:8224
    ds_read_b64_tr_b16 a[178:179], v5 offset:8480
    ds_read_b64_tr_b16 a[180:181], v5 offset:10272
    ds_read_b64_tr_b16 a[182:183], v5 offset:10528
    ds_read_b64_tr_b16 a[184:185], v5 offset:12320
    ds_read_b64_tr_b16 a[186:187], v5 offset:12576
    ds_read_b64_tr_b16 a[188:189], v5 offset:14368
    ds_read_b64_tr_b16 a[190:191], v5 offset:14624
    s_waitcnt lgkmcnt(0)
    v_lshrrev_b32 v5, 2, v2
    v_lshl_add_u32 v5, v3, 2, v5
    v_lshlrev_b32 v5, 7, v5
    v_and_b32 v6, 3, v2
    v_lshl_add_u32 v5, v6, 4, v5
    s_lshl_b32 s33, s22, 15
    v_add_u32 v5, s33, v5

    ds_read_b64_tr_b16 a[192:193], v5 offset:16384
    ds_read_b64_tr_b16 a[194:195], v5 offset:18432
    ds_read_b64_tr_b16 a[196:197], v5 offset:20480
    ds_read_b64_tr_b16 a[198:199], v5 offset:22528
    ds_read_b64_tr_b16 a[200:201], v5 offset:24576
    ds_read_b64_tr_b16 a[202:203], v5 offset:26624
    ds_read_b64_tr_b16 a[204:205], v5 offset:28672
    ds_read_b64_tr_b16 a[206:207], v5 offset:30720
    s_waitcnt lgkmcnt(0)
    ds_read_b64_tr_b16 a[208:209], v5 offset:16448
    ds_read_b64_tr_b16 a[210:211], v5 offset:18496
    ds_read_b64_tr_b16 a[212:213], v5 offset:20544
    ds_read_b64_tr_b16 a[214:215], v5 offset:22592
    ds_read_b64_tr_b16 a[216:217], v5 offset:24640
    ds_read_b64_tr_b16 a[218:219], v5 offset:26688
    ds_read_b64_tr_b16 a[220:221], v5 offset:28736
    ds_read_b64_tr_b16 a[222:223], v5 offset:30784
    s_waitcnt lgkmcnt(0)
    ds_read_b64_tr_b16 a[224:225], v5 offset:16392
    ds_read_b64_tr_b16 a[226:227], v5 offset:18440
    ds_read_b64_tr_b16 a[228:229], v5 offset:20488
    ds_read_b64_tr_b16 a[230:231], v5 offset:22536
    ds_read_b64_tr_b16 a[232:233], v5 offset:24584
    ds_read_b64_tr_b16 a[234:235], v5 offset:26632
    ds_read_b64_tr_b16 a[236:237], v5 offset:28680
    ds_read_b64_tr_b16 a[238:239], v5 offset:30728
    s_waitcnt lgkmcnt(0)
    ds_read_b64_tr_b16 a[240:241], v5 offset:16456
    ds_read_b64_tr_b16 a[242:243], v5 offset:18504
    ds_read_b64_tr_b16 a[244:245], v5 offset:20552
    ds_read_b64_tr_b16 a[246:247], v5 offset:22600
    ds_read_b64_tr_b16 a[248:249], v5 offset:24648
    ds_read_b64_tr_b16 a[250:251], v5 offset:26696
    ds_read_b64_tr_b16 a[252:253], v5 offset:28744
    ds_read_b64_tr_b16 a[254:255], v5 offset:30792
    s_waitcnt lgkmcnt(0)
    v_and_b32 v4, 7, v2
    v_lshrrev_b32 v5, 3, v2
    v_lshlrev_b32 v6, 11, v4
    v_lshl_add_u32 v6, v5, 6, v6
    v_lshl_add_u32 v6, v3, 4, v6
    s_lshl_b32 s32, s22, 9
    v_add_u32 v6, s32, v6
    s_mov_b32 s12, s48
    s_mov_b32 s13, s49
    s_mov_b32 s14, 16384

    buffer_load_dwordx4 v[24:27], v6, s[12:15], 0 offen offset:0
    buffer_load_dwordx4 v[28:31], v6, s[12:15], 0 offen offset:128
    buffer_load_dwordx4 v[32:35], v6, s[12:15], 0 offen offset:256
    buffer_load_dwordx4 v[36:39], v6, s[12:15], 0 offen offset:384
    s_lshl_b32 s32, s22, 12
    v_add_u32 v7, s32, v13
    s_mul_i32 s32, s22, 6144
    v_add_u32 v8, s32, v13
    v_lshlrev_b32 v9, 3, v1
    s_add_u32 s32, s32, 4096
    v_add_u32 v9, s32, v9
    s_mul_i32 s32, s52, 6144
    s_cmp_eq_u32 s22, 2
    s_cbranch_scc1 mega_kernel_c_astv
    v_lshlrev_b32 v10, 4, v4
    v_lshl_add_u32 v10, v3, 8, v10
    v_lshl_add_u32 v10, v5, 3, v10
    s_lshr_b32 s33, s53, 1
    s_lshl_b32 s33, s33, 10
    s_add_u32 s32, s32, s33
    s_and_b32 s33, s53, 1
    s_lshl_b32 s33, s33, 7
    s_add_u32 s32, s32, s33
    s_and_b32 s33, s22, 1
    s_lshl_b32 s33, s33, 11
    s_add_u32 s32, s32, s33
    v_add_u32 v10, s32, v10
    s_branch mega_kernel_c_astd
mega_kernel_c_astv:
    v_lshlrev_b32 v10, 3, v1
    s_lshl_b32 s33, s53, 9
    s_add_u32 s32, s32, s33
    s_add_u32 s32, s32, 4096
    v_add_u32 v10, s32, v10
mega_kernel_c_astd:
    s_and_b32 s32, s22, 1
    s_lshl_b32 s33, s32, 10
    v_add_u32 v11, s33, v13
    v_lshrrev_b32 v11, 1, v11
    s_lshl_b32 s33, s32, 3
    s_lshl_b32 s32, s21, 10
    s_add_u32 s32, s32, s33
    v_add_u32 v12, s32, v13
    s_lshl_b32 s32, s20, 2
    s_add_u32 s32, s32, s22
    s_lshl_b32 s37, s32, 12
    s_add_u32 s37, s37, 57049088
    s_lshl_b32 s32, s32, 13
    s_add_u32 s28, s32, 23494656
    s_add_u32 s29, s28, 4096
    s_add_u32 s30, s32, 40271872
    s_add_u32 s31, s30, 4096
    s_lshl_b32 s32, s21, 2
    s_add_u32 s32, s32, s22
    s_and_b32 s33, s32, 31
    s_lshl_b32 s33, s33, 10
    s_cmp_lt_u32 s32, 32
    s_cselect_b32 s32, 0, 16777216
    s_add_u32 s32, s32, s33
    s_lshl_b32 s33, s20, 15
    s_add_u32 s32, s32, s33
    s_add_u32 s32, s32, 23494656
    v_add_u32 v246, s32, v13
    s_mul_i32 s88, s20, 24576
    s_add_u32 s88, s88, 163840
    s_lshl_b32 s89, s20, 14
    s_add_u32 s89, s89, 950272
    s_lshl_b32 s90, s21, 14
    s_add_u32 s90, s90, 1474560
    s_lshl_b32 s91, s20, 11
    s_add_u32 s91, s91, s90
    s_mul_i32 s32, s22, 3072
    v_add_u32 v14, s32, v13
    s_lshl_b32 s32, s22, 10
    v_add_u32 v15, s32, v13
    s_lshl_b32 s32, s22, 11
    s_add_u32 s32, s32, 12288
    v_add_u32 v16, s32, v13
    s_and_b32 s32, s22, 1
    s_lshl_b32 s32, s32, 10
    s_add_u32 s32, s32, 12288
    v_add_u32 v17, s32, v13
    v_mov_b32 v20, -1
    v_mov_b32 v21, -1
    v_mov_b32 v22, -1
    v_mov_b32 v23, -1
    s_mov_b32 s24, 2000000
    s_mov_b32 s23, 0

    s_mov_b32 s38, 0x3e0293ee
    s_barrier
    v_mov_b32 v248, 0
    s_lshl_b32 s95, s20, 11
    s_add_u32 s95, s95, 33792
    s_lshl_b32 s96, s20, 12
    s_add_u32 s96, s96, 65536
mega_kernel_c_w0:
    buffer_load_dword v247, v248, s[8:11], s95 offen sc1
    s_waitcnt vmcnt(0)
    v_readfirstlane_b32 s32, v247
    s_cmp_ge_u32 s32, 8
    s_cbranch_scc1 mega_kernel_c_w0ok
    s_sub_u32 s24, s24, 1
    s_cbranch_scc1 mega_kernel_c_exit
    s_sleep 2
    s_branch mega_kernel_c_w0
mega_kernel_c_w0ok:

    buffer_load_dwordx4 v[160:163], v13, s[8:11], s28 offen offset:0 sc1
    buffer_load_dwordx4 v[164:167], v13, s[8:11], s28 offen offset:1024 sc1
    buffer_load_dwordx4 v[168:171], v13, s[8:11], s28 offen offset:2048 sc1
    buffer_load_dwordx4 v[172:175], v13, s[8:11], s28 offen offset:3072 sc1
    buffer_load_dwordx4 v[176:179], v13, s[8:11], s29 offen offset:0 sc1
    buffer_load_dwordx4 v[180:183], v13, s[8:11], s29 offen offset:1024 sc1
    buffer_load_dwordx4 v[184:187], v13, s[8:11], s29 offen offset:2048 sc1
    buffer_load_dwordx4 v[188:191], v13, s[8:11], s29 offen offset:3072 sc1
    s_waitcnt vmcnt(0)
    v_min_u32 v24, -2, v24
    v_min_u32 v26, -2, v26
    v_min_u32 v28, -2, v28
    v_min_u32 v30, -2, v30
    v_min_u32 v32, -2, v32
    v_min_u32 v34, -2, v34
    v_min_u32 v36, -2, v36
    v_min_u32 v38, -2, v38
    s_mov_b32 s25, s89
    s_cmp_lg_u32 s3, 0
    s_cbranch_scc1 mega_kernel_f_p1
    s_branch mega_kernel_c_p1
mega_kernel_c_loop:
    s_mov_b32 s25, s63
    buffer_load_dwordx4 v[24:27], v7, s[8:11], s25 offen offset:0 sc1
    buffer_load_dwordx4 v[28:31], v7, s[8:11], s25 offen offset:1024 sc1
    buffer_load_dwordx4 v[32:35], v7, s[8:11], s25 offen offset:2048 sc1
    buffer_load_dwordx4 v[36:39], v7, s[8:11], s25 offen offset:3072 sc1
mega_kernel_c_p1:
    s_and_b32 s32, s23, 3
    s_mul_i32 s32, s32, 196608
    s_add_u32 s26, s32, s88
    s_add_u32 s32, s23, 3
    s_and_b32 s32, s32, 3
    s_mul_i32 s34, s32, 196608
    s_add_u32 s34, s34, s88
    s_lshl_b32 s35, s32, 17
    s_add_u32 s35, s35, s89
    s_add_u32 s32, s23, 2
    s_and_b32 s32, s32, 3
    s_lshl_b32 s36, s32, 18
    s_add_u32 s36, s36, s91
    s_and_b32 s32, s23, 3
    s_lshl_b32 s32, s32, 18
    s_add_u32 s27, s32, s90
    s_add_u32 s62, s32, s91
    s_add_u32 s59, s27, 4096
    s_add_u32 s60, s27, 8192
    s_add_u32 s61, s27, 12288
    s_add_u32 s32, s23, 1
    s_and_b32 s32, s32, 3
    s_lshl_b32 s32, s32, 17
    s_add_u32 s63, s32, s89
    v_mov_b32 v228, 0xff800000
    v_mov_b32 v229, 0xff800000
    v_mov_b32 v230, 0xff800000
    v_mov_b32 v231, 0xff800000
    v_mov_b32 v242, 0
    v_mov_b32 v243, 0
    s_waitcnt vmcnt(3)
    v_max_u32 v4, v24, v26
    v_cmp_eq_u32 vcc, -1, v4
    s_cbranch_vccnz mega_kernel_c_pD_s0
mega_kernel_c_pD_k0:
    v_mfma_f32_16x16x32_bf16 v[56:59], a[0:3], v[24:27], 0
    v_mov_b32_dpp v40, v24 row_ror:8 row_mask:0xf bank_mask:0xf
    v_mfma_f32_16x16x32_bf16 v[60:63], a[36:39], v[24:27], 0
    v_mov_b32_dpp v41, v25 row_ror:8 row_mask:0xf bank_mask:0xf
    v_mfma_f32_16x16x32_bf16 v[64:67], a[64:67], v[24:27], 0
    v_mov_b32_dpp v42, v26 row_ror:8 row_mask:0xf bank_mask:0xf
    v_mfma_f32_16x16x32_bf16 v[68:71], a[100:103], v[24:27], 0
    v_mov_b32_dpp v43, v27 row_ror:8 row_mask:0xf bank_mask:0xf
    s_nop 1
    v_mfma_f32_16x16x32_bf16 v[56:59], a[4:7], v[40:43], v[56:59]
    v_mfma_f32_16x16x32_bf16 v[60:63], a[32:35], v[40:43], v[60:63]
    v_mfma_f32_16x16x32_bf16 v[64:67], a[68:71], v[40:43], v[64:67]
    v_mfma_f32_16x16x32_bf16 v[68:71], a[96:99], v[40:43], v[68:71]
    s_waitcnt vmcnt(2)
    v_max_u32 v4, v28, v30
    v_cmp_eq_u32 vcc, -1, v4
    s_cbranch_vccnz mega_kernel_c_pD_s1
mega_kernel_c_pD_k1:
    v_mfma_f32_16x16x32_bf16 v[56:59], a[8:11], v[28:31], v[56:59]
    v_mov_b32_dpp v44, v28 row_ror:8 row_mask:0xf bank_mask:0xf
    v_mfma_f32_16x16x32_bf16 v[60:63], a[44:47], v[28:31], v[60:63]
    v_mov_b32_dpp v45, v29 row_ror:8 row_mask:0xf bank_mask:0xf
    v_mfma_f32_16x16x32_bf16 v[64:67], a[72:75], v[28:31], v[64:67]
    v_mov_b32_dpp v46, v30 row_ror:8 row_mask:0xf bank_mask:0xf
    v_mfma_f32_16x16x32_bf16 v[68:71], a[108:111], v[28:31], v[68:71]
    v_mov_b32_dpp v47, v31 row_ror:8 row_mask:0xf bank_mask:0xf
    s_nop 1
    v_mfma_f32_16x16x32_bf16 v[56:59], a[12:15], v[44:47], v[56:59]
    v_mfma_f32_16x16x32_bf16 v[60:63], a[40:43], v[44:47], v[60:63]
    v_mfma_f32_16x16x32_bf16 v[64:67], a[76:79], v[44:47], v[64:67]
    v_mfma_f32_16x16x32_bf16 v[68:71], a[104:107], v[44:47], v[68:71]
    s_waitcnt vmcnt(1)
    v_max_u32 v4, v32, v34
    v_cmp_eq_u32 vcc, -1, v4
    s_cbranch_vccnz mega_kernel_c_pD_s2
mega_kernel_c_pD_k2:
    v_mfma_f32_16x16x32_bf16 v[56:59], a[16:19], v[32:35], v[56:59]
    v_mov_b32_dpp v48, v32 row_ror:8 row_mask:0xf bank_mask:0xf
    v_mfma_f32_16x16x32_bf16 v[60:63], a[52:55], v[32:35], v[60:63]
    v_mov_b32_dpp v49, v33 row_ror:8 row_mask:0xf bank_mask:0xf
    v_mfma_f32_16x16x32_bf16 v[64:67], a[80:83], v[32:35], v[64:67]
    v_mov_b32_dpp v50, v34 row_ror:8 row_mask:0xf bank_mask:0xf
    v_mfma_f32_16x16x32_bf16 v[68:71], a[116:119], v[32:35], v[68:71]
    v_mov_b32_dpp v51, v35 row_ror:8 row_mask:0xf bank_mask:0xf
    s_nop 1
    v_mfma_f32_16x16x32_bf16 v[56:59], a[20:23], v[48:51], v[56:59]
    v_mfma_f32_16x16x32_bf16 v[60:63], a[48:51], v[48:51], v[60:63]
    v_mfma_f32_16x16x32_bf16 v[64:67], a[84:87], v[48:51], v[64:67]
    v_mfma_f32_16x16x32_bf16 v[68:71], a[112:115], v[48:51], v[68:71]
    s_waitcnt vmcnt(0)
    v_max_u32 v4, v36, v38
    v_cmp_eq_u32 vcc, -1, v4
    s_cbranch_vccnz mega_kernel_c_pD_s3
mega_kernel_c_pD_k3:
    v_mfma_f32_16x16x32_bf16 v[56:59], a[24:27], v[36:39], v[56:59]
    v_mov_b32_dpp v52, v36 row_ror:8 row_mask:0xf bank_mask:0xf
    v_mfma_f32_16x16x32_bf16 v[60:63], a[60:63], v[36:39], v[60:63]
    v_mov_b32_dpp v53, v37 row_ror:8 row_mask:0xf bank_mask:0xf
    v_mfma_f32_16x16x32_bf16 v[64:67], a[88:91], v[36:39], v[64:67]
    v_mov_b32_dpp v54, v38 row_ror:8 row_mask:0xf bank_mask:0xf
    v_mfma_f32_16x16x32_bf16 v[68:71], a[124:127], v[36:39], v[68:71]
    v_mov_b32_dpp v55, v39 row_ror:8 row_mask:0xf bank_mask:0xf
    s_nop 1
    v_mfma_f32_16x16x32_bf16 v[56:59], a[28:31], v[52:55], v[56:59]
    v_mfma_f32_16x16x32_bf16 v[60:63], a[56:59], v[52:55], v[60:63]
    v_mfma_f32_16x16x32_bf16 v[64:67], a[92:95], v[52:55], v[64:67]
    v_mfma_f32_16x16x32_bf16 v[68:71], a[120:123], v[52:55], v[68:71]
    v_mfma_f32_16x16x32_bf16 v[72:75], v[24:27], a[128:131], 0
    v_mfma_f32_16x16x32_bf16 v[76:79], v[24:27], a[164:167], 0
    s_nop 3
    v_mov_b32_dpp v56, v60 quad_perm:[0,1,2,3] row_mask:0xf bank_mask:0xc
    v_mov_b32_dpp v57, v61 quad_perm:[0,1,2,3] row_mask:0xf bank_mask:0xc
    v_mov_b32_dpp v58, v62 quad_perm:[0,1,2,3] row_mask:0xf bank_mask:0xc
    v_mov_b32_dpp v59, v63 quad_perm:[0,1,2,3] row_mask:0xf bank_mask:0xc
    v_mov_b32_dpp v64, v68 quad_perm:[0,1,2,3] row_mask:0xf bank_mask:0xc
    v_mov_b32_dpp v65, v69 quad_perm:[0,1,2,3] row_mask:0xf bank_mask:0xc
    v_mov_b32_dpp v66, v70 quad_perm:[0,1,2,3] row_mask:0xf bank_mask:0xc
    v_mov_b32_dpp v67, v71 quad_perm:[0,1,2,3] row_mask:0xf bank_mask:0xc
    ds_write_b128 v14, v[56:59] offset:0
    ds_write_b128 v14, v[64:67] offset:1024
    v_mfma_f32_16x16x32_bf16 v[72:75], v[40:43], a[132:135], v[72:75]
    v_mfma_f32_16x16x32_bf16 v[76:79], v[40:43], a[160:163], v[76:79]
    s_waitcnt lgkmcnt(0)
    s_barrier
    s_cmp_ge_u32 s22, 2
    s_cbranch_scc1 mega_kernel_c_skipA

    ds_read_b128 v[104:107], v15 offset:0
    ds_read_b128 v[108:111], v15 offset:3072
    ds_read_b128 v[112:115], v15 offset:6144
    ds_read_b128 v[116:119], v15 offset:9216
    v_mfma_f32_16x16x32_bf16 v[72:75], v[28:31], a[136:139], v[72:75]
    v_mfma_f32_16x16x32_bf16 v[76:79], v[28:31], a[172:175], v[76:79]
    v_mfma_f32_16x16x32_bf16 v[72:75], v[44:47], a[140:143], v[72:75]
    v_mfma_f32_16x16x32_bf16 v[76:79], v[44:47], a[168:171], v[76:79]
    s_waitcnt lgkmcnt(0)
    v_add_f32 v104, v104, v108
    v_add_f32 v112, v112, v116
    v_add_f32 v105, v105, v109
    v_add_f32 v113, v113, v117
    v_add_f32 v106, v106, v110
    v_add_f32 v114, v114, v118
    v_add_f32 v107, v107, v111
    v_add_f32 v115, v115, v119
    v_add_f32 v104, v104, v112
    v_add_f32 v105, v105, v113
    v_add_f32 v106, v106, v114
    v_add_f32 v107, v107, v115
    v_cvt_pk_bf16_f32 v108, v104, v105
    v_cvt_pk_bf16_f32 v109, v106, v107
    s_nop 0
    v_min_u32 v108, -2, v108
    v_min_u32 v109, -2, v109
    buffer_store_dwordx2 v[108:109], v10, s[8:11], s26 offen

    v_mfma_f32_16x16x32_bf16 v[72:75], v[32:35], a[144:147], v[72:75]
    buffer_load_dwordx4 v[192:195], v13, s[8:11], s30 offen offset:0 sc1
    v_mfma_f32_16x16x32_bf16 v[76:79], v[32:35], a[180:183], v[76:79]
    buffer_load_dwordx4 v[196:199], v13, s[8:11], s30 offen offset:1024 sc1
    v_mfma_f32_16x16x32_bf16 v[72:75], v[48:51], a[148:151], v[72:75]
    buffer_load_dwordx4 v[200:203], v13, s[8:11], s30 offen offset:2048 sc1
    v_mfma_f32_16x16x32_bf16 v[76:79], v[48:51], a[176:179], v[76:79]
    buffer_load_dwordx4 v[204:207], v13, s[8:11], s30 offen offset:3072 sc1
    v_mfma_f32_16x16x32_bf16 v[72:75], v[36:39], a[152:155], v[72:75]
    buffer_load_dwordx4 v[208:211], v13, s[8:11], s31 offen offset:0 sc1
    v_mfma_f32_16x16x32_bf16 v[76:79], v[36:39], a[188:191], v[76:79]
    buffer_load_dwordx4 v[212:215], v13, s[8:11], s31 offen offset:1024 sc1
    v_mfma_f32_16x16x32_bf16 v[72:75], v[52:55], a[156:159], v[72:75]
    buffer_load_dwordx4 v[216:219], v13, s[8:11], s31 offen offset:2048 sc1
    v_mfma_f32_16x16x32_bf16 v[76:79], v[52:55], a[184:187], v[76:79]
    buffer_load_dwordx4 v[220:223], v13, s[8:11], s31 offen offset:3072 sc1
    s_branch mega_kernel_c_vdone
mega_kernel_c_skipA:
    v_mfma_f32_16x16x32_bf16 v[72:75], v[28:31], a[136:139], v[72:75]
    buffer_load_dwordx4 v[192:195], v13, s[8:11], s30 offen offset:0 sc1
    v_mfma_f32_16x16x32_bf16 v[76:79], v[28:31], a[172:175], v[76:79]
    buffer_load_dwordx4 v[196:199], v13, s[8:11], s30 offen offset:1024 sc1
    v_mfma_f32_16x16x32_bf16 v[72:75], v[44:47], a[140:143], v[72:75]
    buffer_load_dwordx4 v[200:203], v13, s[8:11], s30 offen offset:2048 sc1
    v_mfma_f32_16x16x32_bf16 v[76:79], v[44:47], a[168:171], v[76:79]
    buffer_load_dwordx4 v[204:207], v13, s[8:11], s30 offen offset:3072 sc1
    v_mfma_f32_16x16x32_bf16 v[72:75], v[32:35], a[144:147], v[72:75]
    buffer_load_dwordx4 v[208:211], v13, s[8:11], s31 offen offset:0 sc1
    v_mfma_f32_16x16x32_bf16 v[76:79], v[32:35], a[180:183], v[76:79]
    buffer_load_dwordx4 v[212:215], v13, s[8:11], s31 offen offset:1024 sc1
    v_mfma_f32_16x16x32_bf16 v[72:75], v[48:51], a[148:151], v[72:75]
    buffer_load_dwordx4 v[216:219], v13, s[8:11], s31 offen offset:2048 sc1
    v_mfma_f32_16x16x32_bf16 v[76:79], v[48:51], a[176:179], v[76:79]
    buffer_load_dwordx4 v[220:223], v13, s[8:11], s31 offen offset:3072 sc1
    v_mfma_f32_16x16x32_bf16 v[72:75], v[36:39], a[152:155], v[72:75]
    v_mfma_f32_16x16x32_bf16 v[76:79], v[36:39], a[188:191], v[76:79]
    v_mfma_f32_16x16x32_bf16 v[72:75], v[52:55], a[156:159], v[72:75]
    v_mfma_f32_16x16x32_bf16 v[76:79], v[52:55], a[184:187], v[76:79]
mega_kernel_c_vdone:
    s_nop 7
    v_mov_b32_dpp v72, v76 quad_perm:[0,1,2,3] row_mask:0xc bank_mask:0xf
    v_mov_b32_dpp v73, v77 quad_perm:[0,1,2,3] row_mask:0xc bank_mask:0xf
    v_mov_b32_dpp v74, v78 quad_perm:[0,1,2,3] row_mask:0xc bank_mask:0xf
    v_mov_b32_dpp v75, v79 quad_perm:[0,1,2,3] row_mask:0xc bank_mask:0xf
    ds_write_b128 v14, v[72:75] offset:2048
    buffer_load_dwordx4 v[136:139], v8, s[8:11], s26 offen offset:0 sc1
    buffer_load_dwordx4 v[140:143], v8, s[8:11], s26 offen offset:1024 sc1
    buffer_load_dwordx4 v[144:147], v8, s[8:11], s26 offen offset:2048 sc1
    buffer_load_dwordx4 v[148:151], v8, s[8:11], s26 offen offset:3072 sc1
    s_waitcnt lgkmcnt(0)
    s_barrier
    s_cmp_lg_u32 s22, 2
    s_cbranch_scc1 mega_kernel_c_skipV

    ds_read_b128 v[104:107], v15 offset:0
    ds_read_b128 v[108:111], v15 offset:3072
    ds_read_b128 v[112:115], v15 offset:6144
    ds_read_b128 v[116:119], v15 offset:9216
    s_waitcnt lgkmcnt(0)
    v_add_f32 v104, v104, v108
    v_add_f32 v112, v112, v116
    v_add_f32 v105, v105, v109
    v_add_f32 v113, v113, v117
    v_add_f32 v106, v106, v110
    v_add_f32 v114, v114, v118
    v_add_f32 v107, v107, v111
    v_add_f32 v115, v115, v119
    v_add_f32 v104, v104, v112
    v_add_f32 v105, v105, v113
    v_add_f32 v106, v106, v114
    v_add_f32 v107, v107, v115
    v_cvt_pk_bf16_f32 v108, v104, v105
    v_cvt_pk_bf16_f32 v109, v106, v107
    s_nop 0
    v_min_u32 v108, -2, v108
    v_min_u32 v109, -2, v109
    buffer_store_dwordx2 v[108:109], v10, s[8:11], s26 offen
    s_waitcnt vmcnt(1)
    s_branch mega_kernel_c_skipV2
mega_kernel_c_skipV:
    s_waitcnt vmcnt(0)
mega_kernel_c_skipV2:

    v_max3_u32 v4, v136, v138, v140
    v_max3_u32 v4, v4, v142, v144
    v_max3_u32 v4, v4, v146, v148
    v_max_u32 v4, v4, v150
    v_cmp_eq_u32 vcc, -1, v4
    s_cbranch_vccnz mega_kernel_c_pA_s0
mega_kernel_c_pA_k0:
mega_kernel_c_kvchka:
    v_readfirstlane_b32 s32, v247
    s_cmp_ge_u32 s32, 8
    s_cbranch_scc1 mega_kernel_c_kvoka
    s_add_u32 s32, s23, 1
    s_lshr_b32 s32, s32, 2
    s_lshl_b32 s32, s32, 7
    s_add_u32 s32, s32, s95
    buffer_load_dword v247, v248, s[8:11], s32 offen sc1
    s_sub_u32 s24, s24, 1
    s_cbranch_scc1 mega_kernel_c_exit
    s_waitcnt vmcnt(0)
    s_branch mega_kernel_c_kvchka
mega_kernel_c_kvoka:

    buffer_load_dwordx2 v[152:153], v9, s[8:11], s26 offen offset:0 sc1
    buffer_load_dwordx2 v[154:155], v9, s[8:11], s26 offen offset:512 sc1
    buffer_load_dwordx2 v[156:157], v9, s[8:11], s26 offen offset:1024 sc1
    buffer_load_dwordx2 v[158:159], v9, s[8:11], s26 offen offset:1536 sc1
    s_add_u32 s32, s23, 2
    s_lshr_b32 s32, s32, 2
    s_min_u32 s32, s32, 15
    s_lshl_b32 s32, s32, 7
    s_add_u32 s32, s32, s95
    buffer_load_dword v247, v248, s[8:11], s32 offen sc1

    s_cmp_eq_u32 s23, 63
    s_cbranch_scc1 mega_kernel_c_last

    v_mfma_f32_16x16x32_bf16 v[224:227], v[144:147], v[136:139], 0
    v_mov_b32_dpp v40, v136 row_ror:8 row_mask:0xf bank_mask:0xf
    v_mfma_f32_16x16x32_bf16 v[224:227], v[148:151], v[140:143], v[224:227]
    v_mov_b32_dpp v41, v137 row_ror:8 row_mask:0xf bank_mask:0xf
    v_mfma_f32_16x16x32_bf16 v[104:107], v[160:163], v[136:139], 0
    v_mov_b32_dpp v42, v138 row_ror:8 row_mask:0xf bank_mask:0xf
    v_mfma_f32_16x16x32_bf16 v[108:111], v[180:183], v[136:139], 0
    v_mov_b32_dpp v43, v139 row_ror:8 row_mask:0xf bank_mask:0xf
    v_mfma_f32_16x16x32_bf16 v[104:107], v[168:171], v[140:143], v[104:107]
    v_mov_b32_dpp v44, v140 row_ror:8 row_mask:0xf bank_mask:0xf
    v_mfma_f32_16x16x32_bf16 v[108:111], v[188:191], v[140:143], v[108:111]
    v_mov_b32_dpp v45, v141 row_ror:8 row_mask:0xf bank_mask:0xf
    v_mov_b32_dpp v46, v142 row_ror:8 row_mask:0xf bank_mask:0xf
    v_mov_b32_dpp v47, v143 row_ror:8 row_mask:0xf bank_mask:0xf
    s_nop 0
    v_mfma_f32_16x16x32_bf16 v[104:107], v[164:167], v[40:43], v[104:107]
    v_permlane32_swap_b32 v224, v232
    v_mfma_f32_16x16x32_bf16 v[108:111], v[176:179], v[40:43], v[108:111]
    v_permlane32_swap_b32 v225, v233
    v_mfma_f32_16x16x32_bf16 v[104:107], v[172:175], v[44:47], v[104:107]
    v_permlane32_swap_b32 v226, v234
    v_mfma_f32_16x16x32_bf16 v[108:111], v[184:187], v[44:47], v[108:111]
    v_permlane32_swap_b32 v227, v235
    s_add_u32 s28, s28, 262144
    s_add_u32 s29, s29, 262144
    s_add_u32 s30, s30, 262144
    s_add_u32 s31, s31, 262144

    v_add_f32_dpp v228, v232, v224 row_ror:8 row_mask:0x3 bank_mask:0x3
    v_add_f32_dpp v229, v233, v225 row_ror:8 row_mask:0x3 bank_mask:0x3
    v_add_f32_dpp v230, v234, v226 row_ror:8 row_mask:0x3 bank_mask:0x3
    v_add_f32_dpp v231, v235, v227 row_ror:8 row_mask:0x3 bank_mask:0x3
    v_max3_f32 v249, v228, v229, v230
    v_max_f32 v249, v249, v231
    s_nop 1

    v_mov_b32_dpp v104, v108 quad_perm:[0,1,2,3] row_mask:0xf bank_mask:0xc
    v_mov_b32_dpp v105, v109 quad_perm:[0,1,2,3] row_mask:0xf bank_mask:0xc
    v_mov_b32_dpp v106, v110 quad_perm:[0,1,2,3] row_mask:0xf bank_mask:0xc
    v_mov_b32_dpp v107, v111 quad_perm:[0,1,2,3] row_mask:0xf bank_mask:0xc
    v_max3_f32 v249, v249, v104, v105
    v_max3_f32 v249, v249, v106, v107
    s_nop 1
    v_max_f32_dpp v250, v249, v249 row_ror:8 row_mask:0xf bank_mask:0xf
    v_max_f32_dpp v249, v249, v249 row_ror:8 row_mask:0xf bank_mask:0xf
    s_nop 1
    v_permlane16_swap_b32 v249, v250
    s_nop 0
    v_max_f32 v252, v249, v250
    v_max_f32 v249, v249, v250
    s_nop 1
    v_permlane32_swap_b32 v249, v252
    s_nop 0
    v_max_f32 v249, v249, v252
    v_mul_f32 v249, s38, v249

    v_fma_f32 v104, v104, s38, -v249
    v_fma_f32 v105, v105, s38, -v249
    v_fma_f32 v106, v106, s38, -v249
    v_fma_f32 v107, v107, s38, -v249
    v_exp_f32 v104, v104
    v_exp_f32 v105, v105
    v_exp_f32 v106, v106
    v_exp_f32 v107, v107
    v_fma_f32 v228, v228, s38, -v249
    v_fma_f32 v229, v229, s38, -v249
    v_fma_f32 v230, v230, s38, -v249
    v_fma_f32 v231, v231, s38, -v249
    v_cvt_pk_bf16_f32 v236, v104, v105
    v_cvt_pk_bf16_f32 v237, v106, v107
    v_exp_f32 v228, v228
    v_exp_f32 v229, v229
    v_mov_b32_dpp v238, v236 row_ror:8 row_mask:0xf bank_mask:0xf
    v_mov_b32_dpp v239, v237 row_ror:8 row_mask:0xf bank_mask:0xf
    v_exp_f32 v230, v230
    v_exp_f32 v231, v231

    v_mfma_f32_16x16x32_bf16 v[56:59], v[192:195], v[236:239], 0
    v_cvt_pk_bf16_f32 v240, v228, v229
    v_cvt_pk_bf16_f32 v244, v228, v229
    v_mfma_f32_16x16x32_bf16 v[60:63], v[196:199], v[236:239], 0
    v_cvt_pk_bf16_f32 v241, v230, v231
    v_cvt_pk_bf16_f32 v245, v230, v231
    v_mfma_f32_16x16x32_bf16 v[64:67], v[200:203], v[236:239], 0
    v_add_f32 v251, v104, v105
    v_permlane32_swap_b32 v242, v244
    v_mfma_f32_16x16x32_bf16 v[68:71], v[204:207], v[236:239], 0
    v_add_f32 v252, v106, v107
    v_permlane32_swap_b32 v243, v245
    s_waitcnt vmcnt(1)
    v_max3_u32 v4, v152, v154, v156
    v_max_u32 v4, v4, v158
    v_cmp_eq_u32 vcc, -1, v4
    s_cbranch_vccnz mega_kernel_c_pV_s0
mega_kernel_c_pV_k0:
    v_mfma_f32_16x16x16_bf16 v[56:59], v[152:153], v[240:241], v[56:59]
    v_add_f32 v250, v228, v229
    v_mfma_f32_16x16x16_bf16 v[60:63], v[152:153], v[242:243], v[60:63]
    v_add_f32 v251, v251, v252
    v_mfma_f32_16x16x16_bf16 v[64:67], v[154:155], v[240:241], v[64:67]
    v_add_f32 v252, v230, v231
    v_mfma_f32_16x16x16_bf16 v[68:71], v[154:155], v[242:243], v[68:71]
    v_add_f32 v251, v251, v250
    v_mfma_f32_16x16x32_bf16 v[72:75], v[208:211], v[236:239], 0
    v_add_f32 v251, v251, v252
    v_mfma_f32_16x16x32_bf16 v[76:79], v[212:215], v[236:239], 0
    buffer_load_dwordx4 v[160:163], v13, s[8:11], s28 offen offset:0 sc1
    v_mfma_f32_16x16x16_bf16 v[72:75], v[156:157], v[240:241], v[72:75]
    v_add_f32_dpp v250, v251, v251 row_ror:8 row_mask:0xf bank_mask:0xf
    v_mfma_f32_16x16x16_bf16 v[76:79], v[156:157], v[242:243], v[76:79]
    v_add_f32_dpp v251, v251, v251 row_ror:8 row_mask:0xf bank_mask:0xf
    v_mfma_f32_16x16x32_bf16 v[80:83], v[216:219], v[236:239], 0
    v_cvt_pk_bf16_f32 v24, v56, v57
    v_cvt_pk_bf16_f32 v25, v58, v59
    v_mfma_f32_16x16x32_bf16 v[84:87], v[220:223], v[236:239], 0
    v_cvt_pk_bf16_f32 v26, v60, v61
    v_cvt_pk_bf16_f32 v27, v62, v63
    v_mfma_f32_16x16x16_bf16 v[80:83], v[158:159], v[240:241], v[80:83]
    v_permlane16_swap_b32 v251, v250
    buffer_load_dwordx4 v[164:167], v13, s[8:11], s28 offen offset:1024 sc1
    v_mfma_f32_16x16x16_bf16 v[84:87], v[158:159], v[242:243], v[84:87]
    v_cvt_pk_bf16_f32 v28, v64, v65
    v_cvt_pk_bf16_f32 v29, v66, v67
    v_mfma_f32_16x16x32_bf16 v[88:91], a[192:195], v[24:27], 0
    v_cvt_pk_bf16_f32 v30, v68, v69
    v_cvt_pk_bf16_f32 v31, v70, v71
    v_mfma_f32_16x16x32_bf16 v[92:95], a[208:211], v[24:27], 0
    v_add_f32 v252, v251, v250
    buffer_load_dwordx4 v[168:171], v13, s[8:11], s28 offen offset:2048 sc1
    v_mfma_f32_16x16x32_bf16 v[96:99], a[224:227], v[24:27], 0
    v_add_f32 v251, v251, v250
    buffer_load_dwordx4 v[172:175], v13, s[8:11], s28 offen offset:3072 sc1
    v_mfma_f32_16x16x32_bf16 v[100:103], a[240:243], v[24:27], 0
    buffer_load_dwordx4 v[176:179], v13, s[8:11], s29 offen offset:0 sc1
    v_mfma_f32_16x16x32_bf16 v[88:91], a[196:199], v[28:31], v[88:91]
    v_cvt_pk_bf16_f32 v32, v72, v73
    v_cvt_pk_bf16_f32 v33, v74, v75
    v_mfma_f32_16x16x32_bf16 v[92:95], a[212:215], v[28:31], v[92:95]
    v_cvt_pk_bf16_f32 v34, v76, v77
    v_cvt_pk_bf16_f32 v35, v78, v79
    v_mfma_f32_16x16x32_bf16 v[96:99], a[228:231], v[28:31], v[96:99]
    v_permlane32_swap_b32 v251, v252
    buffer_load_dwordx4 v[180:183], v13, s[8:11], s29 offen offset:1024 sc1
    v_mfma_f32_16x16x32_bf16 v[100:103], a[244:247], v[28:31], v[100:103]
    v_cvt_pk_bf16_f32 v36, v80, v81
    v_cvt_pk_bf16_f32 v37, v82, v83
    v_mfma_f32_16x16x32_bf16 v[88:91], a[200:203], v[32:35], v[88:91]
    v_cvt_pk_bf16_f32 v38, v84, v85
    v_cvt_pk_bf16_f32 v39, v86, v87
    v_mfma_f32_16x16x32_bf16 v[92:95], a[216:219], v[32:35], v[92:95]
    v_add_f32 v251, v251, v252
    buffer_load_dwordx4 v[184:187], v13, s[8:11], s29 offen offset:2048 sc1
    v_mfma_f32_16x16x32_bf16 v[96:99], a[232:235], v[32:35], v[96:99]
    buffer_load_dwordx4 v[188:191], v13, s[8:11], s29 offen offset:3072 sc1
    v_mfma_f32_16x16x32_bf16 v[100:103], a[248:251], v[32:35], v[100:103]
    v_rcp_f32 v251, v251
    v_mfma_f32_16x16x32_bf16 v[88:91], a[204:207], v[36:39], v[88:91]
    v_mfma_f32_16x16x32_bf16 v[92:95], a[220:223], v[36:39], v[92:95]
    v_mfma_f32_16x16x32_bf16 v[96:99], a[236:239], v[36:39], v[96:99]
    v_mfma_f32_16x16x32_bf16 v[100:103], a[252:255], v[36:39], v[100:103]
    s_cmp_eq_u32 s22, 3
    s_cbranch_scc1 mega_kernel_c_rs3
    buffer_store_dwordx2 v[20:21], v10, s[8:11], s34 offen
mega_kernel_c_rs3:

    s_nop 3
    v_mov_b32_dpp v88, v92 row_ror:8 row_mask:0xf bank_mask:0xc
    v_mov_b32_dpp v89, v93 row_ror:8 row_mask:0xf bank_mask:0xc
    v_mov_b32_dpp v90, v94 row_ror:8 row_mask:0xf bank_mask:0xc
    v_mov_b32_dpp v91, v95 row_ror:8 row_mask:0xf bank_mask:0xc
    v_mul_f32 v88, v88, v251
    v_mul_f32 v89, v89, v251
    v_mul_f32 v90, v90, v251
    v_mul_f32 v91, v91, v251
    v_mov_b32_dpp v96, v100 row_ror:8 row_mask:0xf bank_mask:0xc
    v_mov_b32_dpp v97, v101 row_ror:8 row_mask:0xf bank_mask:0xc
    v_mov_b32_dpp v98, v102 row_ror:8 row_mask:0xf bank_mask:0xc
    v_mov_b32_dpp v99, v103 row_ror:8 row_mask:0xf bank_mask:0xc
    ds_write_b128 v16, v[88:91] offset:0
    v_mul_f32 v96, v96, v251
    v_mul_f32 v97, v97, v251
    v_mul_f32 v98, v98, v251
    v_mul_f32 v99, v99, v251
    ds_write_b128 v16, v[96:99] offset:1024
    s_waitcnt lgkmcnt(0)
    s_barrier
    s_cmp_ge_u32 s22, 2
    s_cbranch_scc1 mega_kernel_c_cpoll

    ds_read_b128 v[104:107], v17 offset:0
    ds_read_b128 v[108:111], v17 offset:2048
    ds_read_b128 v[112:115], v17 offset:4096
    ds_read_b128 v[116:119], v17 offset:6144
    s_waitcnt lgkmcnt(0)
    v_add_f32 v104, v104, v108
    v_add_f32 v112, v112, v116
    v_add_f32 v105, v105, v109
    v_add_f32 v113, v113, v117
    v_add_f32 v106, v106, v110
    v_add_f32 v114, v114, v118
    v_add_f32 v107, v107, v111
    v_add_f32 v115, v115, v119
    v_add_f32 v104, v104, v112
    v_add_f32 v105, v105, v113
    v_add_f32 v106, v106, v114
    v_add_f32 v107, v107, v115
    v_cvt_pk_bf16_f32 v108, v104, v105
    v_cvt_pk_bf16_f32 v109, v106, v107
    s_nop 0
    v_min_u32 v108, -2, v108
    v_min_u32 v109, -2, v109
    buffer_store_dwordx2 v[108:109], v11, s[8:11], s62 offen sc1
    buffer_store_dwordx2 v[20:21], v11, s[8:11], s36 offen sc1
    s_add_u32 s32, s23, 2
    s_and_b32 s33, s32, 3
    s_cmp_eq_u32 s33, 0
    s_cbranch_scc1 mega_kernel_c_nopf1
    s_cmp_ge_u32 s32, 64
    s_cbranch_scc1 mega_kernel_c_nopf1
    s_lshl_b32 s32, s32, 18
    buffer_load_dword v6, v246, s[8:11], s32 offen sc1
mega_kernel_c_nopf1:

    s_sub_u32 s32, s23, 1
    s_and_b32 s33, s32, 15
    s_cmp_lg_u32 s33, s21
    s_cbranch_scc1 mega_kernel_c_nopub1
    s_cmp_eq_u32 s23, 0
    s_cbranch_scc1 mega_kernel_c_nopub1
    s_lshl_b32 s32, s32, 6
    s_add_u32 s32, s32, s96
    v_mov_b32 v5, 1
    s_mov_b64 exec, 1
    buffer_atomic_add v5, v248, s[8:11], s32 offen
    s_mov_b64 exec, -1
mega_kernel_c_nopub1:

    s_and_b32 s32, s23, 15
    s_cmp_lg_u32 s32, s21
    s_cbranch_scc1 mega_kernel_c_nokvm1
    s_lshl_b32 s32, s23, 17
    s_add_u32 s32, s32, s37
    s_add_u32 s33, s32, 2048
    v_lshlrev_b32 v5, 3, v1
    buffer_store_dwordx4 v[144:147], v13, s[8:11], s32 offen offset:0 sc1
    buffer_store_dwordx4 v[148:151], v13, s[8:11], s32 offen offset:1024 sc1
    buffer_store_dwordx2 v[152:153], v5, s[8:11], s33 offen offset:0 sc1
    buffer_store_dwordx2 v[154:155], v5, s[8:11], s33 offen offset:512 sc1
    buffer_store_dwordx2 v[156:157], v5, s[8:11], s33 offen offset:1024 sc1
    buffer_store_dwordx2 v[158:159], v5, s[8:11], s33 offen offset:1536 sc1
mega_kernel_c_nokvm1:

    s_add_u32 s23, s23, 1
    s_branch mega_kernel_c_b3
mega_kernel_c_cpoll:
    buffer_store_dwordx2 v[20:21], v12, s[8:11], s35 offen
    s_add_u32 s32, s23, 2
    s_and_b32 s33, s32, 3
    s_cmp_eq_u32 s33, 0
    s_cbranch_scc1 mega_kernel_c_nopf3
    s_cmp_ge_u32 s32, 64
    s_cbranch_scc1 mega_kernel_c_nopf3
    s_lshl_b32 s32, s32, 18
    buffer_load_dword v6, v246, s[8:11], s32 offen sc1
mega_kernel_c_nopf3:

    s_sub_u32 s32, s23, 1
    s_and_b32 s33, s32, 15
    s_cmp_lg_u32 s33, s21
    s_cbranch_scc1 mega_kernel_c_nopub3
    s_cmp_eq_u32 s23, 0
    s_cbranch_scc1 mega_kernel_c_nopub3
    s_lshl_b32 s32, s32, 6
    s_add_u32 s32, s32, s96
    v_mov_b32 v5, 1
    s_mov_b64 exec, 1
    buffer_atomic_add v5, v248, s[8:11], s32 offen
    s_mov_b64 exec, -1
mega_kernel_c_nopub3:

    s_and_b32 s32, s23, 15
    s_cmp_lg_u32 s32, s21
    s_cbranch_scc1 mega_kernel_c_nokvm3
    s_lshl_b32 s32, s23, 17
    s_add_u32 s32, s32, s37
    s_add_u32 s33, s32, 2048
    v_lshlrev_b32 v5, 3, v1
    buffer_store_dwordx4 v[144:147], v13, s[8:11], s32 offen offset:0 sc1
    buffer_store_dwordx4 v[148:151], v13, s[8:11], s32 offen offset:1024 sc1
    buffer_store_dwordx2 v[152:153], v5, s[8:11], s33 offen offset:0 sc1
    buffer_store_dwordx2 v[154:155], v5, s[8:11], s33 offen offset:512 sc1
    buffer_store_dwordx2 v[156:157], v5, s[8:11], s33 offen offset:1024 sc1
    buffer_store_dwordx2 v[158:159], v5, s[8:11], s33 offen offset:1536 sc1
mega_kernel_c_nokvm3:

    s_add_u32 s23, s23, 1
    s_sleep 10
    buffer_load_dwordx2 v[120:121], v11, s[8:11], s27 offen offset:0 sc1
    buffer_load_dwordx2 v[122:123], v11, s[8:11], s27 offen offset:2048 sc1
    buffer_load_dwordx2 v[124:125], v11, s[8:11], s59 offen offset:0 sc1
    buffer_load_dwordx2 v[126:127], v11, s[8:11], s59 offen offset:2048 sc1
    buffer_load_dwordx2 v[128:129], v11, s[8:11], s60 offen offset:0 sc1
    buffer_load_dwordx2 v[130:131], v11, s[8:11], s60 offen offset:2048 sc1
    buffer_load_dwordx2 v[132:133], v11, s[8:11], s61 offen offset:0 sc1
    buffer_load_dwordx2 v[134:135], v11, s[8:11], s61 offen offset:2048 sc1
    s_waitcnt vmcnt(0)
    v_max3_u32 v4, v120, v122, v124
    v_max3_u32 v4, v4, v126, v128
    v_max3_u32 v4, v4, v130, v132
    v_max_u32 v4, v4, v134
    v_cmp_eq_u32 vcc, -1, v4
    s_cbranch_vccnz mega_kernel_c_pC_s0
mega_kernel_c_pC_k0:
    v_lshlrev_b32 v104, 16, v120
    v_and_b32 v105, 0xffff0000, v120
    v_lshlrev_b32 v106, 16, v121
    v_and_b32 v107, 0xffff0000, v121
    v_lshlrev_b32 v108, 16, v122
    v_and_b32 v109, 0xffff0000, v122
    v_lshlrev_b32 v110, 16, v123
    v_and_b32 v111, 0xffff0000, v123
    v_lshlrev_b32 v112, 16, v124
    v_and_b32 v113, 0xffff0000, v124
    v_lshlrev_b32 v114, 16, v125
    v_and_b32 v115, 0xffff0000, v125
    v_pk_add_f32 v[104:105], v[104:105], v[112:113]
    v_pk_add_f32 v[106:107], v[106:107], v[114:115]
    v_lshlrev_b32 v116, 16, v126
    v_and_b32 v117, 0xffff0000, v126
    v_lshlrev_b32 v118, 16, v127
    v_and_b32 v119, 0xffff0000, v127
    v_pk_add_f32 v[108:109], v[108:109], v[116:117]
    v_pk_add_f32 v[110:111], v[110:111], v[118:119]
    v_lshlrev_b32 v112, 16, v128
    v_and_b32 v113, 0xffff0000, v128
    v_lshlrev_b32 v114, 16, v129
    v_and_b32 v115, 0xffff0000, v129
    v_pk_add_f32 v[104:105], v[104:105], v[112:113]
    v_pk_add_f32 v[106:107], v[106:107], v[114:115]
    v_lshlrev_b32 v116, 16, v130
    v_and_b32 v117, 0xffff0000, v130
    v_lshlrev_b32 v118, 16, v131
    v_and_b32 v119, 0xffff0000, v131
    v_pk_add_f32 v[108:109], v[108:109], v[116:117]
    v_pk_add_f32 v[110:111], v[110:111], v[118:119]
    v_lshlrev_b32 v112, 16, v132
    v_and_b32 v113, 0xffff0000, v132
    v_lshlrev_b32 v114, 16, v133
    v_and_b32 v115, 0xffff0000, v133
    v_pk_add_f32 v[104:105], v[104:105], v[112:113]
    v_pk_add_f32 v[106:107], v[106:107], v[114:115]
    v_lshlrev_b32 v116, 16, v134
    v_and_b32 v117, 0xffff0000, v134
    v_lshlrev_b32 v118, 16, v135
    v_and_b32 v119, 0xffff0000, v135
    v_pk_add_f32 v[108:109], v[108:109], v[116:117]
    v_pk_add_f32 v[110:111], v[110:111], v[118:119]
    v_pk_add_f32 v[104:105], v[104:105], v[108:109]
    v_pk_add_f32 v[106:107], v[106:107], v[110:111]
    v_cvt_pk_bf16_f32 v108, v104, v105
    v_cvt_pk_bf16_f32 v109, v106, v107
    s_nop 0
    v_min_u32 v108, -2, v108
    v_min_u32 v109, -2, v109
    buffer_store_dwordx2 v[108:109], v12, s[8:11], s63 offen

mega_kernel_c_b3:
    s_barrier
    s_branch mega_kernel_c_loop

mega_kernel_c_pD_s0:
    buffer_load_dwordx4 v[24:27], v7, s[8:11], s25 offen offset:0 sc1
    buffer_load_dwordx4 v[28:31], v7, s[8:11], s25 offen offset:1024 sc1
    buffer_load_dwordx4 v[32:35], v7, s[8:11], s25 offen offset:2048 sc1
    buffer_load_dwordx4 v[36:39], v7, s[8:11], s25 offen offset:3072 sc1
    s_sub_u32 s24, s24, 1
    s_movk_i32 s58, 16
    s_cbranch_scc1 mega_kernel_c_fail
    s_waitcnt vmcnt(0)
    v_max_u32 v4, v24, v26
    v_cmp_eq_u32 vcc, -1, v4
    s_cbranch_vccnz mega_kernel_c_pD_s0
    s_branch mega_kernel_c_pD_k0
mega_kernel_c_pD_s1:
    buffer_load_dwordx4 v[28:31], v7, s[8:11], s25 offen offset:1024 sc1
    buffer_load_dwordx4 v[32:35], v7, s[8:11], s25 offen offset:2048 sc1
    buffer_load_dwordx4 v[36:39], v7, s[8:11], s25 offen offset:3072 sc1
    s_sub_u32 s24, s24, 1
    s_movk_i32 s58, 17
    s_cbranch_scc1 mega_kernel_c_fail
    s_waitcnt vmcnt(0)
    v_max_u32 v4, v28, v30
    v_cmp_eq_u32 vcc, -1, v4
    s_cbranch_vccnz mega_kernel_c_pD_s1
    s_branch mega_kernel_c_pD_k1
mega_kernel_c_pD_s2:
    buffer_load_dwordx4 v[32:35], v7, s[8:11], s25 offen offset:2048 sc1
    buffer_load_dwordx4 v[36:39], v7, s[8:11], s25 offen offset:3072 sc1
    s_sub_u32 s24, s24, 1
    s_movk_i32 s58, 18
    s_cbranch_scc1 mega_kernel_c_fail
    s_waitcnt vmcnt(0)
    v_max_u32 v4, v32, v34
    v_cmp_eq_u32 vcc, -1, v4
    s_cbranch_vccnz mega_kernel_c_pD_s2
    s_branch mega_kernel_c_pD_k2
mega_kernel_c_pD_s3:
    buffer_load_dwordx4 v[36:39], v7, s[8:11], s25 offen offset:3072 sc1
    s_sub_u32 s24, s24, 1
    s_movk_i32 s58, 19
    s_cbranch_scc1 mega_kernel_c_fail
    s_waitcnt vmcnt(0)
    v_max_u32 v4, v36, v38
    v_cmp_eq_u32 vcc, -1, v4
    s_cbranch_vccnz mega_kernel_c_pD_s3
    s_branch mega_kernel_c_pD_k3
mega_kernel_c_pA_s0:
    buffer_load_dwordx4 v[136:139], v8, s[8:11], s26 offen offset:0 sc1
    buffer_load_dwordx4 v[140:143], v8, s[8:11], s26 offen offset:1024 sc1
    buffer_load_dwordx4 v[144:147], v8, s[8:11], s26 offen offset:2048 sc1
    buffer_load_dwordx4 v[148:151], v8, s[8:11], s26 offen offset:3072 sc1
    s_sub_u32 s24, s24, 1
    s_movk_i32 s58, 32
    s_cbranch_scc1 mega_kernel_c_fail
    s_waitcnt vmcnt(0)
    v_max3_u32 v4, v136, v138, v140
    v_max3_u32 v4, v4, v142, v144
    v_max3_u32 v4, v4, v146, v148
    v_max_u32 v4, v4, v150
    v_cmp_eq_u32 vcc, -1, v4
    s_cbranch_vccnz mega_kernel_c_pA_s0
    s_branch mega_kernel_c_pA_k0
mega_kernel_c_pV_s0:
    buffer_load_dwordx2 v[152:153], v9, s[8:11], s26 offen offset:0 sc1
    buffer_load_dwordx2 v[154:155], v9, s[8:11], s26 offen offset:512 sc1
    buffer_load_dwordx2 v[156:157], v9, s[8:11], s26 offen offset:1024 sc1
    buffer_load_dwordx2 v[158:159], v9, s[8:11], s26 offen offset:1536 sc1
    s_sub_u32 s24, s24, 1
    s_movk_i32 s58, 48
    s_cbranch_scc1 mega_kernel_c_fail
    s_waitcnt vmcnt(0)
    v_max3_u32 v4, v152, v154, v156
    v_max_u32 v4, v4, v158
    v_cmp_eq_u32 vcc, -1, v4
    s_cbranch_vccnz mega_kernel_c_pV_s0
    s_branch mega_kernel_c_pV_k0
mega_kernel_c_pC_s0:
    buffer_load_dwordx2 v[120:121], v11, s[8:11], s27 offen offset:0 sc1
    buffer_load_dwordx2 v[122:123], v11, s[8:11], s27 offen offset:2048 sc1
    buffer_load_dwordx2 v[124:125], v11, s[8:11], s59 offen offset:0 sc1
    buffer_load_dwordx2 v[126:127], v11, s[8:11], s59 offen offset:2048 sc1
    buffer_load_dwordx2 v[128:129], v11, s[8:11], s60 offen offset:0 sc1
    buffer_load_dwordx2 v[130:131], v11, s[8:11], s60 offen offset:2048 sc1
    buffer_load_dwordx2 v[132:133], v11, s[8:11], s61 offen offset:0 sc1
    buffer_load_dwordx2 v[134:135], v11, s[8:11], s61 offen offset:2048 sc1
    s_sub_u32 s24, s24, 1
    s_movk_i32 s58, 64
    s_cbranch_scc1 mega_kernel_c_fail
    s_waitcnt vmcnt(0)
    v_max3_u32 v4, v120, v122, v124
    v_max3_u32 v4, v4, v126, v128
    v_max3_u32 v4, v4, v130, v132
    v_max_u32 v4, v4, v134
    v_cmp_eq_u32 vcc, -1, v4
    s_cbranch_vccnz mega_kernel_c_pC_s0
    s_branch mega_kernel_c_pC_k0
mega_kernel_c_last:
mega_kernel_c_lastspin:
    buffer_load_dwordx2 v[152:153], v9, s[8:11], s26 offen offset:0 sc1
    buffer_load_dwordx2 v[154:155], v9, s[8:11], s26 offen offset:512 sc1
    buffer_load_dwordx2 v[156:157], v9, s[8:11], s26 offen offset:1024 sc1
    buffer_load_dwordx2 v[158:159], v9, s[8:11], s26 offen offset:1536 sc1
    s_waitcnt vmcnt(0)
    v_max3_u32 v4, v152, v154, v156
    v_max_u32 v4, v4, v158
    v_cmp_eq_u32 vcc, -1, v4
    s_cbranch_vccz mega_kernel_c_lastok
    s_sub_u32 s24, s24, 1
    s_cbranch_scc1 mega_kernel_c_exit
    s_branch mega_kernel_c_lastspin
mega_kernel_c_lastok:
    s_sub_u32 s32, s23, 1
    s_and_b32 s33, s32, 15
    s_cmp_lg_u32 s33, s21
    s_cbranch_scc1 mega_kernel_c_nopubL
    s_cmp_eq_u32 s23, 0
    s_cbranch_scc1 mega_kernel_c_nopubL
    s_lshl_b32 s32, s32, 6
    s_add_u32 s32, s32, s96
    v_mov_b32 v5, 1
    s_mov_b64 exec, 1
    buffer_atomic_add v5, v248, s[8:11], s32 offen
    s_mov_b64 exec, -1
mega_kernel_c_nopubL:

    s_and_b32 s32, s23, 15
    s_cmp_lg_u32 s32, s21
    s_cbranch_scc1 mega_kernel_c_nokvm2
    s_lshl_b32 s32, s23, 17
    s_add_u32 s32, s32, s37
    s_add_u32 s33, s32, 2048
    v_lshlrev_b32 v5, 3, v1
    buffer_store_dwordx4 v[144:147], v13, s[8:11], s32 offen offset:0 sc1
    buffer_store_dwordx4 v[148:151], v13, s[8:11], s32 offen offset:1024 sc1
    buffer_store_dwordx2 v[152:153], v5, s[8:11], s33 offen offset:0 sc1
    buffer_store_dwordx2 v[154:155], v5, s[8:11], s33 offen offset:512 sc1
    buffer_store_dwordx2 v[156:157], v5, s[8:11], s33 offen offset:1024 sc1
    buffer_store_dwordx2 v[158:159], v5, s[8:11], s33 offen offset:1536 sc1
mega_kernel_c_nokvm2:

    s_and_b32 s32, s23, 15
    s_cmp_lg_u32 s32, s21
    s_cbranch_scc1 mega_kernel_c_done
    s_waitcnt vmcnt(0)
    s_lshl_b32 s32, s23, 6
    s_add_u32 s32, s32, s96
    v_mov_b32 v5, 1
    s_mov_b64 exec, 1
    buffer_atomic_add v5, v248, s[8:11], s32 offen
    s_mov_b64 exec, -1

mega_kernel_c_done:
    s_branch mega_kernel_post
mega_kernel_c_exit:
    s_endpgm
mega_kernel_c_fail:
    s_lshl_b32 s32, s20, 4
    s_add_u32 s32, s32, s21
    s_lshl_b32 s32, s32, 2
    s_add_u32 s32, s32, s22
    s_lshl_b32 s32, s32, 2
    s_add_u32 s32, s32, 98009088
    s_lshl_b32 s33, s23, 8
    s_or_b32 s33, s33, s58
    s_or_b32 s33, s33, 0x10000
    v_mov_b32 v4, s33
    v_mov_b32 v5, 0
    buffer_store_dword v4, v5, s[8:11], s32 offen
    s_endpgm

mega_kernel_f_loop:
    s_mov_b32 s25, s63
    buffer_load_dwordx4 v[24:27], v7, s[8:11], s25 offen offset:0 sc1
    buffer_load_dwordx4 v[28:31], v7, s[8:11], s25 offen offset:1024 sc1
    buffer_load_dwordx4 v[32:35], v7, s[8:11], s25 offen offset:2048 sc1
    buffer_load_dwordx4 v[36:39], v7, s[8:11], s25 offen offset:3072 sc1
mega_kernel_f_p1:
    s_and_b32 s32, s23, 3
    s_mul_i32 s32, s32, 196608
    s_add_u32 s26, s32, s88
    s_add_u32 s32, s23, 3
    s_and_b32 s32, s32, 3
    s_mul_i32 s34, s32, 196608
    s_add_u32 s34, s34, s88
    s_lshl_b32 s35, s32, 17
    s_add_u32 s35, s35, s89
    s_add_u32 s32, s23, 2
    s_and_b32 s32, s32, 3
    s_lshl_b32 s36, s32, 18
    s_add_u32 s36, s36, s91
    s_and_b32 s32, s23, 3
    s_lshl_b32 s32, s32, 18
    s_add_u32 s27, s32, s90
    s_add_u32 s62, s32, s91
    s_add_u32 s59, s27, 4096
    s_add_u32 s60, s27, 8192
    s_add_u32 s61, s27, 12288
    s_add_u32 s32, s23, 1
    s_and_b32 s32, s32, 3
    s_lshl_b32 s32, s32, 17
    s_add_u32 s63, s32, s89
    v_mov_b32 v228, 0xff800000
    v_mov_b32 v229, 0xff800000
    v_mov_b32 v230, 0xff800000
    v_mov_b32 v231, 0xff800000
    v_mov_b32 v242, 0
    v_mov_b32 v243, 0
    s_waitcnt vmcnt(3)
    v_max_u32 v4, v24, v26
    v_cmp_eq_u32 vcc, -1, v4
    s_cbranch_vccnz mega_kernel_f_pD_s0
mega_kernel_f_pD_k0:
    v_mfma_f32_16x16x32_bf16 v[56:59], a[0:3], v[24:27], 0
    v_mov_b32_dpp v40, v24 row_ror:8 row_mask:0xf bank_mask:0xf
    v_mfma_f32_16x16x32_bf16 v[60:63], a[36:39], v[24:27], 0
    v_mov_b32_dpp v41, v25 row_ror:8 row_mask:0xf bank_mask:0xf
    v_mfma_f32_16x16x32_bf16 v[64:67], a[64:67], v[24:27], 0
    v_mov_b32_dpp v42, v26 row_ror:8 row_mask:0xf bank_mask:0xf
    v_mfma_f32_16x16x32_bf16 v[68:71], a[100:103], v[24:27], 0
    v_mov_b32_dpp v43, v27 row_ror:8 row_mask:0xf bank_mask:0xf
    s_nop 1
    v_mfma_f32_16x16x32_bf16 v[56:59], a[4:7], v[40:43], v[56:59]
    v_mfma_f32_16x16x32_bf16 v[60:63], a[32:35], v[40:43], v[60:63]
    v_mfma_f32_16x16x32_bf16 v[64:67], a[68:71], v[40:43], v[64:67]
    v_mfma_f32_16x16x32_bf16 v[68:71], a[96:99], v[40:43], v[68:71]
    s_waitcnt vmcnt(2)
    v_max_u32 v4, v28, v30
    v_cmp_eq_u32 vcc, -1, v4
    s_cbranch_vccnz mega_kernel_f_pD_s1
mega_kernel_f_pD_k1:
    v_mfma_f32_16x16x32_bf16 v[56:59], a[8:11], v[28:31], v[56:59]
    v_mov_b32_dpp v44, v28 row_ror:8 row_mask:0xf bank_mask:0xf
    v_mfma_f32_16x16x32_bf16 v[60:63], a[44:47], v[28:31], v[60:63]
    v_mov_b32_dpp v45, v29 row_ror:8 row_mask:0xf bank_mask:0xf
    v_mfma_f32_16x16x32_bf16 v[64:67], a[72:75], v[28:31], v[64:67]
    v_mov_b32_dpp v46, v30 row_ror:8 row_mask:0xf bank_mask:0xf
    v_mfma_f32_16x16x32_bf16 v[68:71], a[108:111], v[28:31], v[68:71]
    v_mov_b32_dpp v47, v31 row_ror:8 row_mask:0xf bank_mask:0xf
    s_nop 1
    v_mfma_f32_16x16x32_bf16 v[56:59], a[12:15], v[44:47], v[56:59]
    v_mfma_f32_16x16x32_bf16 v[60:63], a[40:43], v[44:47], v[60:63]
    v_mfma_f32_16x16x32_bf16 v[64:67], a[76:79], v[44:47], v[64:67]
    v_mfma_f32_16x16x32_bf16 v[68:71], a[104:107], v[44:47], v[68:71]
    s_waitcnt vmcnt(1)
    v_max_u32 v4, v32, v34
    v_cmp_eq_u32 vcc, -1, v4
    s_cbranch_vccnz mega_kernel_f_pD_s2
mega_kernel_f_pD_k2:
    v_mfma_f32_16x16x32_bf16 v[56:59], a[16:19], v[32:35], v[56:59]
    v_mov_b32_dpp v48, v32 row_ror:8 row_mask:0xf bank_mask:0xf
    v_mfma_f32_16x16x32_bf16 v[60:63], a[52:55], v[32:35], v[60:63]
    v_mov_b32_dpp v49, v33 row_ror:8 row_mask:0xf bank_mask:0xf
    v_mfma_f32_16x16x32_bf16 v[64:67], a[80:83], v[32:35], v[64:67]
    v_mov_b32_dpp v50, v34 row_ror:8 row_mask:0xf bank_mask:0xf
    v_mfma_f32_16x16x32_bf16 v[68:71], a[116:119], v[32:35], v[68:71]
    v_mov_b32_dpp v51, v35 row_ror:8 row_mask:0xf bank_mask:0xf
    s_nop 1
    v_mfma_f32_16x16x32_bf16 v[56:59], a[20:23], v[48:51], v[56:59]
    v_mfma_f32_16x16x32_bf16 v[60:63], a[48:51], v[48:51], v[60:63]
    v_mfma_f32_16x16x32_bf16 v[64:67], a[84:87], v[48:51], v[64:67]
    v_mfma_f32_16x16x32_bf16 v[68:71], a[112:115], v[48:51], v[68:71]
    s_waitcnt vmcnt(0)
    v_max_u32 v4, v36, v38
    v_cmp_eq_u32 vcc, -1, v4
    s_cbranch_vccnz mega_kernel_f_pD_s3
mega_kernel_f_pD_k3:
    v_mfma_f32_16x16x32_bf16 v[56:59], a[24:27], v[36:39], v[56:59]
    v_mov_b32_dpp v52, v36 row_ror:8 row_mask:0xf bank_mask:0xf
    v_mfma_f32_16x16x32_bf16 v[60:63], a[60:63], v[36:39], v[60:63]
    v_mov_b32_dpp v53, v37 row_ror:8 row_mask:0xf bank_mask:0xf
    v_mfma_f32_16x16x32_bf16 v[64:67], a[88:91], v[36:39], v[64:67]
    v_mov_b32_dpp v54, v38 row_ror:8 row_mask:0xf bank_mask:0xf
    v_mfma_f32_16x16x32_bf16 v[68:71], a[124:127], v[36:39], v[68:71]
    v_mov_b32_dpp v55, v39 row_ror:8 row_mask:0xf bank_mask:0xf
    s_nop 1
    v_mfma_f32_16x16x32_bf16 v[56:59], a[28:31], v[52:55], v[56:59]
    v_mfma_f32_16x16x32_bf16 v[60:63], a[56:59], v[52:55], v[60:63]
    v_mfma_f32_16x16x32_bf16 v[64:67], a[92:95], v[52:55], v[64:67]
    v_mfma_f32_16x16x32_bf16 v[68:71], a[120:123], v[52:55], v[68:71]
    v_mfma_f32_16x16x32_bf16 v[72:75], v[24:27], a[128:131], 0
    v_mfma_f32_16x16x32_bf16 v[76:79], v[24:27], a[164:167], 0
    s_nop 3
    v_mov_b32_dpp v56, v60 quad_perm:[0,1,2,3] row_mask:0xf bank_mask:0xc
    v_mov_b32_dpp v57, v61 quad_perm:[0,1,2,3] row_mask:0xf bank_mask:0xc
    v_mov_b32_dpp v58, v62 quad_perm:[0,1,2,3] row_mask:0xf bank_mask:0xc
    v_mov_b32_dpp v59, v63 quad_perm:[0,1,2,3] row_mask:0xf bank_mask:0xc
    v_mov_b32_dpp v64, v68 quad_perm:[0,1,2,3] row_mask:0xf bank_mask:0xc
    v_mov_b32_dpp v65, v69 quad_perm:[0,1,2,3] row_mask:0xf bank_mask:0xc
    v_mov_b32_dpp v66, v70 quad_perm:[0,1,2,3] row_mask:0xf bank_mask:0xc
    v_mov_b32_dpp v67, v71 quad_perm:[0,1,2,3] row_mask:0xf bank_mask:0xc
    ds_write_b128 v14, v[56:59] offset:0
    ds_write_b128 v14, v[64:67] offset:1024
    v_mfma_f32_16x16x32_bf16 v[72:75], v[40:43], a[132:135], v[72:75]
    v_mfma_f32_16x16x32_bf16 v[76:79], v[40:43], a[160:163], v[76:79]
    s_waitcnt lgkmcnt(0)
    s_barrier
    s_cmp_ge_u32 s22, 2
    s_cbranch_scc1 mega_kernel_f_skipA

    ds_read_b128 v[104:107], v15 offset:0
    ds_read_b128 v[108:111], v15 offset:3072
    ds_read_b128 v[112:115], v15 offset:6144
    ds_read_b128 v[116:119], v15 offset:9216
    v_mfma_f32_16x16x32_bf16 v[72:75], v[28:31], a[136:139], v[72:75]
    v_mfma_f32_16x16x32_bf16 v[76:79], v[28:31], a[172:175], v[76:79]
    v_mfma_f32_16x16x32_bf16 v[72:75], v[44:47], a[140:143], v[72:75]
    v_mfma_f32_16x16x32_bf16 v[76:79], v[44:47], a[168:171], v[76:79]
    s_waitcnt lgkmcnt(0)
    v_add_f32 v104, v104, v108
    v_add_f32 v112, v112, v116
    v_add_f32 v105, v105, v109
    v_add_f32 v113, v113, v117
    v_add_f32 v106, v106, v110
    v_add_f32 v114, v114, v118
    v_add_f32 v107, v107, v111
    v_add_f32 v115, v115, v119
    v_add_f32 v104, v104, v112
    v_add_f32 v105, v105, v113
    v_add_f32 v106, v106, v114
    v_add_f32 v107, v107, v115
    v_cvt_pk_bf16_f32 v108, v104, v105
    v_cvt_pk_bf16_f32 v109, v106, v107
    s_nop 0
    v_min_u32 v108, -2, v108
    v_min_u32 v109, -2, v109
    buffer_store_dwordx2 v[108:109], v10, s[8:11], s26 offen sc1

    v_mfma_f32_16x16x32_bf16 v[72:75], v[32:35], a[144:147], v[72:75]
    buffer_load_dwordx4 v[192:195], v13, s[8:11], s30 offen offset:0 sc1
    v_mfma_f32_16x16x32_bf16 v[76:79], v[32:35], a[180:183], v[76:79]
    buffer_load_dwordx4 v[196:199], v13, s[8:11], s30 offen offset:1024 sc1
    v_mfma_f32_16x16x32_bf16 v[72:75], v[48:51], a[148:151], v[72:75]
    buffer_load_dwordx4 v[200:203], v13, s[8:11], s30 offen offset:2048 sc1
    v_mfma_f32_16x16x32_bf16 v[76:79], v[48:51], a[176:179], v[76:79]
    buffer_load_dwordx4 v[204:207], v13, s[8:11], s30 offen offset:3072 sc1
    v_mfma_f32_16x16x32_bf16 v[72:75], v[36:39], a[152:155], v[72:75]
    buffer_load_dwordx4 v[208:211], v13, s[8:11], s31 offen offset:0 sc1
    v_mfma_f32_16x16x32_bf16 v[76:79], v[36:39], a[188:191], v[76:79]
    buffer_load_dwordx4 v[212:215], v13, s[8:11], s31 offen offset:1024 sc1
    v_mfma_f32_16x16x32_bf16 v[72:75], v[52:55], a[156:159], v[72:75]
    buffer_load_dwordx4 v[216:219], v13, s[8:11], s31 offen offset:2048 sc1
    v_mfma_f32_16x16x32_bf16 v[76:79], v[52:55], a[184:187], v[76:79]
    buffer_load_dwordx4 v[220:223], v13, s[8:11], s31 offen offset:3072 sc1
    s_branch mega_kernel_f_vdone
mega_kernel_f_skipA:
    v_mfma_f32_16x16x32_bf16 v[72:75], v[28:31], a[136:139], v[72:75]
    buffer_load_dwordx4 v[192:195], v13, s[8:11], s30 offen offset:0 sc1
    v_mfma_f32_16x16x32_bf16 v[76:79], v[28:31], a[172:175], v[76:79]
    buffer_load_dwordx4 v[196:199], v13, s[8:11], s30 offen offset:1024 sc1
    v_mfma_f32_16x16x32_bf16 v[72:75], v[44:47], a[140:143], v[72:75]
    buffer_load_dwordx4 v[200:203], v13, s[8:11], s30 offen offset:2048 sc1
    v_mfma_f32_16x16x32_bf16 v[76:79], v[44:47], a[168:171], v[76:79]
    buffer_load_dwordx4 v[204:207], v13, s[8:11], s30 offen offset:3072 sc1
    v_mfma_f32_16x16x32_bf16 v[72:75], v[32:35], a[144:147], v[72:75]
    buffer_load_dwordx4 v[208:211], v13, s[8:11], s31 offen offset:0 sc1
    v_mfma_f32_16x16x32_bf16 v[76:79], v[32:35], a[180:183], v[76:79]
    buffer_load_dwordx4 v[212:215], v13, s[8:11], s31 offen offset:1024 sc1
    v_mfma_f32_16x16x32_bf16 v[72:75], v[48:51], a[148:151], v[72:75]
    buffer_load_dwordx4 v[216:219], v13, s[8:11], s31 offen offset:2048 sc1
    v_mfma_f32_16x16x32_bf16 v[76:79], v[48:51], a[176:179], v[76:79]
    buffer_load_dwordx4 v[220:223], v13, s[8:11], s31 offen offset:3072 sc1
    v_mfma_f32_16x16x32_bf16 v[72:75], v[36:39], a[152:155], v[72:75]
    v_mfma_f32_16x16x32_bf16 v[76:79], v[36:39], a[188:191], v[76:79]
    v_mfma_f32_16x16x32_bf16 v[72:75], v[52:55], a[156:159], v[72:75]
    v_mfma_f32_16x16x32_bf16 v[76:79], v[52:55], a[184:187], v[76:79]
mega_kernel_f_vdone:
    s_nop 7
    v_mov_b32_dpp v72, v76 quad_perm:[0,1,2,3] row_mask:0xc bank_mask:0xf
    v_mov_b32_dpp v73, v77 quad_perm:[0,1,2,3] row_mask:0xc bank_mask:0xf
    v_mov_b32_dpp v74, v78 quad_perm:[0,1,2,3] row_mask:0xc bank_mask:0xf
    v_mov_b32_dpp v75, v79 quad_perm:[0,1,2,3] row_mask:0xc bank_mask:0xf
    ds_write_b128 v14, v[72:75] offset:2048
    buffer_load_dwordx4 v[136:139], v8, s[8:11], s26 offen offset:0 sc1
    buffer_load_dwordx4 v[140:143], v8, s[8:11], s26 offen offset:1024 sc1
    buffer_load_dwordx4 v[144:147], v8, s[8:11], s26 offen offset:2048 sc1
    buffer_load_dwordx4 v[148:151], v8, s[8:11], s26 offen offset:3072 sc1
    s_waitcnt lgkmcnt(0)
    s_barrier
    s_cmp_lg_u32 s22, 2
    s_cbranch_scc1 mega_kernel_f_skipV

    ds_read_b128 v[104:107], v15 offset:0
    ds_read_b128 v[108:111], v15 offset:3072
    ds_read_b128 v[112:115], v15 offset:6144
    ds_read_b128 v[116:119], v15 offset:9216
    s_waitcnt lgkmcnt(0)
    v_add_f32 v104, v104, v108
    v_add_f32 v112, v112, v116
    v_add_f32 v105, v105, v109
    v_add_f32 v113, v113, v117
    v_add_f32 v106, v106, v110
    v_add_f32 v114, v114, v118
    v_add_f32 v107, v107, v111
    v_add_f32 v115, v115, v119
    v_add_f32 v104, v104, v112
    v_add_f32 v105, v105, v113
    v_add_f32 v106, v106, v114
    v_add_f32 v107, v107, v115
    v_cvt_pk_bf16_f32 v108, v104, v105
    v_cvt_pk_bf16_f32 v109, v106, v107
    s_nop 0
    v_min_u32 v108, -2, v108
    v_min_u32 v109, -2, v109
    buffer_store_dwordx2 v[108:109], v10, s[8:11], s26 offen sc1
    s_waitcnt vmcnt(1)
    s_branch mega_kernel_f_skipV2
mega_kernel_f_skipV:
    s_waitcnt vmcnt(0)
mega_kernel_f_skipV2:

    v_max3_u32 v4, v136, v138, v140
    v_max3_u32 v4, v4, v142, v144
    v_max3_u32 v4, v4, v146, v148
    v_max_u32 v4, v4, v150
    v_cmp_eq_u32 vcc, -1, v4
    s_cbranch_vccnz mega_kernel_f_pA_s0
mega_kernel_f_pA_k0:
mega_kernel_f_kvchka:
    v_readfirstlane_b32 s32, v247
    s_cmp_ge_u32 s32, 8
    s_cbranch_scc1 mega_kernel_f_kvoka
    s_add_u32 s32, s23, 1
    s_lshr_b32 s32, s32, 2
    s_lshl_b32 s32, s32, 7
    s_add_u32 s32, s32, s95
    buffer_load_dword v247, v248, s[8:11], s32 offen sc1
    s_sub_u32 s24, s24, 1
    s_cbranch_scc1 mega_kernel_f_exit
    s_waitcnt vmcnt(0)
    s_branch mega_kernel_f_kvchka
mega_kernel_f_kvoka:

    buffer_load_dwordx2 v[152:153], v9, s[8:11], s26 offen offset:0 sc1
    buffer_load_dwordx2 v[154:155], v9, s[8:11], s26 offen offset:512 sc1
    buffer_load_dwordx2 v[156:157], v9, s[8:11], s26 offen offset:1024 sc1
    buffer_load_dwordx2 v[158:159], v9, s[8:11], s26 offen offset:1536 sc1
    s_add_u32 s32, s23, 2
    s_lshr_b32 s32, s32, 2
    s_min_u32 s32, s32, 15
    s_lshl_b32 s32, s32, 7
    s_add_u32 s32, s32, s95
    buffer_load_dword v247, v248, s[8:11], s32 offen sc1

    s_cmp_eq_u32 s23, 63
    s_cbranch_scc1 mega_kernel_f_last

    v_mfma_f32_16x16x32_bf16 v[224:227], v[144:147], v[136:139], 0
    v_mov_b32_dpp v40, v136 row_ror:8 row_mask:0xf bank_mask:0xf
    v_mfma_f32_16x16x32_bf16 v[224:227], v[148:151], v[140:143], v[224:227]
    v_mov_b32_dpp v41, v137 row_ror:8 row_mask:0xf bank_mask:0xf
    v_mfma_f32_16x16x32_bf16 v[104:107], v[160:163], v[136:139], 0
    v_mov_b32_dpp v42, v138 row_ror:8 row_mask:0xf bank_mask:0xf
    v_mfma_f32_16x16x32_bf16 v[108:111], v[180:183], v[136:139], 0
    v_mov_b32_dpp v43, v139 row_ror:8 row_mask:0xf bank_mask:0xf
    v_mfma_f32_16x16x32_bf16 v[104:107], v[168:171], v[140:143], v[104:107]
    v_mov_b32_dpp v44, v140 row_ror:8 row_mask:0xf bank_mask:0xf
    v_mfma_f32_16x16x32_bf16 v[108:111], v[188:191], v[140:143], v[108:111]
    v_mov_b32_dpp v45, v141 row_ror:8 row_mask:0xf bank_mask:0xf
    v_mov_b32_dpp v46, v142 row_ror:8 row_mask:0xf bank_mask:0xf
    v_mov_b32_dpp v47, v143 row_ror:8 row_mask:0xf bank_mask:0xf
    s_nop 0
    v_mfma_f32_16x16x32_bf16 v[104:107], v[164:167], v[40:43], v[104:107]
    v_permlane32_swap_b32 v224, v232
    v_mfma_f32_16x16x32_bf16 v[108:111], v[176:179], v[40:43], v[108:111]
    v_permlane32_swap_b32 v225, v233
    v_mfma_f32_16x16x32_bf16 v[104:107], v[172:175], v[44:47], v[104:107]
    v_permlane32_swap_b32 v226, v234
    v_mfma_f32_16x16x32_bf16 v[108:111], v[184:187], v[44:47], v[108:111]
    v_permlane32_swap_b32 v227, v235
    s_add_u32 s28, s28, 262144
    s_add_u32 s29, s29, 262144
    s_add_u32 s30, s30, 262144
    s_add_u32 s31, s31, 262144

    v_add_f32_dpp v228, v232, v224 row_ror:8 row_mask:0x3 bank_mask:0x3
    v_add_f32_dpp v229, v233, v225 row_ror:8 row_mask:0x3 bank_mask:0x3
    v_add_f32_dpp v230, v234, v226 row_ror:8 row_mask:0x3 bank_mask:0x3
    v_add_f32_dpp v231, v235, v227 row_ror:8 row_mask:0x3 bank_mask:0x3
    v_max3_f32 v249, v228, v229, v230
    v_max_f32 v249, v249, v231
    s_nop 1

    v_mov_b32_dpp v104, v108 quad_perm:[0,1,2,3] row_mask:0xf bank_mask:0xc
    v_mov_b32_dpp v105, v109 quad_perm:[0,1,2,3] row_mask:0xf bank_mask:0xc
    v_mov_b32_dpp v106, v110 quad_perm:[0,1,2,3] row_mask:0xf bank_mask:0xc
    v_mov_b32_dpp v107, v111 quad_perm:[0,1,2,3] row_mask:0xf bank_mask:0xc
    v_max3_f32 v249, v249, v104, v105
    v_max3_f32 v249, v249, v106, v107
    s_nop 1
    v_max_f32_dpp v250, v249, v249 row_ror:8 row_mask:0xf bank_mask:0xf
    v_max_f32_dpp v249, v249, v249 row_ror:8 row_mask:0xf bank_mask:0xf
    s_nop 1
    v_permlane16_swap_b32 v249, v250
    s_nop 0
    v_max_f32 v252, v249, v250
    v_max_f32 v249, v249, v250
    s_nop 1
    v_permlane32_swap_b32 v249, v252
    s_nop 0
    v_max_f32 v249, v249, v252
    v_mul_f32 v249, s38, v249

    v_fma_f32 v104, v104, s38, -v249
    v_fma_f32 v105, v105, s38, -v249
    v_fma_f32 v106, v106, s38, -v249
    v_fma_f32 v107, v107, s38, -v249
    v_exp_f32 v104, v104
    v_exp_f32 v105, v105
    v_exp_f32 v106, v106
    v_exp_f32 v107, v107
    v_fma_f32 v228, v228, s38, -v249
    v_fma_f32 v229, v229, s38, -v249
    v_fma_f32 v230, v230, s38, -v249
    v_fma_f32 v231, v231, s38, -v249
    v_cvt_pk_bf16_f32 v236, v104, v105
    v_cvt_pk_bf16_f32 v237, v106, v107
    v_exp_f32 v228, v228
    v_exp_f32 v229, v229
    v_mov_b32_dpp v238, v236 row_ror:8 row_mask:0xf bank_mask:0xf
    v_mov_b32_dpp v239, v237 row_ror:8 row_mask:0xf bank_mask:0xf
    v_exp_f32 v230, v230
    v_exp_f32 v231, v231

    v_mfma_f32_16x16x32_bf16 v[56:59], v[192:195], v[236:239], 0
    v_cvt_pk_bf16_f32 v240, v228, v229
    v_cvt_pk_bf16_f32 v244, v228, v229
    v_mfma_f32_16x16x32_bf16 v[60:63], v[196:199], v[236:239], 0
    v_cvt_pk_bf16_f32 v241, v230, v231
    v_cvt_pk_bf16_f32 v245, v230, v231
    v_mfma_f32_16x16x32_bf16 v[64:67], v[200:203], v[236:239], 0
    v_add_f32 v251, v104, v105
    v_permlane32_swap_b32 v242, v244
    v_mfma_f32_16x16x32_bf16 v[68:71], v[204:207], v[236:239], 0
    v_add_f32 v252, v106, v107
    v_permlane32_swap_b32 v243, v245
    s_waitcnt vmcnt(1)
    v_max3_u32 v4, v152, v154, v156
    v_max_u32 v4, v4, v158
    v_cmp_eq_u32 vcc, -1, v4
    s_cbranch_vccnz mega_kernel_f_pV_s0
mega_kernel_f_pV_k0:
    v_mfma_f32_16x16x16_bf16 v[56:59], v[152:153], v[240:241], v[56:59]
    v_add_f32 v250, v228, v229
    v_mfma_f32_16x16x16_bf16 v[60:63], v[152:153], v[242:243], v[60:63]
    v_add_f32 v251, v251, v252
    v_mfma_f32_16x16x16_bf16 v[64:67], v[154:155], v[240:241], v[64:67]
    v_add_f32 v252, v230, v231
    v_mfma_f32_16x16x16_bf16 v[68:71], v[154:155], v[242:243], v[68:71]
    v_add_f32 v251, v251, v250
    v_mfma_f32_16x16x32_bf16 v[72:75], v[208:211], v[236:239], 0
    v_add_f32 v251, v251, v252
    v_mfma_f32_16x16x32_bf16 v[76:79], v[212:215], v[236:239], 0
    buffer_load_dwordx4 v[160:163], v13, s[8:11], s28 offen offset:0 sc1
    v_mfma_f32_16x16x16_bf16 v[72:75], v[156:157], v[240:241], v[72:75]
    v_add_f32_dpp v250, v251, v251 row_ror:8 row_mask:0xf bank_mask:0xf
    v_mfma_f32_16x16x16_bf16 v[76:79], v[156:157], v[242:243], v[76:79]
    v_add_f32_dpp v251, v251, v251 row_ror:8 row_mask:0xf bank_mask:0xf
    v_mfma_f32_16x16x32_bf16 v[80:83], v[216:219], v[236:239], 0
    v_cvt_pk_bf16_f32 v24, v56, v57
    v_cvt_pk_bf16_f32 v25, v58, v59
    v_mfma_f32_16x16x32_bf16 v[84:87], v[220:223], v[236:239], 0
    v_cvt_pk_bf16_f32 v26, v60, v61
    v_cvt_pk_bf16_f32 v27, v62, v63
    v_mfma_f32_16x16x16_bf16 v[80:83], v[158:159], v[240:241], v[80:83]
    v_permlane16_swap_b32 v251, v250
    buffer_load_dwordx4 v[164:167], v13, s[8:11], s28 offen offset:1024 sc1
    v_mfma_f32_16x16x16_bf16 v[84:87], v[158:159], v[242:243], v[84:87]
    v_cvt_pk_bf16_f32 v28, v64, v65
    v_cvt_pk_bf16_f32 v29, v66, v67
    v_mfma_f32_16x16x32_bf16 v[88:91], a[192:195], v[24:27], 0
    v_cvt_pk_bf16_f32 v30, v68, v69
    v_cvt_pk_bf16_f32 v31, v70, v71
    v_mfma_f32_16x16x32_bf16 v[92:95], a[208:211], v[24:27], 0
    v_add_f32 v252, v251, v250
    buffer_load_dwordx4 v[168:171], v13, s[8:11], s28 offen offset:2048 sc1
    v_mfma_f32_16x16x32_bf16 v[96:99], a[224:227], v[24:27], 0
    v_add_f32 v251, v251, v250
    buffer_load_dwordx4 v[172:175], v13, s[8:11], s28 offen offset:3072 sc1
    v_mfma_f32_16x16x32_bf16 v[100:103], a[240:243], v[24:27], 0
    buffer_load_dwordx4 v[176:179], v13, s[8:11], s29 offen offset:0 sc1
    v_mfma_f32_16x16x32_bf16 v[88:91], a[196:199], v[28:31], v[88:91]
    v_cvt_pk_bf16_f32 v32, v72, v73
    v_cvt_pk_bf16_f32 v33, v74, v75
    v_mfma_f32_16x16x32_bf16 v[92:95], a[212:215], v[28:31], v[92:95]
    v_cvt_pk_bf16_f32 v34, v76, v77
    v_cvt_pk_bf16_f32 v35, v78, v79
    v_mfma_f32_16x16x32_bf16 v[96:99], a[228:231], v[28:31], v[96:99]
    v_permlane32_swap_b32 v251, v252
    buffer_load_dwordx4 v[180:183], v13, s[8:11], s29 offen offset:1024 sc1
    v_mfma_f32_16x16x32_bf16 v[100:103], a[244:247], v[28:31], v[100:103]
    v_cvt_pk_bf16_f32 v36, v80, v81
    v_cvt_pk_bf16_f32 v37, v82, v83
    v_mfma_f32_16x16x32_bf16 v[88:91], a[200:203], v[32:35], v[88:91]
    v_cvt_pk_bf16_f32 v38, v84, v85
    v_cvt_pk_bf16_f32 v39, v86, v87
    v_mfma_f32_16x16x32_bf16 v[92:95], a[216:219], v[32:35], v[92:95]
    v_add_f32 v251, v251, v252
    buffer_load_dwordx4 v[184:187], v13, s[8:11], s29 offen offset:2048 sc1
    v_mfma_f32_16x16x32_bf16 v[96:99], a[232:235], v[32:35], v[96:99]
    buffer_load_dwordx4 v[188:191], v13, s[8:11], s29 offen offset:3072 sc1
    v_mfma_f32_16x16x32_bf16 v[100:103], a[248:251], v[32:35], v[100:103]
    v_rcp_f32 v251, v251
    v_mfma_f32_16x16x32_bf16 v[88:91], a[204:207], v[36:39], v[88:91]
    v_mfma_f32_16x16x32_bf16 v[92:95], a[220:223], v[36:39], v[92:95]
    v_mfma_f32_16x16x32_bf16 v[96:99], a[236:239], v[36:39], v[96:99]
    v_mfma_f32_16x16x32_bf16 v[100:103], a[252:255], v[36:39], v[100:103]
    s_cmp_eq_u32 s22, 3
    s_cbranch_scc1 mega_kernel_f_rs3
    buffer_store_dwordx2 v[20:21], v10, s[8:11], s34 offen sc1
mega_kernel_f_rs3:

    s_nop 3
    v_mov_b32_dpp v88, v92 row_ror:8 row_mask:0xf bank_mask:0xc
    v_mov_b32_dpp v89, v93 row_ror:8 row_mask:0xf bank_mask:0xc
    v_mov_b32_dpp v90, v94 row_ror:8 row_mask:0xf bank_mask:0xc
    v_mov_b32_dpp v91, v95 row_ror:8 row_mask:0xf bank_mask:0xc
    v_mul_f32 v88, v88, v251
    v_mul_f32 v89, v89, v251
    v_mul_f32 v90, v90, v251
    v_mul_f32 v91, v91, v251
    v_mov_b32_dpp v96, v100 row_ror:8 row_mask:0xf bank_mask:0xc
    v_mov_b32_dpp v97, v101 row_ror:8 row_mask:0xf bank_mask:0xc
    v_mov_b32_dpp v98, v102 row_ror:8 row_mask:0xf bank_mask:0xc
    v_mov_b32_dpp v99, v103 row_ror:8 row_mask:0xf bank_mask:0xc
    ds_write_b128 v16, v[88:91] offset:0
    v_mul_f32 v96, v96, v251
    v_mul_f32 v97, v97, v251
    v_mul_f32 v98, v98, v251
    v_mul_f32 v99, v99, v251
    ds_write_b128 v16, v[96:99] offset:1024
    s_waitcnt lgkmcnt(0)
    s_barrier
    s_cmp_ge_u32 s22, 2
    s_cbranch_scc1 mega_kernel_f_cpoll

    ds_read_b128 v[104:107], v17 offset:0
    ds_read_b128 v[108:111], v17 offset:2048
    ds_read_b128 v[112:115], v17 offset:4096
    ds_read_b128 v[116:119], v17 offset:6144
    s_waitcnt lgkmcnt(0)
    v_add_f32 v104, v104, v108
    v_add_f32 v112, v112, v116
    v_add_f32 v105, v105, v109
    v_add_f32 v113, v113, v117
    v_add_f32 v106, v106, v110
    v_add_f32 v114, v114, v118
    v_add_f32 v107, v107, v111
    v_add_f32 v115, v115, v119
    v_add_f32 v104, v104, v112
    v_add_f32 v105, v105, v113
    v_add_f32 v106, v106, v114
    v_add_f32 v107, v107, v115
    v_cvt_pk_bf16_f32 v108, v104, v105
    v_cvt_pk_bf16_f32 v109, v106, v107
    s_nop 0
    v_min_u32 v108, -2, v108
    v_min_u32 v109, -2, v109
    buffer_store_dwordx2 v[108:109], v11, s[8:11], s62 offen sc1
    buffer_store_dwordx2 v[20:21], v11, s[8:11], s36 offen sc1
    s_add_u32 s32, s23, 2
    s_and_b32 s33, s32, 3
    s_cmp_eq_u32 s33, 0
    s_cbranch_scc1 mega_kernel_f_nopf1
    s_cmp_ge_u32 s32, 64
    s_cbranch_scc1 mega_kernel_f_nopf1
    s_lshl_b32 s32, s32, 18
    buffer_load_dword v6, v246, s[8:11], s32 offen sc1
mega_kernel_f_nopf1:

    s_sub_u32 s32, s23, 1
    s_and_b32 s33, s32, 15
    s_cmp_lg_u32 s33, s21
    s_cbranch_scc1 mega_kernel_f_nopub1
    s_cmp_eq_u32 s23, 0
    s_cbranch_scc1 mega_kernel_f_nopub1
    s_lshl_b32 s32, s32, 6
    s_add_u32 s32, s32, s96
    v_mov_b32 v5, 1
    s_mov_b64 exec, 1
    buffer_atomic_add v5, v248, s[8:11], s32 offen
    s_mov_b64 exec, -1
mega_kernel_f_nopub1:

    s_and_b32 s32, s23, 15
    s_cmp_lg_u32 s32, s21
    s_cbranch_scc1 mega_kernel_f_nokvm1
    s_lshl_b32 s32, s23, 17
    s_add_u32 s32, s32, s37
    s_add_u32 s33, s32, 2048
    v_lshlrev_b32 v5, 3, v1
    buffer_store_dwordx4 v[144:147], v13, s[8:11], s32 offen offset:0 sc1
    buffer_store_dwordx4 v[148:151], v13, s[8:11], s32 offen offset:1024 sc1
    buffer_store_dwordx2 v[152:153], v5, s[8:11], s33 offen offset:0 sc1
    buffer_store_dwordx2 v[154:155], v5, s[8:11], s33 offen offset:512 sc1
    buffer_store_dwordx2 v[156:157], v5, s[8:11], s33 offen offset:1024 sc1
    buffer_store_dwordx2 v[158:159], v5, s[8:11], s33 offen offset:1536 sc1
mega_kernel_f_nokvm1:

    s_add_u32 s23, s23, 1
    s_branch mega_kernel_f_b3
mega_kernel_f_cpoll:
    buffer_store_dwordx2 v[20:21], v12, s[8:11], s35 offen sc1
    s_add_u32 s32, s23, 2
    s_and_b32 s33, s32, 3
    s_cmp_eq_u32 s33, 0
    s_cbranch_scc1 mega_kernel_f_nopf3
    s_cmp_ge_u32 s32, 64
    s_cbranch_scc1 mega_kernel_f_nopf3
    s_lshl_b32 s32, s32, 18
    buffer_load_dword v6, v246, s[8:11], s32 offen sc1
mega_kernel_f_nopf3:

    s_sub_u32 s32, s23, 1
    s_and_b32 s33, s32, 15
    s_cmp_lg_u32 s33, s21
    s_cbranch_scc1 mega_kernel_f_nopub3
    s_cmp_eq_u32 s23, 0
    s_cbranch_scc1 mega_kernel_f_nopub3
    s_lshl_b32 s32, s32, 6
    s_add_u32 s32, s32, s96
    v_mov_b32 v5, 1
    s_mov_b64 exec, 1
    buffer_atomic_add v5, v248, s[8:11], s32 offen
    s_mov_b64 exec, -1
mega_kernel_f_nopub3:

    s_and_b32 s32, s23, 15
    s_cmp_lg_u32 s32, s21
    s_cbranch_scc1 mega_kernel_f_nokvm3
    s_lshl_b32 s32, s23, 17
    s_add_u32 s32, s32, s37
    s_add_u32 s33, s32, 2048
    v_lshlrev_b32 v5, 3, v1
    buffer_store_dwordx4 v[144:147], v13, s[8:11], s32 offen offset:0 sc1
    buffer_store_dwordx4 v[148:151], v13, s[8:11], s32 offen offset:1024 sc1
    buffer_store_dwordx2 v[152:153], v5, s[8:11], s33 offen offset:0 sc1
    buffer_store_dwordx2 v[154:155], v5, s[8:11], s33 offen offset:512 sc1
    buffer_store_dwordx2 v[156:157], v5, s[8:11], s33 offen offset:1024 sc1
    buffer_store_dwordx2 v[158:159], v5, s[8:11], s33 offen offset:1536 sc1
mega_kernel_f_nokvm3:

    s_add_u32 s23, s23, 1
    s_sleep 10
    buffer_load_dwordx2 v[120:121], v11, s[8:11], s27 offen offset:0 sc1
    buffer_load_dwordx2 v[122:123], v11, s[8:11], s27 offen offset:2048 sc1
    buffer_load_dwordx2 v[124:125], v11, s[8:11], s59 offen offset:0 sc1
    buffer_load_dwordx2 v[126:127], v11, s[8:11], s59 offen offset:2048 sc1
    buffer_load_dwordx2 v[128:129], v11, s[8:11], s60 offen offset:0 sc1
    buffer_load_dwordx2 v[130:131], v11, s[8:11], s60 offen offset:2048 sc1
    buffer_load_dwordx2 v[132:133], v11, s[8:11], s61 offen offset:0 sc1
    buffer_load_dwordx2 v[134:135], v11, s[8:11], s61 offen offset:2048 sc1
    s_waitcnt vmcnt(0)
    v_max3_u32 v4, v120, v122, v124
    v_max3_u32 v4, v4, v126, v128
    v_max3_u32 v4, v4, v130, v132
    v_max_u32 v4, v4, v134
    v_cmp_eq_u32 vcc, -1, v4
    s_cbranch_vccnz mega_kernel_f_pC_s0
mega_kernel_f_pC_k0:
    v_lshlrev_b32 v104, 16, v120
    v_and_b32 v105, 0xffff0000, v120
    v_lshlrev_b32 v106, 16, v121
    v_and_b32 v107, 0xffff0000, v121
    v_lshlrev_b32 v108, 16, v122
    v_and_b32 v109, 0xffff0000, v122
    v_lshlrev_b32 v110, 16, v123
    v_and_b32 v111, 0xffff0000, v123
    v_lshlrev_b32 v112, 16, v124
    v_and_b32 v113, 0xffff0000, v124
    v_lshlrev_b32 v114, 16, v125
    v_and_b32 v115, 0xffff0000, v125
    v_pk_add_f32 v[104:105], v[104:105], v[112:113]
    v_pk_add_f32 v[106:107], v[106:107], v[114:115]
    v_lshlrev_b32 v116, 16, v126
    v_and_b32 v117, 0xffff0000, v126
    v_lshlrev_b32 v118, 16, v127
    v_and_b32 v119, 0xffff0000, v127
    v_pk_add_f32 v[108:109], v[108:109], v[116:117]
    v_pk_add_f32 v[110:111], v[110:111], v[118:119]
    v_lshlrev_b32 v112, 16, v128
    v_and_b32 v113, 0xffff0000, v128
    v_lshlrev_b32 v114, 16, v129
    v_and_b32 v115, 0xffff0000, v129
    v_pk_add_f32 v[104:105], v[104:105], v[112:113]
    v_pk_add_f32 v[106:107], v[106:107], v[114:115]
    v_lshlrev_b32 v116, 16, v130
    v_and_b32 v117, 0xffff0000, v130
    v_lshlrev_b32 v118, 16, v131
    v_and_b32 v119, 0xffff0000, v131
    v_pk_add_f32 v[108:109], v[108:109], v[116:117]
    v_pk_add_f32 v[110:111], v[110:111], v[118:119]
    v_lshlrev_b32 v112, 16, v132
    v_and_b32 v113, 0xffff0000, v132
    v_lshlrev_b32 v114, 16, v133
    v_and_b32 v115, 0xffff0000, v133
    v_pk_add_f32 v[104:105], v[104:105], v[112:113]
    v_pk_add_f32 v[106:107], v[106:107], v[114:115]
    v_lshlrev_b32 v116, 16, v134
    v_and_b32 v117, 0xffff0000, v134
    v_lshlrev_b32 v118, 16, v135
    v_and_b32 v119, 0xffff0000, v135
    v_pk_add_f32 v[108:109], v[108:109], v[116:117]
    v_pk_add_f32 v[110:111], v[110:111], v[118:119]
    v_pk_add_f32 v[104:105], v[104:105], v[108:109]
    v_pk_add_f32 v[106:107], v[106:107], v[110:111]
    v_cvt_pk_bf16_f32 v108, v104, v105
    v_cvt_pk_bf16_f32 v109, v106, v107
    s_nop 0
    v_min_u32 v108, -2, v108
    v_min_u32 v109, -2, v109
    buffer_store_dwordx2 v[108:109], v12, s[8:11], s63 offen sc1

mega_kernel_f_b3:
    s_barrier
    s_branch mega_kernel_f_loop

mega_kernel_f_pD_s0:
    buffer_load_dwordx4 v[24:27], v7, s[8:11], s25 offen offset:0 sc1
    buffer_load_dwordx4 v[28:31], v7, s[8:11], s25 offen offset:1024 sc1
    buffer_load_dwordx4 v[32:35], v7, s[8:11], s25 offen offset:2048 sc1
    buffer_load_dwordx4 v[36:39], v7, s[8:11], s25 offen offset:3072 sc1
    s_sub_u32 s24, s24, 1
    s_movk_i32 s58, 16
    s_cbranch_scc1 mega_kernel_f_fail
    s_waitcnt vmcnt(0)
    v_max_u32 v4, v24, v26
    v_cmp_eq_u32 vcc, -1, v4
    s_cbranch_vccnz mega_kernel_f_pD_s0
    s_branch mega_kernel_f_pD_k0
mega_kernel_f_pD_s1:
    buffer_load_dwordx4 v[28:31], v7, s[8:11], s25 offen offset:1024 sc1
    buffer_load_dwordx4 v[32:35], v7, s[8:11], s25 offen offset:2048 sc1
    buffer_load_dwordx4 v[36:39], v7, s[8:11], s25 offen offset:3072 sc1
    s_sub_u32 s24, s24, 1
    s_movk_i32 s58, 17
    s_cbranch_scc1 mega_kernel_f_fail
    s_waitcnt vmcnt(0)
    v_max_u32 v4, v28, v30
    v_cmp_eq_u32 vcc, -1, v4
    s_cbranch_vccnz mega_kernel_f_pD_s1
    s_branch mega_kernel_f_pD_k1
mega_kernel_f_pD_s2:
    buffer_load_dwordx4 v[32:35], v7, s[8:11], s25 offen offset:2048 sc1
    buffer_load_dwordx4 v[36:39], v7, s[8:11], s25 offen offset:3072 sc1
    s_sub_u32 s24, s24, 1
    s_movk_i32 s58, 18
    s_cbranch_scc1 mega_kernel_f_fail
    s_waitcnt vmcnt(0)
    v_max_u32 v4, v32, v34
    v_cmp_eq_u32 vcc, -1, v4
    s_cbranch_vccnz mega_kernel_f_pD_s2
    s_branch mega_kernel_f_pD_k2
mega_kernel_f_pD_s3:
    buffer_load_dwordx4 v[36:39], v7, s[8:11], s25 offen offset:3072 sc1
    s_sub_u32 s24, s24, 1
    s_movk_i32 s58, 19
    s_cbranch_scc1 mega_kernel_f_fail
    s_waitcnt vmcnt(0)
    v_max_u32 v4, v36, v38
    v_cmp_eq_u32 vcc, -1, v4
    s_cbranch_vccnz mega_kernel_f_pD_s3
    s_branch mega_kernel_f_pD_k3
mega_kernel_f_pA_s0:
    buffer_load_dwordx4 v[136:139], v8, s[8:11], s26 offen offset:0 sc1
    buffer_load_dwordx4 v[140:143], v8, s[8:11], s26 offen offset:1024 sc1
    buffer_load_dwordx4 v[144:147], v8, s[8:11], s26 offen offset:2048 sc1
    buffer_load_dwordx4 v[148:151], v8, s[8:11], s26 offen offset:3072 sc1
    s_sub_u32 s24, s24, 1
    s_movk_i32 s58, 32
    s_cbranch_scc1 mega_kernel_f_fail
    s_waitcnt vmcnt(0)
    v_max3_u32 v4, v136, v138, v140
    v_max3_u32 v4, v4, v142, v144
    v_max3_u32 v4, v4, v146, v148
    v_max_u32 v4, v4, v150
    v_cmp_eq_u32 vcc, -1, v4
    s_cbranch_vccnz mega_kernel_f_pA_s0
    s_branch mega_kernel_f_pA_k0
mega_kernel_f_pV_s0:
    buffer_load_dwordx2 v[152:153], v9, s[8:11], s26 offen offset:0 sc1
    buffer_load_dwordx2 v[154:155], v9, s[8:11], s26 offen offset:512 sc1
    buffer_load_dwordx2 v[156:157], v9, s[8:11], s26 offen offset:1024 sc1
    buffer_load_dwordx2 v[158:159], v9, s[8:11], s26 offen offset:1536 sc1
    s_sub_u32 s24, s24, 1
    s_movk_i32 s58, 48
    s_cbranch_scc1 mega_kernel_f_fail
    s_waitcnt vmcnt(0)
    v_max3_u32 v4, v152, v154, v156
    v_max_u32 v4, v4, v158
    v_cmp_eq_u32 vcc, -1, v4
    s_cbranch_vccnz mega_kernel_f_pV_s0
    s_branch mega_kernel_f_pV_k0
mega_kernel_f_pC_s0:
    buffer_load_dwordx2 v[120:121], v11, s[8:11], s27 offen offset:0 sc1
    buffer_load_dwordx2 v[122:123], v11, s[8:11], s27 offen offset:2048 sc1
    buffer_load_dwordx2 v[124:125], v11, s[8:11], s59 offen offset:0 sc1
    buffer_load_dwordx2 v[126:127], v11, s[8:11], s59 offen offset:2048 sc1
    buffer_load_dwordx2 v[128:129], v11, s[8:11], s60 offen offset:0 sc1
    buffer_load_dwordx2 v[130:131], v11, s[8:11], s60 offen offset:2048 sc1
    buffer_load_dwordx2 v[132:133], v11, s[8:11], s61 offen offset:0 sc1
    buffer_load_dwordx2 v[134:135], v11, s[8:11], s61 offen offset:2048 sc1
    s_sub_u32 s24, s24, 1
    s_movk_i32 s58, 64
    s_cbranch_scc1 mega_kernel_f_fail
    s_waitcnt vmcnt(0)
    v_max3_u32 v4, v120, v122, v124
    v_max3_u32 v4, v4, v126, v128
    v_max3_u32 v4, v4, v130, v132
    v_max_u32 v4, v4, v134
    v_cmp_eq_u32 vcc, -1, v4
    s_cbranch_vccnz mega_kernel_f_pC_s0
    s_branch mega_kernel_f_pC_k0
mega_kernel_f_last:
mega_kernel_f_lastspin:
    buffer_load_dwordx2 v[152:153], v9, s[8:11], s26 offen offset:0 sc1
    buffer_load_dwordx2 v[154:155], v9, s[8:11], s26 offen offset:512 sc1
    buffer_load_dwordx2 v[156:157], v9, s[8:11], s26 offen offset:1024 sc1
    buffer_load_dwordx2 v[158:159], v9, s[8:11], s26 offen offset:1536 sc1
    s_waitcnt vmcnt(0)
    v_max3_u32 v4, v152, v154, v156
    v_max_u32 v4, v4, v158
    v_cmp_eq_u32 vcc, -1, v4
    s_cbranch_vccz mega_kernel_f_lastok
    s_sub_u32 s24, s24, 1
    s_cbranch_scc1 mega_kernel_f_exit
    s_branch mega_kernel_f_lastspin
mega_kernel_f_lastok:
    s_sub_u32 s32, s23, 1
    s_and_b32 s33, s32, 15
    s_cmp_lg_u32 s33, s21
    s_cbranch_scc1 mega_kernel_f_nopubL
    s_cmp_eq_u32 s23, 0
    s_cbranch_scc1 mega_kernel_f_nopubL
    s_lshl_b32 s32, s32, 6
    s_add_u32 s32, s32, s96
    v_mov_b32 v5, 1
    s_mov_b64 exec, 1
    buffer_atomic_add v5, v248, s[8:11], s32 offen
    s_mov_b64 exec, -1
mega_kernel_f_nopubL:

    s_and_b32 s32, s23, 15
    s_cmp_lg_u32 s32, s21
    s_cbranch_scc1 mega_kernel_f_nokvm2
    s_lshl_b32 s32, s23, 17
    s_add_u32 s32, s32, s37
    s_add_u32 s33, s32, 2048
    v_lshlrev_b32 v5, 3, v1
    buffer_store_dwordx4 v[144:147], v13, s[8:11], s32 offen offset:0 sc1
    buffer_store_dwordx4 v[148:151], v13, s[8:11], s32 offen offset:1024 sc1
    buffer_store_dwordx2 v[152:153], v5, s[8:11], s33 offen offset:0 sc1
    buffer_store_dwordx2 v[154:155], v5, s[8:11], s33 offen offset:512 sc1
    buffer_store_dwordx2 v[156:157], v5, s[8:11], s33 offen offset:1024 sc1
    buffer_store_dwordx2 v[158:159], v5, s[8:11], s33 offen offset:1536 sc1
mega_kernel_f_nokvm2:

    s_and_b32 s32, s23, 15
    s_cmp_lg_u32 s32, s21
    s_cbranch_scc1 mega_kernel_f_done
    s_waitcnt vmcnt(0)
    s_lshl_b32 s32, s23, 6
    s_add_u32 s32, s32, s96
    v_mov_b32 v5, 1
    s_mov_b64 exec, 1
    buffer_atomic_add v5, v248, s[8:11], s32 offen
    s_mov_b64 exec, -1

mega_kernel_f_done:
    s_branch mega_kernel_post
mega_kernel_f_exit:
    s_endpgm
mega_kernel_f_fail:
    s_lshl_b32 s32, s20, 4
    s_add_u32 s32, s32, s21
    s_lshl_b32 s32, s32, 2
    s_add_u32 s32, s32, s22
    s_lshl_b32 s32, s32, 2
    s_add_u32 s32, s32, 98009088
    s_lshl_b32 s33, s23, 8
    s_or_b32 s33, s33, s58
    s_or_b32 s33, s33, 0x10000
    v_mov_b32 v4, s33
    v_mov_b32 v5, 0
    buffer_store_dword v4, v5, s[8:11], s32 offen
    s_endpgm

mega_kernel_post:
    s_waitcnt vmcnt(0) lgkmcnt(0)
    s_mov_b64 exec, -1
    s_mov_b32 s38, s20
    s_mov_b32 s61, s21
    s_add_u32 s55, s21, 16
    s_mov_b32 s20, s22
    v_and_b32 v1, 63, v0
    v_and_b32 v2, 15, v1
    v_lshrrev_b32 v3, 4, v1
    v_lshlrev_b32 v4, 4, v1
    s_cmp_ge_u32 s61, 10
    s_cbranch_scc1 mega_kernel_w_tail0
    s_cmp_ge_u32 s61, 8
    s_cselect_b32 s39, -3, -2
    s_branch mega_kernel_w_init

mega_kernel_exit:
    s_endpgm
.section .rodata,"a"
.p2align 6
.amdhsa_kernel pre_kernel
  .amdhsa_next_free_vgpr 256
  .amdhsa_next_free_sgpr 48
  .amdhsa_accum_offset 256
  .amdhsa_group_segment_fixed_size 0
  .amdhsa_kernarg_size 136
  .amdhsa_user_sgpr_count 2
  .amdhsa_user_sgpr_kernarg_segment_ptr 1
  .amdhsa_system_sgpr_workgroup_id_x 1
.end_amdhsa_kernel
.p2align 6
.amdhsa_kernel mega_kernel
  .amdhsa_next_free_vgpr 512
  .amdhsa_next_free_sgpr 100
  .amdhsa_accum_offset 256
  .amdhsa_group_segment_fixed_size 0
  .amdhsa_kernarg_size 136
  .amdhsa_user_sgpr_count 2
  .amdhsa_user_sgpr_kernarg_segment_ptr 1
  .amdhsa_system_sgpr_workgroup_id_x 1
.end_amdhsa_kernel
```
